```python
import torch

def _softmax(x, axis=-1):
    return torch.softmax(x, dim=axis)

def _gelu(x):
    return torch.nn.functional.gelu(x, approximate='tanh')

def _silu(x):
    return torch.nn.functional.silu(x)

def _sigmoid(x):
    return torch.sigmoid(x)

def _layernorm(x, axis=-1, eps=1e-05):
    m = x.mean(dim=axis, keepdim=True)
    v = x.var(dim=axis, keepdim=True, unbiased=False)
    return (x - m) / torch.sqrt(v + eps)

def _scatter_add(tgt, idx, src, axis=0):
    return tgt.clone().index_add_(axis, idx, src)

def _segment_sum(src, seg, n):
    out = torch.zeros((n,) + src.shape[1:], dtype=src.dtype)
    return out.index_add_(0, seg, src)

def _pad(x, pw):
    flat = tuple((v for pair in reversed(pw) for v in pair))
    return torch.nn.functional.pad(x, flat)
kernel_name = 'standalone__conformer_family_branchformer__speech'

def setup_inputs():

    _w = lambda a: (lambda t: t.to(torch.bfloat16) if t.is_floating_point() else t)(torch.as_tensor(a))
    B, T, D, K = (2, 4000, 512, 5)
    s = float(D) ** (-0.5)
    return {'x': _w((lambda *s: torch.randn(*s, dtype=torch.bfloat16) * 0.05)(B, T, D)), 'w_q': _w((lambda *s: torch.randn(*s, dtype=torch.bfloat16) * 1.6)(D, D) * s), 'w_k': _w((lambda *s: torch.randn(*s, dtype=torch.bfloat16) * 1.6)(D, D) * s), 'w_v': _w((lambda *s: torch.randn(*s, dtype=torch.bfloat16) * 0.4)(D, D) * s), 'w_ao': _w((lambda *s: torch.randn(*s, dtype=torch.bfloat16) * 0.4)(D, D) * s), 'w_up': _w((lambda *s: torch.randn(*s, dtype=torch.bfloat16) * 0.8)(D, 2 * D) * s), 'dw': _w((lambda *s: torch.randn(*s, dtype=torch.bfloat16) * 0.8)(K, D) * (1.0 / K)), 'w_dn': _w((lambda *s: torch.randn(*s, dtype=torch.bfloat16) * 0.4)(D, D) * s), 'w_merge': _w((lambda *s: torch.randn(*s, dtype=torch.bfloat16) * 0.4)(2 * D, D) * s)}

def reference(x, w_q, w_k, w_v, w_ao, w_up, dw, w_dn, w_merge):
    B, T, D = x.shape
    K = dw.shape[0]
    xa = _layernorm(x, axis=-1)
    q = torch.einsum('btd,de->bte', xa, w_q)
    k = torch.einsum('btd,de->bte', xa, w_k)
    v = torch.einsum('btd,de->bte', xa, w_v)
    logits = torch.einsum('btd,bsd->bts', q, k) * float(D) ** (-0.5)
    attn = _softmax(logits, axis=-1)
    ya = torch.einsum('bts,bsd->btd', attn, v)
    ya = torch.einsum('btd,de->bte', ya, w_ao)
    xc = _layernorm(x, axis=-1)
    h = _gelu(torch.einsum('btd,de->bte', xc, w_up))
    u = h[..., :D].clone()
    g = _layernorm(h[..., D:], axis=-1)
    pad = K // 2
    gp = _pad(g, ((0, 0), (pad, pad), (0, 0)))
    conv = torch.zeros_like(g)
    for i in range(K):
        conv = conv + gp[:, i:i + T, :] * dw[i][None, None, :]
    yc = torch.einsum('btd,de->bte', u * conv, w_dn)
    merged = torch.concatenate([ya, yc], axis=-1)
    out = torch.einsum('btf,fd->btd', merged, w_merge)
    return x + out
```

```asm
; @launch grid=(256,1,1) block=(256,1,1) lds=163840
.amdgcn_target "amdgcn-amd-amdhsa--gfx950"
.text
.globl standalone__conformer_family_branchformer__speech_kernel
.p2align 8
.type standalone__conformer_family_branchformer__speech_kernel,@function
standalone__conformer_family_branchformer__speech_kernel:
    s_cmp_ge_u32 s2, 256
    s_cbranch_scc1 L_end
    s_load_dwordx2 s[4:5], s[0:1], 88
    s_load_dwordx2 s[6:7], s[0:1], 0
    s_load_dwordx2 s[40:41], s[0:1], 8
    s_load_dwordx2 s[8:9], s[0:1], 16
    s_load_dwordx2 s[96:97], s[0:1], 40
    s_load_dwordx2 s[44:45], s[0:1], 48
    s_load_dwordx4 s[48:51], s[0:1], 72
    s_load_dwordx4 s[52:55], s[0:1], 24
    s_load_dwordx4 s[56:59], s[0:1], 56
    s_and_b32 s20, s2, 7
    s_lshl_b32 s20, s20, 5
    s_lshr_b32 s21, s2, 3
    s_add_u32 s31, s20, s21
    s_and_b32 s20, s31, 62
    s_cmp_eq_u32 s20, 60
    s_cselect_b32 s20, 64, 0
    s_xor_b32 s31, s31, s20
    s_lshr_b32 s21, s31, 7
    s_and_b32 s22, s31, 1
    s_bfe_u32 s23, s31, 0x60001
    v_lshrrev_b32 v1, 6, v0
    v_and_b32 v2, 63, v0
    v_readfirstlane_b32 s16, v1
    v_lshlrev_b32 v3, 4, v2
    s_mul_i32 s24, s21, 4096000
    s_mul_i32 s25, s22, 1
    s_add_i32 s25, s25, 62
    s_lshl_b32 s27, s23, 16
    s_waitcnt lgkmcnt(0)
    s_add_u32 s32, s6, s24
    s_addc_u32 s33, s7, 0
    s_and_b32 s33, s33, 0xffff
    s_mov_b32 s34, 4096000
    s_mov_b32 s35, 0x00020000
    v_lshrrev_b32 v4, 3, v2
    v_and_b32 v5, 7, v2
    v_lshlrev_b32 v5, 4, v5
    v_lshl_add_u32 v4, v4, 10, v5
    s_lshl_b32 s26, s16, 14
    s_add_u32 s26, s26, s27
    s_lshl_b32 s28, s22, 9
    s_add_u32 s26, s26, s28
    v_mov_b32 v1, v4
    s_mov_b32 s20, s26
    s_xor_b32 s7, s20, 0
    buffer_load_dwordx4 v[16:19], v1, s[32:35], s7 offen offset:0
    buffer_load_dwordx4 v[20:23], v1, s[32:35], s7 offen offset:128
    buffer_load_dwordx4 v[24:27], v1, s[32:35], s7 offen offset:256
    buffer_load_dwordx4 v[28:31], v1, s[32:35], s7 offen offset:384
    s_xor_b32 s7, s20, 512
    buffer_load_dwordx4 v[32:35], v1, s[32:35], s7 offen offset:0
    buffer_load_dwordx4 v[36:39], v1, s[32:35], s7 offen offset:128
    buffer_load_dwordx4 v[40:43], v1, s[32:35], s7 offen offset:256
    buffer_load_dwordx4 v[44:47], v1, s[32:35], s7 offen offset:384
    s_xor_b32 s7, s20, 8192
    buffer_load_dwordx4 v[48:51], v1, s[32:35], s7 offen offset:0
    buffer_load_dwordx4 v[52:55], v1, s[32:35], s7 offen offset:128
    buffer_load_dwordx4 v[56:59], v1, s[32:35], s7 offen offset:256
    buffer_load_dwordx4 v[60:63], v1, s[32:35], s7 offen offset:384
    s_xor_b32 s7, s20, 8704
    buffer_load_dwordx4 v[64:67], v1, s[32:35], s7 offen offset:0
    buffer_load_dwordx4 v[68:71], v1, s[32:35], s7 offen offset:128
    buffer_load_dwordx4 v[72:75], v1, s[32:35], s7 offen offset:256
    buffer_load_dwordx4 v[76:79], v1, s[32:35], s7 offen offset:384
    s_and_b32 s97, s97, 0xffff
    s_mov_b32 s98, 1048576
    s_mov_b32 s99, 0x00020000
    v_lshlrev_b32 v7, 7, v2
    s_lshr_b32 s26, s2, 3
    s_lshl_b32 s26, s26, 2
    s_add_u32 s26, s26, s16
    s_getpc_b64 s[28:29]
L_pc1:
    s_mul_i32 s30, s26, 640
    v_and_b32 v12, 7, v2
    v_min_u32 v12, 4, v12
    v_lshl_add_u32 v12, v12, 7, s30
    v_min_u32 v12, L_end - L_pc1, v12
    global_load_dword v0, v12, s[28:29]
    s_and_b32 s41, s41, 0xffff
    s_mov_b32 s42, 524288
    s_mov_b32 s43, 0x00020000
    s_and_b32 s9, s9, 0xffff
    s_mov_b32 s10, 524288
    s_mov_b32 s11, 0x00020000
    s_and_b32 s45, s45, 0xffff
    s_mov_b32 s46, 5120
    s_mov_b32 s47, 0x00020000
    s_mov_b32 s12, s4
    s_and_b32 s13, s5, 0xffff
    s_mov_b32 s14, 67108864
    s_mov_b32 s15, 0x00020000
    s_mov_b32 s92, s50
    s_and_b32 s93, s51, 0xffff
    s_mov_b32 s94, 256
    s_mov_b32 s95, 0x00020000
    s_add_u32 s36, s48, s24
    s_addc_u32 s37, s49, 0
    s_and_b32 s37, s37, 0xffff
    s_mov_b32 s38, 4096000
    s_mov_b32 s39, 0x00020000
    s_and_b32 s17, s2, 6
    s_lshl_b32 s17, s17, 5
    s_and_b32 s18, s2, 24
    s_lshl_b32 s18, s18, 1
    s_add_u32 s17, s17, s18
    s_and_b32 s18, s2, 1
    s_lshl_b32 s18, s18, 3
    s_add_u32 s17, s17, s18
    s_lshr_b32 s18, s2, 5
    s_add_u32 s100, s17, s18
    s_lshr_b32 s17, s100, 4
    s_lshl_b32 s17, s17, 15
    s_and_b32 s18, s100, 15
    s_lshl_b32 s18, s18, 15
    s_lshl_b32 s19, s16, 13
    s_add_u32 s17, s17, s19
    s_add_u32 s18, s18, s19
    s_mul_i32 s19, s16, 4224
    s_cmp_ge_u32 s23, 63
    s_cbranch_scc1 L_aux
    v_lshrrev_b32 v12, 3, v2
    v_and_b32 v13, 7, v2
    v_and_b32 v14, 2, v12
    v_xor_b32 v14, v13, v14
    v_lshlrev_b32 v14, 4, v14
    v_lshl_add_u32 v80, v12, 11, v14
    v_xor_b32 v81, 64, v80
    v_add_u32 v81, 15360, v81
    v_add_u32 v82, 30720, v80
    v_add_u32 v83, 30720, v81
    s_lshl_b32 s26, s22, 2
    s_add_u32 s26, s26, s16
    s_lshl_b32 s28, s22, 1
    s_add_u32 s28, s28, s16
    s_lshl_b32 s29, s23, 0
    s_add_u32 s28, s28, s29
    s_and_b32 s28, s28, 3
    s_lshl_b32 s3, s26, 7
    s_lshl_b32 s29, s28, 18
    s_add_u32 s3, s3, s29
    s_and_b32 s29, s23, 0
    s_lshl_b32 s29, s29, 14
    s_add_u32 s3, s3, s29
    s_mul_i32 s6, s16, 20480
    v_and_b32 v4, 15, v2
    v_lshrrev_b32 v5, 4, v2
    s_and_b32 s26, s16, 1
    s_lshl_b32 s26, s26, 13
    s_cmp_lt_u32 s16, 2
    s_cselect_b32 s28, 2304, 0
    s_add_u32 s26, s26, s28
    s_add_u32 s26, s26, 81920
    v_mul_u32_u24 v85, 144, v12
    v_lshl_add_u32 v85, v13, 4, v85
    v_add_u32 v85, s26, v85
    v_lshlrev_b32 v86, 9, v12
    v_lshl_add_u32 v86, v13, 4, v86
    v_mul_u32_u24 v84, 144, v4
    v_lshl_add_u32 v84, v5, 3, v84
    v_add_u32 v84, s26, v84
    s_lshl_b32 s26, s16, 14
    s_add_u32 s26, s26, 98304
    s_lshl_b32 s28, s22, 13
    s_add_u32 s28, s28, s26
    v_lshrrev_b32 v14, 1, v12
    v_xor_b32 v14, v13, v14
    v_lshlrev_b32 v14, 4, v14
    v_lshl_add_u32 v14, v12, 7, v14
    v_add_u32 v12, s28, v14
    v_xor_b32 v116, 0x440, v12
    v_xor_b32 v117, 0x2440, v12
    v_xor_b32 v15, 0x2000, v12
    s_mov_b32 s101, 0xffff0000
    v_lshrrev_b32 v13, 1, v4
    v_xor_b32 v13, v5, v13
    v_lshlrev_b32 v13, 4, v13
    v_lshl_add_u32 v88, v4, 7, v13
    v_and_b32 v13, 0x27, v2
    v_and_b32 v14, 8, v2
    v_lshl_add_u32 v13, v14, 1, v13
    v_and_b32 v14, 16, v2
    v_lshrrev_b32 v14, 1, v14
    v_add_lshl_u32 v90, v13, v14, 4
    s_lshr_b32 s26, s3, 17
    s_lshl_b32 s26, s26, 11
    s_add_u32 s26, s26, 98304
    s_bfe_u32 s28, s3, 0x10010
    s_lshl_b32 s28, s28, 6
    s_add_u32 s26, s26, s28
    v_xor_b32 v88, s26, v88
    v_lshrrev_b32 v14, 2, v4
    v_lshl_add_u32 v14, v5, 3, v14
    v_lshlrev_b32 v14, 7, v14
    v_and_b32 v13, 3, v2
    v_lshl_add_u32 v14, v13, 3, v14
    v_and_b32 v13, 24, v2
    v_lshl_add_u32 v14, v13, 2, v14
    v_add_u32 v92, s6, v14
    v_xor_b32 v93, 32, v92
    v_xor_b32 v94, 64, v92
    v_xor_b32 v95, 96, v92
    v_mov_b32 v13, 88832
    v_mov_b32 v14, 0
    ds_write_b32 v13, v14
    v_and_b32 v4, 15, v2
    v_lshrrev_b32 v5, 4, v2
    v_mul_u32_u24 v6, 1056, v4
    v_lshl_add_u32 v6, v5, 4, v6
    v_add_u32 v6, 96256, v6
    s_and_b32 s26, s16, 1
    s_lshr_b32 s28, s16, 1
    s_mul_i32 s29, s26, 16896
    v_add_u32 v7, s29, v6
    s_mul_i32 s29, s28, 16896
    v_add_u32 v6, s29, v6
    s_bfe_u32 s29, s100, 0x30001
    s_lshl_b32 s29, s29, 16
    s_lshr_b32 s30, s100, 4
    s_lshl_b32 s30, s30, 12
    s_add_u32 s29, s29, s30
    s_and_b32 s30, s100, 1
    s_lshl_b32 s30, s30, 1
    s_add_u32 s30, s30, s28
    s_lshl_b32 s30, s30, 10
    s_add_u32 s29, s29, s30
    s_lshl_b32 s30, s26, 9
    s_add_u32 s29, s29, s30
    s_add_u32 s30, s29, 59768832
    s_lshl_b32 s29, s28, 10
    s_lshl_b32 s26, s26, 3
    s_add_u32 s29, s29, s26
    s_add_u32 s29, s29, 86528
    v_add_u32 v112, s29, v3
    s_lshl_b32 s29, s16, 9
    s_add_u32 s29, s29, 86528
    v_and_b32 v114, 0x1ff, v3
    v_add_u32 v113, s29, v114
    s_waitcnt vmcnt(16)
    s_add_u32 m0, s19, 96256
    s_nop 0
    buffer_load_dwordx4 v3, s[40:43], s17 offen offset:0 lds
    s_add_u32 m0, s19, 96288
    s_nop 0
    buffer_load_dwordx4 v3, s[40:43], s17 offen offset:1024 lds
    s_add_u32 m0, s19, 96320
    s_nop 0
    buffer_load_dwordx4 v3, s[40:43], s17 offen offset:2048 lds
    s_add_u32 m0, s19, 96352
    s_nop 0
    buffer_load_dwordx4 v3, s[40:43], s17 offen offset:3072 lds
    s_add_u32 m0, s19, 113152
    s_add_u32 s17, s17, 4096
    buffer_load_dwordx4 v3, s[40:43], s17 offen offset:0 lds
    s_add_u32 m0, s19, 113184
    s_nop 0
    buffer_load_dwordx4 v3, s[40:43], s17 offen offset:1024 lds
    s_add_u32 m0, s19, 113216
    s_nop 0
    buffer_load_dwordx4 v3, s[40:43], s17 offen offset:2048 lds
    s_add_u32 m0, s19, 113248
    s_nop 0
    buffer_load_dwordx4 v3, s[40:43], s17 offen offset:3072 lds
    v_lshlrev_b32 v128, 16, v16
    v_and_b32 v129, s101, v16
    v_lshlrev_b32 v130, 16, v17
    v_and_b32 v131, s101, v17
    v_lshlrev_b32 v132, 16, v18
    v_and_b32 v133, s101, v18
    v_lshlrev_b32 v134, 16, v19
    v_and_b32 v135, s101, v19
    v_pk_add_f32 v[96:97], v[128:129], 0
    v_pk_mul_f32 v[98:99], v[128:129], v[128:129]
    v_pk_add_f32 v[96:97], v[96:97], v[130:131]
    v_pk_fma_f32 v[98:99], v[130:131], v[130:131], v[98:99]
    v_pk_add_f32 v[96:97], v[96:97], v[132:133]
    v_pk_fma_f32 v[98:99], v[132:133], v[132:133], v[98:99]
    v_pk_add_f32 v[96:97], v[96:97], v[134:135]
    v_pk_fma_f32 v[98:99], v[134:135], v[134:135], v[98:99]
    s_waitcnt vmcnt(23)
    s_add_u32 m0, s19, 130048
    s_nop 0
    buffer_load_dwordx4 v3, s[8:11], s18 offen offset:0 lds
    v_lshlrev_b32 v136, 16, v20
    v_and_b32 v137, s101, v20
    v_lshlrev_b32 v138, 16, v21
    v_and_b32 v139, s101, v21
    v_lshlrev_b32 v140, 16, v22
    v_and_b32 v141, s101, v22
    v_lshlrev_b32 v142, 16, v23
    v_and_b32 v143, s101, v23
    v_pk_add_f32 v[96:97], v[96:97], v[136:137]
    v_pk_fma_f32 v[98:99], v[136:137], v[136:137], v[98:99]
    v_pk_add_f32 v[96:97], v[96:97], v[138:139]
    v_pk_fma_f32 v[98:99], v[138:139], v[138:139], v[98:99]
    v_pk_add_f32 v[96:97], v[96:97], v[140:141]
    v_pk_fma_f32 v[98:99], v[140:141], v[140:141], v[98:99]
    v_pk_add_f32 v[96:97], v[96:97], v[142:143]
    v_pk_fma_f32 v[98:99], v[142:143], v[142:143], v[98:99]
    s_waitcnt vmcnt(23)
    s_add_u32 m0, s19, 130080
    s_nop 0
    buffer_load_dwordx4 v3, s[8:11], s18 offen offset:1024 lds
    v_lshlrev_b32 v144, 16, v24
    v_and_b32 v145, s101, v24
    v_lshlrev_b32 v146, 16, v25
    v_and_b32 v147, s101, v25
    v_lshlrev_b32 v148, 16, v26
    v_and_b32 v149, s101, v26
    v_lshlrev_b32 v150, 16, v27
    v_and_b32 v151, s101, v27
    v_pk_add_f32 v[96:97], v[96:97], v[144:145]
    v_pk_fma_f32 v[98:99], v[144:145], v[144:145], v[98:99]
    v_pk_add_f32 v[96:97], v[96:97], v[146:147]
    v_pk_fma_f32 v[98:99], v[146:147], v[146:147], v[98:99]
    v_pk_add_f32 v[96:97], v[96:97], v[148:149]
    v_pk_fma_f32 v[98:99], v[148:149], v[148:149], v[98:99]
    v_pk_add_f32 v[96:97], v[96:97], v[150:151]
    v_pk_fma_f32 v[98:99], v[150:151], v[150:151], v[98:99]
    s_waitcnt vmcnt(23)
    s_add_u32 m0, s19, 130112
    s_nop 0
    buffer_load_dwordx4 v3, s[8:11], s18 offen offset:2048 lds
    v_lshlrev_b32 v152, 16, v28
    v_and_b32 v153, s101, v28
    v_lshlrev_b32 v154, 16, v29
    v_and_b32 v155, s101, v29
    v_lshlrev_b32 v156, 16, v30
    v_and_b32 v157, s101, v30
    v_lshlrev_b32 v158, 16, v31
    v_and_b32 v159, s101, v31
    v_pk_add_f32 v[96:97], v[96:97], v[152:153]
    v_pk_fma_f32 v[98:99], v[152:153], v[152:153], v[98:99]
    v_pk_add_f32 v[96:97], v[96:97], v[154:155]
    v_pk_fma_f32 v[98:99], v[154:155], v[154:155], v[98:99]
    v_pk_add_f32 v[96:97], v[96:97], v[156:157]
    v_pk_fma_f32 v[98:99], v[156:157], v[156:157], v[98:99]
    v_pk_add_f32 v[96:97], v[96:97], v[158:159]
    v_pk_fma_f32 v[98:99], v[158:159], v[158:159], v[98:99]
    s_waitcnt vmcnt(23)
    s_add_u32 m0, s19, 130144
    s_nop 0
    buffer_load_dwordx4 v3, s[8:11], s18 offen offset:3072 lds
    v_lshlrev_b32 v160, 16, v32
    v_and_b32 v161, s101, v32
    v_lshlrev_b32 v162, 16, v33
    v_and_b32 v163, s101, v33
    v_lshlrev_b32 v164, 16, v34
    v_and_b32 v165, s101, v34
    v_lshlrev_b32 v166, 16, v35
    v_and_b32 v167, s101, v35
    v_pk_add_f32 v[96:97], v[96:97], v[160:161]
    v_pk_fma_f32 v[98:99], v[160:161], v[160:161], v[98:99]
    v_pk_add_f32 v[96:97], v[96:97], v[162:163]
    v_pk_fma_f32 v[98:99], v[162:163], v[162:163], v[98:99]
    v_pk_add_f32 v[96:97], v[96:97], v[164:165]
    v_pk_fma_f32 v[98:99], v[164:165], v[164:165], v[98:99]
    v_pk_add_f32 v[96:97], v[96:97], v[166:167]
    v_pk_fma_f32 v[98:99], v[166:167], v[166:167], v[98:99]
    s_waitcnt vmcnt(23)
    s_add_u32 m0, s19, 146944
    s_add_u32 s18, s18, 4096
    buffer_load_dwordx4 v3, s[8:11], s18 offen offset:0 lds
    v_lshlrev_b32 v168, 16, v36
    v_and_b32 v169, s101, v36
    v_lshlrev_b32 v170, 16, v37
    v_and_b32 v171, s101, v37
    v_lshlrev_b32 v172, 16, v38
    v_and_b32 v173, s101, v38
    v_lshlrev_b32 v174, 16, v39
    v_and_b32 v175, s101, v39
    v_pk_add_f32 v[96:97], v[96:97], v[168:169]
    v_pk_fma_f32 v[98:99], v[168:169], v[168:169], v[98:99]
    v_pk_add_f32 v[96:97], v[96:97], v[170:171]
    v_pk_fma_f32 v[98:99], v[170:171], v[170:171], v[98:99]
    v_pk_add_f32 v[96:97], v[96:97], v[172:173]
    v_pk_fma_f32 v[98:99], v[172:173], v[172:173], v[98:99]
    v_pk_add_f32 v[96:97], v[96:97], v[174:175]
    v_pk_fma_f32 v[98:99], v[174:175], v[174:175], v[98:99]
    s_waitcnt vmcnt(23)
    s_add_u32 m0, s19, 146976
    s_nop 0
    buffer_load_dwordx4 v3, s[8:11], s18 offen offset:1024 lds
    v_lshlrev_b32 v176, 16, v40
    v_and_b32 v177, s101, v40
    v_lshlrev_b32 v178, 16, v41
    v_and_b32 v179, s101, v41
    v_lshlrev_b32 v180, 16, v42
    v_and_b32 v181, s101, v42
    v_lshlrev_b32 v182, 16, v43
    v_and_b32 v183, s101, v43
    v_pk_add_f32 v[96:97], v[96:97], v[176:177]
    v_pk_fma_f32 v[98:99], v[176:177], v[176:177], v[98:99]
    v_pk_add_f32 v[96:97], v[96:97], v[178:179]
    v_pk_fma_f32 v[98:99], v[178:179], v[178:179], v[98:99]
    v_pk_add_f32 v[96:97], v[96:97], v[180:181]
    v_pk_fma_f32 v[98:99], v[180:181], v[180:181], v[98:99]
    v_pk_add_f32 v[96:97], v[96:97], v[182:183]
    v_pk_fma_f32 v[98:99], v[182:183], v[182:183], v[98:99]
    s_waitcnt vmcnt(23)
    s_add_u32 m0, s19, 147008
    s_nop 0
    buffer_load_dwordx4 v3, s[8:11], s18 offen offset:2048 lds
    v_lshlrev_b32 v184, 16, v44
    v_and_b32 v185, s101, v44
    v_lshlrev_b32 v186, 16, v45
    v_and_b32 v187, s101, v45
    v_lshlrev_b32 v188, 16, v46
    v_and_b32 v189, s101, v46
    v_lshlrev_b32 v190, 16, v47
    v_and_b32 v191, s101, v47
    v_pk_add_f32 v[96:97], v[96:97], v[184:185]
    v_pk_fma_f32 v[98:99], v[184:185], v[184:185], v[98:99]
    v_pk_add_f32 v[96:97], v[96:97], v[186:187]
    v_pk_fma_f32 v[98:99], v[186:187], v[186:187], v[98:99]
    v_pk_add_f32 v[96:97], v[96:97], v[188:189]
    v_pk_fma_f32 v[98:99], v[188:189], v[188:189], v[98:99]
    v_pk_add_f32 v[96:97], v[96:97], v[190:191]
    v_pk_fma_f32 v[98:99], v[190:191], v[190:191], v[98:99]
    v_add_f32 v96, v96, v97
    v_add_f32 v98, v98, v99
    s_nop 0
    v_add_f32_dpp v96, v96, v96 quad_perm:[1,0,3,2] row_mask:0xf bank_mask:0xf
    v_add_f32_dpp v98, v98, v98 quad_perm:[1,0,3,2] row_mask:0xf bank_mask:0xf
    s_nop 0
    v_add_f32_dpp v96, v96, v96 quad_perm:[2,3,0,1] row_mask:0xf bank_mask:0xf
    v_add_f32_dpp v98, v98, v98 quad_perm:[2,3,0,1] row_mask:0xf bank_mask:0xf
    s_nop 0
    v_add_f32_dpp v96, v96, v96 row_half_mirror row_mask:0xf bank_mask:0xf
    v_add_f32_dpp v98, v98, v98 row_half_mirror row_mask:0xf bank_mask:0xf
    v_mul_f32 v96, 0xbb000000, v96
    v_mul_f32 v98, 0x3b000000, v98
    v_fma_f32 v98, -v96, v96, v98
    v_max_f32 v98, 0, v98
    v_add_f32 v98, 0x3727c5ac, v98
    v_rsq_f32 v100, v98
    s_nop 0
    v_mul_f32 v100, 0x3eeff558, v100
    v_mul_f32 v101, v96, v100
    v_pk_fma_f32 v[128:129], v[128:129], v[100:101], v[100:101] op_sel:[0,0,1] op_sel_hi:[1,0,1]
    v_pk_fma_f32 v[130:131], v[130:131], v[100:101], v[100:101] op_sel:[0,0,1] op_sel_hi:[1,0,1]
    v_pk_fma_f32 v[132:133], v[132:133], v[100:101], v[100:101] op_sel:[0,0,1] op_sel_hi:[1,0,1]
    v_pk_fma_f32 v[134:135], v[134:135], v[100:101], v[100:101] op_sel:[0,0,1] op_sel_hi:[1,0,1]
    v_cvt_pk_bf16_f32 v16, v128, v129
    v_cvt_pk_bf16_f32 v17, v130, v131
    v_cvt_pk_bf16_f32 v18, v132, v133
    v_cvt_pk_bf16_f32 v19, v134, v135
    s_waitcnt vmcnt(23)
    s_add_u32 m0, s19, 147040
    s_nop 0
    buffer_load_dwordx4 v3, s[8:11], s18 offen offset:3072 lds
    v_lshlrev_b32 v192, 16, v48
    v_and_b32 v193, s101, v48
    v_lshlrev_b32 v194, 16, v49
    v_and_b32 v195, s101, v49
    v_lshlrev_b32 v196, 16, v50
    v_and_b32 v197, s101, v50
    v_lshlrev_b32 v198, 16, v51
    v_and_b32 v199, s101, v51
    v_pk_add_f32 v[104:105], v[192:193], 0
    v_pk_mul_f32 v[106:107], v[192:193], v[192:193]
    v_pk_add_f32 v[104:105], v[104:105], v[194:195]
    v_pk_fma_f32 v[106:107], v[194:195], v[194:195], v[106:107]
    v_pk_add_f32 v[104:105], v[104:105], v[196:197]
    v_pk_fma_f32 v[106:107], v[196:197], v[196:197], v[106:107]
    v_pk_add_f32 v[104:105], v[104:105], v[198:199]
    v_pk_fma_f32 v[106:107], v[198:199], v[198:199], v[106:107]
    v_pk_fma_f32 v[136:137], v[136:137], v[100:101], v[100:101] op_sel:[0,0,1] op_sel_hi:[1,0,1]
    v_pk_fma_f32 v[138:139], v[138:139], v[100:101], v[100:101] op_sel:[0,0,1] op_sel_hi:[1,0,1]
    v_pk_fma_f32 v[140:141], v[140:141], v[100:101], v[100:101] op_sel:[0,0,1] op_sel_hi:[1,0,1]
    v_pk_fma_f32 v[142:143], v[142:143], v[100:101], v[100:101] op_sel:[0,0,1] op_sel_hi:[1,0,1]
    v_cvt_pk_bf16_f32 v20, v136, v137
    v_cvt_pk_bf16_f32 v21, v138, v139
    v_cvt_pk_bf16_f32 v22, v140, v141
    v_cvt_pk_bf16_f32 v23, v142, v143
    s_waitcnt vmcnt(23)
    v_mov_b32 v14, 0
    v_lshlrev_b32 v13, 2, v2
    s_lshl_b32 s26, s31, 2
    s_add_u32 s26, s26, s16
    s_lshl_b32 s28, s26, 8
    s_add_u32 s28, s28, 58720256
    buffer_store_dword v14, v13, s[12:15], s28 offen sc1
    s_lshl_b32 s28, s31, 5
    s_add_u32 s28, s28, s16
    s_lshl_b32 s28, s28, 2
    s_add_u32 s28, s28, 58982400
    v_and_b32 v13, 48, v2
    s_getreg_b32 s26, hwreg(HW_REG_XCC_ID, 0, 4)
    v_cmp_eq_u32 vcc, 48, v13
    v_mov_b32 v14, s26
    s_nop 0
    v_cndmask_b32 v14, 0, v14, vcc
    buffer_store_dword v14, v13, s[12:15], s28 offen sc1
    v_lshlrev_b32 v200, 16, v52
    v_and_b32 v201, s101, v52
    v_lshlrev_b32 v202, 16, v53
    v_and_b32 v203, s101, v53
    v_lshlrev_b32 v204, 16, v54
    v_and_b32 v205, s101, v54
    v_lshlrev_b32 v206, 16, v55
    v_and_b32 v207, s101, v55
    v_pk_add_f32 v[104:105], v[104:105], v[200:201]
    v_pk_fma_f32 v[106:107], v[200:201], v[200:201], v[106:107]
    v_pk_add_f32 v[104:105], v[104:105], v[202:203]
    v_pk_fma_f32 v[106:107], v[202:203], v[202:203], v[106:107]
    v_pk_add_f32 v[104:105], v[104:105], v[204:205]
    v_pk_fma_f32 v[106:107], v[204:205], v[204:205], v[106:107]
    v_pk_add_f32 v[104:105], v[104:105], v[206:207]
    v_pk_fma_f32 v[106:107], v[206:207], v[206:207], v[106:107]
    v_pk_fma_f32 v[144:145], v[144:145], v[100:101], v[100:101] op_sel:[0,0,1] op_sel_hi:[1,0,1]
    v_pk_fma_f32 v[146:147], v[146:147], v[100:101], v[100:101] op_sel:[0,0,1] op_sel_hi:[1,0,1]
    v_pk_fma_f32 v[148:149], v[148:149], v[100:101], v[100:101] op_sel:[0,0,1] op_sel_hi:[1,0,1]
    v_pk_fma_f32 v[150:151], v[150:151], v[100:101], v[100:101] op_sel:[0,0,1] op_sel_hi:[1,0,1]
    v_cvt_pk_bf16_f32 v24, v144, v145
    v_cvt_pk_bf16_f32 v25, v146, v147
    v_cvt_pk_bf16_f32 v26, v148, v149
    v_cvt_pk_bf16_f32 v27, v150, v151
    s_waitcnt vmcnt(24)
    s_add_u32 m0, s6, 0
    s_xor_b32 s7, s3, 1024
    buffer_load_dwordx4 v80, s[96:99], s7 offen offset:0 lds
    v_lshlrev_b32 v208, 16, v56
    v_and_b32 v209, s101, v56
    v_lshlrev_b32 v210, 16, v57
    v_and_b32 v211, s101, v57
    v_lshlrev_b32 v212, 16, v58
    v_and_b32 v213, s101, v58
    v_lshlrev_b32 v214, 16, v59
    v_and_b32 v215, s101, v59
    v_pk_add_f32 v[104:105], v[104:105], v[208:209]
    v_pk_fma_f32 v[106:107], v[208:209], v[208:209], v[106:107]
    v_pk_add_f32 v[104:105], v[104:105], v[210:211]
    v_pk_fma_f32 v[106:107], v[210:211], v[210:211], v[106:107]
    v_pk_add_f32 v[104:105], v[104:105], v[212:213]
    v_pk_fma_f32 v[106:107], v[212:213], v[212:213], v[106:107]
    v_pk_add_f32 v[104:105], v[104:105], v[214:215]
    v_pk_fma_f32 v[106:107], v[214:215], v[214:215], v[106:107]
    v_pk_fma_f32 v[152:153], v[152:153], v[100:101], v[100:101] op_sel:[0,0,1] op_sel_hi:[1,0,1]
    v_pk_fma_f32 v[154:155], v[154:155], v[100:101], v[100:101] op_sel:[0,0,1] op_sel_hi:[1,0,1]
    v_pk_fma_f32 v[156:157], v[156:157], v[100:101], v[100:101] op_sel:[0,0,1] op_sel_hi:[1,0,1]
    v_pk_fma_f32 v[158:159], v[158:159], v[100:101], v[100:101] op_sel:[0,0,1] op_sel_hi:[1,0,1]
    v_cvt_pk_bf16_f32 v28, v152, v153
    v_cvt_pk_bf16_f32 v29, v154, v155
    v_cvt_pk_bf16_f32 v30, v156, v157
    v_cvt_pk_bf16_f32 v31, v158, v159
    s_waitcnt vmcnt(24)
    buffer_load_dwordx4 v81, s[96:99], s7 offen offset:1024 lds
    v_lshlrev_b32 v216, 16, v60
    v_and_b32 v217, s101, v60
    v_lshlrev_b32 v218, 16, v61
    v_and_b32 v219, s101, v61
    v_lshlrev_b32 v220, 16, v62
    v_and_b32 v221, s101, v62
    v_lshlrev_b32 v222, 16, v63
    v_and_b32 v223, s101, v63
    v_pk_add_f32 v[104:105], v[104:105], v[216:217]
    v_pk_fma_f32 v[106:107], v[216:217], v[216:217], v[106:107]
    v_pk_add_f32 v[104:105], v[104:105], v[218:219]
    v_pk_fma_f32 v[106:107], v[218:219], v[218:219], v[106:107]
    v_pk_add_f32 v[104:105], v[104:105], v[220:221]
    v_pk_fma_f32 v[106:107], v[220:221], v[220:221], v[106:107]
    v_pk_add_f32 v[104:105], v[104:105], v[222:223]
    v_pk_fma_f32 v[106:107], v[222:223], v[222:223], v[106:107]
    v_pk_fma_f32 v[160:161], v[160:161], v[100:101], v[100:101] op_sel:[0,0,1] op_sel_hi:[1,0,1]
    v_pk_fma_f32 v[162:163], v[162:163], v[100:101], v[100:101] op_sel:[0,0,1] op_sel_hi:[1,0,1]
    v_pk_fma_f32 v[164:165], v[164:165], v[100:101], v[100:101] op_sel:[0,0,1] op_sel_hi:[1,0,1]
    v_pk_fma_f32 v[166:167], v[166:167], v[100:101], v[100:101] op_sel:[0,0,1] op_sel_hi:[1,0,1]
    v_cvt_pk_bf16_f32 v32, v160, v161
    v_cvt_pk_bf16_f32 v33, v162, v163
    v_cvt_pk_bf16_f32 v34, v164, v165
    v_cvt_pk_bf16_f32 v35, v166, v167
    s_waitcnt vmcnt(24)
    buffer_load_dwordx4 v82, s[96:99], s7 offen offset:2048 lds
    v_lshlrev_b32 v224, 16, v64
    v_and_b32 v225, s101, v64
    v_lshlrev_b32 v226, 16, v65
    v_and_b32 v227, s101, v65
    v_lshlrev_b32 v228, 16, v66
    v_and_b32 v229, s101, v66
    v_lshlrev_b32 v230, 16, v67
    v_and_b32 v231, s101, v67
    v_pk_add_f32 v[104:105], v[104:105], v[224:225]
    v_pk_fma_f32 v[106:107], v[224:225], v[224:225], v[106:107]
    v_pk_add_f32 v[104:105], v[104:105], v[226:227]
    v_pk_fma_f32 v[106:107], v[226:227], v[226:227], v[106:107]
    v_pk_add_f32 v[104:105], v[104:105], v[228:229]
    v_pk_fma_f32 v[106:107], v[228:229], v[228:229], v[106:107]
    v_pk_add_f32 v[104:105], v[104:105], v[230:231]
    v_pk_fma_f32 v[106:107], v[230:231], v[230:231], v[106:107]
    v_pk_fma_f32 v[168:169], v[168:169], v[100:101], v[100:101] op_sel:[0,0,1] op_sel_hi:[1,0,1]
    v_pk_fma_f32 v[170:171], v[170:171], v[100:101], v[100:101] op_sel:[0,0,1] op_sel_hi:[1,0,1]
    v_pk_fma_f32 v[172:173], v[172:173], v[100:101], v[100:101] op_sel:[0,0,1] op_sel_hi:[1,0,1]
    v_pk_fma_f32 v[174:175], v[174:175], v[100:101], v[100:101] op_sel:[0,0,1] op_sel_hi:[1,0,1]
    v_cvt_pk_bf16_f32 v36, v168, v169
    v_cvt_pk_bf16_f32 v37, v170, v171
    v_cvt_pk_bf16_f32 v38, v172, v173
    v_cvt_pk_bf16_f32 v39, v174, v175
    s_waitcnt vmcnt(24)
    buffer_load_dwordx4 v83, s[96:99], s7 offen offset:3072 lds
    v_lshlrev_b32 v232, 16, v68
    v_and_b32 v233, s101, v68
    v_lshlrev_b32 v234, 16, v69
    v_and_b32 v235, s101, v69
    v_lshlrev_b32 v236, 16, v70
    v_and_b32 v237, s101, v70
    v_lshlrev_b32 v238, 16, v71
    v_and_b32 v239, s101, v71
    v_pk_add_f32 v[104:105], v[104:105], v[232:233]
    v_pk_fma_f32 v[106:107], v[232:233], v[232:233], v[106:107]
    v_pk_add_f32 v[104:105], v[104:105], v[234:235]
    v_pk_fma_f32 v[106:107], v[234:235], v[234:235], v[106:107]
    v_pk_add_f32 v[104:105], v[104:105], v[236:237]
    v_pk_fma_f32 v[106:107], v[236:237], v[236:237], v[106:107]
    v_pk_add_f32 v[104:105], v[104:105], v[238:239]
    v_pk_fma_f32 v[106:107], v[238:239], v[238:239], v[106:107]
    v_pk_fma_f32 v[176:177], v[176:177], v[100:101], v[100:101] op_sel:[0,0,1] op_sel_hi:[1,0,1]
    v_pk_fma_f32 v[178:179], v[178:179], v[100:101], v[100:101] op_sel:[0,0,1] op_sel_hi:[1,0,1]
    v_pk_fma_f32 v[180:181], v[180:181], v[100:101], v[100:101] op_sel:[0,0,1] op_sel_hi:[1,0,1]
    v_pk_fma_f32 v[182:183], v[182:183], v[100:101], v[100:101] op_sel:[0,0,1] op_sel_hi:[1,0,1]
    v_cvt_pk_bf16_f32 v40, v176, v177
    v_cvt_pk_bf16_f32 v41, v178, v179
    v_cvt_pk_bf16_f32 v42, v180, v181
    v_cvt_pk_bf16_f32 v43, v182, v183
    s_waitcnt vmcnt(24)
    s_add_u32 m0, s6, 4096
    s_xor_b32 s7, s3, 66560
    buffer_load_dwordx4 v80, s[96:99], s7 offen offset:0 lds
    v_lshlrev_b32 v240, 16, v72
    v_and_b32 v241, s101, v72
    v_lshlrev_b32 v242, 16, v73
    v_and_b32 v243, s101, v73
    v_lshlrev_b32 v244, 16, v74
    v_and_b32 v245, s101, v74
    v_lshlrev_b32 v246, 16, v75
    v_and_b32 v247, s101, v75
    v_pk_add_f32 v[104:105], v[104:105], v[240:241]
    v_pk_fma_f32 v[106:107], v[240:241], v[240:241], v[106:107]
    v_pk_add_f32 v[104:105], v[104:105], v[242:243]
    v_pk_fma_f32 v[106:107], v[242:243], v[242:243], v[106:107]
    v_pk_add_f32 v[104:105], v[104:105], v[244:245]
    v_pk_fma_f32 v[106:107], v[244:245], v[244:245], v[106:107]
    v_pk_add_f32 v[104:105], v[104:105], v[246:247]
    v_pk_fma_f32 v[106:107], v[246:247], v[246:247], v[106:107]
    v_pk_fma_f32 v[184:185], v[184:185], v[100:101], v[100:101] op_sel:[0,0,1] op_sel_hi:[1,0,1]
    v_pk_fma_f32 v[186:187], v[186:187], v[100:101], v[100:101] op_sel:[0,0,1] op_sel_hi:[1,0,1]
    v_pk_fma_f32 v[188:189], v[188:189], v[100:101], v[100:101] op_sel:[0,0,1] op_sel_hi:[1,0,1]
    v_pk_fma_f32 v[190:191], v[190:191], v[100:101], v[100:101] op_sel:[0,0,1] op_sel_hi:[1,0,1]
    v_cvt_pk_bf16_f32 v44, v184, v185
    v_cvt_pk_bf16_f32 v45, v186, v187
    v_cvt_pk_bf16_f32 v46, v188, v189
    v_cvt_pk_bf16_f32 v47, v190, v191
    s_waitcnt vmcnt(24)
    buffer_load_dwordx4 v81, s[96:99], s7 offen offset:1024 lds
    v_lshlrev_b32 v248, 16, v76
    v_and_b32 v249, s101, v76
    v_lshlrev_b32 v250, 16, v77
    v_and_b32 v251, s101, v77
    v_lshlrev_b32 v252, 16, v78
    v_and_b32 v253, s101, v78
    v_lshlrev_b32 v254, 16, v79
    v_and_b32 v255, s101, v79
    v_pk_add_f32 v[104:105], v[104:105], v[248:249]
    v_pk_fma_f32 v[106:107], v[248:249], v[248:249], v[106:107]
    v_pk_add_f32 v[104:105], v[104:105], v[250:251]
    v_pk_fma_f32 v[106:107], v[250:251], v[250:251], v[106:107]
    v_pk_add_f32 v[104:105], v[104:105], v[252:253]
    v_pk_fma_f32 v[106:107], v[252:253], v[252:253], v[106:107]
    v_pk_add_f32 v[104:105], v[104:105], v[254:255]
    v_pk_fma_f32 v[106:107], v[254:255], v[254:255], v[106:107]
    v_add_f32 v104, v104, v105
    v_add_f32 v106, v106, v107
    s_nop 0
    v_add_f32_dpp v104, v104, v104 quad_perm:[1,0,3,2] row_mask:0xf bank_mask:0xf
    v_add_f32_dpp v106, v106, v106 quad_perm:[1,0,3,2] row_mask:0xf bank_mask:0xf
    s_nop 0
    v_add_f32_dpp v104, v104, v104 quad_perm:[2,3,0,1] row_mask:0xf bank_mask:0xf
    v_add_f32_dpp v106, v106, v106 quad_perm:[2,3,0,1] row_mask:0xf bank_mask:0xf
    s_nop 0
    v_add_f32_dpp v104, v104, v104 row_half_mirror row_mask:0xf bank_mask:0xf
    v_add_f32_dpp v106, v106, v106 row_half_mirror row_mask:0xf bank_mask:0xf
    v_mul_f32 v104, 0xbb000000, v104
    v_mul_f32 v106, 0x3b000000, v106
    v_fma_f32 v106, -v104, v104, v106
    v_max_f32 v106, 0, v106
    v_add_f32 v106, 0x3727c5ac, v106
    v_rsq_f32 v108, v106
    s_nop 0
    v_mul_f32 v108, 0x3eeff558, v108
    v_mul_f32 v109, v104, v108
    buffer_load_dwordx4 v82, s[96:99], s7 offen offset:2048 lds
    buffer_load_dwordx4 v83, s[96:99], s7 offen offset:3072 lds
    v_pk_fma_f32 v[192:193], v[192:193], v[108:109], v[108:109] op_sel:[0,0,1] op_sel_hi:[1,0,1]
    v_pk_fma_f32 v[194:195], v[194:195], v[108:109], v[108:109] op_sel:[0,0,1] op_sel_hi:[1,0,1]
    v_pk_fma_f32 v[196:197], v[196:197], v[108:109], v[108:109] op_sel:[0,0,1] op_sel_hi:[1,0,1]
    v_pk_fma_f32 v[198:199], v[198:199], v[108:109], v[108:109] op_sel:[0,0,1] op_sel_hi:[1,0,1]
    v_cvt_pk_bf16_f32 v48, v192, v193
    v_cvt_pk_bf16_f32 v49, v194, v195
    v_cvt_pk_bf16_f32 v50, v196, v197
    v_cvt_pk_bf16_f32 v51, v198, v199
    s_add_u32 m0, s6, 8192
    s_xor_b32 s7, s3, 132096
    buffer_load_dwordx4 v80, s[96:99], s7 offen offset:0 lds
    buffer_load_dwordx4 v81, s[96:99], s7 offen offset:1024 lds
    v_pk_fma_f32 v[200:201], v[200:201], v[108:109], v[108:109] op_sel:[0,0,1] op_sel_hi:[1,0,1]
    v_pk_fma_f32 v[202:203], v[202:203], v[108:109], v[108:109] op_sel:[0,0,1] op_sel_hi:[1,0,1]
    v_pk_fma_f32 v[204:205], v[204:205], v[108:109], v[108:109] op_sel:[0,0,1] op_sel_hi:[1,0,1]
    v_pk_fma_f32 v[206:207], v[206:207], v[108:109], v[108:109] op_sel:[0,0,1] op_sel_hi:[1,0,1]
    v_cvt_pk_bf16_f32 v52, v200, v201
    v_cvt_pk_bf16_f32 v53, v202, v203
    v_cvt_pk_bf16_f32 v54, v204, v205
    v_cvt_pk_bf16_f32 v55, v206, v207
    buffer_load_dwordx4 v82, s[96:99], s7 offen offset:2048 lds
    buffer_load_dwordx4 v83, s[96:99], s7 offen offset:3072 lds
    v_pk_fma_f32 v[208:209], v[208:209], v[108:109], v[108:109] op_sel:[0,0,1] op_sel_hi:[1,0,1]
    v_pk_fma_f32 v[210:211], v[210:211], v[108:109], v[108:109] op_sel:[0,0,1] op_sel_hi:[1,0,1]
    v_pk_fma_f32 v[212:213], v[212:213], v[108:109], v[108:109] op_sel:[0,0,1] op_sel_hi:[1,0,1]
    v_pk_fma_f32 v[214:215], v[214:215], v[108:109], v[108:109] op_sel:[0,0,1] op_sel_hi:[1,0,1]
    v_cvt_pk_bf16_f32 v56, v208, v209
    v_cvt_pk_bf16_f32 v57, v210, v211
    v_cvt_pk_bf16_f32 v58, v212, v213
    v_cvt_pk_bf16_f32 v59, v214, v215
    s_lshl_b32 s26, s2, 12
    s_lshr_b32 s28, s16, 1
    s_lshl_b32 s28, s28, 11
    s_add_u32 s26, s26, s28
    s_and_b32 s28, s16, 1
    s_lshl_b32 s28, s28, 9
    s_add_u32 s26, s26, s28
    v_lshlrev_b32 v14, 3, v2
    buffer_load_dword v0, v14, s[96:99], s26 offen
    s_lshl_b32 s28, s2, 2
    s_add_u32 s28, s28, s16
    s_lshl_b32 s28, s28, 10
    v_add_u32 v14, s28, v3
    global_load_dword v0, v14, s[58:59]
    v_pk_fma_f32 v[216:217], v[216:217], v[108:109], v[108:109] op_sel:[0,0,1] op_sel_hi:[1,0,1]
    v_pk_fma_f32 v[218:219], v[218:219], v[108:109], v[108:109] op_sel:[0,0,1] op_sel_hi:[1,0,1]
    v_pk_fma_f32 v[220:221], v[220:221], v[108:109], v[108:109] op_sel:[0,0,1] op_sel_hi:[1,0,1]
    v_pk_fma_f32 v[222:223], v[222:223], v[108:109], v[108:109] op_sel:[0,0,1] op_sel_hi:[1,0,1]
    v_cvt_pk_bf16_f32 v60, v216, v217
    v_cvt_pk_bf16_f32 v61, v218, v219
    v_cvt_pk_bf16_f32 v62, v220, v221
    v_cvt_pk_bf16_f32 v63, v222, v223
    s_waitcnt vmcnt(16)
    s_barrier
    ds_read_b128 a[0:3], v7 offset:0
    ds_read_b128 a[4:7], v6 offset:33792
    ds_read_b128 a[8:11], v7 offset:64
    ds_read_b128 a[12:15], v6 offset:33856
    ds_read_b128 a[16:19], v7 offset:128
    ds_read_b128 a[20:23], v6 offset:33920
    ds_read_b128 a[24:27], v7 offset:192
    ds_read_b128 a[28:31], v6 offset:33984
    ds_read_b128 a[32:35], v7 offset:256
    ds_read_b128 a[36:39], v6 offset:34048
    ds_read_b128 a[40:43], v7 offset:320
    ds_read_b128 a[44:47], v6 offset:34112
    v_pk_fma_f32 v[224:225], v[224:225], v[108:109], v[108:109] op_sel:[0,0,1] op_sel_hi:[1,0,1]
    v_pk_fma_f32 v[226:227], v[226:227], v[108:109], v[108:109] op_sel:[0,0,1] op_sel_hi:[1,0,1]
    v_pk_fma_f32 v[228:229], v[228:229], v[108:109], v[108:109] op_sel:[0,0,1] op_sel_hi:[1,0,1]
    v_pk_fma_f32 v[230:231], v[230:231], v[108:109], v[108:109] op_sel:[0,0,1] op_sel_hi:[1,0,1]
    v_cvt_pk_bf16_f32 v64, v224, v225
    v_cvt_pk_bf16_f32 v65, v226, v227
    v_cvt_pk_bf16_f32 v66, v228, v229
    v_cvt_pk_bf16_f32 v67, v230, v231
    ds_read_b128 a[48:51], v7 offset:384
    ds_read_b128 a[52:55], v6 offset:34176
    s_waitcnt lgkmcnt(12)
    v_mfma_f32_16x16x32_bf16 v[8:11], a[0:3], a[4:7], 0
    ds_read_b128 a[56:59], v7 offset:448
    ds_read_b128 a[60:63], v6 offset:34240
    s_waitcnt lgkmcnt(12)
    v_mfma_f32_16x16x32_bf16 v[8:11], a[8:11], a[12:15], v[8:11]
    ds_read_b128 a[64:67], v7 offset:512
    ds_read_b128 a[68:71], v6 offset:34304
    s_waitcnt lgkmcnt(12)
    v_mfma_f32_16x16x32_bf16 v[8:11], a[16:19], a[20:23], v[8:11]
    ds_read_b128 a[72:75], v7 offset:576
    ds_read_b128 a[76:79], v6 offset:34368
    s_waitcnt lgkmcnt(12)
    v_mfma_f32_16x16x32_bf16 v[8:11], a[24:27], a[28:31], v[8:11]
    ds_read_b128 a[80:83], v7 offset:640
    ds_read_b128 a[84:87], v6 offset:34432
    s_waitcnt lgkmcnt(12)
    v_mfma_f32_16x16x32_bf16 v[8:11], a[32:35], a[36:39], v[8:11]
    ds_read_b128 a[88:91], v7 offset:704
    ds_read_b128 a[92:95], v6 offset:34496
    s_waitcnt lgkmcnt(12)
    v_mfma_f32_16x16x32_bf16 v[8:11], a[40:43], a[44:47], v[8:11]
    ds_read_b128 a[96:99], v7 offset:768
    ds_read_b128 a[100:103], v6 offset:34560
    s_waitcnt lgkmcnt(12)
    v_mfma_f32_16x16x32_bf16 v[8:11], a[48:51], a[52:55], v[8:11]
    ds_read_b128 a[104:107], v7 offset:832
    ds_read_b128 a[108:111], v6 offset:34624
    s_waitcnt lgkmcnt(12)
    v_mfma_f32_16x16x32_bf16 v[8:11], a[56:59], a[60:63], v[8:11]
    ds_read_b128 a[112:115], v7 offset:896
    ds_read_b128 a[116:119], v6 offset:34688
    s_waitcnt lgkmcnt(12)
    v_mfma_f32_16x16x32_bf16 v[8:11], a[64:67], a[68:71], v[8:11]
    ds_read_b128 a[120:123], v7 offset:960
    ds_read_b128 a[124:127], v6 offset:34752
    s_waitcnt lgkmcnt(12)
    v_mfma_f32_16x16x32_bf16 v[8:11], a[72:75], a[76:79], v[8:11]
    s_waitcnt lgkmcnt(10)
    v_mfma_f32_16x16x32_bf16 v[8:11], a[80:83], a[84:87], v[8:11]
    s_waitcnt lgkmcnt(8)
    v_mfma_f32_16x16x32_bf16 v[8:11], a[88:91], a[92:95], v[8:11]
    s_waitcnt lgkmcnt(6)
    v_mfma_f32_16x16x32_bf16 v[8:11], a[96:99], a[100:103], v[8:11]
    s_waitcnt lgkmcnt(4)
    v_mfma_f32_16x16x32_bf16 v[8:11], a[104:107], a[108:111], v[8:11]
    s_waitcnt lgkmcnt(2)
    v_mfma_f32_16x16x32_bf16 v[8:11], a[112:115], a[116:119], v[8:11]
    s_waitcnt lgkmcnt(0)
    v_mfma_f32_16x16x32_bf16 v[8:11], a[120:123], a[124:127], v[8:11]
    v_pk_fma_f32 v[232:233], v[232:233], v[108:109], v[108:109] op_sel:[0,0,1] op_sel_hi:[1,0,1]
    v_pk_fma_f32 v[234:235], v[234:235], v[108:109], v[108:109] op_sel:[0,0,1] op_sel_hi:[1,0,1]
    v_pk_fma_f32 v[236:237], v[236:237], v[108:109], v[108:109] op_sel:[0,0,1] op_sel_hi:[1,0,1]
    v_pk_fma_f32 v[238:239], v[238:239], v[108:109], v[108:109] op_sel:[0,0,1] op_sel_hi:[1,0,1]
    v_cvt_pk_bf16_f32 v68, v232, v233
    v_cvt_pk_bf16_f32 v69, v234, v235
    v_cvt_pk_bf16_f32 v70, v236, v237
    v_cvt_pk_bf16_f32 v71, v238, v239
    v_mul_f32 v8, 0x3e949ec1, v8
    v_mul_f32 v9, 0x3e949ec1, v9
    v_mul_f32 v10, 0x3e949ec1, v10
    v_mul_f32 v11, 0x3e949ec1, v11
    v_cvt_pk_bf16_f32 v8, v8, v9
    v_cvt_pk_bf16_f32 v9, v10, v11
    ds_write_b64 v112, v[8:9]
    v_pk_fma_f32 v[240:241], v[240:241], v[108:109], v[108:109] op_sel:[0,0,1] op_sel_hi:[1,0,1]
    v_pk_fma_f32 v[242:243], v[242:243], v[108:109], v[108:109] op_sel:[0,0,1] op_sel_hi:[1,0,1]
    v_pk_fma_f32 v[244:245], v[244:245], v[108:109], v[108:109] op_sel:[0,0,1] op_sel_hi:[1,0,1]
    v_pk_fma_f32 v[246:247], v[246:247], v[108:109], v[108:109] op_sel:[0,0,1] op_sel_hi:[1,0,1]
    v_cvt_pk_bf16_f32 v72, v240, v241
    v_cvt_pk_bf16_f32 v73, v242, v243
    v_cvt_pk_bf16_f32 v74, v244, v245
    v_cvt_pk_bf16_f32 v75, v246, v247
    v_pk_fma_f32 v[248:249], v[248:249], v[108:109], v[108:109] op_sel:[0,0,1] op_sel_hi:[1,0,1]
    v_pk_fma_f32 v[250:251], v[250:251], v[108:109], v[108:109] op_sel:[0,0,1] op_sel_hi:[1,0,1]
    v_pk_fma_f32 v[252:253], v[252:253], v[108:109], v[108:109] op_sel:[0,0,1] op_sel_hi:[1,0,1]
    v_pk_fma_f32 v[254:255], v[254:255], v[108:109], v[108:109] op_sel:[0,0,1] op_sel_hi:[1,0,1]
    v_cvt_pk_bf16_f32 v76, v248, v249
    v_cvt_pk_bf16_f32 v77, v250, v251
    v_cvt_pk_bf16_f32 v78, v252, v253
    v_cvt_pk_bf16_f32 v79, v254, v255
    s_waitcnt lgkmcnt(0)
    s_barrier
    ds_read_b128 v[8:11], v113
    ds_write_b128 v12, v[16:19] offset:0
    ds_write_b128 v12, v[20:23] offset:2048
    ds_write_b128 v12, v[24:27] offset:4096
    ds_write_b128 v12, v[28:31] offset:6144
    s_waitcnt lgkmcnt(4)
    buffer_store_dwordx4 v[8:11], v114, s[12:15], s30 offen sc1
    s_add_u32 m0, s6, 12288
    s_xor_b32 s7, s3, 197632
    buffer_load_dwordx4 v80, s[96:99], s7 offen offset:0 lds
    buffer_load_dwordx4 v81, s[96:99], s7 offen offset:1024 lds
    ds_write_b128 v15, v[32:35] offset:0
    buffer_load_dwordx4 v82, s[96:99], s7 offen offset:2048 lds
    buffer_load_dwordx4 v83, s[96:99], s7 offen offset:3072 lds
    ds_write_b128 v15, v[36:39] offset:2048
    s_add_u32 m0, s6, 16384
    s_xor_b32 s7, s3, 263168
    buffer_load_dwordx4 v80, s[96:99], s7 offen offset:0 lds
    buffer_load_dwordx4 v81, s[96:99], s7 offen offset:1024 lds
    ds_write_b128 v15, v[40:43] offset:4096
    buffer_load_dwordx4 v82, s[96:99], s7 offen offset:2048 lds
    buffer_load_dwordx4 v83, s[96:99], s7 offen offset:3072 lds
    ds_write_b128 v15, v[44:47] offset:6144
    ds_write_b128 v116, v[48:51] offset:0
    ds_write_b128 v116, v[52:55] offset:2048
    ds_write_b128 v116, v[56:59] offset:4096
    ds_write_b128 v116, v[60:63] offset:6144
    ds_write_b128 v117, v[64:67] offset:0
    ds_write_b128 v117, v[68:71] offset:2048
    ds_write_b128 v117, v[72:75] offset:4096
    s_waitcnt lgkmcnt(14)
    ds_write_b128 v117, v[76:79] offset:6144
    s_add_u32 s8, s4, s24
    s_addc_u32 s9, s5, 0
    s_and_b32 s9, s9, 0xffff
    s_mov_b32 s10, 4096000
    s_mov_b32 s11, 0x00020000
    s_lshr_b32 s19, s3, 16
    s_lshl_b32 s19, s19, 10
    s_add_u32 s19, s19, s27
    v_and_b32 v13, 3, v2
    s_waitcnt lgkmcnt(0)
    s_waitcnt vmcnt(8)
    s_barrier
    v_xor_b32 v89, 0, v88
    ds_read_b128 a[0:3], v89 offset:0
    ds_read_b128 a[64:67], v89 offset:16384
    ds_read_b128 a[128:131], v89 offset:32768
    ds_read_b128 a[192:195], v89 offset:49152
    ds_read_b64_tr_b16 v[16:17], v92 offset:0
    ds_read_b64_tr_b16 v[18:19], v92 offset:512
    ds_read_b64_tr_b16 v[20:21], v93 offset:0
    ds_read_b64_tr_b16 v[22:23], v93 offset:512
    ds_read_b64_tr_b16 v[24:25], v94 offset:0
    ds_read_b64_tr_b16 v[26:27], v94 offset:512
    ds_read_b64_tr_b16 v[28:29], v95 offset:0
    ds_read_b64_tr_b16 v[30:31], v95 offset:512
    s_cmp_lg_u32 s16, 0
    s_cbranch_scc1 L_sig1
    v_mov_b32 v14, 1
    s_and_b32 s26, s2, 3
    s_lshl_b32 s26, s26, 6
    s_mov_b64 exec, 1
    buffer_atomic_add v14, off, s[92:95], s26 offset:0
    s_mov_b64 exec, -1
L_sig1:
    v_xor_b32 v89, 64, v88
    ds_read_b128 a[4:7], v89 offset:0
    ds_read_b128 a[68:71], v89 offset:16384
    ds_read_b128 a[132:135], v89 offset:32768
    s_waitcnt lgkmcnt(14)
    ds_read_b128 a[196:199], v89 offset:49152
    s_mov_b32 s0, 0xc09d30fc
    s_mov_b32 s1, 0x3eeff558
    v_lshlrev_b32 v13, 6, v13
    s_cmp_eq_u32 s16, 1
    s_cselect_b32 s26, 0, 0x1000
    v_add_u32 v12, s26, v13
    s_lshl_b32 s17, s31, 16
    s_lshl_b32 s26, s16, 7
    s_add_u32 s17, s17, s26
    s_add_u32 s17, s17, 33554432
    s_waitcnt lgkmcnt(4)
    v_mfma_f32_16x16x32_bf16 v[128:131], v[16:19], a[0:3], 0
    ds_read_b64_tr_b16 v[32:33], v92 offset:4096
    v_mfma_f32_16x16x32_bf16 v[144:147], v[20:23], a[0:3], 0
    ds_read_b64_tr_b16 v[34:35], v92 offset:4608
    v_mfma_f32_16x16x32_bf16 v[132:135], v[16:19], a[64:67], 0
    ds_read_b64_tr_b16 v[36:37], v93 offset:4096
    v_mfma_f32_16x16x32_bf16 v[148:151], v[20:23], a[64:67], 0
    ds_read_b64_tr_b16 v[38:39], v93 offset:4608
    v_mfma_f32_16x16x32_bf16 v[136:139], v[16:19], a[128:131], 0
    ds_read_b64_tr_b16 v[40:41], v94 offset:4096
    v_mfma_f32_16x16x32_bf16 v[152:155], v[20:23], a[128:131], 0
    ds_read_b64_tr_b16 v[42:43], v94 offset:4608
    v_mfma_f32_16x16x32_bf16 v[140:143], v[16:19], a[192:195], 0
    ds_read_b64_tr_b16 v[44:45], v95 offset:4096
    v_mfma_f32_16x16x32_bf16 v[156:159], v[20:23], a[192:195], 0
    ds_read_b64_tr_b16 v[46:47], v95 offset:4608
    v_mfma_f32_16x16x32_bf16 v[172:175], v[24:27], a[192:195], 0
    v_xor_b32 v89, 2048, v88
    ds_read_b128 a[8:11], v89 offset:0
    v_mfma_f32_16x16x32_bf16 v[188:191], v[28:31], a[192:195], 0
    s_add_u32 m0, s6, 0
    s_xor_b32 s7, s3, 328704
    buffer_load_dwordx4 v80, s[96:99], s7 offen offset:0 lds
    v_mfma_f32_16x16x32_bf16 v[168:171], v[24:27], a[128:131], 0
    ds_read_b128 a[72:75], v89 offset:16384
    v_mfma_f32_16x16x32_bf16 v[184:187], v[28:31], a[128:131], 0
    buffer_load_dwordx4 v81, s[96:99], s7 offen offset:1024 lds
    v_mfma_f32_16x16x32_bf16 v[164:167], v[24:27], a[64:67], 0
    ds_read_b128 a[136:139], v89 offset:32768
    v_mfma_f32_16x16x32_bf16 v[180:183], v[28:31], a[64:67], 0
    buffer_load_dwordx4 v82, s[96:99], s7 offen offset:2048 lds
    v_mfma_f32_16x16x32_bf16 v[160:163], v[24:27], a[0:3], 0
    s_waitcnt lgkmcnt(14)
    ds_read_b128 a[200:203], v89 offset:49152
    v_mfma_f32_16x16x32_bf16 v[176:179], v[28:31], a[0:3], 0
    buffer_load_dwordx4 v83, s[96:99], s7 offen offset:3072 lds
    s_waitcnt lgkmcnt(4)
    v_mfma_f32_16x16x32_bf16 v[128:131], v[32:35], a[4:7], v[128:131]
    ds_read_b64_tr_b16 v[16:17], v92 offset:8192
    v_mfma_f32_16x16x32_bf16 v[144:147], v[36:39], a[4:7], v[144:147]
    ds_read_b64_tr_b16 v[18:19], v92 offset:8704
    v_mfma_f32_16x16x32_bf16 v[132:135], v[32:35], a[68:71], v[132:135]
    ds_read_b64_tr_b16 v[20:21], v93 offset:8192
    v_mfma_f32_16x16x32_bf16 v[148:151], v[36:39], a[68:71], v[148:151]
    ds_read_b64_tr_b16 v[22:23], v93 offset:8704
    v_mfma_f32_16x16x32_bf16 v[136:139], v[32:35], a[132:135], v[136:139]
    ds_read_b64_tr_b16 v[24:25], v94 offset:8192
    v_mfma_f32_16x16x32_bf16 v[152:155], v[36:39], a[132:135], v[152:155]
    ds_read_b64_tr_b16 v[26:27], v94 offset:8704
    v_mfma_f32_16x16x32_bf16 v[140:143], v[32:35], a[196:199], v[140:143]
    ds_read_b64_tr_b16 v[28:29], v95 offset:8192
    v_mfma_f32_16x16x32_bf16 v[156:159], v[36:39], a[196:199], v[156:159]
    ds_read_b64_tr_b16 v[30:31], v95 offset:8704
    v_mfma_f32_16x16x32_bf16 v[172:175], v[40:43], a[196:199], v[172:175]
    v_xor_b32 v89, 2112, v88
    ds_read_b128 a[12:15], v89 offset:0
    v_mfma_f32_16x16x32_bf16 v[188:191], v[44:47], a[196:199], v[188:191]
    s_add_u32 m0, s6, 4096
    s_xor_b32 s7, s3, 394240
    buffer_load_dwordx4 v80, s[96:99], s7 offen offset:0 lds
    v_mfma_f32_16x16x32_bf16 v[168:171], v[40:43], a[132:135], v[168:171]
    ds_read_b128 a[76:79], v89 offset:16384
    v_mfma_f32_16x16x32_bf16 v[184:187], v[44:47], a[132:135], v[184:187]
    buffer_load_dwordx4 v81, s[96:99], s7 offen offset:1024 lds
    v_mfma_f32_16x16x32_bf16 v[164:167], v[40:43], a[68:71], v[164:167]
    ds_read_b128 a[140:143], v89 offset:32768
    v_mfma_f32_16x16x32_bf16 v[180:183], v[44:47], a[68:71], v[180:183]
    buffer_load_dwordx4 v82, s[96:99], s7 offen offset:2048 lds
    v_mfma_f32_16x16x32_bf16 v[160:163], v[40:43], a[4:7], v[160:163]
    s_waitcnt lgkmcnt(14)
    ds_read_b128 a[204:207], v89 offset:49152
    v_mfma_f32_16x16x32_bf16 v[176:179], v[44:47], a[4:7], v[176:179]
    buffer_load_dwordx4 v83, s[96:99], s7 offen offset:3072 lds
    s_waitcnt lgkmcnt(4)
    v_mfma_f32_16x16x32_bf16 v[128:131], v[16:19], a[8:11], v[128:131]
    s_waitcnt vmcnt(12)
    ds_read_b64_tr_b16 v[32:33], v92 offset:12288
    v_mfma_f32_16x16x32_bf16 v[144:147], v[20:23], a[8:11], v[144:147]
    ds_read_b64_tr_b16 v[34:35], v92 offset:12800
    v_mfma_f32_16x16x32_bf16 v[132:135], v[16:19], a[72:75], v[132:135]
    ds_read_b64_tr_b16 v[36:37], v93 offset:12288
    v_mfma_f32_16x16x32_bf16 v[148:151], v[20:23], a[72:75], v[148:151]
    ds_read_b64_tr_b16 v[38:39], v93 offset:12800
    v_mfma_f32_16x16x32_bf16 v[136:139], v[16:19], a[136:139], v[136:139]
    ds_read_b64_tr_b16 v[40:41], v94 offset:12288
    v_mfma_f32_16x16x32_bf16 v[152:155], v[20:23], a[136:139], v[152:155]
    ds_read_b64_tr_b16 v[42:43], v94 offset:12800
    v_mfma_f32_16x16x32_bf16 v[140:143], v[16:19], a[200:203], v[140:143]
    ds_read_b64_tr_b16 v[44:45], v95 offset:12288
    v_mfma_f32_16x16x32_bf16 v[156:159], v[20:23], a[200:203], v[156:159]
    ds_read_b64_tr_b16 v[46:47], v95 offset:12800
    v_mfma_f32_16x16x32_bf16 v[172:175], v[24:27], a[200:203], v[172:175]
    v_xor_b32 v89, 4096, v88
    ds_read_b128 a[16:19], v89 offset:0
    v_mfma_f32_16x16x32_bf16 v[188:191], v[28:31], a[200:203], v[188:191]
    s_add_u32 m0, s6, 8192
    s_xor_b32 s7, s3, 459776
    buffer_load_dwordx4 v80, s[96:99], s7 offen offset:0 lds
    v_mfma_f32_16x16x32_bf16 v[168:171], v[24:27], a[136:139], v[168:171]
    ds_read_b128 a[80:83], v89 offset:16384
    v_mfma_f32_16x16x32_bf16 v[184:187], v[28:31], a[136:139], v[184:187]
    buffer_load_dwordx4 v81, s[96:99], s7 offen offset:1024 lds
    v_mfma_f32_16x16x32_bf16 v[164:167], v[24:27], a[72:75], v[164:167]
    ds_read_b128 a[144:147], v89 offset:32768
    v_mfma_f32_16x16x32_bf16 v[180:183], v[28:31], a[72:75], v[180:183]
    buffer_load_dwordx4 v82, s[96:99], s7 offen offset:2048 lds
    v_mfma_f32_16x16x32_bf16 v[160:163], v[24:27], a[8:11], v[160:163]
    s_waitcnt lgkmcnt(14)
    ds_read_b128 a[208:211], v89 offset:49152
    v_mfma_f32_16x16x32_bf16 v[176:179], v[28:31], a[8:11], v[176:179]
    buffer_load_dwordx4 v83, s[96:99], s7 offen offset:3072 lds
    s_waitcnt lgkmcnt(4)
    v_mfma_f32_16x16x32_bf16 v[128:131], v[32:35], a[12:15], v[128:131]
    s_waitcnt vmcnt(12)
    ds_read_b64_tr_b16 v[16:17], v92 offset:16384
    v_mfma_f32_16x16x32_bf16 v[144:147], v[36:39], a[12:15], v[144:147]
    ds_read_b64_tr_b16 v[18:19], v92 offset:16896
    v_mfma_f32_16x16x32_bf16 v[132:135], v[32:35], a[76:79], v[132:135]
    ds_read_b64_tr_b16 v[20:21], v93 offset:16384
    v_mfma_f32_16x16x32_bf16 v[148:151], v[36:39], a[76:79], v[148:151]
    ds_read_b64_tr_b16 v[22:23], v93 offset:16896
    v_mfma_f32_16x16x32_bf16 v[136:139], v[32:35], a[140:143], v[136:139]
    ds_read_b64_tr_b16 v[24:25], v94 offset:16384
    v_mfma_f32_16x16x32_bf16 v[152:155], v[36:39], a[140:143], v[152:155]
    ds_read_b64_tr_b16 v[26:27], v94 offset:16896
    v_mfma_f32_16x16x32_bf16 v[140:143], v[32:35], a[204:207], v[140:143]
    ds_read_b64_tr_b16 v[28:29], v95 offset:16384
    v_mfma_f32_16x16x32_bf16 v[156:159], v[36:39], a[204:207], v[156:159]
    ds_read_b64_tr_b16 v[30:31], v95 offset:16896
    v_mfma_f32_16x16x32_bf16 v[172:175], v[40:43], a[204:207], v[172:175]
    v_xor_b32 v89, 4160, v88
    ds_read_b128 a[20:23], v89 offset:0
    v_mfma_f32_16x16x32_bf16 v[188:191], v[44:47], a[204:207], v[188:191]
    s_add_u32 m0, s6, 12288
    s_xor_b32 s7, s3, 525312
    buffer_load_dwordx4 v80, s[96:99], s7 offen offset:0 lds
    v_mfma_f32_16x16x32_bf16 v[168:171], v[40:43], a[140:143], v[168:171]
    ds_read_b128 a[84:87], v89 offset:16384
    v_mfma_f32_16x16x32_bf16 v[184:187], v[44:47], a[140:143], v[184:187]
    buffer_load_dwordx4 v81, s[96:99], s7 offen offset:1024 lds
    v_mfma_f32_16x16x32_bf16 v[164:167], v[40:43], a[76:79], v[164:167]
    ds_read_b128 a[148:151], v89 offset:32768
    v_mfma_f32_16x16x32_bf16 v[180:183], v[44:47], a[76:79], v[180:183]
    buffer_load_dwordx4 v82, s[96:99], s7 offen offset:2048 lds
    v_mfma_f32_16x16x32_bf16 v[160:163], v[40:43], a[12:15], v[160:163]
    s_waitcnt lgkmcnt(14)
    ds_read_b128 a[212:215], v89 offset:49152
    v_mfma_f32_16x16x32_bf16 v[176:179], v[44:47], a[12:15], v[176:179]
    buffer_load_dwordx4 v83, s[96:99], s7 offen offset:3072 lds
    s_waitcnt lgkmcnt(4)
    v_mfma_f32_16x16x32_bf16 v[128:131], v[16:19], a[16:19], v[128:131]
    s_waitcnt vmcnt(12)
    ds_read_b64_tr_b16 v[32:33], v92 offset:0
    v_mfma_f32_16x16x32_bf16 v[144:147], v[20:23], a[16:19], v[144:147]
    ds_read_b64_tr_b16 v[34:35], v92 offset:512
    v_mfma_f32_16x16x32_bf16 v[132:135], v[16:19], a[80:83], v[132:135]
    ds_read_b64_tr_b16 v[36:37], v93 offset:0
    v_mfma_f32_16x16x32_bf16 v[148:151], v[20:23], a[80:83], v[148:151]
    ds_read_b64_tr_b16 v[38:39], v93 offset:512
    v_mfma_f32_16x16x32_bf16 v[136:139], v[16:19], a[144:147], v[136:139]
    ds_read_b64_tr_b16 v[40:41], v94 offset:0
    v_mfma_f32_16x16x32_bf16 v[152:155], v[20:23], a[144:147], v[152:155]
    ds_read_b64_tr_b16 v[42:43], v94 offset:512
    v_mfma_f32_16x16x32_bf16 v[140:143], v[16:19], a[208:211], v[140:143]
    ds_read_b64_tr_b16 v[44:45], v95 offset:0
    v_mfma_f32_16x16x32_bf16 v[156:159], v[20:23], a[208:211], v[156:159]
    ds_read_b64_tr_b16 v[46:47], v95 offset:512
    v_mfma_f32_16x16x32_bf16 v[172:175], v[24:27], a[208:211], v[172:175]
    v_xor_b32 v89, 6144, v88
    ds_read_b128 a[24:27], v89 offset:0
    v_mfma_f32_16x16x32_bf16 v[188:191], v[28:31], a[208:211], v[188:191]
    s_add_u32 m0, s6, 16384
    s_xor_b32 s7, s3, 590848
    buffer_load_dwordx4 v80, s[96:99], s7 offen offset:0 lds
    v_mfma_f32_16x16x32_bf16 v[168:171], v[24:27], a[144:147], v[168:171]
    ds_read_b128 a[88:91], v89 offset:16384
    v_mfma_f32_16x16x32_bf16 v[184:187], v[28:31], a[144:147], v[184:187]
    buffer_load_dwordx4 v81, s[96:99], s7 offen offset:1024 lds
    v_mfma_f32_16x16x32_bf16 v[164:167], v[24:27], a[80:83], v[164:167]
    ds_read_b128 a[152:155], v89 offset:32768
    v_mfma_f32_16x16x32_bf16 v[180:183], v[28:31], a[80:83], v[180:183]
    buffer_load_dwordx4 v82, s[96:99], s7 offen offset:2048 lds
    v_mfma_f32_16x16x32_bf16 v[160:163], v[24:27], a[16:19], v[160:163]
    s_waitcnt lgkmcnt(14)
    ds_read_b128 a[216:219], v89 offset:49152
    v_mfma_f32_16x16x32_bf16 v[176:179], v[28:31], a[16:19], v[176:179]
    buffer_load_dwordx4 v83, s[96:99], s7 offen offset:3072 lds
    s_waitcnt lgkmcnt(4)
    v_mfma_f32_16x16x32_bf16 v[128:131], v[32:35], a[20:23], v[128:131]
    s_waitcnt vmcnt(12)
    ds_read_b64_tr_b16 v[16:17], v92 offset:4096
    v_mfma_f32_16x16x32_bf16 v[144:147], v[36:39], a[20:23], v[144:147]
    ds_read_b64_tr_b16 v[18:19], v92 offset:4608
    v_mfma_f32_16x16x32_bf16 v[132:135], v[32:35], a[84:87], v[132:135]
    ds_read_b64_tr_b16 v[20:21], v93 offset:4096
    v_mfma_f32_16x16x32_bf16 v[148:151], v[36:39], a[84:87], v[148:151]
    ds_read_b64_tr_b16 v[22:23], v93 offset:4608
    v_mfma_f32_16x16x32_bf16 v[136:139], v[32:35], a[148:151], v[136:139]
    ds_read_b64_tr_b16 v[24:25], v94 offset:4096
    v_mfma_f32_16x16x32_bf16 v[152:155], v[36:39], a[148:151], v[152:155]
    ds_read_b64_tr_b16 v[26:27], v94 offset:4608
    v_mfma_f32_16x16x32_bf16 v[140:143], v[32:35], a[212:215], v[140:143]
    ds_read_b64_tr_b16 v[28:29], v95 offset:4096
    v_mfma_f32_16x16x32_bf16 v[156:159], v[36:39], a[212:215], v[156:159]
    ds_read_b64_tr_b16 v[30:31], v95 offset:4608
    v_mfma_f32_16x16x32_bf16 v[172:175], v[40:43], a[212:215], v[172:175]
    v_xor_b32 v89, 6208, v88
    ds_read_b128 a[28:31], v89 offset:0
    v_mfma_f32_16x16x32_bf16 v[188:191], v[44:47], a[212:215], v[188:191]
    s_add_u32 m0, s6, 0
    s_xor_b32 s7, s3, 656384
    buffer_load_dwordx4 v80, s[96:99], s7 offen offset:0 lds
    v_mfma_f32_16x16x32_bf16 v[168:171], v[40:43], a[148:151], v[168:171]
    ds_read_b128 a[92:95], v89 offset:16384
    v_mfma_f32_16x16x32_bf16 v[184:187], v[44:47], a[148:151], v[184:187]
    buffer_load_dwordx4 v81, s[96:99], s7 offen offset:1024 lds
    v_mfma_f32_16x16x32_bf16 v[164:167], v[40:43], a[84:87], v[164:167]
    ds_read_b128 a[156:159], v89 offset:32768
    v_mfma_f32_16x16x32_bf16 v[180:183], v[44:47], a[84:87], v[180:183]
    buffer_load_dwordx4 v82, s[96:99], s7 offen offset:2048 lds
    v_mfma_f32_16x16x32_bf16 v[160:163], v[40:43], a[20:23], v[160:163]
    s_waitcnt lgkmcnt(14)
    ds_read_b128 a[220:223], v89 offset:49152
    v_mfma_f32_16x16x32_bf16 v[176:179], v[44:47], a[20:23], v[176:179]
    buffer_load_dwordx4 v83, s[96:99], s7 offen offset:3072 lds
    s_waitcnt lgkmcnt(4)
    v_mfma_f32_16x16x32_bf16 v[128:131], v[16:19], a[24:27], v[128:131]
    s_waitcnt vmcnt(12)
    ds_read_b64_tr_b16 v[32:33], v92 offset:8192
    v_mfma_f32_16x16x32_bf16 v[144:147], v[20:23], a[24:27], v[144:147]
    ds_read_b64_tr_b16 v[34:35], v92 offset:8704
    v_mfma_f32_16x16x32_bf16 v[132:135], v[16:19], a[88:91], v[132:135]
    ds_read_b64_tr_b16 v[36:37], v93 offset:8192
    v_mfma_f32_16x16x32_bf16 v[148:151], v[20:23], a[88:91], v[148:151]
    ds_read_b64_tr_b16 v[38:39], v93 offset:8704
    v_mfma_f32_16x16x32_bf16 v[136:139], v[16:19], a[152:155], v[136:139]
    ds_read_b64_tr_b16 v[40:41], v94 offset:8192
    v_mfma_f32_16x16x32_bf16 v[152:155], v[20:23], a[152:155], v[152:155]
    ds_read_b64_tr_b16 v[42:43], v94 offset:8704
    v_mfma_f32_16x16x32_bf16 v[140:143], v[16:19], a[216:219], v[140:143]
    ds_read_b64_tr_b16 v[44:45], v95 offset:8192
    v_mfma_f32_16x16x32_bf16 v[156:159], v[20:23], a[216:219], v[156:159]
    ds_read_b64_tr_b16 v[46:47], v95 offset:8704
    v_mfma_f32_16x16x32_bf16 v[172:175], v[24:27], a[216:219], v[172:175]
    v_xor_b32 v89, 8192, v88
    ds_read_b128 a[32:35], v89 offset:0
    v_mfma_f32_16x16x32_bf16 v[188:191], v[28:31], a[216:219], v[188:191]
    s_add_u32 m0, s6, 4096
    s_xor_b32 s7, s3, 721920
    buffer_load_dwordx4 v80, s[96:99], s7 offen offset:0 lds
    v_mfma_f32_16x16x32_bf16 v[168:171], v[24:27], a[152:155], v[168:171]
    ds_read_b128 a[96:99], v89 offset:16384
    v_mfma_f32_16x16x32_bf16 v[184:187], v[28:31], a[152:155], v[184:187]
    buffer_load_dwordx4 v81, s[96:99], s7 offen offset:1024 lds
    v_mfma_f32_16x16x32_bf16 v[164:167], v[24:27], a[88:91], v[164:167]
    ds_read_b128 a[160:163], v89 offset:32768
    v_mfma_f32_16x16x32_bf16 v[180:183], v[28:31], a[88:91], v[180:183]
    buffer_load_dwordx4 v82, s[96:99], s7 offen offset:2048 lds
    v_mfma_f32_16x16x32_bf16 v[160:163], v[24:27], a[24:27], v[160:163]
    s_waitcnt lgkmcnt(14)
    ds_read_b128 a[224:227], v89 offset:49152
    v_mfma_f32_16x16x32_bf16 v[176:179], v[28:31], a[24:27], v[176:179]
    buffer_load_dwordx4 v83, s[96:99], s7 offen offset:3072 lds
    s_waitcnt lgkmcnt(4)
    v_mfma_f32_16x16x32_bf16 v[128:131], v[32:35], a[28:31], v[128:131]
    s_waitcnt vmcnt(12)
    ds_read_b64_tr_b16 v[16:17], v92 offset:12288
    v_mfma_f32_16x16x32_bf16 v[144:147], v[36:39], a[28:31], v[144:147]
    ds_read_b64_tr_b16 v[18:19], v92 offset:12800
    v_mfma_f32_16x16x32_bf16 v[132:135], v[32:35], a[92:95], v[132:135]
    ds_read_b64_tr_b16 v[20:21], v93 offset:12288
    v_mfma_f32_16x16x32_bf16 v[148:151], v[36:39], a[92:95], v[148:151]
    ds_read_b64_tr_b16 v[22:23], v93 offset:12800
    v_mfma_f32_16x16x32_bf16 v[136:139], v[32:35], a[156:159], v[136:139]
    ds_read_b64_tr_b16 v[24:25], v94 offset:12288
    v_mfma_f32_16x16x32_bf16 v[152:155], v[36:39], a[156:159], v[152:155]
    ds_read_b64_tr_b16 v[26:27], v94 offset:12800
    v_mfma_f32_16x16x32_bf16 v[140:143], v[32:35], a[220:223], v[140:143]
    ds_read_b64_tr_b16 v[28:29], v95 offset:12288
    v_mfma_f32_16x16x32_bf16 v[156:159], v[36:39], a[220:223], v[156:159]
    ds_read_b64_tr_b16 v[30:31], v95 offset:12800
    v_mfma_f32_16x16x32_bf16 v[172:175], v[40:43], a[220:223], v[172:175]
    v_xor_b32 v89, 8256, v88
    ds_read_b128 a[36:39], v89 offset:0
    v_mfma_f32_16x16x32_bf16 v[188:191], v[44:47], a[220:223], v[188:191]
    s_add_u32 m0, s6, 8192
    s_xor_b32 s7, s3, 787456
    buffer_load_dwordx4 v80, s[96:99], s7 offen offset:0 lds
    v_mfma_f32_16x16x32_bf16 v[168:171], v[40:43], a[156:159], v[168:171]
    ds_read_b128 a[100:103], v89 offset:16384
    v_mfma_f32_16x16x32_bf16 v[184:187], v[44:47], a[156:159], v[184:187]
    buffer_load_dwordx4 v81, s[96:99], s7 offen offset:1024 lds
    v_mfma_f32_16x16x32_bf16 v[164:167], v[40:43], a[92:95], v[164:167]
    ds_read_b128 a[164:167], v89 offset:32768
    v_mfma_f32_16x16x32_bf16 v[180:183], v[44:47], a[92:95], v[180:183]
    buffer_load_dwordx4 v82, s[96:99], s7 offen offset:2048 lds
    v_mfma_f32_16x16x32_bf16 v[160:163], v[40:43], a[28:31], v[160:163]
    s_waitcnt lgkmcnt(14)
    ds_read_b128 a[228:231], v89 offset:49152
    v_mfma_f32_16x16x32_bf16 v[176:179], v[44:47], a[28:31], v[176:179]
    buffer_load_dwordx4 v83, s[96:99], s7 offen offset:3072 lds
    s_waitcnt lgkmcnt(4)
    v_mfma_f32_16x16x32_bf16 v[128:131], v[16:19], a[32:35], v[128:131]
    s_waitcnt vmcnt(12)
    ds_read_b64_tr_b16 v[32:33], v92 offset:16384
    v_mfma_f32_16x16x32_bf16 v[144:147], v[20:23], a[32:35], v[144:147]
    ds_read_b64_tr_b16 v[34:35], v92 offset:16896
    v_mfma_f32_16x16x32_bf16 v[132:135], v[16:19], a[96:99], v[132:135]
    ds_read_b64_tr_b16 v[36:37], v93 offset:16384
    v_mfma_f32_16x16x32_bf16 v[148:151], v[20:23], a[96:99], v[148:151]
    ds_read_b64_tr_b16 v[38:39], v93 offset:16896
    v_mfma_f32_16x16x32_bf16 v[136:139], v[16:19], a[160:163], v[136:139]
    ds_read_b64_tr_b16 v[40:41], v94 offset:16384
    v_mfma_f32_16x16x32_bf16 v[152:155], v[20:23], a[160:163], v[152:155]
    ds_read_b64_tr_b16 v[42:43], v94 offset:16896
    v_mfma_f32_16x16x32_bf16 v[140:143], v[16:19], a[224:227], v[140:143]
    ds_read_b64_tr_b16 v[44:45], v95 offset:16384
    v_mfma_f32_16x16x32_bf16 v[156:159], v[20:23], a[224:227], v[156:159]
    ds_read_b64_tr_b16 v[46:47], v95 offset:16896
    v_mfma_f32_16x16x32_bf16 v[172:175], v[24:27], a[224:227], v[172:175]
    v_xor_b32 v89, 10240, v88
    ds_read_b128 a[40:43], v89 offset:0
    buffer_load_dword v14, v12, s[92:95], 0 offen offset:0 sc1
    v_mfma_f32_16x16x32_bf16 v[188:191], v[28:31], a[224:227], v[188:191]
    s_add_u32 m0, s6, 12288
    s_xor_b32 s7, s3, 852992
    buffer_load_dwordx4 v80, s[96:99], s7 offen offset:0 lds
    v_mfma_f32_16x16x32_bf16 v[168:171], v[24:27], a[160:163], v[168:171]
    ds_read_b128 a[104:107], v89 offset:16384
    v_mfma_f32_16x16x32_bf16 v[184:187], v[28:31], a[160:163], v[184:187]
    buffer_load_dwordx4 v81, s[96:99], s7 offen offset:1024 lds
    v_mfma_f32_16x16x32_bf16 v[164:167], v[24:27], a[96:99], v[164:167]
    ds_read_b128 a[168:171], v89 offset:32768
    v_mfma_f32_16x16x32_bf16 v[180:183], v[28:31], a[96:99], v[180:183]
    buffer_load_dwordx4 v82, s[96:99], s7 offen offset:2048 lds
    v_mfma_f32_16x16x32_bf16 v[160:163], v[24:27], a[32:35], v[160:163]
    s_waitcnt lgkmcnt(14)
    ds_read_b128 a[232:235], v89 offset:49152
    v_mfma_f32_16x16x32_bf16 v[176:179], v[28:31], a[32:35], v[176:179]
    buffer_load_dwordx4 v83, s[96:99], s7 offen offset:3072 lds
    s_waitcnt lgkmcnt(4)
    v_mfma_f32_16x16x32_bf16 v[128:131], v[32:35], a[36:39], v[128:131]
    s_waitcnt vmcnt(13)
    ds_read_b64_tr_b16 v[16:17], v92 offset:0
    v_mfma_f32_16x16x32_bf16 v[144:147], v[36:39], a[36:39], v[144:147]
    ds_read_b64_tr_b16 v[18:19], v92 offset:512
    v_mfma_f32_16x16x32_bf16 v[132:135], v[32:35], a[100:103], v[132:135]
    ds_read_b64_tr_b16 v[20:21], v93 offset:0
    v_mfma_f32_16x16x32_bf16 v[148:151], v[36:39], a[100:103], v[148:151]
    ds_read_b64_tr_b16 v[22:23], v93 offset:512
    v_mfma_f32_16x16x32_bf16 v[136:139], v[32:35], a[164:167], v[136:139]
    ds_read_b64_tr_b16 v[24:25], v94 offset:0
    v_mfma_f32_16x16x32_bf16 v[152:155], v[36:39], a[164:167], v[152:155]
    ds_read_b64_tr_b16 v[26:27], v94 offset:512
    v_mfma_f32_16x16x32_bf16 v[140:143], v[32:35], a[228:231], v[140:143]
    ds_read_b64_tr_b16 v[28:29], v95 offset:0
    v_mfma_f32_16x16x32_bf16 v[156:159], v[36:39], a[228:231], v[156:159]
    ds_read_b64_tr_b16 v[30:31], v95 offset:512
    v_mfma_f32_16x16x32_bf16 v[172:175], v[40:43], a[228:231], v[172:175]
    v_xor_b32 v89, 10304, v88
    ds_read_b128 a[44:47], v89 offset:0
    v_mfma_f32_16x16x32_bf16 v[188:191], v[44:47], a[228:231], v[188:191]
    s_add_u32 m0, s6, 16384
    s_xor_b32 s7, s3, 918528
    buffer_load_dwordx4 v80, s[96:99], s7 offen offset:0 lds
    v_mfma_f32_16x16x32_bf16 v[168:171], v[40:43], a[164:167], v[168:171]
    ds_read_b128 a[108:111], v89 offset:16384
    v_mfma_f32_16x16x32_bf16 v[184:187], v[44:47], a[164:167], v[184:187]
    buffer_load_dwordx4 v81, s[96:99], s7 offen offset:1024 lds
    v_mfma_f32_16x16x32_bf16 v[164:167], v[40:43], a[100:103], v[164:167]
    ds_read_b128 a[172:175], v89 offset:32768
    v_mfma_f32_16x16x32_bf16 v[180:183], v[44:47], a[100:103], v[180:183]
    buffer_load_dwordx4 v82, s[96:99], s7 offen offset:2048 lds
    v_mfma_f32_16x16x32_bf16 v[160:163], v[40:43], a[36:39], v[160:163]
    s_waitcnt lgkmcnt(14)
    ds_read_b128 a[236:239], v89 offset:49152
    v_mfma_f32_16x16x32_bf16 v[176:179], v[44:47], a[36:39], v[176:179]
    buffer_load_dwordx4 v83, s[96:99], s7 offen offset:3072 lds
    s_waitcnt lgkmcnt(4)
    v_mfma_f32_16x16x32_bf16 v[128:131], v[16:19], a[40:43], v[128:131]
    s_waitcnt vmcnt(13)
    ds_read_b64_tr_b16 v[32:33], v92 offset:4096
    v_mfma_f32_16x16x32_bf16 v[144:147], v[20:23], a[40:43], v[144:147]
    ds_read_b64_tr_b16 v[34:35], v92 offset:4608
    v_mfma_f32_16x16x32_bf16 v[132:135], v[16:19], a[104:107], v[132:135]
    ds_read_b64_tr_b16 v[36:37], v93 offset:4096
    v_mfma_f32_16x16x32_bf16 v[148:151], v[20:23], a[104:107], v[148:151]
    ds_read_b64_tr_b16 v[38:39], v93 offset:4608
    v_mfma_f32_16x16x32_bf16 v[136:139], v[16:19], a[168:171], v[136:139]
    ds_read_b64_tr_b16 v[40:41], v94 offset:4096
    v_mfma_f32_16x16x32_bf16 v[152:155], v[20:23], a[168:171], v[152:155]
    ds_read_b64_tr_b16 v[42:43], v94 offset:4608
    v_mfma_f32_16x16x32_bf16 v[140:143], v[16:19], a[232:235], v[140:143]
    ds_read_b64_tr_b16 v[44:45], v95 offset:4096
    v_mfma_f32_16x16x32_bf16 v[156:159], v[20:23], a[232:235], v[156:159]
    ds_read_b64_tr_b16 v[46:47], v95 offset:4608
    v_mfma_f32_16x16x32_bf16 v[172:175], v[24:27], a[232:235], v[172:175]
    v_xor_b32 v89, 12288, v88
    ds_read_b128 a[48:51], v89 offset:0
    v_mfma_f32_16x16x32_bf16 v[188:191], v[28:31], a[232:235], v[188:191]
    s_add_u32 m0, s6, 0
    s_xor_b32 s7, s3, 984064
    buffer_load_dwordx4 v80, s[96:99], s7 offen offset:0 lds
    v_mfma_f32_16x16x32_bf16 v[168:171], v[24:27], a[168:171], v[168:171]
    ds_read_b128 a[112:115], v89 offset:16384
    v_mfma_f32_16x16x32_bf16 v[184:187], v[28:31], a[168:171], v[184:187]
    buffer_load_dwordx4 v81, s[96:99], s7 offen offset:1024 lds
    v_mfma_f32_16x16x32_bf16 v[164:167], v[24:27], a[104:107], v[164:167]
    ds_read_b128 a[176:179], v89 offset:32768
    v_mfma_f32_16x16x32_bf16 v[180:183], v[28:31], a[104:107], v[180:183]
    buffer_load_dwordx4 v82, s[96:99], s7 offen offset:2048 lds
    v_mfma_f32_16x16x32_bf16 v[160:163], v[24:27], a[40:43], v[160:163]
    s_waitcnt lgkmcnt(14)
    ds_read_b128 a[240:243], v89 offset:49152
    v_mfma_f32_16x16x32_bf16 v[176:179], v[28:31], a[40:43], v[176:179]
    buffer_load_dwordx4 v83, s[96:99], s7 offen offset:3072 lds
    s_cmp_ge_u32 s16, 2
    s_cbranch_scc1 L_fpv
    s_waitcnt lgkmcnt(4)
    v_mfma_f32_16x16x32_bf16 v[128:131], v[32:35], a[44:47], v[128:131]
    s_waitcnt vmcnt(13)
    ds_read_b64_tr_b16 v[16:17], v92 offset:8192
    v_mfma_f32_16x16x32_bf16 v[144:147], v[36:39], a[44:47], v[144:147]
    ds_read_b64_tr_b16 v[18:19], v92 offset:8704
    v_mfma_f32_16x16x32_bf16 v[132:135], v[32:35], a[108:111], v[132:135]
    ds_read_b64_tr_b16 v[20:21], v93 offset:8192
    v_mfma_f32_16x16x32_bf16 v[148:151], v[36:39], a[108:111], v[148:151]
    ds_read_b64_tr_b16 v[22:23], v93 offset:8704
    v_mfma_f32_16x16x32_bf16 v[136:139], v[32:35], a[172:175], v[136:139]
    ds_read_b64_tr_b16 v[24:25], v94 offset:8192
    v_mfma_f32_16x16x32_bf16 v[152:155], v[36:39], a[172:175], v[152:155]
    ds_read_b64_tr_b16 v[26:27], v94 offset:8704
    v_mfma_f32_16x16x32_bf16 v[140:143], v[32:35], a[236:239], v[140:143]
    ds_read_b64_tr_b16 v[28:29], v95 offset:8192
    v_mfma_f32_16x16x32_bf16 v[156:159], v[36:39], a[236:239], v[156:159]
    ds_read_b64_tr_b16 v[30:31], v95 offset:8704
    v_mfma_f32_16x16x32_bf16 v[172:175], v[40:43], a[236:239], v[172:175]
    v_xor_b32 v89, 12352, v88
    ds_read_b128 a[52:55], v89 offset:0
    s_waitcnt vmcnt(12)
    s_cmp_lg_u32 s16, 1
    s_cbranch_scc1 L_c1_ok
    v_cmp_le_u32 vcc, 64, v14
    s_nop 1
    s_cmp_eq_u64 vcc, -1
    s_cbranch_scc0 L_c1_retry
L_c1_ok:
    s_barrier
    s_lshl_b32 s26, s22, 1
    s_add_u32 s26, s26, s16
    s_lshl_b32 s20, s26, 17
    s_lshr_b32 s28, s3, 16
    s_lshl_b32 s28, s28, 12
    s_add_u32 s20, s20, s28
    s_add_u32 s20, s20, 59768832
    v_mfma_f32_16x16x32_bf16 v[188:191], v[44:47], a[236:239], v[188:191]
    v_mfma_f32_16x16x32_bf16 v[168:171], v[40:43], a[172:175], v[168:171]
    ds_read_b128 a[116:119], v89 offset:16384
    s_xor_b32 s26, s31, 1
    s_lshl_b32 s26, s26, 7
    s_add_u32 s26, s26, 58982448
    buffer_load_dword v1, off, s[12:15], s26 sc1
    v_mfma_f32_16x16x32_bf16 v[184:187], v[44:47], a[172:175], v[184:187]
    s_xor_b32 s28, s19, 1024
    buffer_store_dwordx4 a[4:7], v90, s[8:11], s28 offen sc1
    v_mfma_f32_16x16x32_bf16 v[164:167], v[40:43], a[108:111], v[164:167]
    ds_read_b128 a[180:183], v89 offset:32768
    v_mfma_f32_16x16x32_bf16 v[180:183], v[44:47], a[108:111], v[180:183]
    v_mfma_f32_16x16x32_bf16 v[160:163], v[40:43], a[44:47], v[160:163]
    s_waitcnt lgkmcnt(14)
    ds_read_b128 a[244:247], v89 offset:49152
    s_xor_b32 s28, s19, 0
    buffer_store_dwordx4 a[0:3], v90, s[8:11], s28 offen sc1
    v_mfma_f32_16x16x32_bf16 v[176:179], v[44:47], a[44:47], v[176:179]
    s_waitcnt lgkmcnt(4)
    v_mfma_f32_16x16x32_bf16 v[128:131], v[16:19], a[48:51], v[128:131]
    s_waitcnt vmcnt(11)
    ds_read_b64_tr_b16 v[32:33], v92 offset:12288
    v_mfma_f32_16x16x32_bf16 v[144:147], v[20:23], a[48:51], v[144:147]
    ds_read_b64_tr_b16 v[34:35], v92 offset:12800
    v_mfma_f32_16x16x32_bf16 v[132:135], v[16:19], a[112:115], v[132:135]
    ds_read_b64_tr_b16 v[36:37], v93 offset:12288
    v_mfma_f32_16x16x32_bf16 v[148:151], v[20:23], a[112:115], v[148:151]
    ds_read_b64_tr_b16 v[38:39], v93 offset:12800
    v_mfma_f32_16x16x32_bf16 v[136:139], v[16:19], a[176:179], v[136:139]
    ds_read_b64_tr_b16 v[40:41], v94 offset:12288
    v_mfma_f32_16x16x32_bf16 v[152:155], v[20:23], a[176:179], v[152:155]
    ds_read_b64_tr_b16 v[42:43], v94 offset:12800
    v_mfma_f32_16x16x32_bf16 v[140:143], v[16:19], a[240:243], v[140:143]
    ds_read_b64_tr_b16 v[44:45], v95 offset:12288
    v_mfma_f32_16x16x32_bf16 v[156:159], v[20:23], a[240:243], v[156:159]
    ds_read_b64_tr_b16 v[46:47], v95 offset:12800
    v_mfma_f32_16x16x32_bf16 v[172:175], v[24:27], a[240:243], v[172:175]
    v_xor_b32 v89, 14336, v88
    ds_read_b128 a[56:59], v89 offset:0
    v_mfma_f32_16x16x32_bf16 v[188:191], v[28:31], a[240:243], v[188:191]
    s_xor_b32 s42, s20, 0
    buffer_load_dwordx4 v[48:51], v3, s[12:15], s42 offen offset:0 sc1
    v_mfma_f32_16x16x32_bf16 v[168:171], v[24:27], a[176:179], v[168:171]
    ds_read_b128 a[120:123], v89 offset:16384
    v_mfma_f32_16x16x32_bf16 v[184:187], v[28:31], a[176:179], v[184:187]
    buffer_load_dwordx4 v[52:55], v3, s[12:15], s42 offen offset:1024 sc1
    v_mfma_f32_16x16x32_bf16 v[164:167], v[24:27], a[112:115], v[164:167]
    ds_read_b128 a[184:187], v89 offset:32768
    v_mfma_f32_16x16x32_bf16 v[180:183], v[28:31], a[112:115], v[180:183]
    buffer_load_dwordx4 v[56:59], v3, s[12:15], s42 offen offset:2048 sc1
    v_mfma_f32_16x16x32_bf16 v[160:163], v[24:27], a[48:51], v[160:163]
    s_waitcnt lgkmcnt(14)
    ds_read_b128 a[248:251], v89 offset:49152
    s_xor_b32 s28, s19, 2048
    buffer_store_dwordx4 a[8:11], v90, s[8:11], s28 offen sc1
    v_mfma_f32_16x16x32_bf16 v[176:179], v[28:31], a[48:51], v[176:179]
    buffer_load_dwordx4 v[60:63], v3, s[12:15], s42 offen offset:3072 sc1
    s_waitcnt lgkmcnt(4)
    v_mfma_f32_16x16x32_bf16 v[128:131], v[32:35], a[52:55], v[128:131]
    s_waitcnt vmcnt(12)
    ds_read_b64_tr_b16 v[16:17], v92 offset:16384
    v_mfma_f32_16x16x32_bf16 v[144:147], v[36:39], a[52:55], v[144:147]
    ds_read_b64_tr_b16 v[18:19], v92 offset:16896
    v_mfma_f32_16x16x32_bf16 v[132:135], v[32:35], a[116:119], v[132:135]
    ds_read_b64_tr_b16 v[20:21], v93 offset:16384
    v_mfma_f32_16x16x32_bf16 v[148:151], v[36:39], a[116:119], v[148:151]
    ds_read_b64_tr_b16 v[22:23], v93 offset:16896
    v_mfma_f32_16x16x32_bf16 v[136:139], v[32:35], a[180:183], v[136:139]
    ds_read_b64_tr_b16 v[24:25], v94 offset:16384
    v_mfma_f32_16x16x32_bf16 v[152:155], v[36:39], a[180:183], v[152:155]
    ds_read_b64_tr_b16 v[26:27], v94 offset:16896
    v_mfma_f32_16x16x32_bf16 v[140:143], v[32:35], a[244:247], v[140:143]
    ds_read_b64_tr_b16 v[28:29], v95 offset:16384
    v_mfma_f32_16x16x32_bf16 v[156:159], v[36:39], a[244:247], v[156:159]
    ds_read_b64_tr_b16 v[30:31], v95 offset:16896
    v_mfma_f32_16x16x32_bf16 v[172:175], v[40:43], a[244:247], v[172:175]
    v_xor_b32 v89, 14400, v88
    ds_read_b128 a[60:63], v89 offset:0
    v_mfma_f32_16x16x32_bf16 v[188:191], v[44:47], a[244:247], v[188:191]
    s_xor_b32 s42, s20, 4096
    buffer_load_dwordx4 v[64:67], v3, s[12:15], s42 offen offset:0 sc1
    v_mfma_f32_16x16x32_bf16 v[168:171], v[40:43], a[180:183], v[168:171]
    ds_read_b128 a[124:127], v89 offset:16384
    v_mfma_f32_16x16x32_bf16 v[184:187], v[44:47], a[180:183], v[184:187]
    buffer_load_dwordx4 v[68:71], v3, s[12:15], s42 offen offset:1024 sc1
    v_mfma_f32_16x16x32_bf16 v[164:167], v[40:43], a[116:119], v[164:167]
    ds_read_b128 a[188:191], v89 offset:32768
    v_mfma_f32_16x16x32_bf16 v[180:183], v[44:47], a[116:119], v[180:183]
    buffer_load_dwordx4 v[72:75], v3, s[12:15], s42 offen offset:2048 sc1
    v_mfma_f32_16x16x32_bf16 v[160:163], v[40:43], a[52:55], v[160:163]
    s_waitcnt lgkmcnt(14)
    ds_read_b128 a[252:255], v89 offset:49152
    s_xor_b32 s28, s19, 3072
    buffer_store_dwordx4 a[12:15], v90, s[8:11], s28 offen sc1
    v_mfma_f32_16x16x32_bf16 v[176:179], v[44:47], a[52:55], v[176:179]
    buffer_load_dwordx4 v[76:79], v3, s[12:15], s42 offen offset:3072 sc1
    s_waitcnt lgkmcnt(4)
    v_mfma_f32_16x16x32_bf16 v[128:131], v[16:19], a[56:59], v[128:131]
    s_waitcnt vmcnt(13)
    ds_read_b64_tr_b16 v[32:33], v92 offset:0
    v_mfma_f32_16x16x32_bf16 v[144:147], v[20:23], a[56:59], v[144:147]
    ds_read_b64_tr_b16 v[34:35], v92 offset:512
    v_mfma_f32_16x16x32_bf16 v[132:135], v[16:19], a[120:123], v[132:135]
    ds_read_b64_tr_b16 v[36:37], v93 offset:0
    v_mfma_f32_16x16x32_bf16 v[148:151], v[20:23], a[120:123], v[148:151]
    ds_read_b64_tr_b16 v[38:39], v93 offset:512
    v_mfma_f32_16x16x32_bf16 v[136:139], v[16:19], a[184:187], v[136:139]
    ds_read_b64_tr_b16 v[40:41], v94 offset:0
    v_mfma_f32_16x16x32_bf16 v[152:155], v[20:23], a[184:187], v[152:155]
    ds_read_b64_tr_b16 v[42:43], v94 offset:512
    v_mfma_f32_16x16x32_bf16 v[140:143], v[16:19], a[248:251], v[140:143]
    ds_read_b64_tr_b16 v[44:45], v95 offset:0
    v_mfma_f32_16x16x32_bf16 v[156:159], v[20:23], a[248:251], v[156:159]
    ds_read_b64_tr_b16 v[46:47], v95 offset:512
    v_mfma_f32_16x16x32_bf16 v[172:175], v[24:27], a[248:251], v[172:175]
    v_mfma_f32_16x16x32_bf16 v[188:191], v[28:31], a[248:251], v[188:191]
    s_xor_b32 s42, s20, 8192
    buffer_load_dwordx4 v[96:99], v3, s[12:15], s42 offen offset:0 sc1
    v_mfma_f32_16x16x32_bf16 v[168:171], v[24:27], a[184:187], v[168:171]
    v_mfma_f32_16x16x32_bf16 v[184:187], v[28:31], a[184:187], v[184:187]
    buffer_load_dwordx4 v[100:103], v3, s[12:15], s42 offen offset:1024 sc1
    v_mfma_f32_16x16x32_bf16 v[164:167], v[24:27], a[120:123], v[164:167]
    v_mfma_f32_16x16x32_bf16 v[180:183], v[28:31], a[120:123], v[180:183]
    buffer_load_dwordx4 v[104:107], v3, s[12:15], s42 offen offset:2048 sc1
    v_mfma_f32_16x16x32_bf16 v[160:163], v[24:27], a[56:59], v[160:163]
    s_xor_b32 s28, s19, 16384
    buffer_store_dwordx4 a[64:67], v90, s[8:11], s28 offen sc1
    v_mfma_f32_16x16x32_bf16 v[176:179], v[28:31], a[56:59], v[176:179]
    buffer_load_dwordx4 v[108:111], v3, s[12:15], s42 offen offset:3072 sc1
    s_waitcnt lgkmcnt(0)
    v_mfma_f32_16x16x32_bf16 v[128:131], v[32:35], a[60:63], v[128:131]
    s_lshl_b32 s40, s31, 1
    v_mfma_f32_16x16x32_bf16 v[144:147], v[36:39], a[60:63], v[144:147]
    s_add_u32 s40, s40, s16
    v_mfma_f32_16x16x32_bf16 v[132:135], v[32:35], a[124:127], v[132:135]
    s_lshl_b32 s40, s40, 14
    v_mfma_f32_16x16x32_bf16 v[148:151], v[36:39], a[124:127], v[148:151]
    s_add_u32 s40, s40, 8388608
    v_mfma_f32_16x16x32_bf16 v[136:139], v[32:35], a[188:191], v[136:139]
    s_lshl_b32 s41, s31, 5
    v_mfma_f32_16x16x32_bf16 v[152:155], v[36:39], a[188:191], v[152:155]
    s_add_u32 s41, s41, s16
    v_mfma_f32_16x16x32_bf16 v[140:143], v[32:35], a[252:255], v[140:143]
    s_lshl_b32 s41, s41, 2
    v_mfma_f32_16x16x32_bf16 v[156:159], v[36:39], a[252:255], v[156:159]
    s_add_u32 s41, s41, 58982416
    v_mfma_f32_16x16x32_bf16 v[172:175], v[40:43], a[252:255], v[172:175]
    s_waitcnt vmcnt(17)
    v_readfirstlane_b32 s26, v1
    s_getreg_b32 s21, hwreg(HW_REG_XCC_ID, 0, 4)
    s_xor_b32 s21, s21, s26
    s_barrier
    v_mfma_f32_16x16x32_bf16 v[188:191], v[44:47], a[252:255], v[188:191]
    s_xor_b32 s42, s20, 12288
    buffer_load_dwordx4 v[16:19], v3, s[12:15], s42 offen offset:0 sc1
    v_mfma_f32_16x16x32_bf16 v[168:171], v[40:43], a[188:191], v[168:171]
    v_mfma_f32_16x16x32_bf16 v[184:187], v[44:47], a[188:191], v[184:187]
    buffer_load_dwordx4 v[20:23], v3, s[12:15], s42 offen offset:1024 sc1
    v_mfma_f32_16x16x32_bf16 v[164:167], v[40:43], a[124:127], v[164:167]
    v_mfma_f32_16x16x32_bf16 v[180:183], v[44:47], a[124:127], v[180:183]
    buffer_load_dwordx4 v[24:27], v3, s[12:15], s42 offen offset:2048 sc1
    v_mfma_f32_16x16x32_bf16 v[160:163], v[40:43], a[60:63], v[160:163]
    s_xor_b32 s28, s19, 17408
    buffer_store_dwordx4 a[68:71], v90, s[8:11], s28 offen sc1
    v_mfma_f32_16x16x32_bf16 v[176:179], v[44:47], a[60:63], v[176:179]
    buffer_load_dwordx4 v[28:31], v3, s[12:15], s42 offen offset:3072 sc1
    s_waitcnt vmcnt(15)
    v_mfma_f32_16x16x32_bf16 v[192:195], v[48:51], a[0:3], 0
    v_mfma_f32_16x16x32_bf16 v[208:211], v[52:55], a[0:3], 0
    s_xor_b32 s42, s20, 16384
    buffer_load_dwordx4 v[32:35], v3, s[12:15], s42 offen offset:0 sc1
    v_mfma_f32_16x16x32_bf16 v[196:199], v[48:51], a[64:67], 0
    v_mfma_f32_16x16x32_bf16 v[212:215], v[52:55], a[64:67], 0
    s_xor_b32 s28, s19, 18432
    buffer_store_dwordx4 a[72:75], v90, s[8:11], s28 offen sc1
    v_mfma_f32_16x16x32_bf16 v[200:203], v[48:51], a[128:131], 0
    v_mfma_f32_16x16x32_bf16 v[216:219], v[52:55], a[128:131], 0
    buffer_load_dwordx4 v[36:39], v3, s[12:15], s42 offen offset:1024 sc1
    v_mfma_f32_16x16x32_bf16 v[204:207], v[48:51], a[192:195], 0
    v_mfma_f32_16x16x32_bf16 v[220:223], v[52:55], a[192:195], 0
    v_mfma_f32_16x16x32_bf16 v[236:239], v[56:59], a[192:195], 0
    v_mfma_f32_16x16x32_bf16 v[252:255], v[60:63], a[192:195], 0
    buffer_load_dwordx4 v[40:43], v3, s[12:15], s42 offen offset:2048 sc1
    v_mfma_f32_16x16x32_bf16 v[232:235], v[56:59], a[128:131], 0
    s_lshl_b32 s26, s16, 2
    v_mfma_f32_16x16x32_bf16 v[248:251], v[60:63], a[128:131], 0
    s_xor_b32 s28, s19, 19456
    buffer_store_dwordx4 a[76:79], v90, s[8:11], s28 offen sc1
    s_add_u32 s26, s26, s22
    v_mfma_f32_16x16x32_bf16 v[228:231], v[56:59], a[64:67], 0
    s_lshl_b32 s26, s26, 13
    s_add_u32 s18, s26, 98304
    v_mfma_f32_16x16x32_bf16 v[244:247], v[60:63], a[64:67], 0
    buffer_load_dwordx4 v[44:47], v3, s[12:15], s42 offen offset:3072 sc1
    v_add_u32 v87, s18, v3
    v_mfma_f32_16x16x32_bf16 v[224:227], v[56:59], a[0:3], 0
    s_xor_b32 s18, s18, 0x2000
    v_mfma_f32_16x16x32_bf16 v[240:243], v[60:63], a[0:3], 0
    s_add_u32 s7, s40, 4096
    s_xor_b32 s6, s41, 128
    s_waitcnt vmcnt(16)
    v_mfma_f32_16x16x32_bf16 v[192:195], v[64:67], a[4:7], v[192:195]
    v_mov_b32 v12, 1
    s_cmp_eq_u32 s21, 0
    s_cselect_b32 s46, s14, 0
    s_mov_b64 s[44:45], s[12:13]
    v_mfma_f32_16x16x32_bf16 v[208:211], v[68:71], a[4:7], v[208:211]
    s_xor_b32 s42, s20, 20480
    buffer_load_dwordx4 v[48:51], v3, s[12:15], s42 offen offset:0 sc1
    v_fma_f32 v112, -v128, v128, s0
    v_mfma_f32_16x16x32_bf16 v[196:199], v[64:67], a[68:71], v[196:199]
    v_fma_f32 v113, -v129, v129, s0
    v_fma_f32 v114, -v130, v130, s0
    v_mfma_f32_16x16x32_bf16 v[212:215], v[68:71], a[68:71], v[212:215]
    s_xor_b32 s28, s19, 32768
    buffer_store_dwordx4 a[128:131], v90, s[8:11], s28 offen sc1
    v_mfma_f32_16x16x32_bf16 v[200:203], v[64:67], a[132:135], v[200:203]
    v_fma_f32 v115, -v131, v131, s0
    v_fma_f32 v116, -v144, v144, s0
    v_mfma_f32_16x16x32_bf16 v[216:219], v[68:71], a[132:135], v[216:219]
    buffer_load_dwordx4 v[52:55], v3, s[12:15], s42 offen offset:1024 sc1
    v_fma_f32 v117, -v145, v145, s0
    v_mfma_f32_16x16x32_bf16 v[204:207], v[64:67], a[196:199], v[204:207]
    v_fma_f32 v118, -v146, v146, s0
    v_fma_f32 v119, -v147, v147, s0
    v_mfma_f32_16x16x32_bf16 v[220:223], v[68:71], a[196:199], v[220:223]
    v_mul_f32 v112, v112, v128
    v_mul_f32 v113, v113, v129
    v_mfma_f32_16x16x32_bf16 v[236:239], v[72:75], a[196:199], v[236:239]
    v_mul_f32 v114, v114, v130
    v_mfma_f32_16x16x32_bf16 v[252:255], v[76:79], a[196:199], v[252:255]
    buffer_load_dwordx4 v[56:59], v3, s[12:15], s42 offen offset:2048 sc1
    v_mul_f32 v115, v115, v131
    v_mfma_f32_16x16x32_bf16 v[232:235], v[72:75], a[132:135], v[232:235]
    v_mul_f32 v116, v116, v144
    v_mul_f32 v117, v117, v145
    v_mfma_f32_16x16x32_bf16 v[248:251], v[76:79], a[132:135], v[248:251]
    s_xor_b32 s28, s19, 33792
    buffer_store_dwordx4 a[132:135], v90, s[8:11], s28 offen sc1
    v_mul_f32 v118, v118, v146
    v_mfma_f32_16x16x32_bf16 v[228:231], v[72:75], a[68:71], v[228:231]
    v_mul_f32 v119, v119, v147
    v_mfma_f32_16x16x32_bf16 v[244:247], v[76:79], a[68:71], v[244:247]
    buffer_load_dwordx4 v[60:63], v3, s[12:15], s42 offen offset:3072 sc1
    v_mfma_f32_16x16x32_bf16 v[224:227], v[72:75], a[4:7], v[224:227]
    v_exp_f32 v112, v112
    v_mfma_f32_16x16x32_bf16 v[240:243], v[76:79], a[4:7], v[240:243]
    v_exp_f32 v113, v113
    s_waitcnt vmcnt(17)
    v_mfma_f32_16x16x32_bf16 v[192:195], v[96:99], a[8:11], v[192:195]
    v_exp_f32 v114, v114
    v_mfma_f32_16x16x32_bf16 v[208:211], v[100:103], a[8:11], v[208:211]
    s_xor_b32 s42, s20, 24576
    buffer_load_dwordx4 v[64:67], v3, s[12:15], s42 offen offset:0 sc1
    v_mfma_f32_16x16x32_bf16 v[196:199], v[96:99], a[72:75], v[196:199]
    v_exp_f32 v115, v115
    v_mfma_f32_16x16x32_bf16 v[212:215], v[100:103], a[72:75], v[212:215]
    s_xor_b32 s28, s19, 34816
    buffer_store_dwordx4 a[136:139], v90, s[8:11], s28 offen sc1
    v_exp_f32 v116, v116
    v_mfma_f32_16x16x32_bf16 v[200:203], v[96:99], a[136:139], v[200:203]
    v_exp_f32 v117, v117
    v_mfma_f32_16x16x32_bf16 v[216:219], v[100:103], a[136:139], v[216:219]
    buffer_load_dwordx4 v[68:71], v3, s[12:15], s42 offen offset:1024 sc1
    v_mfma_f32_16x16x32_bf16 v[204:207], v[96:99], a[200:203], v[204:207]
    v_exp_f32 v118, v118
    v_mfma_f32_16x16x32_bf16 v[220:223], v[100:103], a[200:203], v[220:223]
    v_exp_f32 v119, v119
    v_mfma_f32_16x16x32_bf16 v[236:239], v[104:107], a[200:203], v[236:239]
    v_fma_f32 v112, v112, s1, s1
    v_fma_f32 v113, v113, s1, s1
    v_mfma_f32_16x16x32_bf16 v[252:255], v[108:111], a[200:203], v[252:255]
    buffer_load_dwordx4 v[72:75], v3, s[12:15], s42 offen offset:2048 sc1
    v_fma_f32 v114, v114, s1, s1
    v_mfma_f32_16x16x32_bf16 v[232:235], v[104:107], a[136:139], v[232:235]
    v_fma_f32 v115, v115, s1, s1
    v_fma_f32 v116, v116, s1, s1
    v_mfma_f32_16x16x32_bf16 v[248:251], v[108:111], a[136:139], v[248:251]
    s_xor_b32 s28, s19, 35840
    buffer_store_dwordx4 a[140:143], v90, s[8:11], s28 offen sc1
    v_mfma_f32_16x16x32_bf16 v[228:231], v[104:107], a[72:75], v[228:231]
    v_fma_f32 v117, v117, s1, s1
    v_fma_f32 v118, v118, s1, s1
    v_mfma_f32_16x16x32_bf16 v[244:247], v[108:111], a[72:75], v[244:247]
    buffer_load_dwordx4 v[76:79], v3, s[12:15], s42 offen offset:3072 sc1
    v_fma_f32 v119, v119, s1, s1
    v_mfma_f32_16x16x32_bf16 v[224:227], v[104:107], a[8:11], v[224:227]
    v_rcp_f32 v112, v112
    v_mfma_f32_16x16x32_bf16 v[240:243], v[108:111], a[8:11], v[240:243]
    v_rcp_f32 v113, v113
    s_waitcnt vmcnt(18)
    v_mfma_f32_16x16x32_bf16 v[192:195], v[16:19], a[12:15], v[192:195]
    v_mfma_f32_16x16x32_bf16 v[208:211], v[20:23], a[12:15], v[208:211]
    s_xor_b32 s42, s20, 28672
    buffer_load_dwordx4 v[96:99], v3, s[12:15], s42 offen offset:0 sc1
    v_rcp_f32 v114, v114
    v_mfma_f32_16x16x32_bf16 v[196:199], v[16:19], a[76:79], v[196:199]
    v_rcp_f32 v115, v115
    v_mfma_f32_16x16x32_bf16 v[212:215], v[20:23], a[76:79], v[212:215]
    s_xor_b32 s28, s19, 49152
    buffer_store_dwordx4 a[192:195], v90, s[8:11], s28 offen sc1
    v_mfma_f32_16x16x32_bf16 v[200:203], v[16:19], a[140:143], v[200:203]
    v_rcp_f32 v116, v116
    v_mfma_f32_16x16x32_bf16 v[216:219], v[20:23], a[140:143], v[216:219]
    buffer_load_dwordx4 v[100:103], v3, s[12:15], s42 offen offset:1024 sc1
    v_mfma_f32_16x16x32_bf16 v[204:207], v[16:19], a[204:207], v[204:207]
    v_rcp_f32 v117, v117
    v_mfma_f32_16x16x32_bf16 v[220:223], v[20:23], a[204:207], v[220:223]
    v_rcp_f32 v118, v118
    v_mfma_f32_16x16x32_bf16 v[236:239], v[24:27], a[204:207], v[236:239]
    v_rcp_f32 v119, v119
    v_mul_f32 v128, v112, v128
    v_mfma_f32_16x16x32_bf16 v[252:255], v[28:31], a[204:207], v[252:255]
    buffer_load_dwordx4 v[104:107], v3, s[12:15], s42 offen offset:2048 sc1
    v_mfma_f32_16x16x32_bf16 v[232:235], v[24:27], a[140:143], v[232:235]
    v_mul_f32 v129, v113, v129
    v_mul_f32 v130, v114, v130
    v_mfma_f32_16x16x32_bf16 v[248:251], v[28:31], a[140:143], v[248:251]
    s_xor_b32 s28, s19, 50176
    buffer_store_dwordx4 a[196:199], v90, s[8:11], s28 offen sc1
    v_mul_f32 v131, v115, v131
    v_mfma_f32_16x16x32_bf16 v[228:231], v[24:27], a[76:79], v[228:231]
    v_mul_f32 v144, v116, v144
    v_mul_f32 v145, v117, v145
    v_mfma_f32_16x16x32_bf16 v[244:247], v[28:31], a[76:79], v[244:247]
    buffer_load_dwordx4 v[108:111], v3, s[12:15], s42 offen offset:3072 sc1
    v_mul_f32 v146, v118, v146
    v_mfma_f32_16x16x32_bf16 v[224:227], v[24:27], a[12:15], v[224:227]
    v_mul_f32 v147, v119, v147
    v_mfma_f32_16x16x32_bf16 v[240:243], v[28:31], a[12:15], v[240:243]
    v_cvt_pk_bf16_f32 v120, v128, v129
    v_cvt_pk_bf16_f32 v121, v130, v131
    s_waitcnt vmcnt(18)
    v_mfma_f32_16x16x32_bf16 v[192:195], v[32:35], a[16:19], v[192:195]
    v_cvt_pk_bf16_f32 v122, v144, v145
    v_cvt_pk_bf16_f32 v123, v146, v147
    v_mfma_f32_16x16x32_bf16 v[208:211], v[36:39], a[16:19], v[208:211]
    s_xor_b32 s42, s20, 32768
    buffer_load_dwordx4 v[16:19], v3, s[12:15], s42 offen offset:0 sc1
    v_mul_f32 v112, v128, v128
    v_mfma_f32_16x16x32_bf16 v[196:199], v[32:35], a[80:83], v[196:199]
    v_fmac_f32 v112, v129, v129
    v_fmac_f32 v112, v130, v130
    v_mfma_f32_16x16x32_bf16 v[212:215], v[36:39], a[80:83], v[212:215]
    s_xor_b32 s28, s19, 51200
    buffer_store_dwordx4 a[200:203], v90, s[8:11], s28 offen sc1
    v_mfma_f32_16x16x32_bf16 v[200:203], v[32:35], a[144:147], v[200:203]
    v_fmac_f32 v112, v131, v131
    v_fmac_f32 v112, v144, v144
    v_mfma_f32_16x16x32_bf16 v[216:219], v[36:39], a[144:147], v[216:219]
    buffer_load_dwordx4 v[20:23], v3, s[12:15], s42 offen offset:1024 sc1
    v_fmac_f32 v112, v145, v145
    v_mfma_f32_16x16x32_bf16 v[204:207], v[32:35], a[208:211], v[204:207]
    v_fmac_f32 v112, v146, v146
    v_fmac_f32 v112, v147, v147
    v_mfma_f32_16x16x32_bf16 v[220:223], v[36:39], a[208:211], v[220:223]
    v_add_f32 v128, v128, v129
    v_add_f32 v128, v128, v130
    v_mfma_f32_16x16x32_bf16 v[236:239], v[40:43], a[208:211], v[236:239]
    v_add_f32 v128, v128, v131
    v_mfma_f32_16x16x32_bf16 v[252:255], v[44:47], a[208:211], v[252:255]
    buffer_load_dwordx4 v[24:27], v3, s[12:15], s42 offen offset:2048 sc1
    v_add_f32 v128, v128, v144
    v_mfma_f32_16x16x32_bf16 v[232:235], v[40:43], a[144:147], v[232:235]
    v_add_f32 v128, v128, v145
    v_add_f32 v128, v128, v146
    v_mfma_f32_16x16x32_bf16 v[248:251], v[44:47], a[144:147], v[248:251]
    s_xor_b32 s28, s19, 52224
    buffer_store_dwordx4 a[204:207], v90, s[8:11], s28 offen sc1
    v_add_f32 v128, v128, v147
    v_mfma_f32_16x16x32_bf16 v[228:231], v[40:43], a[80:83], v[228:231]
    v_mov_b32 v129, v112
    ds_write_b64 v84, v[120:121] offset:0
    v_mfma_f32_16x16x32_bf16 v[244:247], v[44:47], a[80:83], v[244:247]
    buffer_load_dwordx4 v[28:31], v3, s[12:15], s42 offen offset:3072 sc1
    v_mfma_f32_16x16x32_bf16 v[224:227], v[40:43], a[16:19], v[224:227]
    ds_write_b64 v84, v[122:123] offset:32
    v_fma_f32 v112, -v160, v160, s0
    v_mfma_f32_16x16x32_bf16 v[240:243], v[44:47], a[16:19], v[240:243]
    v_fma_f32 v113, -v161, v161, s0
    v_fma_f32 v114, -v162, v162, s0
    s_waitcnt vmcnt(18)
    v_mfma_f32_16x16x32_bf16 v[192:195], v[48:51], a[20:23], v[192:195]
    v_fma_f32 v115, -v163, v163, s0
    v_fma_f32 v116, -v176, v176, s0
    v_mfma_f32_16x16x32_bf16 v[208:211], v[52:55], a[20:23], v[208:211]
    s_xor_b32 s42, s20, 36864
    buffer_load_dwordx4 v[32:35], v3, s[12:15], s42 offen offset:0 sc1
    v_mfma_f32_16x16x32_bf16 v[196:199], v[48:51], a[84:87], v[196:199]
    v_fma_f32 v117, -v177, v177, s0
    v_fma_f32 v118, -v178, v178, s0
    v_mfma_f32_16x16x32_bf16 v[212:215], v[52:55], a[84:87], v[212:215]
    v_fma_f32 v119, -v179, v179, s0
    v_mul_f32 v112, v112, v160
    v_mfma_f32_16x16x32_bf16 v[200:203], v[48:51], a[148:151], v[200:203]
    v_mul_f32 v113, v113, v161
    v_mul_f32 v114, v114, v162
    v_mfma_f32_16x16x32_bf16 v[216:219], v[52:55], a[148:151], v[216:219]
    buffer_load_dwordx4 v[36:39], v3, s[12:15], s42 offen offset:1024 sc1
    v_mul_f32 v115, v115, v163
    v_mfma_f32_16x16x32_bf16 v[204:207], v[48:51], a[212:215], v[204:207]
    v_mul_f32 v116, v116, v176
    v_mfma_f32_16x16x32_bf16 v[220:223], v[52:55], a[212:215], v[220:223]
    v_mul_f32 v117, v117, v177
    v_mul_f32 v118, v118, v178
    v_mfma_f32_16x16x32_bf16 v[236:239], v[56:59], a[212:215], v[236:239]
    v_mul_f32 v119, v119, v179
    v_mfma_f32_16x16x32_bf16 v[252:255], v[60:63], a[212:215], v[252:255]
    buffer_load_dwordx4 v[40:43], v3, s[12:15], s42 offen offset:2048 sc1
    v_exp_f32 v112, v112
    v_mfma_f32_16x16x32_bf16 v[232:235], v[56:59], a[148:151], v[232:235]
    v_mfma_f32_16x16x32_bf16 v[248:251], v[60:63], a[148:151], v[248:251]
    v_exp_f32 v113, v113
    v_mfma_f32_16x16x32_bf16 v[228:231], v[56:59], a[84:87], v[228:231]
    v_exp_f32 v114, v114
    v_mfma_f32_16x16x32_bf16 v[244:247], v[60:63], a[84:87], v[244:247]
    buffer_load_dwordx4 v[44:47], v3, s[12:15], s42 offen offset:3072 sc1
    v_exp_f32 v115, v115
    v_mfma_f32_16x16x32_bf16 v[224:227], v[56:59], a[20:23], v[224:227]
    v_exp_f32 v116, v116
    v_mfma_f32_16x16x32_bf16 v[240:243], v[60:63], a[20:23], v[240:243]
    s_waitcnt vmcnt(16)
    v_mfma_f32_16x16x32_bf16 v[192:195], v[64:67], a[24:27], v[192:195]
    v_exp_f32 v117, v117
    v_mfma_f32_16x16x32_bf16 v[208:211], v[68:71], a[24:27], v[208:211]
    s_xor_b32 s42, s20, 40960
    buffer_load_dwordx4 v[48:51], v3, s[12:15], s42 offen offset:0 sc1
    v_exp_f32 v118, v118
    v_mfma_f32_16x16x32_bf16 v[196:199], v[64:67], a[88:91], v[196:199]
    v_exp_f32 v119, v119
    v_mfma_f32_16x16x32_bf16 v[212:215], v[68:71], a[88:91], v[212:215]
    v_fma_f32 v112, v112, s1, s1
    v_mfma_f32_16x16x32_bf16 v[200:203], v[64:67], a[152:155], v[200:203]
    v_fma_f32 v113, v113, s1, s1
    v_fma_f32 v114, v114, s1, s1
    v_mfma_f32_16x16x32_bf16 v[216:219], v[68:71], a[152:155], v[216:219]
    buffer_load_dwordx4 v[52:55], v3, s[12:15], s42 offen offset:1024 sc1
    v_fma_f32 v115, v115, s1, s1
    v_mfma_f32_16x16x32_bf16 v[204:207], v[64:67], a[216:219], v[204:207]
    v_fma_f32 v116, v116, s1, s1
    v_fma_f32 v117, v117, s1, s1
    v_mfma_f32_16x16x32_bf16 v[220:223], v[68:71], a[216:219], v[220:223]
    v_fma_f32 v118, v118, s1, s1
    v_mfma_f32_16x16x32_bf16 v[236:239], v[72:75], a[216:219], v[236:239]
    v_fma_f32 v119, v119, s1, s1
    v_mfma_f32_16x16x32_bf16 v[252:255], v[76:79], a[216:219], v[252:255]
    buffer_load_dwordx4 v[56:59], v3, s[12:15], s42 offen offset:2048 sc1
    v_rcp_f32 v112, v112
    v_mfma_f32_16x16x32_bf16 v[232:235], v[72:75], a[152:155], v[232:235]
    v_rcp_f32 v113, v113
    v_mfma_f32_16x16x32_bf16 v[248:251], v[76:79], a[152:155], v[248:251]
    v_rcp_f32 v114, v114
    v_mfma_f32_16x16x32_bf16 v[228:231], v[72:75], a[88:91], v[228:231]
    v_mfma_f32_16x16x32_bf16 v[244:247], v[76:79], a[88:91], v[244:247]
    buffer_load_dwordx4 v[60:63], v3, s[12:15], s42 offen offset:3072 sc1
    v_rcp_f32 v115, v115
    v_mfma_f32_16x16x32_bf16 v[224:227], v[72:75], a[24:27], v[224:227]
    v_rcp_f32 v116, v116
    v_mfma_f32_16x16x32_bf16 v[240:243], v[76:79], a[24:27], v[240:243]
    v_rcp_f32 v117, v117
    s_waitcnt vmcnt(14)
    v_mfma_f32_16x16x32_bf16 v[192:195], v[96:99], a[28:31], v[192:195]
    v_mfma_f32_16x16x32_bf16 v[208:211], v[100:103], a[28:31], v[208:211]
    s_xor_b32 s42, s20, 45056
    buffer_load_dwordx4 v[64:67], v3, s[12:15], s42 offen offset:0 sc1
    v_rcp_f32 v118, v118
    v_mfma_f32_16x16x32_bf16 v[196:199], v[96:99], a[92:95], v[196:199]
    v_rcp_f32 v119, v119
    v_mfma_f32_16x16x32_bf16 v[212:215], v[100:103], a[92:95], v[212:215]
    v_mul_f32 v160, v112, v160
    v_mul_f32 v161, v113, v161
    v_mfma_f32_16x16x32_bf16 v[200:203], v[96:99], a[156:159], v[200:203]
    v_mul_f32 v162, v114, v162
    v_mul_f32 v163, v115, v163
    v_mfma_f32_16x16x32_bf16 v[216:219], v[100:103], a[156:159], v[216:219]
    buffer_load_dwordx4 v[68:71], v3, s[12:15], s42 offen offset:1024 sc1
    v_mfma_f32_16x16x32_bf16 v[204:207], v[96:99], a[220:223], v[204:207]
    v_mul_f32 v176, v116, v176
    v_mul_f32 v177, v117, v177
    v_mfma_f32_16x16x32_bf16 v[220:223], v[100:103], a[220:223], v[220:223]
    v_mov_b32 v1, 88832
    v_mov_b32 v14, 1
    s_waitcnt vmcnt(11)
    s_mov_b64 exec, 1
    ds_add_rtn_u32 v15, v1, v14
    s_mov_b64 exec, -1
    v_mul_f32 v178, v118, v178
    v_mfma_f32_16x16x32_bf16 v[236:239], v[104:107], a[220:223], v[236:239]
    v_mul_f32 v179, v119, v179
    v_cvt_pk_bf16_f32 v124, v160, v161
    v_mfma_f32_16x16x32_bf16 v[252:255], v[108:111], a[220:223], v[252:255]
    buffer_load_dwordx4 v[72:75], v3, s[12:15], s42 offen offset:2048 sc1
    v_cvt_pk_bf16_f32 v125, v162, v163
    v_mfma_f32_16x16x32_bf16 v[232:235], v[104:107], a[156:159], v[232:235]
    v_cvt_pk_bf16_f32 v126, v176, v177
    v_mfma_f32_16x16x32_bf16 v[248:251], v[108:111], a[156:159], v[248:251]
    v_cvt_pk_bf16_f32 v127, v178, v179
    v_add_f32 v128, v128, v160
    v_mfma_f32_16x16x32_bf16 v[228:231], v[104:107], a[92:95], v[228:231]
    v_fmac_f32 v129, v160, v160
    v_add_f32 v128, v128, v161
    v_mfma_f32_16x16x32_bf16 v[244:247], v[108:111], a[92:95], v[244:247]
    buffer_load_dwordx4 v[76:79], v3, s[12:15], s42 offen offset:3072 sc1
    v_fmac_f32 v129, v161, v161
    v_mfma_f32_16x16x32_bf16 v[224:227], v[104:107], a[28:31], v[224:227]
    v_add_f32 v128, v128, v162
    v_mfma_f32_16x16x32_bf16 v[240:243], v[108:111], a[28:31], v[240:243]
    v_fmac_f32 v129, v162, v162
    v_add_f32 v128, v128, v163
    s_waitcnt vmcnt(12)
    v_mfma_f32_16x16x32_bf16 v[192:195], v[16:19], a[32:35], v[192:195]
    v_fmac_f32 v129, v163, v163
    v_add_f32 v128, v128, v176
    v_mfma_f32_16x16x32_bf16 v[208:211], v[20:23], a[32:35], v[208:211]
    s_xor_b32 s42, s20, 49152
    buffer_load_dwordx4 v[96:99], v3, s[12:15], s42 offen offset:0 sc1
    v_fmac_f32 v129, v176, v176
    v_mfma_f32_16x16x32_bf16 v[196:199], v[16:19], a[96:99], v[196:199]
    v_add_f32 v128, v128, v177
    v_fmac_f32 v129, v177, v177
    v_mfma_f32_16x16x32_bf16 v[212:215], v[20:23], a[96:99], v[212:215]
    v_add_f32 v128, v128, v178
    v_mfma_f32_16x16x32_bf16 v[200:203], v[16:19], a[160:163], v[200:203]
    v_fmac_f32 v129, v178, v178
    v_add_f32 v128, v128, v179
    v_mfma_f32_16x16x32_bf16 v[216:219], v[20:23], a[160:163], v[216:219]
    buffer_load_dwordx4 v[100:103], v3, s[12:15], s42 offen offset:1024 sc1
    v_fmac_f32 v129, v179, v179
    v_mfma_f32_16x16x32_bf16 v[204:207], v[16:19], a[224:227], v[204:207]
    ds_write_b64 v84, v[124:125] offset:64
    ds_write_b64 v84, v[126:127] offset:96
    v_mfma_f32_16x16x32_bf16 v[220:223], v[20:23], a[224:227], v[220:223]
    s_waitcnt lgkmcnt(2)
    v_readfirstlane_b32 s28, v15
    s_and_b32 s26, s2, 3
    s_lshl_b32 s26, s26, 6
    s_cmp_lg_u32 s28, 1
    s_cbranch_scc1 L_sig2
    s_mov_b64 exec, 1
    buffer_atomic_add v14, off, s[92:95], s26 offset:8
    s_mov_b64 exec, -1
L_sig2:
    ds_read_b128 v[160:163], v85 offset:0
    v_mfma_f32_16x16x32_bf16 v[236:239], v[24:27], a[224:227], v[236:239]
    ds_read_b128 v[176:179], v85 offset:1152
    v_mfma_f32_16x16x32_bf16 v[252:255], v[28:31], a[224:227], v[252:255]
    buffer_load_dwordx4 v[104:107], v3, s[12:15], s42 offen offset:2048 sc1
    v_fma_f32 v112, -v132, v132, s0
    v_mfma_f32_16x16x32_bf16 v[232:235], v[24:27], a[160:163], v[232:235]
    v_fma_f32 v113, -v133, v133, s0
    v_fma_f32 v114, -v134, v134, s0
    v_mfma_f32_16x16x32_bf16 v[248:251], v[28:31], a[160:163], v[248:251]
    v_fma_f32 v115, -v135, v135, s0
    v_fma_f32 v116, -v148, v148, s0
    v_mfma_f32_16x16x32_bf16 v[228:231], v[24:27], a[96:99], v[228:231]
    v_fma_f32 v117, -v149, v149, s0
    v_mfma_f32_16x16x32_bf16 v[244:247], v[28:31], a[96:99], v[244:247]
    buffer_load_dwordx4 v[108:111], v3, s[12:15], s42 offen offset:3072 sc1
    v_fma_f32 v118, -v150, v150, s0
    v_mfma_f32_16x16x32_bf16 v[224:227], v[24:27], a[32:35], v[224:227]
    v_fma_f32 v119, -v151, v151, s0
    v_mul_f32 v112, v112, v132
    v_mfma_f32_16x16x32_bf16 v[240:243], v[28:31], a[32:35], v[240:243]
    v_mul_f32 v113, v113, v133
    v_mul_f32 v114, v114, v134
    s_waitcnt vmcnt(12)
    v_mfma_f32_16x16x32_bf16 v[192:195], v[32:35], a[36:39], v[192:195]
    v_mul_f32 v115, v115, v135
    v_mfma_f32_16x16x32_bf16 v[208:211], v[36:39], a[36:39], v[208:211]
    s_xor_b32 s42, s20, 53248
    buffer_load_dwordx4 v[16:19], v3, s[12:15], s42 offen offset:0 sc1
    v_mul_f32 v116, v116, v148
    v_mfma_f32_16x16x32_bf16 v[196:199], v[32:35], a[100:103], v[196:199]
    v_mul_f32 v117, v117, v149
    v_mul_f32 v118, v118, v150
    v_mfma_f32_16x16x32_bf16 v[212:215], v[36:39], a[100:103], v[212:215]
    v_mul_f32 v119, v119, v151
    v_mfma_f32_16x16x32_bf16 v[200:203], v[32:35], a[164:167], v[200:203]
    v_exp_f32 v112, v112
    v_mfma_f32_16x16x32_bf16 v[216:219], v[36:39], a[164:167], v[216:219]
    buffer_load_dwordx4 v[20:23], v3, s[12:15], s42 offen offset:1024 sc1
    v_mfma_f32_16x16x32_bf16 v[204:207], v[32:35], a[228:231], v[204:207]
    v_exp_f32 v113, v113
    v_mfma_f32_16x16x32_bf16 v[220:223], v[36:39], a[228:231], v[220:223]
    v_exp_f32 v114, v114
    v_mfma_f32_16x16x32_bf16 v[236:239], v[40:43], a[228:231], v[236:239]
    v_exp_f32 v115, v115
    v_mfma_f32_16x16x32_bf16 v[252:255], v[44:47], a[228:231], v[252:255]
    buffer_load_dwordx4 v[24:27], v3, s[12:15], s42 offen offset:2048 sc1
    v_exp_f32 v116, v116
    v_mfma_f32_16x16x32_bf16 v[232:235], v[40:43], a[164:167], v[232:235]
    v_mfma_f32_16x16x32_bf16 v[248:251], v[44:47], a[164:167], v[248:251]
    v_exp_f32 v117, v117
    v_mfma_f32_16x16x32_bf16 v[228:231], v[40:43], a[100:103], v[228:231]
    v_exp_f32 v118, v118
    v_mfma_f32_16x16x32_bf16 v[244:247], v[44:47], a[100:103], v[244:247]
    buffer_load_dwordx4 v[28:31], v3, s[12:15], s42 offen offset:3072 sc1
    v_exp_f32 v119, v119
    v_mfma_f32_16x16x32_bf16 v[224:227], v[40:43], a[36:39], v[224:227]
    v_fma_f32 v112, v112, s1, s1
    v_mfma_f32_16x16x32_bf16 v[240:243], v[44:47], a[36:39], v[240:243]
    v_fma_f32 v113, v113, s1, s1
    v_fma_f32 v114, v114, s1, s1
    s_waitcnt vmcnt(12)
    v_mfma_f32_16x16x32_bf16 v[192:195], v[48:51], a[40:43], v[192:195]
    v_fma_f32 v115, v115, s1, s1
    v_fma_f32 v116, v116, s1, s1
    v_mfma_f32_16x16x32_bf16 v[208:211], v[52:55], a[40:43], v[208:211]
    s_xor_b32 s42, s20, 57344
    buffer_load_dwordx4 v[32:35], v3, s[12:15], s42 offen offset:0 sc1
    v_fma_f32 v117, v117, s1, s1
    v_mfma_f32_16x16x32_bf16 v[196:199], v[48:51], a[104:107], v[196:199]
    v_fma_f32 v118, v118, s1, s1
    v_fma_f32 v119, v119, s1, s1
    v_mfma_f32_16x16x32_bf16 v[212:215], v[52:55], a[104:107], v[212:215]
    v_mfma_f32_16x16x32_bf16 v[200:203], v[48:51], a[168:171], v[200:203]
    v_rcp_f32 v112, v112
    v_mfma_f32_16x16x32_bf16 v[216:219], v[52:55], a[168:171], v[216:219]
    buffer_load_dwordx4 v[36:39], v3, s[12:15], s42 offen offset:1024 sc1
    v_rcp_f32 v113, v113
    v_mfma_f32_16x16x32_bf16 v[204:207], v[48:51], a[232:235], v[204:207]
    v_rcp_f32 v114, v114
    v_mfma_f32_16x16x32_bf16 v[220:223], v[52:55], a[232:235], v[220:223]
    v_mfma_f32_16x16x32_bf16 v[236:239], v[56:59], a[232:235], v[236:239]
    v_rcp_f32 v115, v115
    v_mfma_f32_16x16x32_bf16 v[252:255], v[60:63], a[232:235], v[252:255]
    buffer_load_dwordx4 v[40:43], v3, s[12:15], s42 offen offset:2048 sc1
    v_rcp_f32 v116, v116
    v_mfma_f32_16x16x32_bf16 v[232:235], v[56:59], a[168:171], v[232:235]
    v_rcp_f32 v117, v117
    v_mfma_f32_16x16x32_bf16 v[248:251], v[60:63], a[168:171], v[248:251]
    v_mfma_f32_16x16x32_bf16 v[228:231], v[56:59], a[104:107], v[228:231]
    v_rcp_f32 v118, v118
    v_mfma_f32_16x16x32_bf16 v[244:247], v[60:63], a[104:107], v[244:247]
    buffer_load_dwordx4 v[44:47], v3, s[12:15], s42 offen offset:3072 sc1
    v_rcp_f32 v119, v119
    v_mfma_f32_16x16x32_bf16 v[224:227], v[56:59], a[40:43], v[224:227]
    v_mul_f32 v132, v112, v132
    v_mul_f32 v133, v113, v133
    v_mfma_f32_16x16x32_bf16 v[240:243], v[60:63], a[40:43], v[240:243]
    v_mul_f32 v134, v114, v134
    v_mul_f32 v135, v115, v135
    s_waitcnt vmcnt(12)
    v_mfma_f32_16x16x32_bf16 v[192:195], v[64:67], a[44:47], v[192:195]
    v_mul_f32 v148, v116, v148
    v_mfma_f32_16x16x32_bf16 v[208:211], v[68:71], a[44:47], v[208:211]
    s_xor_b32 s42, s20, 61440
    buffer_load_dwordx4 v[48:51], v3, s[12:15], s42 offen offset:0 sc1
    v_mul_f32 v149, v117, v149
    v_mfma_f32_16x16x32_bf16 v[196:199], v[64:67], a[108:111], v[196:199]
    v_mul_f32 v150, v118, v150
    v_mul_f32 v151, v119, v151
    v_mfma_f32_16x16x32_bf16 v[212:215], v[68:71], a[108:111], v[212:215]
    v_cvt_pk_bf16_f32 v120, v132, v133
    v_cvt_pk_bf16_f32 v121, v134, v135
    v_mfma_f32_16x16x32_bf16 v[200:203], v[64:67], a[172:175], v[200:203]
    v_cvt_pk_bf16_f32 v122, v148, v149
    v_mfma_f32_16x16x32_bf16 v[216:219], v[68:71], a[172:175], v[216:219]
    buffer_load_dwordx4 v[52:55], v3, s[12:15], s42 offen offset:1024 sc1
    v_cvt_pk_bf16_f32 v123, v150, v151
    v_mfma_f32_16x16x32_bf16 v[204:207], v[64:67], a[236:239], v[204:207]
    v_mul_f32 v112, v132, v132
    v_fmac_f32 v112, v133, v133
    v_mfma_f32_16x16x32_bf16 v[220:223], v[68:71], a[236:239], v[220:223]
    v_fmac_f32 v112, v134, v134
    v_fmac_f32 v112, v135, v135
    v_mfma_f32_16x16x32_bf16 v[236:239], v[72:75], a[236:239], v[236:239]
    v_fmac_f32 v112, v148, v148
    v_fmac_f32 v112, v149, v149
    v_mfma_f32_16x16x32_bf16 v[252:255], v[76:79], a[236:239], v[252:255]
    buffer_load_dwordx4 v[56:59], v3, s[12:15], s42 offen offset:2048 sc1
    v_mfma_f32_16x16x32_bf16 v[232:235], v[72:75], a[172:175], v[232:235]
    v_fmac_f32 v112, v150, v150
    v_fmac_f32 v112, v151, v151
    v_mfma_f32_16x16x32_bf16 v[248:251], v[76:79], a[172:175], v[248:251]
    v_add_f32 v132, v132, v133
    v_add_f32 v132, v132, v134
    v_mfma_f32_16x16x32_bf16 v[228:231], v[72:75], a[108:111], v[228:231]
    v_add_f32 v132, v132, v135
    v_add_f32 v132, v132, v148
    v_mfma_f32_16x16x32_bf16 v[244:247], v[76:79], a[108:111], v[244:247]
    buffer_load_dwordx4 v[60:63], v3, s[12:15], s42 offen offset:3072 sc1
    v_mfma_f32_16x16x32_bf16 v[224:227], v[72:75], a[44:47], v[224:227]
    v_add_f32 v132, v132, v149
    v_add_f32 v132, v132, v150
    v_mfma_f32_16x16x32_bf16 v[240:243], v[76:79], a[44:47], v[240:243]
    v_add_f32 v132, v132, v151
    v_mov_b32 v133, v112
    s_waitcnt vmcnt(12)
    v_mfma_f32_16x16x32_bf16 v[192:195], v[96:99], a[48:51], v[192:195]
    ds_write_b64 v84, v[120:121] offset:0
    ds_write_b64 v84, v[122:123] offset:32
    v_mfma_f32_16x16x32_bf16 v[208:211], v[100:103], a[48:51], v[208:211]
    s_xor_b32 s42, s20, 65536
    buffer_load_dwordx4 v[64:67], v3, s[12:15], s42 offen offset:0 sc1
    s_add_u32 s29, s17, 0
    s_waitcnt lgkmcnt(3)
    buffer_store_dwordx4 v[160:163], v86, s[12:15], s29 offen sc1
    v_mfma_f32_16x16x32_bf16 v[196:199], v[96:99], a[112:115], v[196:199]
    v_fma_f32 v112, -v164, v164, s0
    v_mfma_f32_16x16x32_bf16 v[212:215], v[100:103], a[112:115], v[212:215]
    v_fma_f32 v113, -v165, v165, s0
    v_fma_f32 v114, -v166, v166, s0
    v_mfma_f32_16x16x32_bf16 v[200:203], v[96:99], a[176:179], v[200:203]
    v_fma_f32 v115, -v167, v167, s0
    v_fma_f32 v116, -v180, v180, s0
    v_mfma_f32_16x16x32_bf16 v[216:219], v[100:103], a[176:179], v[216:219]
    buffer_load_dwordx4 v[68:71], v3, s[12:15], s42 offen offset:1024 sc1
    v_fma_f32 v117, -v181, v181, s0
    v_mfma_f32_16x16x32_bf16 v[204:207], v[96:99], a[240:243], v[204:207]
    v_fma_f32 v118, -v182, v182, s0
    v_mfma_f32_16x16x32_bf16 v[220:223], v[100:103], a[240:243], v[220:223]
    v_fma_f32 v119, -v183, v183, s0
    v_mul_f32 v112, v112, v164
    v_mfma_f32_16x16x32_bf16 v[236:239], v[104:107], a[240:243], v[236:239]
    v_mul_f32 v113, v113, v165
    v_mul_f32 v114, v114, v166
    v_mfma_f32_16x16x32_bf16 v[252:255], v[108:111], a[240:243], v[252:255]
    buffer_load_dwordx4 v[72:75], v3, s[12:15], s42 offen offset:2048 sc1
    v_mul_f32 v115, v115, v167
    v_mfma_f32_16x16x32_bf16 v[232:235], v[104:107], a[176:179], v[232:235]
    v_mul_f32 v116, v116, v180
    v_mul_f32 v117, v117, v181
    v_mfma_f32_16x16x32_bf16 v[248:251], v[108:111], a[176:179], v[248:251]
    v_mul_f32 v118, v118, v182
    v_mfma_f32_16x16x32_bf16 v[228:231], v[104:107], a[112:115], v[228:231]
    v_mul_f32 v119, v119, v183
    v_mfma_f32_16x16x32_bf16 v[244:247], v[108:111], a[112:115], v[244:247]
    buffer_load_dwordx4 v[76:79], v3, s[12:15], s42 offen offset:3072 sc1
    v_exp_f32 v112, v112
    v_mfma_f32_16x16x32_bf16 v[224:227], v[104:107], a[48:51], v[224:227]
    v_exp_f32 v113, v113
    v_mfma_f32_16x16x32_bf16 v[240:243], v[108:111], a[48:51], v[240:243]
    s_waitcnt vmcnt(13)
    v_mfma_f32_16x16x32_bf16 v[192:195], v[16:19], a[52:55], v[192:195]
    v_exp_f32 v114, v114
    v_mfma_f32_16x16x32_bf16 v[208:211], v[20:23], a[52:55], v[208:211]
    s_xor_b32 s42, s20, 69632
    buffer_load_dwordx4 v[96:99], v3, s[12:15], s42 offen offset:0 sc1
    v_exp_f32 v115, v115
    v_mfma_f32_16x16x32_bf16 v[196:199], v[16:19], a[116:119], v[196:199]
    v_exp_f32 v116, v116
    v_mfma_f32_16x16x32_bf16 v[212:215], v[20:23], a[116:119], v[212:215]
    v_mfma_f32_16x16x32_bf16 v[200:203], v[16:19], a[180:183], v[200:203]
    v_exp_f32 v117, v117
    v_mfma_f32_16x16x32_bf16 v[216:219], v[20:23], a[180:183], v[216:219]
    buffer_load_dwordx4 v[100:103], v3, s[12:15], s42 offen offset:1024 sc1
    v_exp_f32 v118, v118
    v_mfma_f32_16x16x32_bf16 v[204:207], v[16:19], a[244:247], v[204:207]
    v_exp_f32 v119, v119
    v_mfma_f32_16x16x32_bf16 v[220:223], v[20:23], a[244:247], v[220:223]
    v_fma_f32 v112, v112, s1, s1
    v_fma_f32 v113, v113, s1, s1
    v_mfma_f32_16x16x32_bf16 v[236:239], v[24:27], a[244:247], v[236:239]
    v_fma_f32 v114, v114, s1, s1
    v_mfma_f32_16x16x32_bf16 v[252:255], v[28:31], a[244:247], v[252:255]
    buffer_load_dwordx4 v[104:107], v3, s[12:15], s42 offen offset:2048 sc1
    v_fma_f32 v115, v115, s1, s1
    v_mfma_f32_16x16x32_bf16 v[232:235], v[24:27], a[180:183], v[232:235]
    v_fma_f32 v116, v116, s1, s1
    v_fma_f32 v117, v117, s1, s1
    v_mfma_f32_16x16x32_bf16 v[248:251], v[28:31], a[180:183], v[248:251]
    v_fma_f32 v118, v118, s1, s1
    v_fma_f32 v119, v119, s1, s1
    v_mfma_f32_16x16x32_bf16 v[228:231], v[24:27], a[116:119], v[228:231]
    v_mfma_f32_16x16x32_bf16 v[244:247], v[28:31], a[116:119], v[244:247]
    buffer_load_dwordx4 v[108:111], v3, s[12:15], s42 offen offset:3072 sc1
    v_rcp_f32 v112, v112
    v_mfma_f32_16x16x32_bf16 v[224:227], v[24:27], a[52:55], v[224:227]
    v_rcp_f32 v113, v113
    v_mfma_f32_16x16x32_bf16 v[240:243], v[28:31], a[52:55], v[240:243]
    v_rcp_f32 v114, v114
    s_waitcnt vmcnt(13)
    v_mfma_f32_16x16x32_bf16 v[192:195], v[32:35], a[56:59], v[192:195]
    v_rcp_f32 v115, v115
    v_mfma_f32_16x16x32_bf16 v[208:211], v[36:39], a[56:59], v[208:211]
    s_xor_b32 s42, s20, 73728
    buffer_load_dwordx4 v[16:19], v3, s[12:15], s42 offen offset:0 sc1
    v_mfma_f32_16x16x32_bf16 v[196:199], v[32:35], a[120:123], v[196:199]
    v_rcp_f32 v116, v116
    v_mfma_f32_16x16x32_bf16 v[212:215], v[36:39], a[120:123], v[212:215]
    v_rcp_f32 v117, v117
    v_mfma_f32_16x16x32_bf16 v[200:203], v[32:35], a[184:187], v[200:203]
    v_rcp_f32 v118, v118
    v_mfma_f32_16x16x32_bf16 v[216:219], v[36:39], a[184:187], v[216:219]
    buffer_load_dwordx4 v[20:23], v3, s[12:15], s42 offen offset:1024 sc1
    v_mfma_f32_16x16x32_bf16 v[204:207], v[32:35], a[248:251], v[204:207]
    v_rcp_f32 v119, v119
    v_mfma_f32_16x16x32_bf16 v[220:223], v[36:39], a[248:251], v[220:223]
    v_mul_f32 v164, v112, v164
    v_mul_f32 v165, v113, v165
    v_mfma_f32_16x16x32_bf16 v[236:239], v[40:43], a[248:251], v[236:239]
    v_mul_f32 v166, v114, v166
    v_mul_f32 v167, v115, v167
    v_mfma_f32_16x16x32_bf16 v[252:255], v[44:47], a[248:251], v[252:255]
    buffer_load_dwordx4 v[24:27], v3, s[12:15], s42 offen offset:2048 sc1
    v_mul_f32 v180, v116, v180
    v_mfma_f32_16x16x32_bf16 v[232:235], v[40:43], a[184:187], v[232:235]
    v_mul_f32 v181, v117, v181
    v_mfma_f32_16x16x32_bf16 v[248:251], v[44:47], a[184:187], v[248:251]
    v_mul_f32 v182, v118, v182
    v_mul_f32 v183, v119, v183
    v_mfma_f32_16x16x32_bf16 v[228:231], v[40:43], a[120:123], v[228:231]
    v_cvt_pk_bf16_f32 v124, v164, v165
    v_cvt_pk_bf16_f32 v125, v166, v167
    v_mfma_f32_16x16x32_bf16 v[244:247], v[44:47], a[120:123], v[244:247]
    buffer_load_dwordx4 v[28:31], v3, s[12:15], s42 offen offset:3072 sc1
    v_cvt_pk_bf16_f32 v126, v180, v181
    v_mfma_f32_16x16x32_bf16 v[224:227], v[40:43], a[56:59], v[224:227]
    v_cvt_pk_bf16_f32 v127, v182, v183
    v_mfma_f32_16x16x32_bf16 v[240:243], v[44:47], a[56:59], v[240:243]
    v_add_f32 v132, v132, v164
    v_fmac_f32 v133, v164, v164
    s_waitcnt vmcnt(13)
    v_mfma_f32_16x16x32_bf16 v[192:195], v[48:51], a[60:63], v[192:195]
    v_add_f32 v132, v132, v165
    v_fmac_f32 v133, v165, v165
    v_mfma_f32_16x16x32_bf16 v[208:211], v[52:55], a[60:63], v[208:211]
    s_xor_b32 s42, s20, 77824
    buffer_load_dwordx4 v[32:35], v3, s[12:15], s42 offen offset:0 sc1
    v_add_f32 v132, v132, v166
    v_mfma_f32_16x16x32_bf16 v[196:199], v[48:51], a[124:127], v[196:199]
    v_fmac_f32 v133, v166, v166
    v_add_f32 v132, v132, v167
    v_mfma_f32_16x16x32_bf16 v[212:215], v[52:55], a[124:127], v[212:215]
    v_fmac_f32 v133, v167, v167
    v_mfma_f32_16x16x32_bf16 v[200:203], v[48:51], a[188:191], v[200:203]
    v_add_f32 v132, v132, v180
    v_fmac_f32 v133, v180, v180
    v_mfma_f32_16x16x32_bf16 v[216:219], v[52:55], a[188:191], v[216:219]
    buffer_load_dwordx4 v[36:39], v3, s[12:15], s42 offen offset:1024 sc1
    v_add_f32 v132, v132, v181
    v_mfma_f32_16x16x32_bf16 v[204:207], v[48:51], a[252:255], v[204:207]
    v_fmac_f32 v133, v181, v181
    v_add_f32 v132, v132, v182
    v_mfma_f32_16x16x32_bf16 v[220:223], v[52:55], a[252:255], v[220:223]
    v_fmac_f32 v133, v182, v182
    v_mfma_f32_16x16x32_bf16 v[236:239], v[56:59], a[252:255], v[236:239]
    v_add_f32 v132, v132, v183
    v_fmac_f32 v133, v183, v183
    v_mfma_f32_16x16x32_bf16 v[252:255], v[60:63], a[252:255], v[252:255]
    buffer_load_dwordx4 v[40:43], v3, s[12:15], s42 offen offset:2048 sc1
    ds_write_b64 v84, v[124:125] offset:64
    v_mfma_f32_16x16x32_bf16 v[232:235], v[56:59], a[188:191], v[232:235]
    ds_write_b64 v84, v[126:127] offset:96
    s_add_u32 s29, s17, 4096
    s_waitcnt lgkmcnt(4)
    buffer_store_dwordx4 v[176:179], v86, s[12:15], s29 offen
    v_mfma_f32_16x16x32_bf16 v[248:251], v[60:63], a[188:191], v[248:251]
    ds_read_b128 v[164:167], v85 offset:0
    ds_read_b128 v[180:183], v85 offset:1152
    v_mfma_f32_16x16x32_bf16 v[228:231], v[56:59], a[124:127], v[228:231]
    v_mfma_f32_16x16x32_bf16 v[244:247], v[60:63], a[124:127], v[244:247]
    buffer_load_dwordx4 v[44:47], v3, s[12:15], s42 offen offset:3072 sc1
    v_mfma_f32_16x16x32_bf16 v[224:227], v[56:59], a[60:63], v[224:227]
    v_mfma_f32_16x16x32_bf16 v[240:243], v[60:63], a[60:63], v[240:243]
    s_nop 3
    v_cvt_pk_bf16_f32 v192, v192, v193
    v_cvt_pk_bf16_f32 v193, v194, v195
    v_cvt_pk_bf16_f32 v194, v208, v209
    v_cvt_pk_bf16_f32 v195, v210, v211
    ds_write_b128 v87, v[192:195] offset:0
    v_cvt_pk_bf16_f32 v196, v196, v197
    v_cvt_pk_bf16_f32 v197, v198, v199
    v_cvt_pk_bf16_f32 v198, v212, v213
    v_cvt_pk_bf16_f32 v199, v214, v215
    ds_write_b128 v87, v[196:199] offset:2048
    v_cvt_pk_bf16_f32 v200, v200, v201
    v_cvt_pk_bf16_f32 v201, v202, v203
    v_cvt_pk_bf16_f32 v202, v216, v217
    v_cvt_pk_bf16_f32 v203, v218, v219
    ds_write_b128 v87, v[200:203] offset:4096
    v_cvt_pk_bf16_f32 v204, v204, v205
    v_cvt_pk_bf16_f32 v205, v206, v207
    v_cvt_pk_bf16_f32 v206, v220, v221
    v_cvt_pk_bf16_f32 v207, v222, v223
    ds_write_b128 v87, v[204:207] offset:6144
    v_cvt_pk_bf16_f32 v236, v236, v237
    v_cvt_pk_bf16_f32 v237, v238, v239
    v_cvt_pk_bf16_f32 v238, v252, v253
    v_cvt_pk_bf16_f32 v239, v254, v255
    ds_write_b128 v87, v[236:239] offset:7168
    v_cvt_pk_bf16_f32 v232, v232, v233
    v_cvt_pk_bf16_f32 v233, v234, v235
    v_cvt_pk_bf16_f32 v234, v248, v249
    v_cvt_pk_bf16_f32 v235, v250, v251
    ds_write_b128 v87, v[232:235] offset:5120
    v_cvt_pk_bf16_f32 v228, v228, v229
    v_cvt_pk_bf16_f32 v229, v230, v231
    v_cvt_pk_bf16_f32 v230, v244, v245
    v_cvt_pk_bf16_f32 v231, v246, v247
    ds_write_b128 v87, v[228:231] offset:3072
    v_cvt_pk_bf16_f32 v224, v224, v225
    v_cvt_pk_bf16_f32 v225, v226, v227
    v_cvt_pk_bf16_f32 v226, v240, v241
    v_cvt_pk_bf16_f32 v227, v242, v243
    ds_write_b128 v87, v[224:227] offset:1024
    s_waitcnt vmcnt(13)
    v_mfma_f32_16x16x32_bf16 v[192:195], v[64:67], a[0:3], 0
    v_mfma_f32_16x16x32_bf16 v[208:211], v[68:71], a[0:3], 0
    s_xor_b32 s42, s20, 81920
    buffer_load_dwordx4 v[48:51], v3, s[12:15], s42 offen offset:0 sc1
    v_mfma_f32_16x16x32_bf16 v[196:199], v[64:67], a[64:67], 0
    v_fma_f32 v112, -v136, v136, s0
    v_mfma_f32_16x16x32_bf16 v[212:215], v[68:71], a[64:67], 0
    ds_read_b128 v[80:83], v87 offset:0
    s_waitcnt lgkmcnt(14)
    ds_read_b128 v[92:95], v87 offset:1024
    v_mfma_f32_16x16x32_bf16 v[200:203], v[64:67], a[128:131], 0
    v_fma_f32 v113, -v137, v137, s0
    v_fma_f32 v114, -v138, v138, s0
    v_mfma_f32_16x16x32_bf16 v[216:219], v[68:71], a[128:131], 0
    buffer_load_dwordx4 v[52:55], v3, s[12:15], s42 offen offset:1024 sc1
    v_fma_f32 v115, -v139, v139, s0
    v_mfma_f32_16x16x32_bf16 v[204:207], v[64:67], a[192:195], 0
    v_fma_f32 v116, -v152, v152, s0
    v_fma_f32 v117, -v153, v153, s0
    v_mfma_f32_16x16x32_bf16 v[220:223], v[68:71], a[192:195], 0
    v_fma_f32 v118, -v154, v154, s0
    v_fma_f32 v119, -v155, v155, s0
    v_mfma_f32_16x16x32_bf16 v[236:239], v[72:75], a[192:195], 0
    v_mul_f32 v112, v112, v136
    v_mfma_f32_16x16x32_bf16 v[252:255], v[76:79], a[192:195], 0
    buffer_load_dwordx4 v[56:59], v3, s[12:15], s42 offen offset:2048 sc1
    v_mul_f32 v113, v113, v137
    v_mfma_f32_16x16x32_bf16 v[232:235], v[72:75], a[128:131], 0
    v_mul_f32 v114, v114, v138
    v_mul_f32 v115, v115, v139
    v_mfma_f32_16x16x32_bf16 v[248:251], v[76:79], a[128:131], 0
    v_mul_f32 v116, v116, v152
    v_mul_f32 v117, v117, v153
    v_mfma_f32_16x16x32_bf16 v[228:231], v[72:75], a[64:67], 0
    v_mul_f32 v118, v118, v154
    v_mul_f32 v119, v119, v155
    v_mfma_f32_16x16x32_bf16 v[244:247], v[76:79], a[64:67], 0
    buffer_load_dwordx4 v[60:63], v3, s[12:15], s42 offen offset:3072 sc1
    v_mfma_f32_16x16x32_bf16 v[224:227], v[72:75], a[0:3], 0
    v_exp_f32 v112, v112
    v_mfma_f32_16x16x32_bf16 v[240:243], v[76:79], a[0:3], 0
    s_waitcnt lgkmcnt(1)
    buffer_store_dwordx4 v[80:83], v3, s[12:15], s40 offen offset:0 sc1
    s_waitcnt lgkmcnt(0)
    buffer_store_dwordx4 v[92:95], v3, s[12:15], s40 offen offset:1024 sc1
    s_waitcnt vmcnt(15)
    v_mfma_f32_16x16x32_bf16 v[192:195], v[96:99], a[4:7], v[192:195]
    v_exp_f32 v113, v113
    v_mfma_f32_16x16x32_bf16 v[208:211], v[100:103], a[4:7], v[208:211]
    s_xor_b32 s42, s20, 86016
    buffer_load_dwordx4 v[64:67], v3, s[12:15], s42 offen offset:0 sc1
    v_mfma_f32_16x16x32_bf16 v[196:199], v[96:99], a[68:71], v[196:199]
    v_exp_f32 v114, v114
    v_mfma_f32_16x16x32_bf16 v[212:215], v[100:103], a[68:71], v[212:215]
    ds_read_b128 v[80:83], v87 offset:2048
    ds_read_b128 v[92:95], v87 offset:3072
    v_mfma_f32_16x16x32_bf16 v[200:203], v[96:99], a[132:135], v[200:203]
    v_exp_f32 v115, v115
    v_mfma_f32_16x16x32_bf16 v[216:219], v[100:103], a[132:135], v[216:219]
    buffer_load_dwordx4 v[68:71], v3, s[12:15], s42 offen offset:1024 sc1
    v_mfma_f32_16x16x32_bf16 v[204:207], v[96:99], a[196:199], v[204:207]
    v_exp_f32 v116, v116
    v_mfma_f32_16x16x32_bf16 v[220:223], v[100:103], a[196:199], v[220:223]
    v_exp_f32 v117, v117
    v_mfma_f32_16x16x32_bf16 v[236:239], v[104:107], a[196:199], v[236:239]
    v_exp_f32 v118, v118
    v_mfma_f32_16x16x32_bf16 v[252:255], v[108:111], a[196:199], v[252:255]
    buffer_load_dwordx4 v[72:75], v3, s[12:15], s42 offen offset:2048 sc1
    v_exp_f32 v119, v119
    v_mfma_f32_16x16x32_bf16 v[232:235], v[104:107], a[132:135], v[232:235]
    v_fma_f32 v112, v112, s1, s1
    v_mfma_f32_16x16x32_bf16 v[248:251], v[108:111], a[132:135], v[248:251]
    v_fma_f32 v113, v113, s1, s1
    v_fma_f32 v114, v114, s1, s1
    v_mfma_f32_16x16x32_bf16 v[228:231], v[104:107], a[68:71], v[228:231]
    v_fma_f32 v115, v115, s1, s1
    v_fma_f32 v116, v116, s1, s1
    v_mfma_f32_16x16x32_bf16 v[244:247], v[108:111], a[68:71], v[244:247]
    buffer_load_dwordx4 v[76:79], v3, s[12:15], s42 offen offset:3072 sc1
    v_fma_f32 v117, v117, s1, s1
    v_mfma_f32_16x16x32_bf16 v[224:227], v[104:107], a[4:7], v[224:227]
    v_fma_f32 v118, v118, s1, s1
    v_fma_f32 v119, v119, s1, s1
    v_mfma_f32_16x16x32_bf16 v[240:243], v[108:111], a[4:7], v[240:243]
    s_waitcnt lgkmcnt(1)
    buffer_store_dwordx4 v[80:83], v3, s[12:15], s40 offen offset:2048 sc1
    s_waitcnt lgkmcnt(0)
    buffer_store_dwordx4 v[92:95], v3, s[12:15], s40 offen offset:3072 sc1
    s_waitcnt vmcnt(17)
    v_mfma_f32_16x16x32_bf16 v[192:195], v[16:19], a[8:11], v[192:195]
    v_mfma_f32_16x16x32_bf16 v[208:211], v[20:23], a[8:11], v[208:211]
    s_xor_b32 s42, s20, 90112
    buffer_load_dwordx4 v[96:99], v3, s[12:15], s42 offen offset:0 sc1
    v_rcp_f32 v112, v112
    v_mfma_f32_16x16x32_bf16 v[196:199], v[16:19], a[72:75], v[196:199]
    v_rcp_f32 v113, v113
    v_mfma_f32_16x16x32_bf16 v[212:215], v[20:23], a[72:75], v[212:215]
    ds_read_b128 v[80:83], v87 offset:4096
    ds_read_b128 v[92:95], v87 offset:5120
    v_mfma_f32_16x16x32_bf16 v[200:203], v[16:19], a[136:139], v[200:203]
    v_rcp_f32 v114, v114
    v_mfma_f32_16x16x32_bf16 v[216:219], v[20:23], a[136:139], v[216:219]
    buffer_load_dwordx4 v[100:103], v3, s[12:15], s42 offen offset:1024 sc1
    v_mfma_f32_16x16x32_bf16 v[204:207], v[16:19], a[200:203], v[204:207]
    v_rcp_f32 v115, v115
    v_mfma_f32_16x16x32_bf16 v[220:223], v[20:23], a[200:203], v[220:223]
    v_rcp_f32 v116, v116
    v_mfma_f32_16x16x32_bf16 v[236:239], v[24:27], a[200:203], v[236:239]
    v_rcp_f32 v117, v117
    v_mfma_f32_16x16x32_bf16 v[252:255], v[28:31], a[200:203], v[252:255]
    buffer_load_dwordx4 v[104:107], v3, s[12:15], s42 offen offset:2048 sc1
    v_mfma_f32_16x16x32_bf16 v[232:235], v[24:27], a[136:139], v[232:235]
    v_rcp_f32 v118, v118
    v_mfma_f32_16x16x32_bf16 v[248:251], v[28:31], a[136:139], v[248:251]
    v_rcp_f32 v119, v119
    v_mfma_f32_16x16x32_bf16 v[228:231], v[24:27], a[72:75], v[228:231]
    v_mul_f32 v136, v112, v136
    v_mul_f32 v137, v113, v137
    v_mfma_f32_16x16x32_bf16 v[244:247], v[28:31], a[72:75], v[244:247]
    buffer_load_dwordx4 v[108:111], v3, s[12:15], s42 offen offset:3072 sc1
    v_mul_f32 v138, v114, v138
    v_mfma_f32_16x16x32_bf16 v[224:227], v[24:27], a[8:11], v[224:227]
    v_mul_f32 v139, v115, v139
    v_mul_f32 v152, v116, v152
    v_mfma_f32_16x16x32_bf16 v[240:243], v[28:31], a[8:11], v[240:243]
    s_waitcnt lgkmcnt(1)
    buffer_store_dwordx4 v[80:83], v3, s[12:15], s7 offen offset:0 sc1
    s_waitcnt lgkmcnt(0)
    buffer_store_dwordx4 v[92:95], v3, s[12:15], s7 offen offset:1024 sc1
    s_waitcnt vmcnt(18)
    v_mfma_f32_16x16x32_bf16 v[192:195], v[32:35], a[12:15], v[192:195]
    v_mul_f32 v153, v117, v153
    v_mul_f32 v154, v118, v154
    v_mfma_f32_16x16x32_bf16 v[208:211], v[36:39], a[12:15], v[208:211]
    s_xor_b32 s42, s20, 94208
    buffer_load_dwordx4 v[16:19], v3, s[12:15], s42 offen offset:0 sc1
    v_mul_f32 v155, v119, v155
    v_mfma_f32_16x16x32_bf16 v[196:199], v[32:35], a[76:79], v[196:199]
    v_cvt_pk_bf16_f32 v120, v136, v137
    v_mfma_f32_16x16x32_bf16 v[212:215], v[36:39], a[76:79], v[212:215]
    ds_read_b128 v[80:83], v87 offset:6144
    ds_read_b128 v[92:95], v87 offset:7168
    v_mfma_f32_16x16x32_bf16 v[200:203], v[32:35], a[140:143], v[200:203]
    v_cvt_pk_bf16_f32 v121, v138, v139
    v_cvt_pk_bf16_f32 v122, v152, v153
    v_mfma_f32_16x16x32_bf16 v[216:219], v[36:39], a[140:143], v[216:219]
    buffer_load_dwordx4 v[20:23], v3, s[12:15], s42 offen offset:1024 sc1
    v_cvt_pk_bf16_f32 v123, v154, v155
    v_mfma_f32_16x16x32_bf16 v[204:207], v[32:35], a[204:207], v[204:207]
    v_mul_f32 v112, v136, v136
    v_fmac_f32 v112, v137, v137
    v_mfma_f32_16x16x32_bf16 v[220:223], v[36:39], a[204:207], v[220:223]
    v_fmac_f32 v112, v138, v138
    v_fmac_f32 v112, v139, v139
    v_mfma_f32_16x16x32_bf16 v[236:239], v[40:43], a[204:207], v[236:239]
    v_fmac_f32 v112, v152, v152
    v_mfma_f32_16x16x32_bf16 v[252:255], v[44:47], a[204:207], v[252:255]
    buffer_load_dwordx4 v[24:27], v3, s[12:15], s42 offen offset:2048 sc1
    v_fmac_f32 v112, v153, v153
    v_mfma_f32_16x16x32_bf16 v[232:235], v[40:43], a[140:143], v[232:235]
    v_fmac_f32 v112, v154, v154
    v_fmac_f32 v112, v155, v155
    v_mfma_f32_16x16x32_bf16 v[248:251], v[44:47], a[140:143], v[248:251]
    v_add_f32 v136, v136, v137
    v_add_f32 v136, v136, v138
    v_mfma_f32_16x16x32_bf16 v[228:231], v[40:43], a[76:79], v[228:231]
    v_add_f32 v136, v136, v139
    v_add_f32 v136, v136, v152
    v_mfma_f32_16x16x32_bf16 v[244:247], v[44:47], a[76:79], v[244:247]
    buffer_load_dwordx4 v[28:31], v3, s[12:15], s42 offen offset:3072 sc1
    v_add_f32 v136, v136, v153
    v_mfma_f32_16x16x32_bf16 v[224:227], v[40:43], a[12:15], v[224:227]
    v_add_f32 v136, v136, v154
    v_mfma_f32_16x16x32_bf16 v[240:243], v[44:47], a[12:15], v[240:243]
    s_waitcnt lgkmcnt(1)
    buffer_store_dwordx4 v[80:83], v3, s[12:15], s7 offen offset:2048 sc1
    s_waitcnt lgkmcnt(0)
    buffer_store_dwordx4 v[92:95], v3, s[12:15], s7 offen offset:3072 sc1
    s_waitcnt vmcnt(20)
    v_mfma_f32_16x16x32_bf16 v[192:195], v[48:51], a[16:19], v[192:195]
    v_add_f32 v136, v136, v155
    v_mov_b32 v137, v112
    v_mfma_f32_16x16x32_bf16 v[208:211], v[52:55], a[16:19], v[208:211]
    s_xor_b32 s42, s20, 98304
    buffer_load_dwordx4 v[32:35], v3, s[12:15], s42 offen offset:0 sc1
    ds_write_b64 v84, v[120:121] offset:0
    v_mfma_f32_16x16x32_bf16 v[196:199], v[48:51], a[80:83], v[196:199]
    ds_write_b64 v84, v[122:123] offset:32
    s_add_u32 s29, s17, 8192
    buffer_store_dwordx4 v[164:167], v86, s[12:15], s29 offen
    v_mfma_f32_16x16x32_bf16 v[212:215], v[52:55], a[80:83], v[212:215]
    v_fma_f32 v112, -v168, v168, s0
    v_fma_f32 v113, -v169, v169, s0
    v_mfma_f32_16x16x32_bf16 v[200:203], v[48:51], a[144:147], v[200:203]
    v_fma_f32 v114, -v170, v170, s0
    v_mfma_f32_16x16x32_bf16 v[216:219], v[52:55], a[144:147], v[216:219]
    buffer_load_dwordx4 v[36:39], v3, s[12:15], s42 offen offset:1024 sc1
    v_fma_f32 v115, -v171, v171, s0
    v_mfma_f32_16x16x32_bf16 v[204:207], v[48:51], a[208:211], v[204:207]
    v_fma_f32 v116, -v184, v184, s0
    v_fma_f32 v117, -v185, v185, s0
    v_mfma_f32_16x16x32_bf16 v[220:223], v[52:55], a[208:211], v[220:223]
    v_fma_f32 v118, -v186, v186, s0
    v_fma_f32 v119, -v187, v187, s0
    v_mfma_f32_16x16x32_bf16 v[236:239], v[56:59], a[208:211], v[236:239]
    v_mul_f32 v112, v112, v168
    v_mul_f32 v113, v113, v169
    v_mfma_f32_16x16x32_bf16 v[252:255], v[60:63], a[208:211], v[252:255]
    buffer_load_dwordx4 v[40:43], v3, s[12:15], s42 offen offset:2048 sc1
    v_mfma_f32_16x16x32_bf16 v[232:235], v[56:59], a[144:147], v[232:235]
    v_mul_f32 v114, v114, v170
    v_mul_f32 v115, v115, v171
    v_mfma_f32_16x16x32_bf16 v[248:251], v[60:63], a[144:147], v[248:251]
    v_mul_f32 v116, v116, v184
    v_mul_f32 v117, v117, v185
    v_mfma_f32_16x16x32_bf16 v[228:231], v[56:59], a[80:83], v[228:231]
    v_mul_f32 v118, v118, v186
    v_mul_f32 v119, v119, v187
    v_mfma_f32_16x16x32_bf16 v[244:247], v[60:63], a[80:83], v[244:247]
    buffer_load_dwordx4 v[44:47], v3, s[12:15], s42 offen offset:3072 sc1
    v_mfma_f32_16x16x32_bf16 v[224:227], v[56:59], a[16:19], v[224:227]
    v_exp_f32 v112, v112
    v_mfma_f32_16x16x32_bf16 v[240:243], v[60:63], a[16:19], v[240:243]
    v_exp_f32 v113, v113
    s_waitcnt vmcnt(19)
    v_mfma_f32_16x16x32_bf16 v[192:195], v[64:67], a[20:23], v[192:195]
    v_exp_f32 v114, v114
    v_mfma_f32_16x16x32_bf16 v[208:211], v[68:71], a[20:23], v[208:211]
    s_xor_b32 s42, s20, 102400
    buffer_load_dwordx4 v[48:51], v3, s[12:15], s42 offen offset:0 sc1
    v_mfma_f32_16x16x32_bf16 v[196:199], v[64:67], a[84:87], v[196:199]
    v_exp_f32 v115, v115
    v_mfma_f32_16x16x32_bf16 v[212:215], v[68:71], a[84:87], v[212:215]
    v_exp_f32 v116, v116
    v_mfma_f32_16x16x32_bf16 v[200:203], v[64:67], a[148:151], v[200:203]
    v_exp_f32 v117, v117
    v_mfma_f32_16x16x32_bf16 v[216:219], v[68:71], a[148:151], v[216:219]
    buffer_load_dwordx4 v[52:55], v3, s[12:15], s42 offen offset:1024 sc1
    v_mfma_f32_16x16x32_bf16 v[204:207], v[64:67], a[212:215], v[204:207]
    v_exp_f32 v118, v118
    v_mfma_f32_16x16x32_bf16 v[220:223], v[68:71], a[212:215], v[220:223]
    v_exp_f32 v119, v119
    v_fma_f32 v112, v112, s1, s1
    v_mfma_f32_16x16x32_bf16 v[236:239], v[72:75], a[212:215], v[236:239]
    v_fma_f32 v113, v113, s1, s1
    v_mfma_f32_16x16x32_bf16 v[252:255], v[76:79], a[212:215], v[252:255]
    buffer_load_dwordx4 v[56:59], v3, s[12:15], s42 offen offset:2048 sc1
    v_fma_f32 v114, v114, s1, s1
    v_mfma_f32_16x16x32_bf16 v[232:235], v[72:75], a[148:151], v[232:235]
    v_fma_f32 v115, v115, s1, s1
    v_fma_f32 v116, v116, s1, s1
    v_mfma_f32_16x16x32_bf16 v[248:251], v[76:79], a[148:151], v[248:251]
    v_fma_f32 v117, v117, s1, s1
    v_fma_f32 v118, v118, s1, s1
    v_mfma_f32_16x16x32_bf16 v[228:231], v[72:75], a[84:87], v[228:231]
    v_fma_f32 v119, v119, s1, s1
    v_mfma_f32_16x16x32_bf16 v[244:247], v[76:79], a[84:87], v[244:247]
    buffer_load_dwordx4 v[60:63], v3, s[12:15], s42 offen offset:3072 sc1
    v_rcp_f32 v112, v112
    v_mfma_f32_16x16x32_bf16 v[224:227], v[72:75], a[20:23], v[224:227]
    v_mfma_f32_16x16x32_bf16 v[240:243], v[76:79], a[20:23], v[240:243]
    v_rcp_f32 v113, v113
    s_waitcnt vmcnt(17)
    v_mfma_f32_16x16x32_bf16 v[192:195], v[96:99], a[24:27], v[192:195]
    v_rcp_f32 v114, v114
    v_mfma_f32_16x16x32_bf16 v[208:211], v[100:103], a[24:27], v[208:211]
    s_xor_b32 s42, s20, 106496
    buffer_load_dwordx4 v[64:67], v3, s[12:15], s42 offen offset:0 sc1
    v_rcp_f32 v115, v115
    v_mfma_f32_16x16x32_bf16 v[196:199], v[96:99], a[88:91], v[196:199]
    v_rcp_f32 v116, v116
    v_mfma_f32_16x16x32_bf16 v[212:215], v[100:103], a[88:91], v[212:215]
    v_mfma_f32_16x16x32_bf16 v[200:203], v[96:99], a[152:155], v[200:203]
    v_rcp_f32 v117, v117
    v_mfma_f32_16x16x32_bf16 v[216:219], v[100:103], a[152:155], v[216:219]
    buffer_load_dwordx4 v[68:71], v3, s[12:15], s42 offen offset:1024 sc1
    v_rcp_f32 v118, v118
    v_mfma_f32_16x16x32_bf16 v[204:207], v[96:99], a[216:219], v[204:207]
    v_rcp_f32 v119, v119
    v_mfma_f32_16x16x32_bf16 v[220:223], v[100:103], a[216:219], v[220:223]
    v_mul_f32 v168, v112, v168
    v_mul_f32 v169, v113, v169
    v_mfma_f32_16x16x32_bf16 v[236:239], v[104:107], a[216:219], v[236:239]
    v_mul_f32 v170, v114, v170
    v_mfma_f32_16x16x32_bf16 v[252:255], v[108:111], a[216:219], v[252:255]
    buffer_load_dwordx4 v[72:75], v3, s[12:15], s42 offen offset:2048 sc1
    v_mul_f32 v171, v115, v171
    v_mfma_f32_16x16x32_bf16 v[232:235], v[104:107], a[152:155], v[232:235]
    v_mul_f32 v184, v116, v184
    v_mul_f32 v185, v117, v185
    v_mfma_f32_16x16x32_bf16 v[248:251], v[108:111], a[152:155], v[248:251]
    v_mul_f32 v186, v118, v186
    v_mul_f32 v187, v119, v187
    v_mfma_f32_16x16x32_bf16 v[228:231], v[104:107], a[88:91], v[228:231]
    v_cvt_pk_bf16_f32 v124, v168, v169
    v_cvt_pk_bf16_f32 v125, v170, v171
    v_mfma_f32_16x16x32_bf16 v[244:247], v[108:111], a[88:91], v[244:247]
    buffer_load_dwordx4 v[76:79], v3, s[12:15], s42 offen offset:3072 sc1
    v_cvt_pk_bf16_f32 v126, v184, v185
    v_mfma_f32_16x16x32_bf16 v[224:227], v[104:107], a[24:27], v[224:227]
    v_cvt_pk_bf16_f32 v127, v186, v187
    v_mfma_f32_16x16x32_bf16 v[240:243], v[108:111], a[24:27], v[240:243]
    v_add_f32 v136, v136, v168
    v_fmac_f32 v137, v168, v168
    s_waitcnt vmcnt(15)
    v_mfma_f32_16x16x32_bf16 v[192:195], v[16:19], a[28:31], v[192:195]
    v_add_f32 v136, v136, v169
    v_fmac_f32 v137, v169, v169
    v_mfma_f32_16x16x32_bf16 v[208:211], v[20:23], a[28:31], v[208:211]
    s_xor_b32 s42, s20, 110592
    buffer_load_dwordx4 v[96:99], v3, s[12:15], s42 offen offset:0 sc1
    v_add_f32 v136, v136, v170
    v_mfma_f32_16x16x32_bf16 v[196:199], v[16:19], a[92:95], v[196:199]
    v_fmac_f32 v137, v170, v170
    v_add_f32 v136, v136, v171
    v_mfma_f32_16x16x32_bf16 v[212:215], v[20:23], a[92:95], v[212:215]
    s_waitcnt vmcnt(14)
    buffer_store_dword v12, off, s[12:15], s41 sc1
    v_mfma_f32_16x16x32_bf16 v[200:203], v[16:19], a[156:159], v[200:203]
    v_fmac_f32 v137, v171, v171
    v_add_f32 v136, v136, v184
    v_mfma_f32_16x16x32_bf16 v[216:219], v[20:23], a[156:159], v[216:219]
    buffer_load_dwordx4 v[100:103], v3, s[12:15], s42 offen offset:1024 sc1
    v_fmac_f32 v137, v184, v184
    v_mfma_f32_16x16x32_bf16 v[204:207], v[16:19], a[220:223], v[204:207]
    v_add_f32 v136, v136, v185
    v_fmac_f32 v137, v185, v185
    v_mfma_f32_16x16x32_bf16 v[220:223], v[20:23], a[220:223], v[220:223]
    v_add_f32 v136, v136, v186
    v_fmac_f32 v137, v186, v186
    v_mfma_f32_16x16x32_bf16 v[236:239], v[24:27], a[220:223], v[236:239]
    v_add_f32 v136, v136, v187
    v_mfma_f32_16x16x32_bf16 v[252:255], v[28:31], a[220:223], v[252:255]
    buffer_load_dwordx4 v[104:107], v3, s[12:15], s42 offen offset:2048 sc1
    v_fmac_f32 v137, v187, v187
    v_mfma_f32_16x16x32_bf16 v[232:235], v[24:27], a[156:159], v[232:235]
    ds_write_b64 v84, v[124:125] offset:64
    ds_write_b64 v84, v[126:127] offset:96
    v_mfma_f32_16x16x32_bf16 v[248:251], v[28:31], a[156:159], v[248:251]
    s_add_u32 s29, s17, 12288
    buffer_store_dwordx4 v[180:183], v86, s[12:15], s29 offen
    ds_read_b128 v[168:171], v85 offset:0
    v_mfma_f32_16x16x32_bf16 v[228:231], v[24:27], a[92:95], v[228:231]
    ds_read_b128 v[184:187], v85 offset:1152
    v_fma_f32 v112, -v140, v140, s0
    v_mfma_f32_16x16x32_bf16 v[244:247], v[28:31], a[92:95], v[244:247]
    buffer_load_dwordx4 v[108:111], v3, s[12:15], s42 offen offset:3072 sc1
    v_fma_f32 v113, -v141, v141, s0
    v_mfma_f32_16x16x32_bf16 v[224:227], v[24:27], a[28:31], v[224:227]
    v_fma_f32 v114, -v142, v142, s0
    v_mfma_f32_16x16x32_bf16 v[240:243], v[28:31], a[28:31], v[240:243]
    v_fma_f32 v115, -v143, v143, s0
    v_fma_f32 v116, -v156, v156, s0
    s_waitcnt vmcnt(14)
    v_mfma_f32_16x16x32_bf16 v[192:195], v[32:35], a[32:35], v[192:195]
    v_fma_f32 v117, -v157, v157, s0
    v_fma_f32 v118, -v158, v158, s0
    v_mfma_f32_16x16x32_bf16 v[208:211], v[36:39], a[32:35], v[208:211]
    s_xor_b32 s42, s20, 114688
    buffer_load_dwordx4 v[16:19], v3, s[12:15], s42 offen offset:0 sc1
    v_fma_f32 v119, -v159, v159, s0
    v_mfma_f32_16x16x32_bf16 v[196:199], v[32:35], a[96:99], v[196:199]
    v_mul_f32 v112, v112, v140
    v_mul_f32 v113, v113, v141
    v_mfma_f32_16x16x32_bf16 v[212:215], v[36:39], a[96:99], v[212:215]
    v_mul_f32 v114, v114, v142
    v_mfma_f32_16x16x32_bf16 v[200:203], v[32:35], a[160:163], v[200:203]
    v_mul_f32 v115, v115, v143
    v_mul_f32 v116, v116, v156
    v_mfma_f32_16x16x32_bf16 v[216:219], v[36:39], a[160:163], v[216:219]
    buffer_load_dwordx4 v[20:23], v3, s[12:15], s42 offen offset:1024 sc1
    v_mul_f32 v117, v117, v157
    v_mfma_f32_16x16x32_bf16 v[204:207], v[32:35], a[224:227], v[204:207]
    v_mul_f32 v118, v118, v158
    v_mul_f32 v119, v119, v159
    v_mfma_f32_16x16x32_bf16 v[220:223], v[36:39], a[224:227], v[220:223]
    v_exp_f32 v112, v112
    v_mfma_f32_16x16x32_bf16 v[236:239], v[40:43], a[224:227], v[236:239]
    v_mfma_f32_16x16x32_bf16 v[252:255], v[44:47], a[224:227], v[252:255]
    buffer_load_dwordx4 v[24:27], v3, s[12:15], s42 offen offset:2048 sc1
    v_exp_f32 v113, v113
    v_mfma_f32_16x16x32_bf16 v[232:235], v[40:43], a[160:163], v[232:235]
    v_exp_f32 v114, v114
    v_mfma_f32_16x16x32_bf16 v[248:251], v[44:47], a[160:163], v[248:251]
    v_exp_f32 v115, v115
    v_mfma_f32_16x16x32_bf16 v[228:231], v[40:43], a[96:99], v[228:231]
    v_exp_f32 v116, v116
    v_mfma_f32_16x16x32_bf16 v[244:247], v[44:47], a[96:99], v[244:247]
    buffer_load_dwordx4 v[28:31], v3, s[12:15], s42 offen offset:3072 sc1
    v_mfma_f32_16x16x32_bf16 v[224:227], v[40:43], a[32:35], v[224:227]
    v_exp_f32 v117, v117
    v_mfma_f32_16x16x32_bf16 v[240:243], v[44:47], a[32:35], v[240:243]
    v_exp_f32 v118, v118
    s_waitcnt vmcnt(14)
    v_mfma_f32_16x16x32_bf16 v[192:195], v[48:51], a[36:39], v[192:195]
    v_exp_f32 v119, v119
    v_mfma_f32_16x16x32_bf16 v[208:211], v[52:55], a[36:39], v[208:211]
    s_xor_b32 s42, s20, 118784
    buffer_load_dwordx4 v[32:35], v3, s[12:15], s42 offen offset:0 sc1
    v_fma_f32 v112, v112, s1, s1
    v_mfma_f32_16x16x32_bf16 v[196:199], v[48:51], a[100:103], v[196:199]
    v_fma_f32 v113, v113, s1, s1
    v_mfma_f32_16x16x32_bf16 v[212:215], v[52:55], a[100:103], v[212:215]
    v_fma_f32 v114, v114, s1, s1
    v_fma_f32 v115, v115, s1, s1
    v_mfma_f32_16x16x32_bf16 v[200:203], v[48:51], a[164:167], v[200:203]
    v_fma_f32 v116, v116, s1, s1
    v_fma_f32 v117, v117, s1, s1
    v_mfma_f32_16x16x32_bf16 v[216:219], v[52:55], a[164:167], v[216:219]
    buffer_load_dwordx4 v[36:39], v3, s[12:15], s42 offen offset:1024 sc1
    v_fma_f32 v118, v118, s1, s1
    v_mfma_f32_16x16x32_bf16 v[204:207], v[48:51], a[228:231], v[204:207]
    v_fma_f32 v119, v119, s1, s1
    v_mfma_f32_16x16x32_bf16 v[220:223], v[52:55], a[228:231], v[220:223]
    buffer_load_dword v14, v13, s[92:95], 0 offen offset:8 sc1
    v_rcp_f32 v112, v112
    v_mfma_f32_16x16x32_bf16 v[236:239], v[56:59], a[228:231], v[236:239]
    v_mfma_f32_16x16x32_bf16 v[252:255], v[60:63], a[228:231], v[252:255]
    buffer_load_dwordx4 v[40:43], v3, s[12:15], s42 offen offset:2048 sc1
    v_rcp_f32 v113, v113
    v_mfma_f32_16x16x32_bf16 v[232:235], v[56:59], a[164:167], v[232:235]
    v_rcp_f32 v114, v114
    v_mfma_f32_16x16x32_bf16 v[248:251], v[60:63], a[164:167], v[248:251]
    v_rcp_f32 v115, v115
    v_mfma_f32_16x16x32_bf16 v[228:231], v[56:59], a[100:103], v[228:231]
    v_rcp_f32 v116, v116
    v_mfma_f32_16x16x32_bf16 v[244:247], v[60:63], a[100:103], v[244:247]
    buffer_load_dwordx4 v[44:47], v3, s[12:15], s42 offen offset:3072 sc1
    v_mfma_f32_16x16x32_bf16 v[224:227], v[56:59], a[36:39], v[224:227]
    v_rcp_f32 v117, v117
    v_mfma_f32_16x16x32_bf16 v[240:243], v[60:63], a[36:39], v[240:243]
    v_rcp_f32 v118, v118
    s_waitcnt vmcnt(15)
    v_mfma_f32_16x16x32_bf16 v[192:195], v[64:67], a[40:43], v[192:195]
    v_rcp_f32 v119, v119
    v_mfma_f32_16x16x32_bf16 v[208:211], v[68:71], a[40:43], v[208:211]
    s_xor_b32 s42, s20, 122880
    buffer_load_dwordx4 v[48:51], v3, s[12:15], s42 offen offset:0 sc1
    v_mul_f32 v140, v112, v140
    v_mfma_f32_16x16x32_bf16 v[196:199], v[64:67], a[104:107], v[196:199]
    v_mul_f32 v141, v113, v141
    v_mul_f32 v142, v114, v142
    v_mfma_f32_16x16x32_bf16 v[212:215], v[68:71], a[104:107], v[212:215]
    v_mul_f32 v143, v115, v143
    v_mfma_f32_16x16x32_bf16 v[200:203], v[64:67], a[168:171], v[200:203]
    v_mul_f32 v156, v116, v156
    v_mul_f32 v157, v117, v157
    v_mfma_f32_16x16x32_bf16 v[216:219], v[68:71], a[168:171], v[216:219]
    buffer_load_dwordx4 v[52:55], v3, s[12:15], s42 offen offset:1024 sc1
    v_mul_f32 v158, v118, v158
    v_mfma_f32_16x16x32_bf16 v[204:207], v[64:67], a[232:235], v[204:207]
    v_mul_f32 v159, v119, v159
    v_cvt_pk_bf16_f32 v120, v140, v141
    v_mfma_f32_16x16x32_bf16 v[220:223], v[68:71], a[232:235], v[220:223]
    v_cvt_pk_bf16_f32 v121, v142, v143
    v_cvt_pk_bf16_f32 v122, v156, v157
    v_mfma_f32_16x16x32_bf16 v[236:239], v[72:75], a[232:235], v[236:239]
    v_cvt_pk_bf16_f32 v123, v158, v159
    v_mfma_f32_16x16x32_bf16 v[252:255], v[76:79], a[232:235], v[252:255]
    buffer_load_dwordx4 v[56:59], v3, s[12:15], s42 offen offset:2048 sc1
    v_mul_f32 v112, v140, v140
    v_mfma_f32_16x16x32_bf16 v[232:235], v[72:75], a[168:171], v[232:235]
    v_fmac_f32 v112, v141, v141
    v_fmac_f32 v112, v142, v142
    v_mfma_f32_16x16x32_bf16 v[248:251], v[76:79], a[168:171], v[248:251]
    v_fmac_f32 v112, v143, v143
    v_fmac_f32 v112, v156, v156
    v_mfma_f32_16x16x32_bf16 v[228:231], v[72:75], a[104:107], v[228:231]
    v_fmac_f32 v112, v157, v157
    v_fmac_f32 v112, v158, v158
    v_mfma_f32_16x16x32_bf16 v[244:247], v[76:79], a[104:107], v[244:247]
    buffer_load_dwordx4 v[60:63], v3, s[12:15], s42 offen offset:3072 sc1
    v_mfma_f32_16x16x32_bf16 v[224:227], v[72:75], a[40:43], v[224:227]
    v_fmac_f32 v112, v159, v159
    v_add_f32 v140, v140, v141
    v_mfma_f32_16x16x32_bf16 v[240:243], v[76:79], a[40:43], v[240:243]
    v_add_f32 v140, v140, v142
    v_add_f32 v140, v140, v143
    s_waitcnt vmcnt(13)
    v_mfma_f32_16x16x32_bf16 v[192:195], v[96:99], a[44:47], v[192:195]
    v_add_f32 v140, v140, v156
    v_add_f32 v140, v140, v157
    v_mfma_f32_16x16x32_bf16 v[208:211], v[100:103], a[44:47], v[208:211]
    s_xor_b32 s42, s20, 126976
    buffer_load_dwordx4 v[64:67], v3, s[12:15], s42 offen offset:0 sc1
    v_add_f32 v140, v140, v158
    v_mfma_f32_16x16x32_bf16 v[196:199], v[96:99], a[108:111], v[196:199]
    v_add_f32 v140, v140, v159
    v_mfma_f32_16x16x32_bf16 v[212:215], v[100:103], a[108:111], v[212:215]
    buffer_load_dword v15, off, s[12:15], s6 sc1
    v_mov_b32 v141, v112
    v_mfma_f32_16x16x32_bf16 v[200:203], v[96:99], a[172:175], v[200:203]
    ds_write_b64 v84, v[120:121] offset:0
    ds_write_b64 v84, v[122:123] offset:32
    v_mfma_f32_16x16x32_bf16 v[216:219], v[100:103], a[172:175], v[216:219]
    buffer_load_dwordx4 v[68:71], v3, s[12:15], s42 offen offset:1024 sc1
    s_add_u32 s29, s17, 16384
    s_waitcnt lgkmcnt(3)
    buffer_store_dwordx4 v[168:171], v86, s[12:15], s29 offen
    v_mfma_f32_16x16x32_bf16 v[204:207], v[96:99], a[236:239], v[204:207]
    v_fma_f32 v112, -v172, v172, s0
    v_fma_f32 v113, -v173, v173, s0
    v_mfma_f32_16x16x32_bf16 v[220:223], v[100:103], a[236:239], v[220:223]
    s_mul_i32 s28, s22, 2031616
    s_add_u32 s28, s28, s24
    s_lshl_b32 s26, s25, 15
    s_add_u32 s8, s4, s28
    s_addc_u32 s9, s5, 0
    s_and_b32 s9, s9, 0xffff
    s_mov_b32 s10, s26
    s_mov_b32 s11, 0x00020000
    s_lshl_b32 s19, s16, 14
    v_fma_f32 v114, -v174, v174, s0
    v_mfma_f32_16x16x32_bf16 v[236:239], v[104:107], a[236:239], v[236:239]
    v_fma_f32 v115, -v175, v175, s0
    v_mfma_f32_16x16x32_bf16 v[252:255], v[108:111], a[236:239], v[252:255]
    buffer_load_dwordx4 v[72:75], v3, s[12:15], s42 offen offset:2048 sc1
    v_fma_f32 v116, -v188, v188, s0
    v_mfma_f32_16x16x32_bf16 v[232:235], v[104:107], a[172:175], v[232:235]
    v_fma_f32 v117, -v189, v189, s0
    v_fma_f32 v118, -v190, v190, s0
    v_mfma_f32_16x16x32_bf16 v[248:251], v[108:111], a[172:175], v[248:251]
    v_fma_f32 v119, -v191, v191, s0
    v_mul_f32 v112, v112, v172
    v_mfma_f32_16x16x32_bf16 v[228:231], v[104:107], a[108:111], v[228:231]
    v_mul_f32 v113, v113, v173
    v_mul_f32 v114, v114, v174
    v_mfma_f32_16x16x32_bf16 v[244:247], v[108:111], a[108:111], v[244:247]
    buffer_load_dwordx4 v[76:79], v3, s[12:15], s42 offen offset:3072 sc1
    v_mul_f32 v115, v115, v175
    v_mfma_f32_16x16x32_bf16 v[224:227], v[104:107], a[44:47], v[224:227]
    v_mul_f32 v116, v116, v188
    v_mfma_f32_16x16x32_bf16 v[240:243], v[108:111], a[44:47], v[240:243]
    v_mul_f32 v117, v117, v189
    v_mul_f32 v118, v118, v190
    s_waitcnt vmcnt(15)
    v_mfma_f32_16x16x32_bf16 v[192:195], v[16:19], a[48:51], v[192:195]
    s_waitcnt vmcnt(12)
    v_cmp_le_u32 vcc, 64, v14
    s_nop 1
    s_cmp_eq_u64 vcc, -1
    s_cbranch_scc0 L_c2_retry
L_c2_ok:
    v_mul_f32 v119, v119, v191
    v_mfma_f32_16x16x32_bf16 v[208:211], v[20:23], a[48:51], v[208:211]
    v_exp_f32 v112, v112
    v_mfma_f32_16x16x32_bf16 v[196:199], v[16:19], a[112:115], v[196:199]
    v_exp_f32 v113, v113
    v_mfma_f32_16x16x32_bf16 v[212:215], v[20:23], a[112:115], v[212:215]
    v_mfma_f32_16x16x32_bf16 v[200:203], v[16:19], a[176:179], v[200:203]
    s_add_u32 m0, s19, 0
    s_add_u32 s42, s19, 0
    buffer_load_dwordx4 v3, s[8:11], s42 offen offset:0 sc1 lds
    v_exp_f32 v114, v114
    v_mfma_f32_16x16x32_bf16 v[216:219], v[20:23], a[176:179], v[216:219]
    v_exp_f32 v115, v115
    v_mfma_f32_16x16x32_bf16 v[204:207], v[16:19], a[240:243], v[204:207]
    v_exp_f32 v116, v116
    v_mfma_f32_16x16x32_bf16 v[220:223], v[20:23], a[240:243], v[220:223]
    buffer_load_dwordx4 v3, s[8:11], s42 offen offset:1024 sc1 lds
    v_mfma_f32_16x16x32_bf16 v[236:239], v[24:27], a[240:243], v[236:239]
    v_exp_f32 v117, v117
    v_mfma_f32_16x16x32_bf16 v[252:255], v[28:31], a[240:243], v[252:255]
    v_exp_f32 v118, v118
    v_mfma_f32_16x16x32_bf16 v[232:235], v[24:27], a[176:179], v[232:235]
    buffer_load_dwordx4 v3, s[8:11], s42 offen offset:2048 sc1 lds
    v_mfma_f32_16x16x32_bf16 v[248:251], v[28:31], a[176:179], v[248:251]
    v_exp_f32 v119, v119
    v_fma_f32 v112, v112, s1, s1
    v_mfma_f32_16x16x32_bf16 v[228:231], v[24:27], a[112:115], v[228:231]
    v_fma_f32 v113, v113, s1, s1
    v_fma_f32 v114, v114, s1, s1
    v_mfma_f32_16x16x32_bf16 v[244:247], v[28:31], a[112:115], v[244:247]
    buffer_load_dwordx4 v3, s[8:11], s42 offen offset:3072 sc1 lds
    v_fma_f32 v115, v115, s1, s1
    v_mfma_f32_16x16x32_bf16 v[224:227], v[24:27], a[48:51], v[224:227]
    v_fma_f32 v116, v116, s1, s1
    v_mfma_f32_16x16x32_bf16 v[240:243], v[28:31], a[48:51], v[240:243]
    v_fma_f32 v117, v117, s1, s1
    v_fma_f32 v118, v118, s1, s1
    s_waitcnt vmcnt(14)
    v_mfma_f32_16x16x32_bf16 v[192:195], v[32:35], a[52:55], v[192:195]
    s_waitcnt vmcnt(8)
    v_readfirstlane_b32 s26, v15
    s_cmp_eq_u32 s26, 1
    s_cbranch_scc0 L_qa_retry
L_qa_ok:
    s_xor_b32 s40, s40, 0x8000
    s_xor_b32 s7, s7, 0x8000
    v_fma_f32 v119, v119, s1, s1
    v_mfma_f32_16x16x32_bf16 v[208:211], v[36:39], a[52:55], v[208:211]
    s_add_u32 m0, s18, 0
    s_nop 0
    buffer_load_dwordx4 v3, s[12:15], s40 offen offset:0 sc1 lds
    v_mfma_f32_16x16x32_bf16 v[196:199], v[32:35], a[116:119], v[196:199]
    v_rcp_f32 v112, v112
    v_mfma_f32_16x16x32_bf16 v[212:215], v[36:39], a[116:119], v[212:215]
    buffer_load_dwordx4 v3, s[12:15], s40 offen offset:1024 sc1 lds
    v_rcp_f32 v113, v113
    v_mfma_f32_16x16x32_bf16 v[200:203], v[32:35], a[180:183], v[200:203]
    v_mfma_f32_16x16x32_bf16 v[216:219], v[36:39], a[180:183], v[216:219]
    buffer_load_dwordx4 v3, s[12:15], s40 offen offset:2048 sc1 lds
    v_rcp_f32 v114, v114
    v_mfma_f32_16x16x32_bf16 v[204:207], v[32:35], a[244:247], v[204:207]
    v_rcp_f32 v115, v115
    v_mfma_f32_16x16x32_bf16 v[220:223], v[36:39], a[244:247], v[220:223]
    buffer_load_dwordx4 v3, s[12:15], s40 offen offset:3072 sc1 lds
    v_mfma_f32_16x16x32_bf16 v[236:239], v[40:43], a[244:247], v[236:239]
    v_rcp_f32 v116, v116
    v_mfma_f32_16x16x32_bf16 v[252:255], v[44:47], a[244:247], v[252:255]
    s_add_u32 m0, s18, 4096
    s_nop 0
    buffer_load_dwordx4 v3, s[12:15], s7 offen offset:0 sc1 lds
    v_rcp_f32 v117, v117
    v_mfma_f32_16x16x32_bf16 v[232:235], v[40:43], a[180:183], v[232:235]
    v_mfma_f32_16x16x32_bf16 v[248:251], v[44:47], a[180:183], v[248:251]
    buffer_load_dwordx4 v3, s[12:15], s7 offen offset:1024 sc1 lds
    v_rcp_f32 v118, v118
    v_mfma_f32_16x16x32_bf16 v[228:231], v[40:43], a[116:119], v[228:231]
    v_rcp_f32 v119, v119
    v_mfma_f32_16x16x32_bf16 v[244:247], v[44:47], a[116:119], v[244:247]
    buffer_load_dwordx4 v3, s[12:15], s7 offen offset:2048 sc1 lds
    v_mul_f32 v172, v112, v172
    v_mfma_f32_16x16x32_bf16 v[224:227], v[40:43], a[52:55], v[224:227]
    v_mul_f32 v173, v113, v173
    v_mul_f32 v174, v114, v174
    v_mfma_f32_16x16x32_bf16 v[240:243], v[44:47], a[52:55], v[240:243]
    buffer_load_dwordx4 v3, s[12:15], s7 offen offset:3072 sc1 lds
    v_mul_f32 v175, v115, v175
    v_mfma_f32_16x16x32_bf16 v[192:195], v[48:51], a[56:59], v[192:195]
    v_mul_f32 v188, v116, v188
    v_mfma_f32_16x16x32_bf16 v[208:211], v[52:55], a[56:59], v[208:211]
    v_mul_f32 v189, v117, v189
    v_mul_f32 v190, v118, v190
    v_mfma_f32_16x16x32_bf16 v[196:199], v[48:51], a[120:123], v[196:199]
    v_mul_f32 v191, v119, v191
    v_cvt_pk_bf16_f32 v124, v172, v173
    v_mfma_f32_16x16x32_bf16 v[212:215], v[52:55], a[120:123], v[212:215]
    v_cvt_pk_bf16_f32 v125, v174, v175
    v_cvt_pk_bf16_f32 v126, v188, v189
    v_mfma_f32_16x16x32_bf16 v[200:203], v[48:51], a[184:187], v[200:203]
    v_cvt_pk_bf16_f32 v127, v190, v191
    v_add_f32 v140, v140, v172
    v_mfma_f32_16x16x32_bf16 v[216:219], v[52:55], a[184:187], v[216:219]
    v_fmac_f32 v141, v172, v172
    v_mfma_f32_16x16x32_bf16 v[204:207], v[48:51], a[248:251], v[204:207]
    v_add_f32 v140, v140, v173
    v_fmac_f32 v141, v173, v173
    v_mfma_f32_16x16x32_bf16 v[220:223], v[52:55], a[248:251], v[220:223]
    v_add_f32 v140, v140, v174
    v_fmac_f32 v141, v174, v174
    v_mfma_f32_16x16x32_bf16 v[236:239], v[56:59], a[248:251], v[236:239]
    v_add_f32 v140, v140, v175
    v_fmac_f32 v141, v175, v175
    v_mfma_f32_16x16x32_bf16 v[252:255], v[60:63], a[248:251], v[252:255]
    v_add_f32 v140, v140, v188
    v_mfma_f32_16x16x32_bf16 v[232:235], v[56:59], a[184:187], v[232:235]
    v_fmac_f32 v141, v188, v188
    v_add_f32 v140, v140, v189
    v_mfma_f32_16x16x32_bf16 v[248:251], v[60:63], a[184:187], v[248:251]
    v_fmac_f32 v141, v189, v189
    v_add_f32 v140, v140, v190
    v_mfma_f32_16x16x32_bf16 v[228:231], v[56:59], a[120:123], v[228:231]
    v_fmac_f32 v141, v190, v190
    v_add_f32 v140, v140, v191
    v_mfma_f32_16x16x32_bf16 v[244:247], v[60:63], a[120:123], v[244:247]
    v_fmac_f32 v141, v191, v191
    ds_write_b64 v84, v[124:125] offset:64
    v_mfma_f32_16x16x32_bf16 v[224:227], v[56:59], a[56:59], v[224:227]
    ds_write_b64 v84, v[126:127] offset:96
    v_mfma_f32_16x16x32_bf16 v[240:243], v[60:63], a[56:59], v[240:243]
    s_add_u32 s29, s17, 20480
    s_waitcnt lgkmcnt(4)
    buffer_store_dwordx4 v[184:187], v86, s[12:15], s29 offen
    ds_read_b128 v[172:175], v85 offset:0
    s_waitcnt vmcnt(13)
    v_mfma_f32_16x16x32_bf16 v[192:195], v[64:67], a[60:63], v[192:195]
    ds_read_b128 v[188:191], v85 offset:1152
    v_permlane16_swap_b32 v128, v132
    v_mfma_f32_16x16x32_bf16 v[208:211], v[68:71], a[60:63], v[208:211]
    v_permlane16_swap_b32 v136, v140
    v_permlane16_swap_b32 v129, v133
    v_mfma_f32_16x16x32_bf16 v[196:199], v[64:67], a[124:127], v[196:199]
    v_permlane16_swap_b32 v137, v141
    v_mfma_f32_16x16x32_bf16 v[212:215], v[68:71], a[124:127], v[212:215]
    s_lshl_b32 s43, s22, 2
    v_add_f32 v128, v128, v132
    v_mfma_f32_16x16x32_bf16 v[200:203], v[64:67], a[188:191], v[200:203]
    v_add_f32 v136, v136, v140
    v_add_f32 v129, v129, v133
    v_mfma_f32_16x16x32_bf16 v[216:219], v[68:71], a[188:191], v[216:219]
    v_add_f32 v137, v137, v141
    s_add_u32 s43, s43, s16
    v_mfma_f32_16x16x32_bf16 v[204:207], v[64:67], a[252:255], v[204:207]
    s_lshl_b32 s43, s43, 9
    v_permlane32_swap_b32 v128, v136
    v_mfma_f32_16x16x32_bf16 v[220:223], v[68:71], a[252:255], v[220:223]
    v_permlane32_swap_b32 v129, v137
    v_mfma_f32_16x16x32_bf16 v[236:239], v[72:75], a[252:255], v[236:239]
    s_lshr_b32 s29, s31, 1
    s_lshl_b32 s29, s29, 12
    s_add_u32 s43, s43, s29
    v_add_f32 v112, v128, v136
    v_mfma_f32_16x16x32_bf16 v[252:255], v[76:79], a[252:255], v[252:255]
    v_add_f32 v113, v129, v137
    s_add_u32 s43, s43, 59244544
    v_mfma_f32_16x16x32_bf16 v[232:235], v[72:75], a[188:191], v[232:235]
    v_lshlrev_b32 v114, 3, v2
    buffer_store_dwordx2 v[112:113], v114, s[12:15], s43 offen sc1
    v_mfma_f32_16x16x32_bf16 v[248:251], v[76:79], a[188:191], v[248:251]
    s_add_u32 s29, s17, 24576
    s_waitcnt lgkmcnt(1)
    buffer_store_dwordx4 v[172:175], v86, s[12:15], s29 offen
    s_add_u32 s29, s17, 28672
    s_waitcnt lgkmcnt(0)
    buffer_store_dwordx4 v[188:191], v86, s[12:15], s29 offen sc1
    v_mfma_f32_16x16x32_bf16 v[228:231], v[72:75], a[124:127], v[228:231]
    v_mfma_f32_16x16x32_bf16 v[244:247], v[76:79], a[124:127], v[244:247]
    v_mfma_f32_16x16x32_bf16 v[224:227], v[72:75], a[60:63], v[224:227]
    v_mfma_f32_16x16x32_bf16 v[240:243], v[76:79], a[60:63], v[240:243]
    s_nop 3
    v_cvt_pk_bf16_f32 v192, v192, v193
    v_cvt_pk_bf16_f32 v193, v194, v195
    v_cvt_pk_bf16_f32 v194, v208, v209
    v_cvt_pk_bf16_f32 v195, v210, v211
    s_waitcnt vmcnt(4)
    buffer_store_dwordx4 v[192:195], v3, s[44:47], s40 offen offset:0 nt
    ds_write_b128 v87, v[192:195] offset:16384
    v_cvt_pk_bf16_f32 v196, v196, v197
    v_cvt_pk_bf16_f32 v197, v198, v199
    v_cvt_pk_bf16_f32 v198, v212, v213
    v_cvt_pk_bf16_f32 v199, v214, v215
    buffer_store_dwordx4 v[196:199], v3, s[44:47], s40 offen offset:2048 nt
    ds_write_b128 v87, v[196:199] offset:18432
    v_cvt_pk_bf16_f32 v200, v200, v201
    v_cvt_pk_bf16_f32 v201, v202, v203
    v_cvt_pk_bf16_f32 v202, v216, v217
    v_cvt_pk_bf16_f32 v203, v218, v219
    buffer_store_dwordx4 v[200:203], v3, s[44:47], s7 offen offset:0 nt
    ds_write_b128 v87, v[200:203] offset:20480
    v_cvt_pk_bf16_f32 v204, v204, v205
    v_cvt_pk_bf16_f32 v205, v206, v207
    v_cvt_pk_bf16_f32 v206, v220, v221
    v_cvt_pk_bf16_f32 v207, v222, v223
    buffer_store_dwordx4 v[204:207], v3, s[44:47], s7 offen offset:2048 nt
    ds_write_b128 v87, v[204:207] offset:22528
    v_cvt_pk_bf16_f32 v236, v236, v237
    v_cvt_pk_bf16_f32 v237, v238, v239
    v_cvt_pk_bf16_f32 v238, v252, v253
    v_cvt_pk_bf16_f32 v239, v254, v255
    buffer_store_dwordx4 v[236:239], v3, s[44:47], s7 offen offset:3072 nt
    ds_write_b128 v87, v[236:239] offset:23552
    v_cvt_pk_bf16_f32 v232, v232, v233
    v_cvt_pk_bf16_f32 v233, v234, v235
    v_cvt_pk_bf16_f32 v234, v248, v249
    v_cvt_pk_bf16_f32 v235, v250, v251
    buffer_store_dwordx4 v[232:235], v3, s[44:47], s7 offen offset:1024 nt
    ds_write_b128 v87, v[232:235] offset:21504
    v_cvt_pk_bf16_f32 v228, v228, v229
    v_cvt_pk_bf16_f32 v229, v230, v231
    v_cvt_pk_bf16_f32 v230, v244, v245
    v_cvt_pk_bf16_f32 v231, v246, v247
    buffer_store_dwordx4 v[228:231], v3, s[44:47], s40 offen offset:3072 nt
    ds_write_b128 v87, v[228:231] offset:19456
    v_cvt_pk_bf16_f32 v224, v224, v225
    v_cvt_pk_bf16_f32 v225, v226, v227
    v_cvt_pk_bf16_f32 v226, v240, v241
    v_cvt_pk_bf16_f32 v227, v242, v243
    buffer_store_dwordx4 v[224:227], v3, s[44:47], s40 offen offset:1024 nt
    ds_write_b128 v87, v[224:227] offset:17408
    s_add_u32 m0, s19, 4096
    s_add_u32 s42, s19, 4096
    buffer_load_dwordx4 v3, s[8:11], s42 offen offset:0 sc1 lds
    buffer_load_dwordx4 v3, s[8:11], s42 offen offset:1024 sc1 lds
    buffer_load_dwordx4 v3, s[8:11], s42 offen offset:2048 sc1 lds
    buffer_load_dwordx4 v3, s[8:11], s42 offen offset:3072 sc1 lds
    s_add_u32 m0, s19, 8192
    s_add_u32 s42, s19, 8192
    buffer_load_dwordx4 v3, s[8:11], s42 offen offset:0 sc1 lds
    buffer_load_dwordx4 v3, s[8:11], s42 offen offset:1024 sc1 lds
    buffer_load_dwordx4 v3, s[8:11], s42 offen offset:2048 sc1 lds
    buffer_load_dwordx4 v3, s[8:11], s42 offen offset:3072 sc1 lds
    s_add_u32 m0, s19, 12288
    s_add_u32 s42, s19, 12288
    buffer_load_dwordx4 v3, s[8:11], s42 offen offset:0 sc1 lds
    buffer_load_dwordx4 v3, s[8:11], s42 offen offset:1024 sc1 lds
    buffer_load_dwordx4 v3, s[8:11], s42 offen offset:2048 sc1 lds
    buffer_load_dwordx4 v3, s[8:11], s42 offen offset:3072 sc1 lds
    s_waitcnt vmcnt(12)
    s_cmp_lg_u32 s21, 0
    s_cbranch_scc1 L_rq_far
    buffer_store_dword v12, off, s[12:15], s41 offset:8
L_rq_back:
    buffer_load_dword v15, off, s[12:15], s6 offset:8 sc1
    s_xor_b32 s40, s40, 0x8000
    s_xor_b32 s7, s7, 0x8000
    s_waitcnt vmcnt(0)
    v_readfirstlane_b32 s26, v15
    s_cmp_eq_u32 s26, 1
    s_cbranch_scc0 L_q_retry
L_q_ok:
    s_add_u32 m0, s18, 16384
    s_nop 0
    buffer_load_dwordx4 v3, s[12:15], s40 offen offset:0 sc1 lds
    buffer_load_dwordx4 v3, s[12:15], s40 offen offset:1024 sc1 lds
    buffer_load_dwordx4 v3, s[12:15], s40 offen offset:2048 sc1 lds
    buffer_load_dwordx4 v3, s[12:15], s40 offen offset:3072 sc1 lds
    s_add_u32 m0, s18, 20480
    s_nop 0
    buffer_load_dwordx4 v3, s[12:15], s7 offen offset:0 sc1 lds
    buffer_load_dwordx4 v3, s[12:15], s7 offen offset:1024 sc1 lds
    buffer_load_dwordx4 v3, s[12:15], s7 offen offset:2048 sc1 lds
    buffer_load_dwordx4 v3, s[12:15], s7 offen offset:3072 sc1 lds
    s_mov_b32 s17, s25
    s_mov_b32 s101, 0xf1800000
    v_and_b32 v4, 15, v2
    v_lshrrev_b32 v5, 4, v2
    v_and_b32 v6, 0x27, v2
    v_and_b32 v7, 8, v2
    v_lshl_add_u32 v6, v7, 1, v6
    v_and_b32 v7, 16, v2
    v_lshrrev_b32 v7, 1, v7
    v_add_lshl_u32 v6, v6, v7, 4
    s_lshl_b32 s29, s16, 14
    v_add_u32 v8, s29, v6
    s_lshl_b32 s29, s16, 11
    s_add_u32 s29, s29, 131072
    v_lshl_add_u32 v9, v2, 3, s29
    v_mov_b32 v204, 0
    v_mov_b32 v205, 0
    v_mov_b32 v206, 0
    v_mov_b32 v207, 0
    v_mov_b32 v208, 0xff800000
    v_mov_b32 v209, 0xff800000
    v_mov_b32 v210, 0xff800000
    v_mov_b32 v211, 0xff800000
    s_waitcnt vmcnt(0)
    s_waitcnt lgkmcnt(0)
    s_barrier
    v_add_u32 v7, 98304, v3
    ds_read_b128 a[0:3], v7 offset:0
    ds_read_b128 v[32:35], v8 offset:0
    ds_read_b128 a[4:7], v7 offset:1024
    ds_read_b128 v[36:39], v8 offset:1024
    ds_read_b128 a[8:11], v7 offset:16384
    ds_read_b128 v[40:43], v8 offset:2048
    ds_read_b128 a[12:15], v7 offset:17408
    ds_read_b128 v[44:47], v8 offset:3072
    ds_read_b128 a[16:19], v7 offset:32768
    ds_read_b128 v[48:51], v8 offset:4096
    ds_read_b128 a[20:23], v7 offset:33792
    ds_read_b128 v[52:55], v8 offset:5120
    ds_read_b128 a[24:27], v7 offset:49152
    ds_read_b128 v[56:59], v8 offset:6144
    s_waitcnt lgkmcnt(10)
    v_mfma_f32_16x16x32_bf16 v[160:163], v[32:35], a[0:3], 0
    ds_read_b128 a[28:31], v7 offset:50176
    ds_read_b128 v[60:63], v8 offset:7168
    v_mfma_f32_16x16x32_bf16 v[160:163], v[36:39], a[4:7], v[160:163]
    ds_read_b128 a[32:35], v7 offset:8192
    ds_read_b128 v[64:67], v8 offset:8192
    s_waitcnt lgkmcnt(10)
    v_mfma_f32_16x16x32_bf16 v[160:163], v[40:43], a[8:11], v[160:163]
    ds_read_b128 a[36:39], v7 offset:9216
    ds_read_b128 v[68:71], v8 offset:9216
    v_mfma_f32_16x16x32_bf16 v[160:163], v[44:47], a[12:15], v[160:163]
    ds_read_b128 a[40:43], v7 offset:24576
    ds_read_b128 v[72:75], v8 offset:10240
    s_waitcnt lgkmcnt(10)
    v_mfma_f32_16x16x32_bf16 v[160:163], v[48:51], a[16:19], v[160:163]
    ds_read_b128 a[44:47], v7 offset:25600
    ds_read_b128 v[76:79], v8 offset:11264
    v_mfma_f32_16x16x32_bf16 v[160:163], v[52:55], a[20:23], v[160:163]
    ds_read_b128 a[48:51], v7 offset:40960
    ds_read_b128 v[80:83], v8 offset:12288
    s_waitcnt lgkmcnt(10)
    v_mfma_f32_16x16x32_bf16 v[160:163], v[56:59], a[24:27], v[160:163]
    ds_read_b128 a[52:55], v7 offset:41984
    ds_read_b128 v[84:87], v8 offset:13312
    v_mfma_f32_16x16x32_bf16 v[160:163], v[60:63], a[28:31], v[160:163]
    ds_read_b128 a[56:59], v7 offset:57344
    ds_read_b128 v[88:91], v8 offset:14336
    s_waitcnt lgkmcnt(10)
    v_mfma_f32_16x16x32_bf16 v[160:163], v[64:67], a[32:35], v[160:163]
    ds_read_b128 a[60:63], v7 offset:58368
    ds_read_b128 v[92:95], v8 offset:15360
    v_mfma_f32_16x16x32_bf16 v[160:163], v[68:71], a[36:39], v[160:163]
    ds_read_b128 a[64:67], v7 offset:2048
    ds_read_b128 a[68:71], v7 offset:3072
    s_waitcnt lgkmcnt(10)
    v_mfma_f32_16x16x32_bf16 v[160:163], v[72:75], a[40:43], v[160:163]
    ds_read_b128 a[72:75], v7 offset:18432
    ds_read_b128 a[76:79], v7 offset:19456
    v_mfma_f32_16x16x32_bf16 v[160:163], v[76:79], a[44:47], v[160:163]
    ds_read_b128 a[80:83], v7 offset:34816
    ds_read_b128 a[84:87], v7 offset:35840
    s_waitcnt lgkmcnt(10)
    v_mfma_f32_16x16x32_bf16 v[160:163], v[80:83], a[48:51], v[160:163]
    ds_read_b128 a[88:91], v7 offset:51200
    ds_read_b128 a[92:95], v7 offset:52224
    v_mfma_f32_16x16x32_bf16 v[160:163], v[84:87], a[52:55], v[160:163]
    ds_read_b128 a[96:99], v7 offset:10240
    ds_read_b128 a[100:103], v7 offset:11264
    s_waitcnt lgkmcnt(10)
    v_mfma_f32_16x16x32_bf16 v[160:163], v[88:91], a[56:59], v[160:163]
    ds_read_b128 a[104:107], v7 offset:26624
    s_lshl_b32 s26, s22, 2
    s_add_u32 s26, s26, s16
    v_mfma_f32_16x16x32_bf16 v[160:163], v[92:95], a[60:63], v[160:163]
    ds_read_b128 a[108:111], v7 offset:27648
    s_lshl_b32 s53, s26, 16
    s_add_u32 s53, s53, 63963136
    s_waitcnt lgkmcnt(10)
    v_mfma_f32_16x16x32_bf16 v[164:167], v[32:35], a[64:67], 0
    ds_read_b128 a[112:115], v7 offset:43008
    s_xor_b32 s52, s53, 0x40000
    s_lshl_b32 s58, s26, 7
    v_mfma_f32_16x16x32_bf16 v[164:167], v[36:39], a[68:71], v[164:167]
    ds_read_b128 a[116:119], v7 offset:44032
    s_add_u32 s58, s58, s27
    s_xor_b32 s54, s31, 1
    s_waitcnt lgkmcnt(10)
    v_mfma_f32_16x16x32_bf16 v[164:167], v[40:43], a[72:75], v[164:167]
    ds_read_b128 a[120:123], v7 offset:59392
    s_lshl_b32 s54, s54, 3
    s_add_u32 s54, s54, s16
    v_mfma_f32_16x16x32_bf16 v[164:167], v[44:47], a[76:79], v[164:167]
    ds_read_b128 a[124:127], v7 offset:60416
    s_lshl_b32 s54, s54, 13
    s_add_u32 s54, s54, 33587200
    s_waitcnt lgkmcnt(10)
    v_mfma_f32_16x16x32_bf16 v[164:167], v[48:51], a[80:83], v[164:167]
    ds_read_b128 a[128:131], v7 offset:4096
    s_add_u32 s55, s54, 4096
    s_lshl_b32 s26, s22, 15
    v_mfma_f32_16x16x32_bf16 v[164:167], v[52:55], a[84:87], v[164:167]
    ds_read_b128 a[132:135], v7 offset:5120
    s_add_u32 s50, s52, s26
    s_add_u32 s51, s53, s26
    s_waitcnt lgkmcnt(10)
    v_mfma_f32_16x16x32_bf16 v[164:167], v[56:59], a[88:91], v[164:167]
    ds_read_b128 a[136:139], v7 offset:20480
    s_lshl_b32 s26, s22, 14
    s_add_u32 s52, s52, s26
    v_mfma_f32_16x16x32_bf16 v[164:167], v[60:63], a[92:95], v[164:167]
    ds_read_b128 a[140:143], v7 offset:21504
    s_add_u32 s53, s53, s26
    s_add_u32 s26, s25, 3
    s_waitcnt lgkmcnt(10)
    v_mfma_f32_16x16x32_bf16 v[164:167], v[64:67], a[96:99], v[164:167]
    ds_read_b128 a[144:147], v7 offset:36864
    s_and_b32 s26, s26, 3
    s_lshl_b32 s48, s26, 15
    v_mfma_f32_16x16x32_bf16 v[164:167], v[68:71], a[100:103], v[164:167]
    ds_read_b128 a[148:151], v7 offset:37888
    s_add_u32 s26, s25, 1
    s_and_b32 s26, s26, 3
    s_waitcnt lgkmcnt(10)
    v_mfma_f32_16x16x32_bf16 v[164:167], v[72:75], a[104:107], v[164:167]
    ds_read_b128 a[152:155], v7 offset:53248
    s_lshl_b32 s49, s26, 15
    s_lshl_b32 s56, s31, 5
    v_mfma_f32_16x16x32_bf16 v[164:167], v[76:79], a[108:111], v[164:167]
    ds_read_b128 a[156:159], v7 offset:54272
    s_add_u32 s56, s56, s16
    s_lshl_b32 s56, s56, 2
    s_waitcnt lgkmcnt(10)
    v_mfma_f32_16x16x32_bf16 v[164:167], v[80:83], a[112:115], v[164:167]
    ds_read_b128 a[160:163], v7 offset:12288
    s_add_u32 s56, s56, 58982400
    s_xor_b32 s57, s56, 128
    v_mfma_f32_16x16x32_bf16 v[164:167], v[84:87], a[116:119], v[164:167]
    ds_read_b128 a[164:167], v7 offset:13312
    s_mul_i32 s28, s16, 34
    s_lshl_b32 s29, s23, 6
    s_waitcnt lgkmcnt(10)
    v_mfma_f32_16x16x32_bf16 v[164:167], v[88:91], a[120:123], v[164:167]
    ds_read_b128 a[168:171], v7 offset:28672
    s_add_u32 s28, s28, s29
    s_sub_u32 s28, s28, 2
    v_mfma_f32_16x16x32_bf16 v[164:167], v[92:95], a[124:127], v[164:167]
    ds_read_b128 a[172:175], v7 offset:29696
    v_add_u32 v228, s28, v2
    v_max_i32 v229, 0, v228
    s_waitcnt lgkmcnt(10)
    v_mfma_f32_16x16x32_bf16 v[168:171], v[32:35], a[128:131], 0
    ds_read_b128 a[176:179], v7 offset:45056
    v_min_i32 v229, 3999, v229
    v_lshrrev_b32 v230, 6, v229
    v_mfma_f32_16x16x32_bf16 v[168:171], v[36:39], a[132:135], v[168:171]
    ds_read_b128 a[180:183], v7 offset:46080
    v_and_b32 v229, 63, v229
    v_lshlrev_b32 v229, 3, v229
    s_waitcnt lgkmcnt(10)
    v_mfma_f32_16x16x32_bf16 v[168:171], v[40:43], a[136:139], v[168:171]
    ds_read_b128 a[184:187], v7 offset:61440
    v_lshl_add_u32 v229, v230, 12, v229
    s_lshr_b32 s6, s31, 7
    v_mfma_f32_16x16x32_bf16 v[168:171], v[44:47], a[140:143], v[168:171]
    ds_read_b128 a[188:191], v7 offset:62464
    s_lshl_b32 s6, s6, 18
    s_add_u32 s6, s6, 59244544
    s_waitcnt lgkmcnt(10)
    v_mfma_f32_16x16x32_bf16 v[168:171], v[48:51], a[144:147], v[168:171]
    ds_read_b128 a[192:195], v7 offset:6144
    s_lshl_b32 s28, s16, 1
    s_add_u32 s28, s28, s23
    v_mfma_f32_16x16x32_bf16 v[168:171], v[52:55], a[148:151], v[168:171]
    ds_read_b128 a[196:199], v7 offset:7168
    s_sub_u32 s28, s28, 1
    s_max_i32 s28, s28, 0
    s_waitcnt lgkmcnt(10)
    v_mfma_f32_16x16x32_bf16 v[168:171], v[56:59], a[152:155], v[168:171]
    ds_read_b128 a[200:203], v7 offset:22528
    s_min_i32 s28, s28, 62
    s_sub_u32 s28, s28, s23
    v_mfma_f32_16x16x32_bf16 v[168:171], v[60:63], a[156:159], v[168:171]
    ds_read_b128 a[204:207], v7 offset:23552
    s_lshl_b32 s28, s28, 1
    s_add_u32 s28, s28, s31
    s_waitcnt lgkmcnt(10)
    v_mfma_f32_16x16x32_bf16 v[168:171], v[64:67], a[160:163], v[168:171]
    ds_read_b128 a[208:211], v7 offset:38912
    s_lshl_b32 s28, s28, 16
    s_xor_b32 s29, s16, 1
    v_mfma_f32_16x16x32_bf16 v[168:171], v[68:71], a[164:167], v[168:171]
    ds_read_b128 a[212:215], v7 offset:39936
    s_mul_i32 s29, s29, 31744
    s_add_u32 s28, s28, s29
    s_waitcnt lgkmcnt(10)
    v_mfma_f32_16x16x32_bf16 v[168:171], v[72:75], a[168:171], v[168:171]
    ds_read_b128 a[216:219], v7 offset:55296
    s_add_u32 s7, s28, 33554432
    s_lshl_b32 s29, s16, 10
    v_mfma_f32_16x16x32_bf16 v[168:171], v[76:79], a[172:175], v[168:171]
    ds_read_b128 a[220:223], v7 offset:56320
    s_add_u32 s42, s29, 141312
    s_xor_b32 s28, s31, 1
    s_waitcnt lgkmcnt(10)
    v_mfma_f32_16x16x32_bf16 v[168:171], v[80:83], a[176:179], v[168:171]
    ds_read_b128 a[224:227], v7 offset:14336
    s_lshl_b32 s28, s28, 1
    s_add_u32 s28, s28, s16
    v_mfma_f32_16x16x32_bf16 v[168:171], v[84:87], a[180:183], v[168:171]
    ds_read_b128 a[228:231], v7 offset:15360
    s_lshl_b32 s28, s28, 9
    s_add_u32 s28, s28, 58720256
    s_waitcnt lgkmcnt(10)
    v_mfma_f32_16x16x32_bf16 v[168:171], v[88:91], a[184:187], v[168:171]
    ds_read_b128 a[232:235], v7 offset:30720
    v_lshl_add_u32 v230, v2, 3, s28
    v_writelane_b32 v230, s57, 1
    v_mfma_f32_16x16x32_bf16 v[168:171], v[92:95], a[188:191], v[168:171]
    ds_read_b128 a[236:239], v7 offset:31744
    s_mul_i32 s28, s16, 272
    s_add_u32 s28, s28, 146432
    s_waitcnt lgkmcnt(10)
    v_mfma_f32_16x16x32_bf16 v[172:175], v[32:35], a[192:195], 0
    ds_read_b128 a[240:243], v7 offset:47104
    v_lshl_add_u32 v231, v2, 3, s28
    s_lshl_b32 s28, s16, 5
    v_mfma_f32_16x16x32_bf16 v[172:175], v[36:39], a[196:199], v[172:175]
    ds_read_b128 a[244:247], v7 offset:48128
    v_lshrrev_b32 v12, 5, v2
    v_mul_u32_u24 v12, 16, v12
    s_waitcnt lgkmcnt(10)
    v_mfma_f32_16x16x32_bf16 v[172:175], v[40:43], a[200:203], v[172:175]
    ds_read_b128 a[248:251], v7 offset:63488
    v_add_u32 v12, s28, v12
    v_and_b32 v13, 31, v2
    v_mfma_f32_16x16x32_bf16 v[172:175], v[44:47], a[204:207], v[172:175]
    ds_read_b128 a[252:255], v7 offset:64512
    v_lshlrev_b32 v13, 4, v13
    v_lshl_add_u32 v14, v12, 9, v13
    s_and_b32 s26, s25, 3
    s_waitcnt lgkmcnt(10)
    v_mfma_f32_16x16x32_bf16 v[172:175], v[48:51], a[208:211], v[172:175]
    s_lshl_b32 s26, s26, 15
    v_add_u32 v232, s26, v14
    v_add_u32 v235, s49, v14
    v_mfma_f32_16x16x32_bf16 v[172:175], v[52:55], a[212:215], v[172:175]
    v_and_b32 v14, 4, v12
    v_lshlrev_b32 v14, 5, v14
    v_xor_b32 v236, v235, v14
    s_waitcnt lgkmcnt(8)
    v_mfma_f32_16x16x32_bf16 v[172:175], v[56:59], a[216:219], v[172:175]
    v_add_u32 v238, 143360, v13
    v_add_u32 v13, 141312, v13
    v_cmp_eq_u32 vcc, 0, v12
    v_mfma_f32_16x16x32_bf16 v[172:175], v[60:63], a[220:223], v[172:175]
    v_subrev_u32 v233, 1024, v232
    v_add_u32 v234, 8192, v232
    v_cndmask_b32 v233, v233, v13, vcc
    s_waitcnt lgkmcnt(6)
    v_mfma_f32_16x16x32_bf16 v[172:175], v[64:67], a[224:227], v[172:175]
    v_cmp_eq_u32 vcc, 48, v12
    v_add_u32 v13, 1024, v13
    v_lshlrev_b32 v237, 3, v12
    v_mfma_f32_16x16x32_bf16 v[172:175], v[68:71], a[228:231], v[172:175]
    v_cndmask_b32 v234, v234, v13, vcc
    v_add_u32 v237, 146432, v237
    s_lshl_b32 s28, s16, 9
    s_waitcnt lgkmcnt(4)
    v_mfma_f32_16x16x32_bf16 v[172:175], v[72:75], a[232:235], v[172:175]
    s_lshl_b32 s41, s31, 10
    s_add_u32 s41, s41, s28
    s_add_u32 s41, s41, 58720256
    v_mfma_f32_16x16x32_bf16 v[172:175], v[76:79], a[236:239], v[172:175]
    s_add_u32 s28, s28, 140288
    v_lshlrev_b32 v244, 3, v2
    v_add_u32 v245, s28, v244
    s_waitcnt lgkmcnt(2)
    v_mfma_f32_16x16x32_bf16 v[172:175], v[80:83], a[240:243], v[172:175]
    v_add_u32 v246, 140292, v244
    s_mov_b32 s43, 0xffff0000
    v_mfma_f32_16x16x32_bf16 v[172:175], v[84:87], a[244:247], v[172:175]
    s_waitcnt lgkmcnt(0)
    v_mfma_f32_16x16x32_bf16 v[172:175], v[88:91], a[248:251], v[172:175]
    v_mfma_f32_16x16x32_bf16 v[172:175], v[92:95], a[252:255], v[172:175]
L_qk_again:
    s_barrier
    s_nop 7
    v_max3_f32 v192, v160, v161, v162
    v_max3_f32 v192, v192, v163, v208
    v_max3_f32 v193, v164, v165, v166
    v_max3_f32 v193, v193, v167, v209
    v_max3_f32 v194, v168, v169, v170
    v_max3_f32 v194, v194, v171, v210
    v_max3_f32 v195, v172, v173, v174
    v_max3_f32 v195, v195, v175, v211
    v_mov_b32 v196, v192
    v_mov_b32 v197, v193
    v_mov_b32 v198, v194
    v_mov_b32 v199, v195
    s_nop 1
    v_permlane16_swap_b32 v192, v196
    v_permlane16_swap_b32 v193, v197
    v_permlane16_swap_b32 v194, v198
    v_permlane16_swap_b32 v195, v199
    s_nop 1
    v_max_f32 v192, v192, v196
    v_max_f32 v193, v193, v197
    v_max_f32 v194, v194, v198
    v_max_f32 v195, v195, v199
    v_mov_b32 v196, v192
    v_mov_b32 v197, v193
    v_mov_b32 v198, v194
    v_mov_b32 v199, v195
    s_nop 1
    v_permlane32_swap_b32 v192, v196
    v_permlane32_swap_b32 v193, v197
    v_permlane32_swap_b32 v194, v198
    v_permlane32_swap_b32 v195, v199
    s_nop 1
    v_max_f32 v192, v192, v196
    v_max_f32 v193, v193, v197
    v_max_f32 v194, v194, v198
    v_max_f32 v195, v195, v199
    s_lshl_b32 s29, s16, 8
    s_add_u32 s29, s29, 139264
    v_lshl_add_u32 v10, v4, 4, s29
    ds_write_b128 v10, v[192:195]
    v_xor_b32 v10, 256, v10
    s_waitcnt vmcnt(0) lgkmcnt(0)
    s_barrier
    ds_read_b128 v[196:199], v10
    ds_read_b128 v[96:99], v8 offset:32768
    ds_read_b128 v[100:103], v8 offset:33792
    ds_read_b128 v[104:107], v8 offset:34816
    ds_read_b128 v[108:111], v8 offset:35840
    ds_read_b128 v[112:115], v8 offset:36864
    ds_read_b128 v[116:119], v8 offset:37888
    ds_read_b128 v[120:123], v8 offset:38912
    ds_read_b128 v[124:127], v8 offset:39936
    s_waitcnt lgkmcnt(8)
    v_max_f32 v192, v192, v196
    v_max_f32 v193, v193, v197
    v_max_f32 v194, v194, v198
    v_max_f32 v195, v195, v199
    v_sub_f32 v176, 0, v192
    v_sub_f32 v177, 0, v192
    v_sub_f32 v178, 0, v192
    v_sub_f32 v179, 0, v192
    v_sub_f32 v180, 0, v193
    v_sub_f32 v181, 0, v193
    v_sub_f32 v182, 0, v193
    v_sub_f32 v183, 0, v193
    v_sub_f32 v184, 0, v194
    v_sub_f32 v185, 0, v194
    v_sub_f32 v186, 0, v194
    v_sub_f32 v187, 0, v194
    v_sub_f32 v188, 0, v195
    v_sub_f32 v189, 0, v195
    v_sub_f32 v190, 0, v195
    v_sub_f32 v191, 0, v195
    v_mov_b32 v242, v176
    s_waitcnt lgkmcnt(4)
    ds_read_b128 v[128:131], v8 offset:40960
    ds_read_b128 v[132:135], v8 offset:41984
    v_mov_b32_dpp v242, v180 quad_perm:[0,1,2,3] row_mask:0x2 bank_mask:0xf
    ds_read_b128 v[136:139], v8 offset:43008
    ds_read_b128 v[140:143], v8 offset:44032
    v_mov_b32_dpp v242, v184 quad_perm:[0,1,2,3] row_mask:0x4 bank_mask:0xf
    ds_read_b128 v[144:147], v8 offset:45056
    ds_read_b128 v[148:151], v8 offset:46080
    v_mov_b32_dpp v242, v188 quad_perm:[0,1,2,3] row_mask:0x8 bank_mask:0xf
    ds_read_b128 v[152:155], v8 offset:47104
    ds_read_b128 v[156:159], v8 offset:48128
    v_add_f32 v160, v160, v176
    v_add_f32 v161, v161, v176
    v_add_f32 v162, v162, v176
    v_add_f32 v163, v163, v176
    v_add_f32 v164, v164, v180
    v_add_f32 v165, v165, v180
    v_add_f32 v166, v166, v180
    v_add_f32 v167, v167, v180
    v_add_f32 v168, v168, v184
    v_add_f32 v169, v169, v184
    v_add_f32 v170, v170, v184
    v_add_f32 v171, v171, v184
    v_add_f32 v172, v172, v188
    v_add_f32 v173, v173, v188
    v_add_f32 v174, v174, v188
    v_add_f32 v175, v175, v188
    v_exp_f32 v192, v160
    v_exp_f32 v193, v161
    v_exp_f32 v194, v162
    v_exp_f32 v195, v163
    s_nop 0
    v_cvt_pk_bf16_f32 v200, v192, v193
    v_cvt_pk_bf16_f32 v201, v194, v195
    v_add_f32 v204, v204, v192
    v_add_f32 v204, v204, v193
    v_add_f32 v204, v204, v194
    v_add_f32 v204, v204, v195
    ds_write_b64 v9, v[200:201] offset:0
    s_waitcnt lgkmcnt(1)
    v_mfma_f32_16x16x32_bf16 v[160:163], v[96:99], a[0:3], v[176:179]
    v_exp_f32 v196, v164
    v_exp_f32 v197, v165
    v_exp_f32 v198, v166
    v_mfma_f32_16x16x32_bf16 v[160:163], v[100:103], a[4:7], v[160:163]
    v_exp_f32 v199, v167
    v_add_f32 v205, v205, v196
    v_mfma_f32_16x16x32_bf16 v[160:163], v[104:107], a[8:11], v[160:163]
    v_cvt_pk_bf16_f32 v202, v196, v197
    v_cvt_pk_bf16_f32 v203, v198, v199
    v_mfma_f32_16x16x32_bf16 v[160:163], v[108:111], a[12:15], v[160:163]
    v_add_f32 v205, v205, v197
    v_add_f32 v205, v205, v198
    v_mfma_f32_16x16x32_bf16 v[160:163], v[112:115], a[16:19], v[160:163]
    v_add_f32 v205, v205, v199
    ds_write_b64 v9, v[202:203] offset:512
    v_mfma_f32_16x16x32_bf16 v[160:163], v[116:119], a[20:23], v[160:163]
    v_exp_f32 v192, v168
    v_exp_f32 v193, v169
    v_exp_f32 v194, v170
    v_mfma_f32_16x16x32_bf16 v[160:163], v[120:123], a[24:27], v[160:163]
    v_exp_f32 v195, v171
    v_add_f32 v206, v206, v192
    v_mfma_f32_16x16x32_bf16 v[160:163], v[124:127], a[28:31], v[160:163]
    v_cvt_pk_bf16_f32 v200, v192, v193
    v_cvt_pk_bf16_f32 v201, v194, v195
    v_mfma_f32_16x16x32_bf16 v[160:163], v[128:131], a[32:35], v[160:163]
    v_add_f32 v206, v206, v193
    v_add_f32 v206, v206, v194
    v_mfma_f32_16x16x32_bf16 v[160:163], v[132:135], a[36:39], v[160:163]
    v_add_f32 v206, v206, v195
    ds_write_b64 v9, v[200:201] offset:1024
    v_mfma_f32_16x16x32_bf16 v[160:163], v[136:139], a[40:43], v[160:163]
    v_exp_f32 v196, v172
    v_exp_f32 v197, v173
    v_exp_f32 v198, v174
    v_mfma_f32_16x16x32_bf16 v[160:163], v[140:143], a[44:47], v[160:163]
    v_exp_f32 v199, v175
    v_add_f32 v207, v207, v196
    v_mfma_f32_16x16x32_bf16 v[160:163], v[144:147], a[48:51], v[160:163]
    v_cvt_pk_bf16_f32 v202, v196, v197
    v_cvt_pk_bf16_f32 v203, v198, v199
    v_mfma_f32_16x16x32_bf16 v[160:163], v[148:151], a[52:55], v[160:163]
    v_add_f32 v207, v207, v197
    v_add_f32 v207, v207, v198
    v_mfma_f32_16x16x32_bf16 v[160:163], v[152:155], a[56:59], v[160:163]
    v_add_f32 v207, v207, v199
    ds_write_b64 v9, v[202:203] offset:1536
    v_mfma_f32_16x16x32_bf16 v[160:163], v[156:159], a[60:63], v[160:163]
    v_mfma_f32_16x16x32_bf16 v[164:167], v[156:159], a[124:127], v[180:183]
    v_mfma_f32_16x16x32_bf16 v[164:167], v[152:155], a[120:123], v[164:167]
    v_mfma_f32_16x16x32_bf16 v[164:167], v[148:151], a[116:119], v[164:167]
    v_mfma_f32_16x16x32_bf16 v[164:167], v[144:147], a[112:115], v[164:167]
    s_waitcnt vmcnt(0) lgkmcnt(0)
    s_sub_u32 s17, s17, 1
    s_barrier
    v_and_b32 v11, 3, v2
    v_lshlrev_b32 v11, 6, v11
    v_mov_b32 v7, 64
    v_writelane_b32 v11, 8, 4
    v_writelane_b32 v7, 4, 4
    s_lshr_b32 s40, s31, 1
    s_and_b32 s40, s40, 7
    s_lshl_b32 s40, s40, 1
    s_add_u32 s40, s40, 8
    s_branch L_qk_in
.p2align 6
L_qk_loop:
    v_mfma_f32_16x16x32_bf16 v[160:163], v[148:151], a[52:55], v[160:163]
    s_cbranch_scc1 L_qk_exit
    v_mfma_f32_16x16x32_bf16 v[160:163], v[152:155], a[56:59], v[160:163]
    v_mfma_f32_16x16x32_bf16 v[160:163], v[156:159], a[60:63], v[160:163]
    v_mfma_f32_16x16x32_bf16 v[164:167], v[156:159], a[124:127], v[180:183]
    v_mfma_f32_16x16x32_bf16 v[164:167], v[152:155], a[120:123], v[164:167]
    s_nop 0
    v_mfma_f32_16x16x32_bf16 v[164:167], v[148:151], a[116:119], v[164:167]
    s_waitcnt lgkmcnt(0)
    v_mfma_f32_16x16x32_bf16 v[164:167], v[144:147], a[112:115], v[164:167]
    s_barrier
L_qk_in:
    v_mfma_f32_16x16x32_bf16 v[164:167], v[140:143], a[108:111], v[164:167]
    v_exp_f32 v192, v160
    v_mfma_f32_16x16x32_bf16 v[164:167], v[136:139], a[104:107], v[164:167]
    v_exp_f32 v193, v161
    v_mfma_f32_16x16x32_bf16 v[164:167], v[132:135], a[100:103], v[164:167]
    v_exp_f32 v194, v162
    v_mfma_f32_16x16x32_bf16 v[164:167], v[128:131], a[96:99], v[164:167]
    v_exp_f32 v195, v163
    v_mfma_f32_16x16x32_bf16 v[164:167], v[124:127], a[92:95], v[164:167]
    v_cvt_pk_bf16_f32 v200, v192, v193
    v_cvt_pk_bf16_f32 v201, v194, v195
    v_mfma_f32_16x16x32_bf16 v[164:167], v[120:123], a[88:91], v[164:167]
    ds_write_b64 v9, v[200:201] offset:4096
    v_mfma_f32_16x16x32_bf16 v[164:167], v[116:119], a[84:87], v[164:167]
    v_add_f32 v204, v204, v192
    v_add_f32 v204, v204, v193
    v_mfma_f32_16x16x32_bf16 v[164:167], v[112:115], a[80:83], v[164:167]
    v_xor_b32 v8, 0x10000, v8
    v_add_f32 v204, v204, v194
    v_add_f32 v204, v204, v195
    v_mfma_f32_16x16x32_bf16 v[164:167], v[108:111], a[76:79], v[164:167]
    ds_read_b128 v[32:35], v8 offset:0
    v_mfma_f32_16x16x32_bf16 v[164:167], v[104:107], a[72:75], v[164:167]
    ds_read_b128 v[36:39], v8 offset:1024
    v_mfma_f32_16x16x32_bf16 v[164:167], v[100:103], a[68:71], v[164:167]
    ds_read_b128 v[40:43], v8 offset:2048
    v_mfma_f32_16x16x32_bf16 v[164:167], v[96:99], a[64:67], v[164:167]
    ds_read_b128 v[44:47], v8 offset:3072
    v_mfma_f32_16x16x32_bf16 v[168:171], v[96:99], a[128:131], v[184:187]
    ds_read_b128 v[48:51], v8 offset:4096
    v_mfma_f32_16x16x32_bf16 v[168:171], v[100:103], a[132:135], v[168:171]
    ds_read_b128 v[52:55], v8 offset:5120
    v_mfma_f32_16x16x32_bf16 v[168:171], v[104:107], a[136:139], v[168:171]
    ds_read_b128 v[56:59], v8 offset:6144
    v_mfma_f32_16x16x32_bf16 v[168:171], v[108:111], a[140:143], v[168:171]
    ds_read_b128 v[60:63], v8 offset:7168
    v_mfma_f32_16x16x32_bf16 v[168:171], v[112:115], a[144:147], v[168:171]
    v_exp_f32 v196, v164
    v_mfma_f32_16x16x32_bf16 v[168:171], v[116:119], a[148:151], v[168:171]
    v_exp_f32 v197, v165
    v_mfma_f32_16x16x32_bf16 v[168:171], v[120:123], a[152:155], v[168:171]
    v_exp_f32 v198, v166
    v_mfma_f32_16x16x32_bf16 v[168:171], v[124:127], a[156:159], v[168:171]
    v_exp_f32 v199, v167
    v_mfma_f32_16x16x32_bf16 v[168:171], v[128:131], a[160:163], v[168:171]
    v_cvt_pk_bf16_f32 v202, v196, v197
    v_cvt_pk_bf16_f32 v203, v198, v199
    v_mfma_f32_16x16x32_bf16 v[168:171], v[132:135], a[164:167], v[168:171]
    ds_write_b64 v9, v[202:203] offset:4608
    v_mfma_f32_16x16x32_bf16 v[168:171], v[136:139], a[168:171], v[168:171]
    v_add_f32 v205, v205, v196
    v_add_f32 v205, v205, v197
    v_mfma_f32_16x16x32_bf16 v[168:171], v[140:143], a[172:175], v[168:171]
    v_add_f32 v205, v205, v198
    v_add_f32 v205, v205, v199
    v_mfma_f32_16x16x32_bf16 v[168:171], v[144:147], a[176:179], v[168:171]
    ds_read_b128 v[64:67], v8 offset:8192
    v_mfma_f32_16x16x32_bf16 v[168:171], v[148:151], a[180:183], v[168:171]
    ds_read_b128 v[68:71], v8 offset:9216
    v_mfma_f32_16x16x32_bf16 v[168:171], v[152:155], a[184:187], v[168:171]
    ds_read_b128 v[72:75], v8 offset:10240
    v_mfma_f32_16x16x32_bf16 v[168:171], v[156:159], a[188:191], v[168:171]
    ds_read_b128 v[76:79], v8 offset:11264
    v_mfma_f32_16x16x32_bf16 v[172:175], v[156:159], a[252:255], v[188:191]
    ds_read_b128 v[80:83], v8 offset:12288
    v_mfma_f32_16x16x32_bf16 v[172:175], v[152:155], a[248:251], v[172:175]
    ds_read_b128 v[84:87], v8 offset:13312
    v_mfma_f32_16x16x32_bf16 v[172:175], v[148:151], a[244:247], v[172:175]
    ds_read_b128 v[88:91], v8 offset:14336
    v_mfma_f32_16x16x32_bf16 v[172:175], v[144:147], a[240:243], v[172:175]
    ds_read_b128 v[92:95], v8 offset:15360
    v_mfma_f32_16x16x32_bf16 v[172:175], v[140:143], a[236:239], v[172:175]
    v_exp_f32 v192, v168
    v_mfma_f32_16x16x32_bf16 v[172:175], v[136:139], a[232:235], v[172:175]
    v_exp_f32 v193, v169
    v_mfma_f32_16x16x32_bf16 v[172:175], v[132:135], a[228:231], v[172:175]
    v_exp_f32 v194, v170
    v_mfma_f32_16x16x32_bf16 v[172:175], v[128:131], a[224:227], v[172:175]
    v_exp_f32 v195, v171
    v_mfma_f32_16x16x32_bf16 v[172:175], v[124:127], a[220:223], v[172:175]
    v_cvt_pk_bf16_f32 v200, v192, v193
    v_cvt_pk_bf16_f32 v201, v194, v195
    v_mfma_f32_16x16x32_bf16 v[172:175], v[120:123], a[216:219], v[172:175]
    ds_write_b64 v9, v[200:201] offset:5120
    v_mfma_f32_16x16x32_bf16 v[172:175], v[116:119], a[212:215], v[172:175]
    v_add_f32 v206, v206, v192
    v_add_f32 v206, v206, v193
    v_mfma_f32_16x16x32_bf16 v[172:175], v[112:115], a[208:211], v[172:175]
    v_add_f32 v206, v206, v194
    v_add_f32 v206, v206, v195
    v_mfma_f32_16x16x32_bf16 v[172:175], v[108:111], a[204:207], v[172:175]
    s_cmp_lt_u32 s17, s40
    v_mfma_f32_16x16x32_bf16 v[172:175], v[104:107], a[200:203], v[172:175]
    s_cbranch_scc1 L_touch
    L_touch_ret:
    v_mfma_f32_16x16x32_bf16 v[172:175], v[100:103], a[196:199], v[172:175]
    v_mfma_f32_16x16x32_bf16 v[172:175], v[96:99], a[192:195], v[172:175]
    s_waitcnt lgkmcnt(1)
    v_mfma_f32_16x16x32_bf16 v[160:163], v[32:35], a[0:3], v[176:179]
    s_sub_u32 s17, s17, 1
    v_mfma_f32_16x16x32_bf16 v[160:163], v[36:39], a[4:7], v[160:163]
    s_nop 0
    v_mfma_f32_16x16x32_bf16 v[160:163], v[40:43], a[8:11], v[160:163]
    v_mfma_f32_16x16x32_bf16 v[160:163], v[44:47], a[12:15], v[160:163]
    v_mfma_f32_16x16x32_bf16 v[160:163], v[48:51], a[16:19], v[160:163]
    v_exp_f32 v196, v172
    v_mfma_f32_16x16x32_bf16 v[160:163], v[52:55], a[20:23], v[160:163]
    v_exp_f32 v197, v173
    v_mfma_f32_16x16x32_bf16 v[160:163], v[56:59], a[24:27], v[160:163]
    v_exp_f32 v198, v174
    v_mfma_f32_16x16x32_bf16 v[160:163], v[60:63], a[28:31], v[160:163]
    v_exp_f32 v199, v175
    v_mfma_f32_16x16x32_bf16 v[160:163], v[64:67], a[32:35], v[160:163]
    v_cvt_pk_bf16_f32 v202, v196, v197
    v_cvt_pk_bf16_f32 v203, v198, v199
    v_mfma_f32_16x16x32_bf16 v[160:163], v[68:71], a[36:39], v[160:163]
    ds_write_b64 v9, v[202:203] offset:5632
    v_mfma_f32_16x16x32_bf16 v[160:163], v[72:75], a[40:43], v[160:163]
    v_add_f32 v207, v207, v196
    v_add_f32 v207, v207, v197
    v_mfma_f32_16x16x32_bf16 v[160:163], v[76:79], a[44:47], v[160:163]
    v_add_f32 v207, v207, v198
    v_add_f32 v207, v207, v199
    v_mfma_f32_16x16x32_bf16 v[160:163], v[80:83], a[48:51], v[160:163]
    s_cmp_eq_u32 s17, 0
    v_mfma_f32_16x16x32_bf16 v[160:163], v[84:87], a[52:55], v[160:163]
    s_cbranch_scc1 L_qk_exit
    v_mfma_f32_16x16x32_bf16 v[160:163], v[88:91], a[56:59], v[160:163]
    v_mfma_f32_16x16x32_bf16 v[160:163], v[92:95], a[60:63], v[160:163]
    v_mfma_f32_16x16x32_bf16 v[164:167], v[92:95], a[124:127], v[180:183]
    v_mfma_f32_16x16x32_bf16 v[164:167], v[88:91], a[120:123], v[164:167]
    s_nop 0
    v_mfma_f32_16x16x32_bf16 v[164:167], v[84:87], a[116:119], v[164:167]
    s_waitcnt lgkmcnt(0)
    v_mfma_f32_16x16x32_bf16 v[164:167], v[80:83], a[112:115], v[164:167]
    s_barrier
    v_mfma_f32_16x16x32_bf16 v[164:167], v[76:79], a[108:111], v[164:167]
    v_exp_f32 v192, v160
    v_mfma_f32_16x16x32_bf16 v[164:167], v[72:75], a[104:107], v[164:167]
    v_exp_f32 v193, v161
    v_mfma_f32_16x16x32_bf16 v[164:167], v[68:71], a[100:103], v[164:167]
    v_exp_f32 v194, v162
    v_mfma_f32_16x16x32_bf16 v[164:167], v[64:67], a[96:99], v[164:167]
    v_exp_f32 v195, v163
    v_mfma_f32_16x16x32_bf16 v[164:167], v[60:63], a[92:95], v[164:167]
    v_cvt_pk_bf16_f32 v200, v192, v193
    v_cvt_pk_bf16_f32 v201, v194, v195
    v_mfma_f32_16x16x32_bf16 v[164:167], v[56:59], a[88:91], v[164:167]
    ds_write_b64 v9, v[200:201] offset:0
    v_mfma_f32_16x16x32_bf16 v[164:167], v[52:55], a[84:87], v[164:167]
    v_add_f32 v204, v204, v192
    v_add_f32 v204, v204, v193
    v_mfma_f32_16x16x32_bf16 v[164:167], v[48:51], a[80:83], v[164:167]
    v_add_f32 v204, v204, v194
    v_add_f32 v204, v204, v195
    v_mfma_f32_16x16x32_bf16 v[164:167], v[44:47], a[76:79], v[164:167]
    ds_read_b128 v[96:99], v8 offset:32768
    v_mfma_f32_16x16x32_bf16 v[164:167], v[40:43], a[72:75], v[164:167]
    ds_read_b128 v[100:103], v8 offset:33792
    v_mfma_f32_16x16x32_bf16 v[164:167], v[36:39], a[68:71], v[164:167]
    ds_read_b128 v[104:107], v8 offset:34816
    v_mfma_f32_16x16x32_bf16 v[164:167], v[32:35], a[64:67], v[164:167]
    ds_read_b128 v[108:111], v8 offset:35840
    v_mfma_f32_16x16x32_bf16 v[168:171], v[32:35], a[128:131], v[184:187]
    ds_read_b128 v[112:115], v8 offset:36864
    v_mfma_f32_16x16x32_bf16 v[168:171], v[36:39], a[132:135], v[168:171]
    ds_read_b128 v[116:119], v8 offset:37888
    v_mfma_f32_16x16x32_bf16 v[168:171], v[40:43], a[136:139], v[168:171]
    ds_read_b128 v[120:123], v8 offset:38912
    v_mfma_f32_16x16x32_bf16 v[168:171], v[44:47], a[140:143], v[168:171]
    ds_read_b128 v[124:127], v8 offset:39936
    v_mfma_f32_16x16x32_bf16 v[168:171], v[48:51], a[144:147], v[168:171]
    v_exp_f32 v196, v164
    v_mfma_f32_16x16x32_bf16 v[168:171], v[52:55], a[148:151], v[168:171]
    v_exp_f32 v197, v165
    v_mfma_f32_16x16x32_bf16 v[168:171], v[56:59], a[152:155], v[168:171]
    v_exp_f32 v198, v166
    v_mfma_f32_16x16x32_bf16 v[168:171], v[60:63], a[156:159], v[168:171]
    v_exp_f32 v199, v167
    v_mfma_f32_16x16x32_bf16 v[168:171], v[64:67], a[160:163], v[168:171]
    v_cvt_pk_bf16_f32 v202, v196, v197
    v_cvt_pk_bf16_f32 v203, v198, v199
    v_mfma_f32_16x16x32_bf16 v[168:171], v[68:71], a[164:167], v[168:171]
    ds_write_b64 v9, v[202:203] offset:512
    v_mfma_f32_16x16x32_bf16 v[168:171], v[72:75], a[168:171], v[168:171]
    v_add_f32 v205, v205, v196
    v_add_f32 v205, v205, v197
    v_mfma_f32_16x16x32_bf16 v[168:171], v[76:79], a[172:175], v[168:171]
    v_add_f32 v205, v205, v198
    v_add_f32 v205, v205, v199
    v_mfma_f32_16x16x32_bf16 v[168:171], v[80:83], a[176:179], v[168:171]
    ds_read_b128 v[128:131], v8 offset:40960
    v_mfma_f32_16x16x32_bf16 v[168:171], v[84:87], a[180:183], v[168:171]
    ds_read_b128 v[132:135], v8 offset:41984
    v_mfma_f32_16x16x32_bf16 v[168:171], v[88:91], a[184:187], v[168:171]
    ds_read_b128 v[136:139], v8 offset:43008
    v_mfma_f32_16x16x32_bf16 v[168:171], v[92:95], a[188:191], v[168:171]
    ds_read_b128 v[140:143], v8 offset:44032
    v_mfma_f32_16x16x32_bf16 v[172:175], v[92:95], a[252:255], v[188:191]
    ds_read_b128 v[144:147], v8 offset:45056
    v_mfma_f32_16x16x32_bf16 v[172:175], v[88:91], a[248:251], v[172:175]
    ds_read_b128 v[148:151], v8 offset:46080
    v_mfma_f32_16x16x32_bf16 v[172:175], v[84:87], a[244:247], v[172:175]
    ds_read_b128 v[152:155], v8 offset:47104
    v_mfma_f32_16x16x32_bf16 v[172:175], v[80:83], a[240:243], v[172:175]
    ds_read_b128 v[156:159], v8 offset:48128
    v_mfma_f32_16x16x32_bf16 v[172:175], v[76:79], a[236:239], v[172:175]
    v_exp_f32 v192, v168
    v_mfma_f32_16x16x32_bf16 v[172:175], v[72:75], a[232:235], v[172:175]
    v_exp_f32 v193, v169
    v_mfma_f32_16x16x32_bf16 v[172:175], v[68:71], a[228:231], v[172:175]
    v_exp_f32 v194, v170
    v_mfma_f32_16x16x32_bf16 v[172:175], v[64:67], a[224:227], v[172:175]
    v_exp_f32 v195, v171
    v_mfma_f32_16x16x32_bf16 v[172:175], v[60:63], a[220:223], v[172:175]
    v_cvt_pk_bf16_f32 v200, v192, v193
    v_cvt_pk_bf16_f32 v201, v194, v195
    v_mfma_f32_16x16x32_bf16 v[172:175], v[56:59], a[216:219], v[172:175]
    ds_write_b64 v9, v[200:201] offset:1024
    v_mfma_f32_16x16x32_bf16 v[172:175], v[52:55], a[212:215], v[172:175]
    v_add_f32 v206, v206, v192
    v_add_f32 v206, v206, v193
    v_mfma_f32_16x16x32_bf16 v[172:175], v[48:51], a[208:211], v[172:175]
    v_add_f32 v206, v206, v194
    v_add_f32 v206, v206, v195
    v_mfma_f32_16x16x32_bf16 v[172:175], v[44:47], a[204:207], v[172:175]
    v_mfma_f32_16x16x32_bf16 v[172:175], v[40:43], a[200:203], v[172:175]
    v_mfma_f32_16x16x32_bf16 v[172:175], v[36:39], a[196:199], v[172:175]
    v_mfma_f32_16x16x32_bf16 v[172:175], v[32:35], a[192:195], v[172:175]
    s_waitcnt lgkmcnt(1)
    v_mfma_f32_16x16x32_bf16 v[160:163], v[96:99], a[0:3], v[176:179]
    s_sub_u32 s17, s17, 1
    v_mfma_f32_16x16x32_bf16 v[160:163], v[100:103], a[4:7], v[160:163]
    s_nop 0
    v_mfma_f32_16x16x32_bf16 v[160:163], v[104:107], a[8:11], v[160:163]
    v_mfma_f32_16x16x32_bf16 v[160:163], v[108:111], a[12:15], v[160:163]
    v_mfma_f32_16x16x32_bf16 v[160:163], v[112:115], a[16:19], v[160:163]
    v_exp_f32 v196, v172
    v_mfma_f32_16x16x32_bf16 v[160:163], v[116:119], a[20:23], v[160:163]
    v_exp_f32 v197, v173
    v_mfma_f32_16x16x32_bf16 v[160:163], v[120:123], a[24:27], v[160:163]
    v_exp_f32 v198, v174
    v_mfma_f32_16x16x32_bf16 v[160:163], v[124:127], a[28:31], v[160:163]
    v_exp_f32 v199, v175
    v_mfma_f32_16x16x32_bf16 v[160:163], v[128:131], a[32:35], v[160:163]
    v_cvt_pk_bf16_f32 v202, v196, v197
    v_cvt_pk_bf16_f32 v203, v198, v199
    v_mfma_f32_16x16x32_bf16 v[160:163], v[132:135], a[36:39], v[160:163]
    ds_write_b64 v9, v[202:203] offset:1536
    v_mfma_f32_16x16x32_bf16 v[160:163], v[136:139], a[40:43], v[160:163]
    v_add_f32 v207, v207, v196
    v_add_f32 v207, v207, v197
    v_mfma_f32_16x16x32_bf16 v[160:163], v[140:143], a[44:47], v[160:163]
    v_add_f32 v207, v207, v198
    v_add_f32 v207, v207, v199
    v_mfma_f32_16x16x32_bf16 v[160:163], v[144:147], a[48:51], v[160:163]
    s_cmp_eq_u32 s17, 0
    s_branch L_qk_loop
.p2align 2
L_qk_exit:
L_qk_done:
    v_permlane16_swap_b32 v204, v205
    v_permlane16_swap_b32 v206, v207
    ds_read_b128 v[56:59], v238 offset:0
    ds_read_b128 v[60:63], v238 offset:512
    ds_read_b128 v[64:67], v238 offset:1024
    ds_read_b128 v[68:71], v238 offset:1536
    ds_read_b128 v[72:75], v238 offset:2048
    v_add_f32 v204, v204, v205
    v_add_f32 v206, v206, v207
    s_waitcnt vmcnt(0)
    v_pk_add_f32 v[212:213], v[212:213], v[214:215]
    v_pk_add_f32 v[212:213], v[212:213], v[216:217]
    v_pk_add_f32 v[212:213], v[212:213], v[218:219]
    v_pk_add_f32 v[212:213], v[212:213], v[220:221]
    v_pk_add_f32 v[212:213], v[212:213], v[222:223]
    v_pk_add_f32 v[212:213], v[212:213], v[224:225]
    v_pk_add_f32 v[212:213], v[212:213], v[226:227]
    v_mul_f32 v212, 0x3b000000, v212
    v_mul_f32 v213, 0x3b000000, v213
    v_fma_f32 v213, -v212, v212, v213
    v_max_f32 v213, 0, v213
    v_add_f32 v213, 0x3727c5ac, v213
    v_rsq_f32 v213, v213
    v_cmp_gt_u32 vcc, 4000, v228
    v_mul_f32 v212, v212, v213
    v_sub_f32 v212, 0, v212
    v_cndmask_b32 v214, 0, v213, vcc
    v_cndmask_b32 v215, 0, v212, vcc
    ds_write_b64 v231, v[214:215]
    v_permlane32_swap_b32 v204, v206
    s_nop 0
    v_add_f32 v243, v204, v206
    v_or_b32 v243, 0x80000000, v243
    ds_write_b64 v245, v[242:243]
    s_waitcnt lgkmcnt(0)
    s_barrier
    ds_read2st64_b32 v[192:193], v246 offset0:0 offset1:2
    ds_read_b128 v[112:115], v233 offset:0
    ds_read_b64 v[144:145], v237 offset:0
    ds_read_b128 v[116:119], v233 offset:512
    ds_read_b64 v[146:147], v237 offset:8
    ds_read_b128 v[120:123], v232 offset:0
    ds_read_b64 v[148:149], v237 offset:16
    v_lshlrev_b32 v16, 16, v56
    v_and_b32 v17, s43, v56
    v_lshlrev_b32 v18, 16, v57
    v_and_b32 v19, s43, v57
    v_lshlrev_b32 v20, 16, v58
    v_and_b32 v21, s43, v58
    v_lshlrev_b32 v22, 16, v59
    v_and_b32 v23, s43, v59
    v_lshlrev_b32 v24, 16, v60
    v_and_b32 v25, s43, v60
    v_lshlrev_b32 v26, 16, v61
    v_and_b32 v27, s43, v61
    v_lshlrev_b32 v28, 16, v62
    v_and_b32 v29, s43, v62
    v_lshlrev_b32 v30, 16, v63
    v_and_b32 v31, s43, v63
    v_lshlrev_b32 v32, 16, v64
    v_and_b32 v33, s43, v64
    v_lshlrev_b32 v34, 16, v65
    v_and_b32 v35, s43, v65
    v_lshlrev_b32 v36, 16, v66
    v_and_b32 v37, s43, v66
    v_lshlrev_b32 v38, 16, v67
    v_and_b32 v39, s43, v67
    v_lshlrev_b32 v40, 16, v68
    v_and_b32 v41, s43, v68
    v_lshlrev_b32 v42, 16, v69
    v_and_b32 v43, s43, v69
    v_lshlrev_b32 v44, 16, v70
    v_and_b32 v45, s43, v70
    v_lshlrev_b32 v46, 16, v71
    v_and_b32 v47, s43, v71
    v_lshlrev_b32 v48, 16, v72
    v_and_b32 v49, s43, v72
    v_lshlrev_b32 v50, 16, v73
    v_and_b32 v51, s43, v73
    v_lshlrev_b32 v52, 16, v74
    v_and_b32 v53, s43, v74
    v_lshlrev_b32 v54, 16, v75
    v_and_b32 v55, s43, v75
    s_waitcnt lgkmcnt(6)
    v_add_f32 v192, v192, v193
    v_cmp_nle_f32 vcc, s101, v192
    s_cmp_eq_u32 s101, 0
    s_cselect_b64 s[28:29], 0, vcc
    s_cmp_lg_u64 s[28:29], 0
    s_cbranch_scc1 L_redo
    s_cmp_lg_u32 s21, 0
    s_cbranch_scc1 L_rm_far
    buffer_store_dwordx2 v[242:243], v244, s[12:15], s41 offen
L_rm_back:
    ds_read_b128 v[124:127], v232 offset:512
    ds_read_b64 v[150:151], v237 offset:24
    s_waitcnt lgkmcnt(6)
    v_lshlrev_b32 v56, 16, v112
    v_and_b32 v57, s43, v112
    v_lshlrev_b32 v58, 16, v113
    v_and_b32 v59, s43, v113
    v_lshlrev_b32 v60, 16, v114
    v_and_b32 v61, s43, v114
    v_lshlrev_b32 v62, 16, v115
    v_and_b32 v63, s43, v115
    v_pk_fma_f32 v[56:57], v[56:57], v[144:145], v[144:145] op_sel:[0,0,1] op_sel_hi:[1,0,1]
    v_pk_fma_f32 v[58:59], v[58:59], v[144:145], v[144:145] op_sel:[0,0,1] op_sel_hi:[1,0,1]
    v_pk_fma_f32 v[60:61], v[60:61], v[144:145], v[144:145] op_sel:[0,0,1] op_sel_hi:[1,0,1]
    v_pk_fma_f32 v[62:63], v[62:63], v[144:145], v[144:145] op_sel:[0,0,1] op_sel_hi:[1,0,1]
    ds_read_b128 v[112:115], v232 offset:1024
    ds_read_b64 v[144:145], v237 offset:32
    ds_read_b128 v[128:131], v235 offset:0
    s_waitcnt lgkmcnt(7)
    v_lshlrev_b32 v64, 16, v116
    v_and_b32 v65, s43, v116
    v_lshlrev_b32 v66, 16, v117
    v_and_b32 v67, s43, v117
    v_lshlrev_b32 v68, 16, v118
    v_and_b32 v69, s43, v118
    v_lshlrev_b32 v70, 16, v119
    v_and_b32 v71, s43, v119
    v_pk_fma_f32 v[64:65], v[64:65], v[146:147], v[146:147] op_sel:[0,0,1] op_sel_hi:[1,0,1]
    v_pk_fma_f32 v[66:67], v[66:67], v[146:147], v[146:147] op_sel:[0,0,1] op_sel_hi:[1,0,1]
    v_pk_fma_f32 v[68:69], v[68:69], v[146:147], v[146:147] op_sel:[0,0,1] op_sel_hi:[1,0,1]
    v_pk_fma_f32 v[70:71], v[70:71], v[146:147], v[146:147] op_sel:[0,0,1] op_sel_hi:[1,0,1]
    ds_read_b128 v[116:119], v232 offset:1536
    ds_read_b64 v[146:147], v237 offset:40
    ds_read_b128 v[132:135], v235 offset:512
    s_waitcnt lgkmcnt(8)
    v_lshlrev_b32 v72, 16, v120
    v_and_b32 v73, s43, v120
    v_lshlrev_b32 v74, 16, v121
    v_and_b32 v75, s43, v121
    v_lshlrev_b32 v76, 16, v122
    v_and_b32 v77, s43, v122
    v_lshlrev_b32 v78, 16, v123
    v_and_b32 v79, s43, v123
    v_pk_fma_f32 v[72:73], v[72:73], v[148:149], v[148:149] op_sel:[0,0,1] op_sel_hi:[1,0,1]
    v_pk_fma_f32 v[74:75], v[74:75], v[148:149], v[148:149] op_sel:[0,0,1] op_sel_hi:[1,0,1]
    v_pk_fma_f32 v[76:77], v[76:77], v[148:149], v[148:149] op_sel:[0,0,1] op_sel_hi:[1,0,1]
    v_pk_fma_f32 v[78:79], v[78:79], v[148:149], v[148:149] op_sel:[0,0,1] op_sel_hi:[1,0,1]
    ds_read_b128 v[120:123], v232 offset:2048
    ds_read_b64 v[148:149], v237 offset:48
    ds_read_b128 v[136:139], v235 offset:1024
    s_waitcnt lgkmcnt(9)
    v_lshlrev_b32 v80, 16, v124
    v_and_b32 v81, s43, v124
    v_lshlrev_b32 v82, 16, v125
    v_and_b32 v83, s43, v125
    v_lshlrev_b32 v84, 16, v126
    v_and_b32 v85, s43, v126
    v_lshlrev_b32 v86, 16, v127
    v_and_b32 v87, s43, v127
    v_pk_fma_f32 v[80:81], v[80:81], v[150:151], v[150:151] op_sel:[0,0,1] op_sel_hi:[1,0,1]
    v_pk_fma_f32 v[82:83], v[82:83], v[150:151], v[150:151] op_sel:[0,0,1] op_sel_hi:[1,0,1]
    v_pk_fma_f32 v[84:85], v[84:85], v[150:151], v[150:151] op_sel:[0,0,1] op_sel_hi:[1,0,1]
    v_pk_fma_f32 v[86:87], v[86:87], v[150:151], v[150:151] op_sel:[0,0,1] op_sel_hi:[1,0,1]
    ds_read_b128 v[124:127], v232 offset:2560
    ds_read_b64 v[150:151], v237 offset:56
    ds_read_b128 v[140:143], v235 offset:1536
    s_waitcnt lgkmcnt(9)
    v_lshlrev_b32 v88, 16, v112
    v_pk_mul_f32 v[96:97], v[56:57], v[16:17]
    v_pk_mul_f32 v[98:99], v[58:59], v[18:19]
    v_and_b32 v89, s43, v112
    v_pk_mul_f32 v[100:101], v[60:61], v[20:21]
    v_pk_mul_f32 v[102:103], v[62:63], v[22:23]
    v_lshlrev_b32 v90, 16, v113
    v_pk_fma_f32 v[96:97], v[64:65], v[24:25], v[96:97]
    v_pk_fma_f32 v[98:99], v[66:67], v[26:27], v[98:99]
    v_and_b32 v91, s43, v113
    v_pk_fma_f32 v[100:101], v[68:69], v[28:29], v[100:101]
    v_pk_fma_f32 v[102:103], v[70:71], v[30:31], v[102:103]
    v_lshlrev_b32 v92, 16, v114
    v_pk_fma_f32 v[96:97], v[72:73], v[32:33], v[96:97]
    v_pk_fma_f32 v[98:99], v[74:75], v[34:35], v[98:99]
    v_and_b32 v93, s43, v114
    v_pk_fma_f32 v[100:101], v[76:77], v[36:37], v[100:101]
    v_pk_fma_f32 v[102:103], v[78:79], v[38:39], v[102:103]
    v_lshlrev_b32 v94, 16, v115
    v_pk_fma_f32 v[96:97], v[80:81], v[40:41], v[96:97]
    v_pk_fma_f32 v[98:99], v[82:83], v[42:43], v[98:99]
    v_and_b32 v95, s43, v115
    v_pk_fma_f32 v[100:101], v[84:85], v[44:45], v[100:101]
    v_pk_fma_f32 v[102:103], v[86:87], v[46:47], v[102:103]
    v_pk_fma_f32 v[88:89], v[88:89], v[144:145], v[144:145] op_sel:[0,0,1] op_sel_hi:[1,0,1]
    v_lshlrev_b32 v104, 16, v128
    v_pk_fma_f32 v[90:91], v[90:91], v[144:145], v[144:145] op_sel:[0,0,1] op_sel_hi:[1,0,1]
    v_pk_fma_f32 v[92:93], v[92:93], v[144:145], v[144:145] op_sel:[0,0,1] op_sel_hi:[1,0,1]
    v_and_b32 v105, s43, v128
    v_pk_fma_f32 v[94:95], v[94:95], v[144:145], v[144:145] op_sel:[0,0,1] op_sel_hi:[1,0,1]
    v_pk_fma_f32 v[96:97], v[88:89], v[48:49], v[96:97]
    v_lshlrev_b32 v106, 16, v129
    v_pk_fma_f32 v[98:99], v[90:91], v[50:51], v[98:99]
    v_pk_fma_f32 v[100:101], v[92:93], v[52:53], v[100:101]
    v_and_b32 v107, s43, v129
    v_pk_fma_f32 v[102:103], v[94:95], v[54:55], v[102:103]
    v_pk_mul_f32 v[96:97], v[96:97], v[104:105]
    v_lshlrev_b32 v108, 16, v130
    v_pk_mul_f32 v[98:99], v[98:99], v[106:107]
    v_cvt_pk_bf16_f32 v152, v96, v97
    v_and_b32 v109, s43, v130
    v_cvt_pk_bf16_f32 v153, v98, v99
    v_pk_mul_f32 v[100:101], v[100:101], v[108:109]
    v_lshlrev_b32 v110, 16, v131
    v_cvt_pk_bf16_f32 v154, v100, v101
    v_and_b32 v111, s43, v131
    v_xor_b32 v11, 0, v236
    v_pk_mul_f32 v[102:103], v[102:103], v[110:111]
    v_cvt_pk_bf16_f32 v155, v102, v103
    ds_write_b128 v11, v[152:155] offset:0
    ds_read_b128 v[112:115], v232 offset:3072
    ds_read_b64 v[144:145], v237 offset:64
    ds_read_b128 v[128:131], v235 offset:2048
    s_waitcnt lgkmcnt(10)
    v_lshlrev_b32 v56, 16, v116
    v_pk_mul_f32 v[96:97], v[64:65], v[16:17]
    v_pk_mul_f32 v[98:99], v[66:67], v[18:19]
    v_and_b32 v57, s43, v116
    v_pk_mul_f32 v[100:101], v[68:69], v[20:21]
    v_pk_mul_f32 v[102:103], v[70:71], v[22:23]
    v_lshlrev_b32 v58, 16, v117
    v_pk_fma_f32 v[96:97], v[72:73], v[24:25], v[96:97]
    v_pk_fma_f32 v[98:99], v[74:75], v[26:27], v[98:99]
    v_and_b32 v59, s43, v117
    v_pk_fma_f32 v[100:101], v[76:77], v[28:29], v[100:101]
    v_pk_fma_f32 v[102:103], v[78:79], v[30:31], v[102:103]
    v_lshlrev_b32 v60, 16, v118
    v_pk_fma_f32 v[96:97], v[80:81], v[32:33], v[96:97]
    v_pk_fma_f32 v[98:99], v[82:83], v[34:35], v[98:99]
    v_and_b32 v61, s43, v118
    v_pk_fma_f32 v[100:101], v[84:85], v[36:37], v[100:101]
    v_pk_fma_f32 v[102:103], v[86:87], v[38:39], v[102:103]
    v_lshlrev_b32 v62, 16, v119
    v_pk_fma_f32 v[96:97], v[88:89], v[40:41], v[96:97]
    v_pk_fma_f32 v[98:99], v[90:91], v[42:43], v[98:99]
    v_and_b32 v63, s43, v119
    v_pk_fma_f32 v[100:101], v[92:93], v[44:45], v[100:101]
    v_pk_fma_f32 v[102:103], v[94:95], v[46:47], v[102:103]
    v_pk_fma_f32 v[56:57], v[56:57], v[146:147], v[146:147] op_sel:[0,0,1] op_sel_hi:[1,0,1]
    v_lshlrev_b32 v104, 16, v132
    v_pk_fma_f32 v[58:59], v[58:59], v[146:147], v[146:147] op_sel:[0,0,1] op_sel_hi:[1,0,1]
    v_pk_fma_f32 v[60:61], v[60:61], v[146:147], v[146:147] op_sel:[0,0,1] op_sel_hi:[1,0,1]
    v_and_b32 v105, s43, v132
    v_pk_fma_f32 v[62:63], v[62:63], v[146:147], v[146:147] op_sel:[0,0,1] op_sel_hi:[1,0,1]
    v_pk_fma_f32 v[96:97], v[56:57], v[48:49], v[96:97]
    v_lshlrev_b32 v106, 16, v133
    v_pk_fma_f32 v[98:99], v[58:59], v[50:51], v[98:99]
    v_pk_fma_f32 v[100:101], v[60:61], v[52:53], v[100:101]
    v_and_b32 v107, s43, v133
    v_pk_fma_f32 v[102:103], v[62:63], v[54:55], v[102:103]
    v_pk_mul_f32 v[96:97], v[96:97], v[104:105]
    v_lshlrev_b32 v108, 16, v134
    v_pk_mul_f32 v[98:99], v[98:99], v[106:107]
    v_cvt_pk_bf16_f32 v156, v96, v97
    v_and_b32 v109, s43, v134
    v_cvt_pk_bf16_f32 v157, v98, v99
    v_pk_mul_f32 v[100:101], v[100:101], v[108:109]
    v_lshlrev_b32 v110, 16, v135
    v_cvt_pk_bf16_f32 v158, v100, v101
    v_and_b32 v111, s43, v135
    v_xor_b32 v11, 32, v236
    v_pk_mul_f32 v[102:103], v[102:103], v[110:111]
    v_cvt_pk_bf16_f32 v159, v102, v103
    ds_write_b128 v11, v[156:159] offset:512
    ds_read_b128 v[116:119], v232 offset:3584
    ds_read_b64 v[146:147], v237 offset:72
    ds_read_b128 v[132:135], v235 offset:2560
    s_add_u32 s59, s52, 524288
    buffer_load_dwordx4 a[176:179], v3, s[12:15], s59 offen offset:0 sc1
    buffer_load_dwordx4 a[180:183], v3, s[12:15], s59 offen offset:1024 sc1
    buffer_load_dwordx4 a[184:187], v3, s[12:15], s59 offen offset:2048 sc1
    s_waitcnt lgkmcnt(11)
    v_lshlrev_b32 v64, 16, v120
    v_pk_mul_f32 v[96:97], v[72:73], v[16:17]
    v_pk_mul_f32 v[98:99], v[74:75], v[18:19]
    v_and_b32 v65, s43, v120
    v_pk_mul_f32 v[100:101], v[76:77], v[20:21]
    v_pk_mul_f32 v[102:103], v[78:79], v[22:23]
    v_lshlrev_b32 v66, 16, v121
    v_pk_fma_f32 v[96:97], v[80:81], v[24:25], v[96:97]
    v_pk_fma_f32 v[98:99], v[82:83], v[26:27], v[98:99]
    v_and_b32 v67, s43, v121
    v_pk_fma_f32 v[100:101], v[84:85], v[28:29], v[100:101]
    v_pk_fma_f32 v[102:103], v[86:87], v[30:31], v[102:103]
    v_lshlrev_b32 v68, 16, v122
    v_pk_fma_f32 v[96:97], v[88:89], v[32:33], v[96:97]
    v_pk_fma_f32 v[98:99], v[90:91], v[34:35], v[98:99]
    v_and_b32 v69, s43, v122
    v_pk_fma_f32 v[100:101], v[92:93], v[36:37], v[100:101]
    v_pk_fma_f32 v[102:103], v[94:95], v[38:39], v[102:103]
    v_lshlrev_b32 v70, 16, v123
    v_pk_fma_f32 v[96:97], v[56:57], v[40:41], v[96:97]
    v_pk_fma_f32 v[98:99], v[58:59], v[42:43], v[98:99]
    v_and_b32 v71, s43, v123
    v_pk_fma_f32 v[100:101], v[60:61], v[44:45], v[100:101]
    v_pk_fma_f32 v[102:103], v[62:63], v[46:47], v[102:103]
    v_pk_fma_f32 v[64:65], v[64:65], v[148:149], v[148:149] op_sel:[0,0,1] op_sel_hi:[1,0,1]
    v_lshlrev_b32 v104, 16, v136
    v_pk_fma_f32 v[66:67], v[66:67], v[148:149], v[148:149] op_sel:[0,0,1] op_sel_hi:[1,0,1]
    v_pk_fma_f32 v[68:69], v[68:69], v[148:149], v[148:149] op_sel:[0,0,1] op_sel_hi:[1,0,1]
    v_and_b32 v105, s43, v136
    v_pk_fma_f32 v[70:71], v[70:71], v[148:149], v[148:149] op_sel:[0,0,1] op_sel_hi:[1,0,1]
    v_pk_fma_f32 v[96:97], v[64:65], v[48:49], v[96:97]
    v_lshlrev_b32 v106, 16, v137
    v_pk_fma_f32 v[98:99], v[66:67], v[50:51], v[98:99]
    v_pk_fma_f32 v[100:101], v[68:69], v[52:53], v[100:101]
    v_and_b32 v107, s43, v137
    v_pk_fma_f32 v[102:103], v[70:71], v[54:55], v[102:103]
    v_pk_mul_f32 v[96:97], v[96:97], v[104:105]
    v_lshlrev_b32 v108, 16, v138
    v_pk_mul_f32 v[98:99], v[98:99], v[106:107]
    v_cvt_pk_bf16_f32 v152, v96, v97
    v_and_b32 v109, s43, v138
    v_cvt_pk_bf16_f32 v153, v98, v99
    v_pk_mul_f32 v[100:101], v[100:101], v[108:109]
    v_lshlrev_b32 v110, 16, v139
    v_cvt_pk_bf16_f32 v154, v100, v101
    v_and_b32 v111, s43, v139
    v_xor_b32 v11, 64, v236
    v_pk_mul_f32 v[102:103], v[102:103], v[110:111]
    v_cvt_pk_bf16_f32 v155, v102, v103
    ds_write_b128 v11, v[152:155] offset:1024
    ds_read_b128 v[120:123], v232 offset:4096
    ds_read_b64 v[148:149], v237 offset:80
    ds_read_b128 v[136:139], v235 offset:3072
    buffer_load_dwordx4 a[188:191], v3, s[12:15], s59 offen offset:3072 sc1
    s_add_u32 s59, s52, 528384
    buffer_load_dwordx4 a[192:195], v3, s[12:15], s59 offen offset:0 sc1
    buffer_load_dwordx4 a[196:199], v3, s[12:15], s59 offen offset:1024 sc1
    s_waitcnt lgkmcnt(12)
    v_lshlrev_b32 v72, 16, v124
    v_pk_mul_f32 v[96:97], v[80:81], v[16:17]
    v_pk_mul_f32 v[98:99], v[82:83], v[18:19]
    v_and_b32 v73, s43, v124
    v_pk_mul_f32 v[100:101], v[84:85], v[20:21]
    v_pk_mul_f32 v[102:103], v[86:87], v[22:23]
    v_lshlrev_b32 v74, 16, v125
    v_pk_fma_f32 v[96:97], v[88:89], v[24:25], v[96:97]
    v_pk_fma_f32 v[98:99], v[90:91], v[26:27], v[98:99]
    v_and_b32 v75, s43, v125
    v_pk_fma_f32 v[100:101], v[92:93], v[28:29], v[100:101]
    v_pk_fma_f32 v[102:103], v[94:95], v[30:31], v[102:103]
    v_lshlrev_b32 v76, 16, v126
    v_pk_fma_f32 v[96:97], v[56:57], v[32:33], v[96:97]
    v_pk_fma_f32 v[98:99], v[58:59], v[34:35], v[98:99]
    v_and_b32 v77, s43, v126
    v_pk_fma_f32 v[100:101], v[60:61], v[36:37], v[100:101]
    v_pk_fma_f32 v[102:103], v[62:63], v[38:39], v[102:103]
    v_lshlrev_b32 v78, 16, v127
    v_pk_fma_f32 v[96:97], v[64:65], v[40:41], v[96:97]
    v_pk_fma_f32 v[98:99], v[66:67], v[42:43], v[98:99]
    v_and_b32 v79, s43, v127
    v_pk_fma_f32 v[100:101], v[68:69], v[44:45], v[100:101]
    v_pk_fma_f32 v[102:103], v[70:71], v[46:47], v[102:103]
    v_pk_fma_f32 v[72:73], v[72:73], v[150:151], v[150:151] op_sel:[0,0,1] op_sel_hi:[1,0,1]
    v_lshlrev_b32 v104, 16, v140
    v_pk_fma_f32 v[74:75], v[74:75], v[150:151], v[150:151] op_sel:[0,0,1] op_sel_hi:[1,0,1]
    v_pk_fma_f32 v[76:77], v[76:77], v[150:151], v[150:151] op_sel:[0,0,1] op_sel_hi:[1,0,1]
    v_and_b32 v105, s43, v140
    v_pk_fma_f32 v[78:79], v[78:79], v[150:151], v[150:151] op_sel:[0,0,1] op_sel_hi:[1,0,1]
    v_pk_fma_f32 v[96:97], v[72:73], v[48:49], v[96:97]
    v_lshlrev_b32 v106, 16, v141
    v_pk_fma_f32 v[98:99], v[74:75], v[50:51], v[98:99]
    v_pk_fma_f32 v[100:101], v[76:77], v[52:53], v[100:101]
    v_and_b32 v107, s43, v141
    v_pk_fma_f32 v[102:103], v[78:79], v[54:55], v[102:103]
    v_pk_mul_f32 v[96:97], v[96:97], v[104:105]
    v_lshlrev_b32 v108, 16, v142
    v_pk_mul_f32 v[98:99], v[98:99], v[106:107]
    v_cvt_pk_bf16_f32 v156, v96, v97
    v_and_b32 v109, s43, v142
    v_cvt_pk_bf16_f32 v157, v98, v99
    v_pk_mul_f32 v[100:101], v[100:101], v[108:109]
    v_lshlrev_b32 v110, 16, v143
    v_cvt_pk_bf16_f32 v158, v100, v101
    v_and_b32 v111, s43, v143
    v_xor_b32 v11, 96, v236
    v_pk_mul_f32 v[102:103], v[102:103], v[110:111]
    v_cvt_pk_bf16_f32 v159, v102, v103
    ds_write_b128 v11, v[156:159] offset:1536
    ds_read_b128 v[124:127], v232 offset:4608
    ds_read_b64 v[150:151], v237 offset:88
    s_waitcnt lgkmcnt(14)
    ds_read_b128 v[140:143], v235 offset:3584
    buffer_load_dwordx4 a[200:203], v3, s[12:15], s59 offen offset:2048 sc1
    buffer_load_dwordx4 a[204:207], v3, s[12:15], s59 offen offset:3072 sc1
    s_add_u32 s59, s52, 532480
    buffer_load_dwordx4 a[208:211], v3, s[12:15], s59 offen offset:0 sc1
    s_waitcnt lgkmcnt(12)
    v_lshlrev_b32 v80, 16, v112
    v_pk_mul_f32 v[96:97], v[88:89], v[16:17]
    v_pk_mul_f32 v[98:99], v[90:91], v[18:19]
    v_and_b32 v81, s43, v112
    v_pk_mul_f32 v[100:101], v[92:93], v[20:21]
    v_pk_mul_f32 v[102:103], v[94:95], v[22:23]
    v_lshlrev_b32 v82, 16, v113
    v_pk_fma_f32 v[96:97], v[56:57], v[24:25], v[96:97]
    v_pk_fma_f32 v[98:99], v[58:59], v[26:27], v[98:99]
    v_and_b32 v83, s43, v113
    v_pk_fma_f32 v[100:101], v[60:61], v[28:29], v[100:101]
    v_pk_fma_f32 v[102:103], v[62:63], v[30:31], v[102:103]
    v_lshlrev_b32 v84, 16, v114
    v_pk_fma_f32 v[96:97], v[64:65], v[32:33], v[96:97]
    v_pk_fma_f32 v[98:99], v[66:67], v[34:35], v[98:99]
    v_and_b32 v85, s43, v114
    v_pk_fma_f32 v[100:101], v[68:69], v[36:37], v[100:101]
    v_pk_fma_f32 v[102:103], v[70:71], v[38:39], v[102:103]
    v_lshlrev_b32 v86, 16, v115
    v_pk_fma_f32 v[96:97], v[72:73], v[40:41], v[96:97]
    v_pk_fma_f32 v[98:99], v[74:75], v[42:43], v[98:99]
    v_and_b32 v87, s43, v115
    v_pk_fma_f32 v[100:101], v[76:77], v[44:45], v[100:101]
    v_pk_fma_f32 v[102:103], v[78:79], v[46:47], v[102:103]
    v_pk_fma_f32 v[80:81], v[80:81], v[144:145], v[144:145] op_sel:[0,0,1] op_sel_hi:[1,0,1]
    v_lshlrev_b32 v104, 16, v128
    v_pk_fma_f32 v[82:83], v[82:83], v[144:145], v[144:145] op_sel:[0,0,1] op_sel_hi:[1,0,1]
    v_pk_fma_f32 v[84:85], v[84:85], v[144:145], v[144:145] op_sel:[0,0,1] op_sel_hi:[1,0,1]
    v_and_b32 v105, s43, v128
    v_pk_fma_f32 v[86:87], v[86:87], v[144:145], v[144:145] op_sel:[0,0,1] op_sel_hi:[1,0,1]
    v_pk_fma_f32 v[96:97], v[80:81], v[48:49], v[96:97]
    v_lshlrev_b32 v106, 16, v129
    v_pk_fma_f32 v[98:99], v[82:83], v[50:51], v[98:99]
    v_pk_fma_f32 v[100:101], v[84:85], v[52:53], v[100:101]
    v_and_b32 v107, s43, v129
    v_pk_fma_f32 v[102:103], v[86:87], v[54:55], v[102:103]
    v_pk_mul_f32 v[96:97], v[96:97], v[104:105]
    v_lshlrev_b32 v108, 16, v130
    v_pk_mul_f32 v[98:99], v[98:99], v[106:107]
    v_cvt_pk_bf16_f32 v152, v96, v97
    v_and_b32 v109, s43, v130
    v_cvt_pk_bf16_f32 v153, v98, v99
    v_pk_mul_f32 v[100:101], v[100:101], v[108:109]
    v_lshlrev_b32 v110, 16, v131
    v_cvt_pk_bf16_f32 v154, v100, v101
    v_and_b32 v111, s43, v131
    v_xor_b32 v11, 128, v236
    v_pk_mul_f32 v[102:103], v[102:103], v[110:111]
    v_cvt_pk_bf16_f32 v155, v102, v103
    ds_write_b128 v11, v[152:155] offset:2048
    ds_read_b128 v[112:115], v232 offset:5120
    ds_read_b64 v[144:145], v237 offset:96
    s_waitcnt lgkmcnt(14)
    ds_read_b128 v[128:131], v235 offset:4096
    buffer_load_dwordx4 a[212:215], v3, s[12:15], s59 offen offset:1024 sc1
    buffer_load_dwordx4 a[216:219], v3, s[12:15], s59 offen offset:2048 sc1
    buffer_load_dwordx4 a[220:223], v3, s[12:15], s59 offen offset:3072 sc1
    s_waitcnt lgkmcnt(12)
    v_lshlrev_b32 v88, 16, v116
    v_pk_mul_f32 v[96:97], v[56:57], v[16:17]
    v_pk_mul_f32 v[98:99], v[58:59], v[18:19]
    v_and_b32 v89, s43, v116
    v_pk_mul_f32 v[100:101], v[60:61], v[20:21]
    v_pk_mul_f32 v[102:103], v[62:63], v[22:23]
    v_lshlrev_b32 v90, 16, v117
    v_pk_fma_f32 v[96:97], v[64:65], v[24:25], v[96:97]
    v_pk_fma_f32 v[98:99], v[66:67], v[26:27], v[98:99]
    v_and_b32 v91, s43, v117
    v_pk_fma_f32 v[100:101], v[68:69], v[28:29], v[100:101]
    v_pk_fma_f32 v[102:103], v[70:71], v[30:31], v[102:103]
    v_lshlrev_b32 v92, 16, v118
    v_pk_fma_f32 v[96:97], v[72:73], v[32:33], v[96:97]
    v_pk_fma_f32 v[98:99], v[74:75], v[34:35], v[98:99]
    v_and_b32 v93, s43, v118
    v_pk_fma_f32 v[100:101], v[76:77], v[36:37], v[100:101]
    v_pk_fma_f32 v[102:103], v[78:79], v[38:39], v[102:103]
    v_lshlrev_b32 v94, 16, v119
    v_pk_fma_f32 v[96:97], v[80:81], v[40:41], v[96:97]
    v_pk_fma_f32 v[98:99], v[82:83], v[42:43], v[98:99]
    v_and_b32 v95, s43, v119
    v_pk_fma_f32 v[100:101], v[84:85], v[44:45], v[100:101]
    v_pk_fma_f32 v[102:103], v[86:87], v[46:47], v[102:103]
    v_pk_fma_f32 v[88:89], v[88:89], v[146:147], v[146:147] op_sel:[0,0,1] op_sel_hi:[1,0,1]
    v_lshlrev_b32 v104, 16, v132
    v_pk_fma_f32 v[90:91], v[90:91], v[146:147], v[146:147] op_sel:[0,0,1] op_sel_hi:[1,0,1]
    v_pk_fma_f32 v[92:93], v[92:93], v[146:147], v[146:147] op_sel:[0,0,1] op_sel_hi:[1,0,1]
    v_and_b32 v105, s43, v132
    v_pk_fma_f32 v[94:95], v[94:95], v[146:147], v[146:147] op_sel:[0,0,1] op_sel_hi:[1,0,1]
    v_pk_fma_f32 v[96:97], v[88:89], v[48:49], v[96:97]
    v_lshlrev_b32 v106, 16, v133
    v_pk_fma_f32 v[98:99], v[90:91], v[50:51], v[98:99]
    v_pk_fma_f32 v[100:101], v[92:93], v[52:53], v[100:101]
    v_and_b32 v107, s43, v133
    v_pk_fma_f32 v[102:103], v[94:95], v[54:55], v[102:103]
    v_pk_mul_f32 v[96:97], v[96:97], v[104:105]
    v_lshlrev_b32 v108, 16, v134
    v_pk_mul_f32 v[98:99], v[98:99], v[106:107]
    v_cvt_pk_bf16_f32 v156, v96, v97
    v_and_b32 v109, s43, v134
    v_cvt_pk_bf16_f32 v157, v98, v99
    v_pk_mul_f32 v[100:101], v[100:101], v[108:109]
    v_lshlrev_b32 v110, 16, v135
    v_cvt_pk_bf16_f32 v158, v100, v101
    v_and_b32 v111, s43, v135
    v_xor_b32 v11, 160, v236
    v_pk_mul_f32 v[102:103], v[102:103], v[110:111]
    v_cvt_pk_bf16_f32 v159, v102, v103
    ds_write_b128 v11, v[156:159] offset:2560
    ds_read_b128 v[116:119], v232 offset:5632
    ds_read_b64 v[146:147], v237 offset:104
    s_waitcnt lgkmcnt(14)
    ds_read_b128 v[132:135], v235 offset:4608
    s_add_u32 s59, s52, 536576
    buffer_load_dwordx4 a[224:227], v3, s[12:15], s59 offen offset:0 sc1
    buffer_load_dwordx4 a[228:231], v3, s[12:15], s59 offen offset:1024 sc1
    buffer_load_dwordx4 a[232:235], v3, s[12:15], s59 offen offset:2048 sc1
    s_waitcnt lgkmcnt(12)
    v_lshlrev_b32 v56, 16, v120
    v_pk_mul_f32 v[96:97], v[64:65], v[16:17]
    v_pk_mul_f32 v[98:99], v[66:67], v[18:19]
    v_and_b32 v57, s43, v120
    v_pk_mul_f32 v[100:101], v[68:69], v[20:21]
    v_pk_mul_f32 v[102:103], v[70:71], v[22:23]
    v_lshlrev_b32 v58, 16, v121
    v_pk_fma_f32 v[96:97], v[72:73], v[24:25], v[96:97]
    v_pk_fma_f32 v[98:99], v[74:75], v[26:27], v[98:99]
    v_and_b32 v59, s43, v121
    v_pk_fma_f32 v[100:101], v[76:77], v[28:29], v[100:101]
    v_pk_fma_f32 v[102:103], v[78:79], v[30:31], v[102:103]
    v_lshlrev_b32 v60, 16, v122
    v_pk_fma_f32 v[96:97], v[80:81], v[32:33], v[96:97]
    v_pk_fma_f32 v[98:99], v[82:83], v[34:35], v[98:99]
    v_and_b32 v61, s43, v122
    v_pk_fma_f32 v[100:101], v[84:85], v[36:37], v[100:101]
    v_pk_fma_f32 v[102:103], v[86:87], v[38:39], v[102:103]
    v_lshlrev_b32 v62, 16, v123
    v_pk_fma_f32 v[96:97], v[88:89], v[40:41], v[96:97]
    v_pk_fma_f32 v[98:99], v[90:91], v[42:43], v[98:99]
    v_and_b32 v63, s43, v123
    v_pk_fma_f32 v[100:101], v[92:93], v[44:45], v[100:101]
    v_pk_fma_f32 v[102:103], v[94:95], v[46:47], v[102:103]
    v_pk_fma_f32 v[56:57], v[56:57], v[148:149], v[148:149] op_sel:[0,0,1] op_sel_hi:[1,0,1]
    v_lshlrev_b32 v104, 16, v136
    v_pk_fma_f32 v[58:59], v[58:59], v[148:149], v[148:149] op_sel:[0,0,1] op_sel_hi:[1,0,1]
    v_pk_fma_f32 v[60:61], v[60:61], v[148:149], v[148:149] op_sel:[0,0,1] op_sel_hi:[1,0,1]
    v_and_b32 v105, s43, v136
    v_pk_fma_f32 v[62:63], v[62:63], v[148:149], v[148:149] op_sel:[0,0,1] op_sel_hi:[1,0,1]
    v_pk_fma_f32 v[96:97], v[56:57], v[48:49], v[96:97]
    v_lshlrev_b32 v106, 16, v137
    v_pk_fma_f32 v[98:99], v[58:59], v[50:51], v[98:99]
    v_pk_fma_f32 v[100:101], v[60:61], v[52:53], v[100:101]
    v_and_b32 v107, s43, v137
    v_pk_fma_f32 v[102:103], v[62:63], v[54:55], v[102:103]
    v_pk_mul_f32 v[96:97], v[96:97], v[104:105]
    v_lshlrev_b32 v108, 16, v138
    v_pk_mul_f32 v[98:99], v[98:99], v[106:107]
    v_cvt_pk_bf16_f32 v152, v96, v97
    v_and_b32 v109, s43, v138
    v_cvt_pk_bf16_f32 v153, v98, v99
    v_pk_mul_f32 v[100:101], v[100:101], v[108:109]
    v_lshlrev_b32 v110, 16, v139
    v_cvt_pk_bf16_f32 v154, v100, v101
    v_and_b32 v111, s43, v139
    v_xor_b32 v11, 192, v236
    v_pk_mul_f32 v[102:103], v[102:103], v[110:111]
    v_cvt_pk_bf16_f32 v155, v102, v103
    ds_write_b128 v11, v[152:155] offset:3072
    ds_read_b128 v[120:123], v232 offset:6144
    ds_read_b64 v[148:149], v237 offset:112
    s_waitcnt lgkmcnt(14)
    ds_read_b128 v[136:139], v235 offset:5120
    buffer_load_dwordx4 a[236:239], v3, s[12:15], s59 offen offset:3072 sc1
    s_add_u32 s59, s52, 557056
    buffer_load_dwordx4 a[240:243], v3, s[12:15], s59 offen offset:0 sc1
    buffer_load_dwordx4 a[244:247], v3, s[12:15], s59 offen offset:1024 sc1
    s_waitcnt lgkmcnt(12)
    v_lshlrev_b32 v64, 16, v124
    v_pk_mul_f32 v[96:97], v[72:73], v[16:17]
    v_pk_mul_f32 v[98:99], v[74:75], v[18:19]
    v_and_b32 v65, s43, v124
    v_pk_mul_f32 v[100:101], v[76:77], v[20:21]
    v_pk_mul_f32 v[102:103], v[78:79], v[22:23]
    v_lshlrev_b32 v66, 16, v125
    v_pk_fma_f32 v[96:97], v[80:81], v[24:25], v[96:97]
    v_pk_fma_f32 v[98:99], v[82:83], v[26:27], v[98:99]
    v_and_b32 v67, s43, v125
    v_pk_fma_f32 v[100:101], v[84:85], v[28:29], v[100:101]
    v_pk_fma_f32 v[102:103], v[86:87], v[30:31], v[102:103]
    v_lshlrev_b32 v68, 16, v126
    v_pk_fma_f32 v[96:97], v[88:89], v[32:33], v[96:97]
    v_pk_fma_f32 v[98:99], v[90:91], v[34:35], v[98:99]
    v_and_b32 v69, s43, v126
    v_pk_fma_f32 v[100:101], v[92:93], v[36:37], v[100:101]
    v_pk_fma_f32 v[102:103], v[94:95], v[38:39], v[102:103]
    v_lshlrev_b32 v70, 16, v127
    v_pk_fma_f32 v[96:97], v[56:57], v[40:41], v[96:97]
    v_pk_fma_f32 v[98:99], v[58:59], v[42:43], v[98:99]
    v_and_b32 v71, s43, v127
    v_pk_fma_f32 v[100:101], v[60:61], v[44:45], v[100:101]
    v_pk_fma_f32 v[102:103], v[62:63], v[46:47], v[102:103]
    v_pk_fma_f32 v[64:65], v[64:65], v[150:151], v[150:151] op_sel:[0,0,1] op_sel_hi:[1,0,1]
    v_lshlrev_b32 v104, 16, v140
    v_pk_fma_f32 v[66:67], v[66:67], v[150:151], v[150:151] op_sel:[0,0,1] op_sel_hi:[1,0,1]
    v_pk_fma_f32 v[68:69], v[68:69], v[150:151], v[150:151] op_sel:[0,0,1] op_sel_hi:[1,0,1]
    v_and_b32 v105, s43, v140
    v_pk_fma_f32 v[70:71], v[70:71], v[150:151], v[150:151] op_sel:[0,0,1] op_sel_hi:[1,0,1]
    v_pk_fma_f32 v[96:97], v[64:65], v[48:49], v[96:97]
    v_lshlrev_b32 v106, 16, v141
    v_pk_fma_f32 v[98:99], v[66:67], v[50:51], v[98:99]
    v_pk_fma_f32 v[100:101], v[68:69], v[52:53], v[100:101]
    v_and_b32 v107, s43, v141
    v_pk_fma_f32 v[102:103], v[70:71], v[54:55], v[102:103]
    v_pk_mul_f32 v[96:97], v[96:97], v[104:105]
    v_lshlrev_b32 v108, 16, v142
    v_pk_mul_f32 v[98:99], v[98:99], v[106:107]
    v_cvt_pk_bf16_f32 v156, v96, v97
    v_and_b32 v109, s43, v142
    v_cvt_pk_bf16_f32 v157, v98, v99
    v_pk_mul_f32 v[100:101], v[100:101], v[108:109]
    v_lshlrev_b32 v110, 16, v143
    v_cvt_pk_bf16_f32 v158, v100, v101
    v_and_b32 v111, s43, v143
    v_xor_b32 v11, 224, v236
    v_pk_mul_f32 v[102:103], v[102:103], v[110:111]
    v_cvt_pk_bf16_f32 v159, v102, v103
    ds_write_b128 v11, v[156:159] offset:3584
    ds_read_b128 v[124:127], v232 offset:6656
    ds_read_b64 v[150:151], v237 offset:120
    s_waitcnt lgkmcnt(14)
    ds_read_b128 v[140:143], v235 offset:5632
    buffer_load_dwordx4 a[248:251], v3, s[12:15], s59 offen offset:2048 sc1
    buffer_load_dwordx4 a[252:255], v3, s[12:15], s59 offen offset:3072 sc1
    s_add_u32 s59, s52, 561152
    buffer_load_dwordx4 a[0:3], v3, s[12:15], s59 offen offset:0 sc1
    s_waitcnt lgkmcnt(12)
    v_lshlrev_b32 v72, 16, v112
    v_pk_mul_f32 v[96:97], v[80:81], v[16:17]
    v_pk_mul_f32 v[98:99], v[82:83], v[18:19]
    v_and_b32 v73, s43, v112
    v_pk_mul_f32 v[100:101], v[84:85], v[20:21]
    v_pk_mul_f32 v[102:103], v[86:87], v[22:23]
    v_lshlrev_b32 v74, 16, v113
    v_pk_fma_f32 v[96:97], v[88:89], v[24:25], v[96:97]
    v_pk_fma_f32 v[98:99], v[90:91], v[26:27], v[98:99]
    v_and_b32 v75, s43, v113
    v_pk_fma_f32 v[100:101], v[92:93], v[28:29], v[100:101]
    v_pk_fma_f32 v[102:103], v[94:95], v[30:31], v[102:103]
    v_lshlrev_b32 v76, 16, v114
    v_pk_fma_f32 v[96:97], v[56:57], v[32:33], v[96:97]
    v_pk_fma_f32 v[98:99], v[58:59], v[34:35], v[98:99]
    v_and_b32 v77, s43, v114
    v_pk_fma_f32 v[100:101], v[60:61], v[36:37], v[100:101]
    v_pk_fma_f32 v[102:103], v[62:63], v[38:39], v[102:103]
    v_lshlrev_b32 v78, 16, v115
    v_pk_fma_f32 v[96:97], v[64:65], v[40:41], v[96:97]
    v_pk_fma_f32 v[98:99], v[66:67], v[42:43], v[98:99]
    v_and_b32 v79, s43, v115
    v_pk_fma_f32 v[100:101], v[68:69], v[44:45], v[100:101]
    v_pk_fma_f32 v[102:103], v[70:71], v[46:47], v[102:103]
    v_pk_fma_f32 v[72:73], v[72:73], v[144:145], v[144:145] op_sel:[0,0,1] op_sel_hi:[1,0,1]
    v_lshlrev_b32 v104, 16, v128
    v_pk_fma_f32 v[74:75], v[74:75], v[144:145], v[144:145] op_sel:[0,0,1] op_sel_hi:[1,0,1]
    v_pk_fma_f32 v[76:77], v[76:77], v[144:145], v[144:145] op_sel:[0,0,1] op_sel_hi:[1,0,1]
    v_and_b32 v105, s43, v128
    v_pk_fma_f32 v[78:79], v[78:79], v[144:145], v[144:145] op_sel:[0,0,1] op_sel_hi:[1,0,1]
    v_pk_fma_f32 v[96:97], v[72:73], v[48:49], v[96:97]
    v_lshlrev_b32 v106, 16, v129
    v_pk_fma_f32 v[98:99], v[74:75], v[50:51], v[98:99]
    v_pk_fma_f32 v[100:101], v[76:77], v[52:53], v[100:101]
    v_and_b32 v107, s43, v129
    v_pk_fma_f32 v[102:103], v[78:79], v[54:55], v[102:103]
    v_pk_mul_f32 v[96:97], v[96:97], v[104:105]
    v_lshlrev_b32 v108, 16, v130
    v_pk_mul_f32 v[98:99], v[98:99], v[106:107]
    v_cvt_pk_bf16_f32 v152, v96, v97
    v_and_b32 v109, s43, v130
    v_cvt_pk_bf16_f32 v153, v98, v99
    v_pk_mul_f32 v[100:101], v[100:101], v[108:109]
    v_lshlrev_b32 v110, 16, v131
    v_cvt_pk_bf16_f32 v154, v100, v101
    v_and_b32 v111, s43, v131
    v_xor_b32 v11, 0, v236
    v_pk_mul_f32 v[102:103], v[102:103], v[110:111]
    v_cvt_pk_bf16_f32 v155, v102, v103
    ds_write_b128 v11, v[152:155] offset:4096
    ds_read_b128 v[112:115], v232 offset:7168
    ds_read_b64 v[144:145], v237 offset:128
    s_waitcnt lgkmcnt(14)
    ds_read_b128 v[128:131], v235 offset:6144
    buffer_load_dwordx4 a[4:7], v3, s[12:15], s59 offen offset:1024 sc1
    buffer_load_dwordx4 a[8:11], v3, s[12:15], s59 offen offset:2048 sc1
    buffer_load_dwordx4 a[12:15], v3, s[12:15], s59 offen offset:3072 sc1
    s_waitcnt lgkmcnt(12)
    v_lshlrev_b32 v80, 16, v116
    v_pk_mul_f32 v[96:97], v[88:89], v[16:17]
    v_pk_mul_f32 v[98:99], v[90:91], v[18:19]
    v_and_b32 v81, s43, v116
    v_pk_mul_f32 v[100:101], v[92:93], v[20:21]
    v_pk_mul_f32 v[102:103], v[94:95], v[22:23]
    v_lshlrev_b32 v82, 16, v117
    v_pk_fma_f32 v[96:97], v[56:57], v[24:25], v[96:97]
    v_pk_fma_f32 v[98:99], v[58:59], v[26:27], v[98:99]
    v_and_b32 v83, s43, v117
    v_pk_fma_f32 v[100:101], v[60:61], v[28:29], v[100:101]
    v_pk_fma_f32 v[102:103], v[62:63], v[30:31], v[102:103]
    v_lshlrev_b32 v84, 16, v118
    v_pk_fma_f32 v[96:97], v[64:65], v[32:33], v[96:97]
    v_pk_fma_f32 v[98:99], v[66:67], v[34:35], v[98:99]
    v_and_b32 v85, s43, v118
    v_pk_fma_f32 v[100:101], v[68:69], v[36:37], v[100:101]
    v_pk_fma_f32 v[102:103], v[70:71], v[38:39], v[102:103]
    v_lshlrev_b32 v86, 16, v119
    v_pk_fma_f32 v[96:97], v[72:73], v[40:41], v[96:97]
    v_pk_fma_f32 v[98:99], v[74:75], v[42:43], v[98:99]
    v_and_b32 v87, s43, v119
    v_pk_fma_f32 v[100:101], v[76:77], v[44:45], v[100:101]
    v_pk_fma_f32 v[102:103], v[78:79], v[46:47], v[102:103]
    v_pk_fma_f32 v[80:81], v[80:81], v[146:147], v[146:147] op_sel:[0,0,1] op_sel_hi:[1,0,1]
    v_lshlrev_b32 v104, 16, v132
    v_pk_fma_f32 v[82:83], v[82:83], v[146:147], v[146:147] op_sel:[0,0,1] op_sel_hi:[1,0,1]
    v_pk_fma_f32 v[84:85], v[84:85], v[146:147], v[146:147] op_sel:[0,0,1] op_sel_hi:[1,0,1]
    v_and_b32 v105, s43, v132
    v_pk_fma_f32 v[86:87], v[86:87], v[146:147], v[146:147] op_sel:[0,0,1] op_sel_hi:[1,0,1]
    v_pk_fma_f32 v[96:97], v[80:81], v[48:49], v[96:97]
    v_lshlrev_b32 v106, 16, v133
    v_pk_fma_f32 v[98:99], v[82:83], v[50:51], v[98:99]
    v_pk_fma_f32 v[100:101], v[84:85], v[52:53], v[100:101]
    v_and_b32 v107, s43, v133
    v_pk_fma_f32 v[102:103], v[86:87], v[54:55], v[102:103]
    v_pk_mul_f32 v[96:97], v[96:97], v[104:105]
    v_lshlrev_b32 v108, 16, v134
    v_pk_mul_f32 v[98:99], v[98:99], v[106:107]
    v_cvt_pk_bf16_f32 v156, v96, v97
    v_and_b32 v109, s43, v134
    v_cvt_pk_bf16_f32 v157, v98, v99
    v_pk_mul_f32 v[100:101], v[100:101], v[108:109]
    v_lshlrev_b32 v110, 16, v135
    v_cvt_pk_bf16_f32 v158, v100, v101
    v_and_b32 v111, s43, v135
    v_xor_b32 v11, 32, v236
    v_pk_mul_f32 v[102:103], v[102:103], v[110:111]
    v_cvt_pk_bf16_f32 v159, v102, v103
    ds_write_b128 v11, v[156:159] offset:4608
    ds_read_b128 v[116:119], v232 offset:7680
    ds_read_b64 v[146:147], v237 offset:136
    s_waitcnt lgkmcnt(14)
    ds_read_b128 v[132:135], v235 offset:6656
    s_add_u32 s59, s52, 565248
    buffer_load_dwordx4 a[16:19], v3, s[12:15], s59 offen offset:0 sc1
    buffer_load_dwordx4 a[20:23], v3, s[12:15], s59 offen offset:1024 sc1
    buffer_load_dwordx4 a[24:27], v3, s[12:15], s59 offen offset:2048 sc1
    s_waitcnt lgkmcnt(12)
    v_lshlrev_b32 v88, 16, v120
    v_pk_mul_f32 v[96:97], v[56:57], v[16:17]
    v_pk_mul_f32 v[98:99], v[58:59], v[18:19]
    v_and_b32 v89, s43, v120
    v_pk_mul_f32 v[100:101], v[60:61], v[20:21]
    v_pk_mul_f32 v[102:103], v[62:63], v[22:23]
    v_lshlrev_b32 v90, 16, v121
    v_pk_fma_f32 v[96:97], v[64:65], v[24:25], v[96:97]
    v_pk_fma_f32 v[98:99], v[66:67], v[26:27], v[98:99]
    v_and_b32 v91, s43, v121
    v_pk_fma_f32 v[100:101], v[68:69], v[28:29], v[100:101]
    v_pk_fma_f32 v[102:103], v[70:71], v[30:31], v[102:103]
    v_lshlrev_b32 v92, 16, v122
    v_pk_fma_f32 v[96:97], v[72:73], v[32:33], v[96:97]
    v_pk_fma_f32 v[98:99], v[74:75], v[34:35], v[98:99]
    v_and_b32 v93, s43, v122
    v_pk_fma_f32 v[100:101], v[76:77], v[36:37], v[100:101]
    v_pk_fma_f32 v[102:103], v[78:79], v[38:39], v[102:103]
    v_lshlrev_b32 v94, 16, v123
    v_pk_fma_f32 v[96:97], v[80:81], v[40:41], v[96:97]
    v_pk_fma_f32 v[98:99], v[82:83], v[42:43], v[98:99]
    v_and_b32 v95, s43, v123
    v_pk_fma_f32 v[100:101], v[84:85], v[44:45], v[100:101]
    v_pk_fma_f32 v[102:103], v[86:87], v[46:47], v[102:103]
    v_pk_fma_f32 v[88:89], v[88:89], v[148:149], v[148:149] op_sel:[0,0,1] op_sel_hi:[1,0,1]
    v_lshlrev_b32 v104, 16, v136
    v_pk_fma_f32 v[90:91], v[90:91], v[148:149], v[148:149] op_sel:[0,0,1] op_sel_hi:[1,0,1]
    v_pk_fma_f32 v[92:93], v[92:93], v[148:149], v[148:149] op_sel:[0,0,1] op_sel_hi:[1,0,1]
    v_and_b32 v105, s43, v136
    v_pk_fma_f32 v[94:95], v[94:95], v[148:149], v[148:149] op_sel:[0,0,1] op_sel_hi:[1,0,1]
    v_pk_fma_f32 v[96:97], v[88:89], v[48:49], v[96:97]
    v_lshlrev_b32 v106, 16, v137
    v_pk_fma_f32 v[98:99], v[90:91], v[50:51], v[98:99]
    v_pk_fma_f32 v[100:101], v[92:93], v[52:53], v[100:101]
    v_and_b32 v107, s43, v137
    v_pk_fma_f32 v[102:103], v[94:95], v[54:55], v[102:103]
    v_pk_mul_f32 v[96:97], v[96:97], v[104:105]
    v_lshlrev_b32 v108, 16, v138
    v_pk_mul_f32 v[98:99], v[98:99], v[106:107]
    v_cvt_pk_bf16_f32 v152, v96, v97
    v_and_b32 v109, s43, v138
    v_cvt_pk_bf16_f32 v153, v98, v99
    v_pk_mul_f32 v[100:101], v[100:101], v[108:109]
    v_lshlrev_b32 v110, 16, v139
    v_cvt_pk_bf16_f32 v154, v100, v101
    v_and_b32 v111, s43, v139
    v_xor_b32 v11, 64, v236
    v_pk_mul_f32 v[102:103], v[102:103], v[110:111]
    v_cvt_pk_bf16_f32 v155, v102, v103
    ds_write_b128 v11, v[152:155] offset:5120
    ds_read_b128 v[120:123], v234 offset:0
    ds_read_b64 v[148:149], v237 offset:144
    s_waitcnt lgkmcnt(14)
    ds_read_b128 v[136:139], v235 offset:7168
    buffer_load_dwordx4 a[28:31], v3, s[12:15], s59 offen offset:3072 sc1
    s_add_u32 s59, s52, 569344
    buffer_load_dwordx4 a[32:35], v3, s[12:15], s59 offen offset:0 sc1
    buffer_load_dwordx4 a[36:39], v3, s[12:15], s59 offen offset:1024 sc1
    s_waitcnt lgkmcnt(12)
    v_lshlrev_b32 v56, 16, v124
    v_pk_mul_f32 v[96:97], v[64:65], v[16:17]
    v_pk_mul_f32 v[98:99], v[66:67], v[18:19]
    v_and_b32 v57, s43, v124
    v_pk_mul_f32 v[100:101], v[68:69], v[20:21]
    v_pk_mul_f32 v[102:103], v[70:71], v[22:23]
    v_lshlrev_b32 v58, 16, v125
    v_pk_fma_f32 v[96:97], v[72:73], v[24:25], v[96:97]
    v_pk_fma_f32 v[98:99], v[74:75], v[26:27], v[98:99]
    v_and_b32 v59, s43, v125
    v_pk_fma_f32 v[100:101], v[76:77], v[28:29], v[100:101]
    v_pk_fma_f32 v[102:103], v[78:79], v[30:31], v[102:103]
    v_lshlrev_b32 v60, 16, v126
    v_pk_fma_f32 v[96:97], v[80:81], v[32:33], v[96:97]
    v_pk_fma_f32 v[98:99], v[82:83], v[34:35], v[98:99]
    v_and_b32 v61, s43, v126
    v_pk_fma_f32 v[100:101], v[84:85], v[36:37], v[100:101]
    v_pk_fma_f32 v[102:103], v[86:87], v[38:39], v[102:103]
    v_lshlrev_b32 v62, 16, v127
    v_pk_fma_f32 v[96:97], v[88:89], v[40:41], v[96:97]
    v_pk_fma_f32 v[98:99], v[90:91], v[42:43], v[98:99]
    v_and_b32 v63, s43, v127
    v_pk_fma_f32 v[100:101], v[92:93], v[44:45], v[100:101]
    v_pk_fma_f32 v[102:103], v[94:95], v[46:47], v[102:103]
    v_pk_fma_f32 v[56:57], v[56:57], v[150:151], v[150:151] op_sel:[0,0,1] op_sel_hi:[1,0,1]
    v_lshlrev_b32 v104, 16, v140
    v_pk_fma_f32 v[58:59], v[58:59], v[150:151], v[150:151] op_sel:[0,0,1] op_sel_hi:[1,0,1]
    v_pk_fma_f32 v[60:61], v[60:61], v[150:151], v[150:151] op_sel:[0,0,1] op_sel_hi:[1,0,1]
    v_and_b32 v105, s43, v140
    v_pk_fma_f32 v[62:63], v[62:63], v[150:151], v[150:151] op_sel:[0,0,1] op_sel_hi:[1,0,1]
    v_pk_fma_f32 v[96:97], v[56:57], v[48:49], v[96:97]
    v_lshlrev_b32 v106, 16, v141
    v_pk_fma_f32 v[98:99], v[58:59], v[50:51], v[98:99]
    v_pk_fma_f32 v[100:101], v[60:61], v[52:53], v[100:101]
    v_and_b32 v107, s43, v141
    v_pk_fma_f32 v[102:103], v[62:63], v[54:55], v[102:103]
    v_pk_mul_f32 v[96:97], v[96:97], v[104:105]
    v_lshlrev_b32 v108, 16, v142
    v_pk_mul_f32 v[98:99], v[98:99], v[106:107]
    v_cvt_pk_bf16_f32 v156, v96, v97
    v_and_b32 v109, s43, v142
    v_cvt_pk_bf16_f32 v157, v98, v99
    v_pk_mul_f32 v[100:101], v[100:101], v[108:109]
    v_lshlrev_b32 v110, 16, v143
    v_cvt_pk_bf16_f32 v158, v100, v101
    v_and_b32 v111, s43, v143
    v_xor_b32 v11, 96, v236
    v_pk_mul_f32 v[102:103], v[102:103], v[110:111]
    v_cvt_pk_bf16_f32 v159, v102, v103
    ds_write_b128 v11, v[156:159] offset:5632
    ds_read_b128 v[124:127], v234 offset:512
    ds_read_b64 v[150:151], v237 offset:152
    s_waitcnt lgkmcnt(14)
    ds_read_b128 v[140:143], v235 offset:7680
    buffer_load_dwordx4 a[40:43], v3, s[12:15], s59 offen offset:2048 sc1
    buffer_load_dwordx4 a[44:47], v3, s[12:15], s59 offen offset:3072 sc1
    s_add_u32 s59, s50, 0
    buffer_load_dwordx4 a[48:51], v3, s[12:15], s59 offen offset:0 sc1
    s_waitcnt lgkmcnt(12)
    v_lshlrev_b32 v64, 16, v112
    v_pk_mul_f32 v[96:97], v[72:73], v[16:17]
    v_pk_mul_f32 v[98:99], v[74:75], v[18:19]
    v_and_b32 v65, s43, v112
    v_pk_mul_f32 v[100:101], v[76:77], v[20:21]
    v_pk_mul_f32 v[102:103], v[78:79], v[22:23]
    v_lshlrev_b32 v66, 16, v113
    v_pk_fma_f32 v[96:97], v[80:81], v[24:25], v[96:97]
    v_pk_fma_f32 v[98:99], v[82:83], v[26:27], v[98:99]
    v_and_b32 v67, s43, v113
    v_pk_fma_f32 v[100:101], v[84:85], v[28:29], v[100:101]
    v_pk_fma_f32 v[102:103], v[86:87], v[30:31], v[102:103]
    v_lshlrev_b32 v68, 16, v114
    v_pk_fma_f32 v[96:97], v[88:89], v[32:33], v[96:97]
    v_pk_fma_f32 v[98:99], v[90:91], v[34:35], v[98:99]
    v_and_b32 v69, s43, v114
    v_pk_fma_f32 v[100:101], v[92:93], v[36:37], v[100:101]
    v_pk_fma_f32 v[102:103], v[94:95], v[38:39], v[102:103]
    v_lshlrev_b32 v70, 16, v115
    v_pk_fma_f32 v[96:97], v[56:57], v[40:41], v[96:97]
    v_pk_fma_f32 v[98:99], v[58:59], v[42:43], v[98:99]
    v_and_b32 v71, s43, v115
    v_pk_fma_f32 v[100:101], v[60:61], v[44:45], v[100:101]
    v_pk_fma_f32 v[102:103], v[62:63], v[46:47], v[102:103]
    v_pk_fma_f32 v[64:65], v[64:65], v[144:145], v[144:145] op_sel:[0,0,1] op_sel_hi:[1,0,1]
    v_lshlrev_b32 v104, 16, v128
    v_pk_fma_f32 v[66:67], v[66:67], v[144:145], v[144:145] op_sel:[0,0,1] op_sel_hi:[1,0,1]
    v_pk_fma_f32 v[68:69], v[68:69], v[144:145], v[144:145] op_sel:[0,0,1] op_sel_hi:[1,0,1]
    v_and_b32 v105, s43, v128
    v_pk_fma_f32 v[70:71], v[70:71], v[144:145], v[144:145] op_sel:[0,0,1] op_sel_hi:[1,0,1]
    v_pk_fma_f32 v[96:97], v[64:65], v[48:49], v[96:97]
    v_lshlrev_b32 v106, 16, v129
    v_pk_fma_f32 v[98:99], v[66:67], v[50:51], v[98:99]
    v_pk_fma_f32 v[100:101], v[68:69], v[52:53], v[100:101]
    v_and_b32 v107, s43, v129
    v_pk_fma_f32 v[102:103], v[70:71], v[54:55], v[102:103]
    v_pk_mul_f32 v[96:97], v[96:97], v[104:105]
    v_lshlrev_b32 v108, 16, v130
    v_pk_mul_f32 v[98:99], v[98:99], v[106:107]
    v_cvt_pk_bf16_f32 v152, v96, v97
    v_and_b32 v109, s43, v130
    v_cvt_pk_bf16_f32 v153, v98, v99
    v_pk_mul_f32 v[100:101], v[100:101], v[108:109]
    v_lshlrev_b32 v110, 16, v131
    v_cvt_pk_bf16_f32 v154, v100, v101
    v_and_b32 v111, s43, v131
    v_xor_b32 v11, 128, v236
    v_pk_mul_f32 v[102:103], v[102:103], v[110:111]
    v_cvt_pk_bf16_f32 v155, v102, v103
    ds_write_b128 v11, v[152:155] offset:6144
    buffer_load_dwordx4 a[52:55], v3, s[12:15], s59 offen offset:1024 sc1
    buffer_load_dwordx4 a[56:59], v3, s[12:15], s59 offen offset:2048 sc1
    buffer_load_dwordx4 a[60:63], v3, s[12:15], s59 offen offset:3072 sc1
    s_waitcnt lgkmcnt(9)
    v_lshlrev_b32 v72, 16, v116
    v_pk_mul_f32 v[96:97], v[80:81], v[16:17]
    v_pk_mul_f32 v[98:99], v[82:83], v[18:19]
    v_and_b32 v73, s43, v116
    v_pk_mul_f32 v[100:101], v[84:85], v[20:21]
    v_pk_mul_f32 v[102:103], v[86:87], v[22:23]
    v_lshlrev_b32 v74, 16, v117
    v_pk_fma_f32 v[96:97], v[88:89], v[24:25], v[96:97]
    v_pk_fma_f32 v[98:99], v[90:91], v[26:27], v[98:99]
    v_and_b32 v75, s43, v117
    v_pk_fma_f32 v[100:101], v[92:93], v[28:29], v[100:101]
    v_pk_fma_f32 v[102:103], v[94:95], v[30:31], v[102:103]
    v_lshlrev_b32 v76, 16, v118
    v_pk_fma_f32 v[96:97], v[56:57], v[32:33], v[96:97]
    v_pk_fma_f32 v[98:99], v[58:59], v[34:35], v[98:99]
    v_and_b32 v77, s43, v118
    v_pk_fma_f32 v[100:101], v[60:61], v[36:37], v[100:101]
    v_pk_fma_f32 v[102:103], v[62:63], v[38:39], v[102:103]
    v_lshlrev_b32 v78, 16, v119
    v_pk_fma_f32 v[96:97], v[64:65], v[40:41], v[96:97]
    v_pk_fma_f32 v[98:99], v[66:67], v[42:43], v[98:99]
    v_and_b32 v79, s43, v119
    v_pk_fma_f32 v[100:101], v[68:69], v[44:45], v[100:101]
    v_pk_fma_f32 v[102:103], v[70:71], v[46:47], v[102:103]
    v_pk_fma_f32 v[72:73], v[72:73], v[146:147], v[146:147] op_sel:[0,0,1] op_sel_hi:[1,0,1]
    v_lshlrev_b32 v104, 16, v132
    v_pk_fma_f32 v[74:75], v[74:75], v[146:147], v[146:147] op_sel:[0,0,1] op_sel_hi:[1,0,1]
    v_pk_fma_f32 v[76:77], v[76:77], v[146:147], v[146:147] op_sel:[0,0,1] op_sel_hi:[1,0,1]
    v_and_b32 v105, s43, v132
    v_pk_fma_f32 v[78:79], v[78:79], v[146:147], v[146:147] op_sel:[0,0,1] op_sel_hi:[1,0,1]
    v_pk_fma_f32 v[96:97], v[72:73], v[48:49], v[96:97]
    v_lshlrev_b32 v106, 16, v133
    v_pk_fma_f32 v[98:99], v[74:75], v[50:51], v[98:99]
    v_pk_fma_f32 v[100:101], v[76:77], v[52:53], v[100:101]
    v_and_b32 v107, s43, v133
    v_pk_fma_f32 v[102:103], v[78:79], v[54:55], v[102:103]
    v_pk_mul_f32 v[96:97], v[96:97], v[104:105]
    v_lshlrev_b32 v108, 16, v134
    v_pk_mul_f32 v[98:99], v[98:99], v[106:107]
    v_cvt_pk_bf16_f32 v156, v96, v97
    v_and_b32 v109, s43, v134
    v_cvt_pk_bf16_f32 v157, v98, v99
    v_pk_mul_f32 v[100:101], v[100:101], v[108:109]
    v_lshlrev_b32 v110, 16, v135
    v_cvt_pk_bf16_f32 v158, v100, v101
    v_and_b32 v111, s43, v135
    v_xor_b32 v11, 160, v236
    v_pk_mul_f32 v[102:103], v[102:103], v[110:111]
    v_cvt_pk_bf16_f32 v159, v102, v103
    ds_write_b128 v11, v[156:159] offset:6656
    s_add_u32 s59, s50, 4096
    buffer_load_dwordx4 a[64:67], v3, s[12:15], s59 offen offset:0 sc1
    buffer_load_dwordx4 a[68:71], v3, s[12:15], s59 offen offset:1024 sc1
    buffer_load_dwordx4 a[72:75], v3, s[12:15], s59 offen offset:2048 sc1
    s_waitcnt lgkmcnt(6)
    v_lshlrev_b32 v80, 16, v120
    v_pk_mul_f32 v[96:97], v[88:89], v[16:17]
    v_pk_mul_f32 v[98:99], v[90:91], v[18:19]
    v_and_b32 v81, s43, v120
    v_pk_mul_f32 v[100:101], v[92:93], v[20:21]
    v_pk_mul_f32 v[102:103], v[94:95], v[22:23]
    v_lshlrev_b32 v82, 16, v121
    v_pk_fma_f32 v[96:97], v[56:57], v[24:25], v[96:97]
    v_pk_fma_f32 v[98:99], v[58:59], v[26:27], v[98:99]
    v_and_b32 v83, s43, v121
    v_pk_fma_f32 v[100:101], v[60:61], v[28:29], v[100:101]
    v_pk_fma_f32 v[102:103], v[62:63], v[30:31], v[102:103]
    v_lshlrev_b32 v84, 16, v122
    v_pk_fma_f32 v[96:97], v[64:65], v[32:33], v[96:97]
    v_pk_fma_f32 v[98:99], v[66:67], v[34:35], v[98:99]
    v_and_b32 v85, s43, v122
    v_pk_fma_f32 v[100:101], v[68:69], v[36:37], v[100:101]
    v_pk_fma_f32 v[102:103], v[70:71], v[38:39], v[102:103]
    v_lshlrev_b32 v86, 16, v123
    v_pk_fma_f32 v[96:97], v[72:73], v[40:41], v[96:97]
    v_pk_fma_f32 v[98:99], v[74:75], v[42:43], v[98:99]
    v_and_b32 v87, s43, v123
    v_pk_fma_f32 v[100:101], v[76:77], v[44:45], v[100:101]
    v_pk_fma_f32 v[102:103], v[78:79], v[46:47], v[102:103]
    v_pk_fma_f32 v[80:81], v[80:81], v[148:149], v[148:149] op_sel:[0,0,1] op_sel_hi:[1,0,1]
    v_lshlrev_b32 v104, 16, v136
    v_pk_fma_f32 v[82:83], v[82:83], v[148:149], v[148:149] op_sel:[0,0,1] op_sel_hi:[1,0,1]
    v_pk_fma_f32 v[84:85], v[84:85], v[148:149], v[148:149] op_sel:[0,0,1] op_sel_hi:[1,0,1]
    v_and_b32 v105, s43, v136
    v_pk_fma_f32 v[86:87], v[86:87], v[148:149], v[148:149] op_sel:[0,0,1] op_sel_hi:[1,0,1]
    v_pk_fma_f32 v[96:97], v[80:81], v[48:49], v[96:97]
    v_lshlrev_b32 v106, 16, v137
    v_pk_fma_f32 v[98:99], v[82:83], v[50:51], v[98:99]
    v_pk_fma_f32 v[100:101], v[84:85], v[52:53], v[100:101]
    v_and_b32 v107, s43, v137
    v_pk_fma_f32 v[102:103], v[86:87], v[54:55], v[102:103]
    v_pk_mul_f32 v[96:97], v[96:97], v[104:105]
    v_lshlrev_b32 v108, 16, v138
    v_pk_mul_f32 v[98:99], v[98:99], v[106:107]
    v_cvt_pk_bf16_f32 v152, v96, v97
    v_and_b32 v109, s43, v138
    v_cvt_pk_bf16_f32 v153, v98, v99
    v_pk_mul_f32 v[100:101], v[100:101], v[108:109]
    v_lshlrev_b32 v110, 16, v139
    v_cvt_pk_bf16_f32 v154, v100, v101
    v_and_b32 v111, s43, v139
    v_xor_b32 v11, 192, v236
    v_pk_mul_f32 v[102:103], v[102:103], v[110:111]
    v_cvt_pk_bf16_f32 v155, v102, v103
    ds_write_b128 v11, v[152:155] offset:7168
    buffer_load_dwordx4 a[76:79], v3, s[12:15], s59 offen offset:3072 sc1
    s_waitcnt lgkmcnt(3)
    v_lshlrev_b32 v88, 16, v124
    v_pk_mul_f32 v[96:97], v[56:57], v[16:17]
    v_pk_mul_f32 v[98:99], v[58:59], v[18:19]
    v_and_b32 v89, s43, v124
    v_pk_mul_f32 v[100:101], v[60:61], v[20:21]
    v_pk_mul_f32 v[102:103], v[62:63], v[22:23]
    v_lshlrev_b32 v90, 16, v125
    v_pk_fma_f32 v[96:97], v[64:65], v[24:25], v[96:97]
    v_pk_fma_f32 v[98:99], v[66:67], v[26:27], v[98:99]
    v_and_b32 v91, s43, v125
    v_pk_fma_f32 v[100:101], v[68:69], v[28:29], v[100:101]
    v_pk_fma_f32 v[102:103], v[70:71], v[30:31], v[102:103]
    v_lshlrev_b32 v92, 16, v126
    v_pk_fma_f32 v[96:97], v[72:73], v[32:33], v[96:97]
    v_pk_fma_f32 v[98:99], v[74:75], v[34:35], v[98:99]
    v_and_b32 v93, s43, v126
    v_pk_fma_f32 v[100:101], v[76:77], v[36:37], v[100:101]
    v_pk_fma_f32 v[102:103], v[78:79], v[38:39], v[102:103]
    v_lshlrev_b32 v94, 16, v127
    v_pk_fma_f32 v[96:97], v[80:81], v[40:41], v[96:97]
    v_pk_fma_f32 v[98:99], v[82:83], v[42:43], v[98:99]
    v_and_b32 v95, s43, v127
    v_pk_fma_f32 v[100:101], v[84:85], v[44:45], v[100:101]
    v_pk_fma_f32 v[102:103], v[86:87], v[46:47], v[102:103]
    v_pk_fma_f32 v[88:89], v[88:89], v[150:151], v[150:151] op_sel:[0,0,1] op_sel_hi:[1,0,1]
    v_lshlrev_b32 v104, 16, v140
    v_pk_fma_f32 v[90:91], v[90:91], v[150:151], v[150:151] op_sel:[0,0,1] op_sel_hi:[1,0,1]
    v_pk_fma_f32 v[92:93], v[92:93], v[150:151], v[150:151] op_sel:[0,0,1] op_sel_hi:[1,0,1]
    v_and_b32 v105, s43, v140
    v_pk_fma_f32 v[94:95], v[94:95], v[150:151], v[150:151] op_sel:[0,0,1] op_sel_hi:[1,0,1]
    v_pk_fma_f32 v[96:97], v[88:89], v[48:49], v[96:97]
    v_lshlrev_b32 v106, 16, v141
    v_pk_fma_f32 v[98:99], v[90:91], v[50:51], v[98:99]
    v_pk_fma_f32 v[100:101], v[92:93], v[52:53], v[100:101]
    v_and_b32 v107, s43, v141
    v_pk_fma_f32 v[102:103], v[94:95], v[54:55], v[102:103]
    v_pk_mul_f32 v[96:97], v[96:97], v[104:105]
    v_lshlrev_b32 v108, 16, v142
    v_pk_mul_f32 v[98:99], v[98:99], v[106:107]
    v_cvt_pk_bf16_f32 v156, v96, v97
    v_and_b32 v109, s43, v142
    v_cvt_pk_bf16_f32 v157, v98, v99
    v_pk_mul_f32 v[100:101], v[100:101], v[108:109]
    v_lshlrev_b32 v110, 16, v143
    v_cvt_pk_bf16_f32 v158, v100, v101
    v_and_b32 v111, s43, v143
    v_xor_b32 v11, 224, v236
    v_pk_mul_f32 v[102:103], v[102:103], v[110:111]
    v_cvt_pk_bf16_f32 v159, v102, v103
    ds_write_b128 v11, v[156:159] offset:7680
    s_branch L_tail
.p2align 2
L_touch:
    s_cmp_eq_u32 s40, 6
    s_cbranch_scc1 L_touchb
    s_mov_b32 s40, 6
    s_lshl_b32 s30, s22, 1
    s_add_u32 s30, s30, s16
    s_lshl_b32 s30, s30, 14
    s_add_u32 s30, s30, s27
    s_add_u32 s30, s30, 0
    v_lshlrev_b32 v12, 7, v2
    buffer_load_dword v0, v12, s[32:35], s30 offen
    s_lshl_b32 s30, s22, 1
    s_add_u32 s30, s30, s16
    s_lshl_b32 s30, s30, 14
    s_add_u32 s30, s30, s27
    s_add_u32 s30, s30, 8192
    v_lshlrev_b32 v12, 7, v2
    buffer_load_dword v0, v12, s[32:35], s30 offen
    s_branch L_touch_ret
L_touchb:
    s_lshr_b32 s26, s17, 1
    s_cmp_lg_u32 s26, 2
    s_cbranch_scc1 L_touch2
    buffer_load_dword v14, v11, s[92:95], 0 offen offset:4 sc1
    s_branch L_touch_ret
L_touch2:
    s_cmp_lg_u32 s26, 1
    s_cbranch_scc1 L_touch1
    s_waitcnt vmcnt(0)
    v_cmp_le_u32 vcc, v7, v14
    s_nop 1
    s_cmp_eq_u64 vcc, -1
    s_cbranch_scc0 L_qk_c3_retry
L_qk_c3_ok:
    s_mov_b32 m0, s42
    buffer_load_dwordx2 v[212:213], v229, s[12:15], s6 offen offset:0 sc1
    buffer_load_dwordx2 v[214:215], v229, s[12:15], s6 offen offset:512 sc1
    buffer_load_dwordx2 v[216:217], v229, s[12:15], s6 offen offset:1024 sc1
    buffer_load_dwordx2 v[218:219], v229, s[12:15], s6 offen offset:1536 sc1
    buffer_load_dwordx2 v[220:221], v229, s[12:15], s6 offen offset:2048 sc1
    buffer_load_dwordx2 v[222:223], v229, s[12:15], s6 offen offset:2560 sc1
    buffer_load_dwordx2 v[224:225], v229, s[12:15], s6 offen offset:3072 sc1
    buffer_load_dwordx2 v[226:227], v229, s[12:15], s6 offen offset:3584 sc1
    buffer_load_dwordx4 v3, s[12:15], s7 offen sc1 lds
    buffer_load_dword v0, v230, s[12:15], 0 offen sc1
    s_branch L_touch_ret
L_touch1:
    s_branch L_touch_ret
.p2align 2
L_fpv:
    s_and_b32 s20, s3, 0xffff0000
    s_lshl_b32 s26, s22, 1
    s_add_u32 s26, s26, s16
    s_sub_u32 s26, s26, 2
    s_lshl_b32 s26, s26, 8
    s_add_u32 s20, s20, s26
    s_waitcnt lgkmcnt(4)
    v_mfma_f32_16x16x32_bf16 v[128:131], v[32:35], a[44:47], v[128:131]
    s_waitcnt vmcnt(13)
    ds_read_b64_tr_b16 v[16:17], v92 offset:8192
    v_mfma_f32_16x16x32_bf16 v[144:147], v[36:39], a[44:47], v[144:147]
    ds_read_b64_tr_b16 v[18:19], v92 offset:8704
    v_mfma_f32_16x16x32_bf16 v[132:135], v[32:35], a[108:111], v[132:135]
    ds_read_b64_tr_b16 v[20:21], v93 offset:8192
    v_mfma_f32_16x16x32_bf16 v[148:151], v[36:39], a[108:111], v[148:151]
    ds_read_b64_tr_b16 v[22:23], v93 offset:8704
    v_mfma_f32_16x16x32_bf16 v[136:139], v[32:35], a[172:175], v[136:139]
    ds_read_b64_tr_b16 v[24:25], v94 offset:8192
    v_mfma_f32_16x16x32_bf16 v[152:155], v[36:39], a[172:175], v[152:155]
    ds_read_b64_tr_b16 v[26:27], v94 offset:8704
    v_mfma_f32_16x16x32_bf16 v[140:143], v[32:35], a[236:239], v[140:143]
    ds_read_b64_tr_b16 v[28:29], v95 offset:8192
    v_mfma_f32_16x16x32_bf16 v[156:159], v[36:39], a[236:239], v[156:159]
    ds_read_b64_tr_b16 v[30:31], v95 offset:8704
    v_mfma_f32_16x16x32_bf16 v[172:175], v[40:43], a[236:239], v[172:175]
    v_xor_b32 v89, 12352, v88
    ds_read_b128 a[52:55], v89 offset:0
    s_barrier
    v_mfma_f32_16x16x32_bf16 v[188:191], v[44:47], a[236:239], v[188:191]
    s_add_u32 m0, s6, 4096
    s_xor_b32 s7, s20, 0
    buffer_load_dwordx4 v80, s[96:99], s7 offen offset:0 lds
    v_mfma_f32_16x16x32_bf16 v[168:171], v[40:43], a[172:175], v[168:171]
    ds_read_b128 a[116:119], v89 offset:16384
    s_xor_b32 s26, s31, 1
    s_lshl_b32 s26, s26, 7
    s_add_u32 s26, s26, 58982448
    buffer_load_dword v1, off, s[12:15], s26 sc1
    v_mfma_f32_16x16x32_bf16 v[184:187], v[44:47], a[172:175], v[184:187]
    buffer_load_dwordx4 v81, s[96:99], s7 offen offset:1024 lds
    v_mfma_f32_16x16x32_bf16 v[164:167], v[40:43], a[108:111], v[164:167]
    ds_read_b128 a[180:183], v89 offset:32768
    v_mfma_f32_16x16x32_bf16 v[180:183], v[44:47], a[108:111], v[180:183]
    buffer_load_dwordx4 v82, s[96:99], s7 offen offset:2048 lds
    v_mfma_f32_16x16x32_bf16 v[160:163], v[40:43], a[44:47], v[160:163]
    s_waitcnt lgkmcnt(14)
    ds_read_b128 a[244:247], v89 offset:49152
    v_mfma_f32_16x16x32_bf16 v[176:179], v[44:47], a[44:47], v[176:179]
    buffer_load_dwordx4 v83, s[96:99], s7 offen offset:3072 lds
    s_waitcnt lgkmcnt(4)
    v_mfma_f32_16x16x32_bf16 v[128:131], v[16:19], a[48:51], v[128:131]
    s_waitcnt vmcnt(13)
    ds_read_b64_tr_b16 v[32:33], v92 offset:12288
    v_mfma_f32_16x16x32_bf16 v[144:147], v[20:23], a[48:51], v[144:147]
    ds_read_b64_tr_b16 v[34:35], v92 offset:12800
    v_mfma_f32_16x16x32_bf16 v[132:135], v[16:19], a[112:115], v[132:135]
    ds_read_b64_tr_b16 v[36:37], v93 offset:12288
    v_mfma_f32_16x16x32_bf16 v[148:151], v[20:23], a[112:115], v[148:151]
    ds_read_b64_tr_b16 v[38:39], v93 offset:12800
    v_mfma_f32_16x16x32_bf16 v[136:139], v[16:19], a[176:179], v[136:139]
    ds_read_b64_tr_b16 v[40:41], v94 offset:12288
    v_mfma_f32_16x16x32_bf16 v[152:155], v[20:23], a[176:179], v[152:155]
    ds_read_b64_tr_b16 v[42:43], v94 offset:12800
    v_mfma_f32_16x16x32_bf16 v[140:143], v[16:19], a[240:243], v[140:143]
    ds_read_b64_tr_b16 v[44:45], v95 offset:12288
    v_mfma_f32_16x16x32_bf16 v[156:159], v[20:23], a[240:243], v[156:159]
    ds_read_b64_tr_b16 v[46:47], v95 offset:12800
    v_mfma_f32_16x16x32_bf16 v[172:175], v[24:27], a[240:243], v[172:175]
    v_xor_b32 v89, 14336, v88
    ds_read_b128 a[56:59], v89 offset:0
    v_mfma_f32_16x16x32_bf16 v[188:191], v[28:31], a[240:243], v[188:191]
    s_add_u32 m0, s6, 8192
    s_xor_b32 s7, s20, 65536
    buffer_load_dwordx4 v80, s[96:99], s7 offen offset:0 lds
    v_mfma_f32_16x16x32_bf16 v[168:171], v[24:27], a[176:179], v[168:171]
    ds_read_b128 a[120:123], v89 offset:16384
    v_mfma_f32_16x16x32_bf16 v[184:187], v[28:31], a[176:179], v[184:187]
    buffer_load_dwordx4 v81, s[96:99], s7 offen offset:1024 lds
    v_mfma_f32_16x16x32_bf16 v[164:167], v[24:27], a[112:115], v[164:167]
    ds_read_b128 a[184:187], v89 offset:32768
    v_mfma_f32_16x16x32_bf16 v[180:183], v[28:31], a[112:115], v[180:183]
    buffer_load_dwordx4 v82, s[96:99], s7 offen offset:2048 lds
    v_mfma_f32_16x16x32_bf16 v[160:163], v[24:27], a[48:51], v[160:163]
    s_waitcnt lgkmcnt(14)
    ds_read_b128 a[248:251], v89 offset:49152
    v_mfma_f32_16x16x32_bf16 v[176:179], v[28:31], a[48:51], v[176:179]
    buffer_load_dwordx4 v83, s[96:99], s7 offen offset:3072 lds
    s_waitcnt lgkmcnt(4)
    v_mfma_f32_16x16x32_bf16 v[128:131], v[32:35], a[52:55], v[128:131]
    s_waitcnt vmcnt(13)
    ds_read_b64_tr_b16 v[16:17], v92 offset:16384
    v_mfma_f32_16x16x32_bf16 v[144:147], v[36:39], a[52:55], v[144:147]
    ds_read_b64_tr_b16 v[18:19], v92 offset:16896
    v_mfma_f32_16x16x32_bf16 v[132:135], v[32:35], a[116:119], v[132:135]
    ds_read_b64_tr_b16 v[20:21], v93 offset:16384
    v_mfma_f32_16x16x32_bf16 v[148:151], v[36:39], a[116:119], v[148:151]
    ds_read_b64_tr_b16 v[22:23], v93 offset:16896
    v_mfma_f32_16x16x32_bf16 v[136:139], v[32:35], a[180:183], v[136:139]
    ds_read_b64_tr_b16 v[24:25], v94 offset:16384
    v_mfma_f32_16x16x32_bf16 v[152:155], v[36:39], a[180:183], v[152:155]
    ds_read_b64_tr_b16 v[26:27], v94 offset:16896
    v_mfma_f32_16x16x32_bf16 v[140:143], v[32:35], a[244:247], v[140:143]
    ds_read_b64_tr_b16 v[28:29], v95 offset:16384
    v_mfma_f32_16x16x32_bf16 v[156:159], v[36:39], a[244:247], v[156:159]
    ds_read_b64_tr_b16 v[30:31], v95 offset:16896
    v_mfma_f32_16x16x32_bf16 v[172:175], v[40:43], a[244:247], v[172:175]
    v_xor_b32 v89, 14400, v88
    ds_read_b128 a[60:63], v89 offset:0
    v_mfma_f32_16x16x32_bf16 v[188:191], v[44:47], a[244:247], v[188:191]
    s_add_u32 m0, s6, 12288
    s_xor_b32 s7, s20, 131072
    buffer_load_dwordx4 v80, s[96:99], s7 offen offset:0 lds
    v_mfma_f32_16x16x32_bf16 v[168:171], v[40:43], a[180:183], v[168:171]
    ds_read_b128 a[124:127], v89 offset:16384
    v_mfma_f32_16x16x32_bf16 v[184:187], v[44:47], a[180:183], v[184:187]
    buffer_load_dwordx4 v81, s[96:99], s7 offen offset:1024 lds
    v_mfma_f32_16x16x32_bf16 v[164:167], v[40:43], a[116:119], v[164:167]
    ds_read_b128 a[188:191], v89 offset:32768
    v_mfma_f32_16x16x32_bf16 v[180:183], v[44:47], a[116:119], v[180:183]
    buffer_load_dwordx4 v82, s[96:99], s7 offen offset:2048 lds
    v_mfma_f32_16x16x32_bf16 v[160:163], v[40:43], a[52:55], v[160:163]
    s_waitcnt lgkmcnt(14)
    ds_read_b128 a[252:255], v89 offset:49152
    v_mfma_f32_16x16x32_bf16 v[176:179], v[44:47], a[52:55], v[176:179]
    buffer_load_dwordx4 v83, s[96:99], s7 offen offset:3072 lds
    s_waitcnt lgkmcnt(4)
    v_mfma_f32_16x16x32_bf16 v[128:131], v[16:19], a[56:59], v[128:131]
    s_waitcnt vmcnt(13)
    ds_read_b64_tr_b16 v[32:33], v92 offset:0
    v_mfma_f32_16x16x32_bf16 v[144:147], v[20:23], a[56:59], v[144:147]
    ds_read_b64_tr_b16 v[34:35], v92 offset:512
    v_mfma_f32_16x16x32_bf16 v[132:135], v[16:19], a[120:123], v[132:135]
    ds_read_b64_tr_b16 v[36:37], v93 offset:0
    v_mfma_f32_16x16x32_bf16 v[148:151], v[20:23], a[120:123], v[148:151]
    ds_read_b64_tr_b16 v[38:39], v93 offset:512
    v_mfma_f32_16x16x32_bf16 v[136:139], v[16:19], a[184:187], v[136:139]
    ds_read_b64_tr_b16 v[40:41], v94 offset:0
    v_mfma_f32_16x16x32_bf16 v[152:155], v[20:23], a[184:187], v[152:155]
    ds_read_b64_tr_b16 v[42:43], v94 offset:512
    v_mfma_f32_16x16x32_bf16 v[140:143], v[16:19], a[248:251], v[140:143]
    ds_read_b64_tr_b16 v[44:45], v95 offset:0
    v_mfma_f32_16x16x32_bf16 v[156:159], v[20:23], a[248:251], v[156:159]
    ds_read_b64_tr_b16 v[46:47], v95 offset:512
    v_mfma_f32_16x16x32_bf16 v[172:175], v[24:27], a[248:251], v[172:175]
    v_mfma_f32_16x16x32_bf16 v[188:191], v[28:31], a[248:251], v[188:191]
    s_add_u32 m0, s6, 16384
    s_xor_b32 s7, s20, 196608
    buffer_load_dwordx4 v80, s[96:99], s7 offen offset:0 lds
    v_mfma_f32_16x16x32_bf16 v[168:171], v[24:27], a[184:187], v[168:171]
    v_mfma_f32_16x16x32_bf16 v[184:187], v[28:31], a[184:187], v[184:187]
    buffer_load_dwordx4 v81, s[96:99], s7 offen offset:1024 lds
    v_mfma_f32_16x16x32_bf16 v[164:167], v[24:27], a[120:123], v[164:167]
    v_mfma_f32_16x16x32_bf16 v[180:183], v[28:31], a[120:123], v[180:183]
    buffer_load_dwordx4 v82, s[96:99], s7 offen offset:2048 lds
    v_mfma_f32_16x16x32_bf16 v[160:163], v[24:27], a[56:59], v[160:163]
    v_mfma_f32_16x16x32_bf16 v[176:179], v[28:31], a[56:59], v[176:179]
    buffer_load_dwordx4 v83, s[96:99], s7 offen offset:3072 lds
    s_waitcnt lgkmcnt(0)
    v_mfma_f32_16x16x32_bf16 v[128:131], v[32:35], a[60:63], v[128:131]
    s_waitcnt vmcnt(12)
    ds_read_b64_tr_b16 v[16:17], v92 offset:4096
    v_mfma_f32_16x16x32_bf16 v[144:147], v[36:39], a[60:63], v[144:147]
    ds_read_b64_tr_b16 v[18:19], v92 offset:4608
    v_mfma_f32_16x16x32_bf16 v[132:135], v[32:35], a[124:127], v[132:135]
    ds_read_b64_tr_b16 v[20:21], v93 offset:4096
    v_mfma_f32_16x16x32_bf16 v[148:151], v[36:39], a[124:127], v[148:151]
    ds_read_b64_tr_b16 v[22:23], v93 offset:4608
    v_mfma_f32_16x16x32_bf16 v[136:139], v[32:35], a[188:191], v[136:139]
    ds_read_b64_tr_b16 v[24:25], v94 offset:4096
    v_mfma_f32_16x16x32_bf16 v[152:155], v[36:39], a[188:191], v[152:155]
    ds_read_b64_tr_b16 v[26:27], v94 offset:4608
    v_mfma_f32_16x16x32_bf16 v[140:143], v[32:35], a[252:255], v[140:143]
    ds_read_b64_tr_b16 v[28:29], v95 offset:4096
    v_mfma_f32_16x16x32_bf16 v[156:159], v[36:39], a[252:255], v[156:159]
    ds_read_b64_tr_b16 v[30:31], v95 offset:4608
    v_mfma_f32_16x16x32_bf16 v[172:175], v[40:43], a[252:255], v[172:175]
    v_readfirstlane_b32 s26, v1
    s_getreg_b32 s21, hwreg(HW_REG_XCC_ID, 0, 4)
    s_xor_b32 s21, s21, s26
    s_barrier
    v_mfma_f32_16x16x32_bf16 v[188:191], v[44:47], a[252:255], v[188:191]
    s_add_u32 m0, s6, 0
    s_xor_b32 s7, s20, 262144
    buffer_load_dwordx4 v80, s[96:99], s7 offen offset:0 lds
    v_mfma_f32_16x16x32_bf16 v[168:171], v[40:43], a[188:191], v[168:171]
    v_mfma_f32_16x16x32_bf16 v[184:187], v[44:47], a[188:191], v[184:187]
    buffer_load_dwordx4 v81, s[96:99], s7 offen offset:1024 lds
    v_mfma_f32_16x16x32_bf16 v[164:167], v[40:43], a[124:127], v[164:167]
    v_mfma_f32_16x16x32_bf16 v[180:183], v[44:47], a[124:127], v[180:183]
    buffer_load_dwordx4 v82, s[96:99], s7 offen offset:2048 lds
    v_mfma_f32_16x16x32_bf16 v[160:163], v[40:43], a[60:63], v[160:163]
    v_mfma_f32_16x16x32_bf16 v[176:179], v[44:47], a[60:63], v[176:179]
    buffer_load_dwordx4 v83, s[96:99], s7 offen offset:3072 lds
    s_nop 3
    v_pk_fma_f32 v[112:113], v[128:129], v[128:129], s[0:1] op_sel_hi:[1,1,0] neg_lo:[1,0,0] neg_hi:[1,0,0]
    v_pk_mul_f32 v[112:113], v[112:113], v[128:129]
    v_exp_f32 v112, v112
    v_pk_fma_f32 v[114:115], v[130:131], v[130:131], s[0:1] op_sel_hi:[1,1,0] neg_lo:[1,0,0] neg_hi:[1,0,0]
    v_exp_f32 v113, v113
    v_pk_mul_f32 v[114:115], v[114:115], v[130:131]
    v_exp_f32 v114, v114
    v_pk_fma_f32 v[116:117], v[144:145], v[144:145], s[0:1] op_sel_hi:[1,1,0] neg_lo:[1,0,0] neg_hi:[1,0,0]
    v_exp_f32 v115, v115
    v_pk_mul_f32 v[116:117], v[116:117], v[144:145]
    v_exp_f32 v116, v116
    v_pk_fma_f32 v[118:119], v[146:147], v[146:147], s[0:1] op_sel_hi:[1,1,0] neg_lo:[1,0,0] neg_hi:[1,0,0]
    v_exp_f32 v117, v117
    v_pk_mul_f32 v[118:119], v[118:119], v[146:147]
    v_exp_f32 v118, v118
    v_pk_fma_f32 v[112:113], v[112:113], s[0:1], s[0:1] op_sel:[0,1,1] op_sel_hi:[1,1,1]
    v_exp_f32 v119, v119
    v_pk_fma_f32 v[114:115], v[114:115], s[0:1], s[0:1] op_sel:[0,1,1] op_sel_hi:[1,1,1]
    v_rcp_f32 v112, v112
    v_pk_fma_f32 v[116:117], v[116:117], s[0:1], s[0:1] op_sel:[0,1,1] op_sel_hi:[1,1,1]
    v_rcp_f32 v113, v113
    v_pk_fma_f32 v[118:119], v[118:119], s[0:1], s[0:1] op_sel:[0,1,1] op_sel_hi:[1,1,1]
    v_rcp_f32 v114, v114
    v_pk_mul_f32 v[128:129], v[112:113], v[128:129]
    v_rcp_f32 v115, v115
    v_cvt_pk_bf16_f32 v120, v128, v129
    v_rcp_f32 v116, v116
    v_pk_mul_f32 v[130:131], v[114:115], v[130:131]
    v_rcp_f32 v117, v117
    v_cvt_pk_bf16_f32 v121, v130, v131
    v_rcp_f32 v118, v118
    v_pk_mul_f32 v[144:145], v[116:117], v[144:145]
    v_rcp_f32 v119, v119
    v_cvt_pk_bf16_f32 v122, v144, v145
    v_pk_mul_f32 v[146:147], v[118:119], v[146:147]
    v_cvt_pk_bf16_f32 v123, v146, v147
    v_pk_mul_f32 v[112:113], v[128:129], v[128:129]
    v_pk_add_f32 v[114:115], v[128:129], v[130:131]
    v_pk_fma_f32 v[112:113], v[130:131], v[130:131], v[112:113]
    v_pk_fma_f32 v[112:113], v[144:145], v[144:145], v[112:113]
    v_pk_add_f32 v[114:115], v[114:115], v[144:145]
    v_pk_fma_f32 v[112:113], v[146:147], v[146:147], v[112:113]
    v_pk_add_f32 v[114:115], v[114:115], v[146:147]
    v_add_f32 v128, v114, v115
    v_add_f32 v129, v112, v113
    ds_write_b64 v84, v[120:121] offset:0
    ds_write_b64 v84, v[122:123] offset:32
    v_pk_fma_f32 v[112:113], v[160:161], v[160:161], s[0:1] op_sel_hi:[1,1,0] neg_lo:[1,0,0] neg_hi:[1,0,0]
    v_pk_mul_f32 v[112:113], v[112:113], v[160:161]
    v_exp_f32 v112, v112
    v_pk_fma_f32 v[114:115], v[162:163], v[162:163], s[0:1] op_sel_hi:[1,1,0] neg_lo:[1,0,0] neg_hi:[1,0,0]
    v_exp_f32 v113, v113
    v_pk_mul_f32 v[114:115], v[114:115], v[162:163]
    v_exp_f32 v114, v114
    v_pk_fma_f32 v[116:117], v[176:177], v[176:177], s[0:1] op_sel_hi:[1,1,0] neg_lo:[1,0,0] neg_hi:[1,0,0]
    v_exp_f32 v115, v115
    v_pk_mul_f32 v[116:117], v[116:117], v[176:177]
    v_exp_f32 v116, v116
    v_pk_fma_f32 v[118:119], v[178:179], v[178:179], s[0:1] op_sel_hi:[1,1,0] neg_lo:[1,0,0] neg_hi:[1,0,0]
    v_exp_f32 v117, v117
    v_pk_mul_f32 v[118:119], v[118:119], v[178:179]
    v_exp_f32 v118, v118
    v_pk_fma_f32 v[112:113], v[112:113], s[0:1], s[0:1] op_sel:[0,1,1] op_sel_hi:[1,1,1]
    v_exp_f32 v119, v119
    v_pk_fma_f32 v[114:115], v[114:115], s[0:1], s[0:1] op_sel:[0,1,1] op_sel_hi:[1,1,1]
    v_rcp_f32 v112, v112
    v_pk_fma_f32 v[116:117], v[116:117], s[0:1], s[0:1] op_sel:[0,1,1] op_sel_hi:[1,1,1]
    v_rcp_f32 v113, v113
    v_pk_fma_f32 v[118:119], v[118:119], s[0:1], s[0:1] op_sel:[0,1,1] op_sel_hi:[1,1,1]
    v_rcp_f32 v114, v114
    v_pk_mul_f32 v[160:161], v[112:113], v[160:161]
    v_rcp_f32 v115, v115
    v_cvt_pk_bf16_f32 v124, v160, v161
    v_rcp_f32 v116, v116
    v_pk_mul_f32 v[162:163], v[114:115], v[162:163]
    v_rcp_f32 v117, v117
    v_cvt_pk_bf16_f32 v125, v162, v163
    v_rcp_f32 v118, v118
    v_pk_mul_f32 v[176:177], v[116:117], v[176:177]
    v_rcp_f32 v119, v119
    v_cvt_pk_bf16_f32 v126, v176, v177
    v_pk_mul_f32 v[178:179], v[118:119], v[178:179]
    v_cvt_pk_bf16_f32 v127, v178, v179
    v_pk_mul_f32 v[112:113], v[160:161], v[160:161]
    v_pk_add_f32 v[114:115], v[160:161], v[162:163]
    v_pk_fma_f32 v[112:113], v[162:163], v[162:163], v[112:113]
    v_pk_fma_f32 v[112:113], v[176:177], v[176:177], v[112:113]
    v_pk_add_f32 v[114:115], v[114:115], v[176:177]
    v_pk_fma_f32 v[112:113], v[178:179], v[178:179], v[112:113]
    v_pk_add_f32 v[114:115], v[114:115], v[178:179]
    v_add_f32 v114, v114, v115
    v_add_f32 v115, v112, v113
    v_pk_add_f32 v[128:129], v[128:129], v[114:115]
    ds_write_b64 v84, v[124:125] offset:64
    ds_write_b64 v84, v[126:127] offset:96
    ds_read_b128 v[160:163], v85 offset:0
    ds_read_b128 v[176:179], v85 offset:1152
    v_pk_fma_f32 v[112:113], v[132:133], v[132:133], s[0:1] op_sel_hi:[1,1,0] neg_lo:[1,0,0] neg_hi:[1,0,0]
    v_pk_mul_f32 v[112:113], v[112:113], v[132:133]
    v_exp_f32 v112, v112
    v_pk_fma_f32 v[114:115], v[134:135], v[134:135], s[0:1] op_sel_hi:[1,1,0] neg_lo:[1,0,0] neg_hi:[1,0,0]
    v_exp_f32 v113, v113
    v_pk_mul_f32 v[114:115], v[114:115], v[134:135]
    v_exp_f32 v114, v114
    v_pk_fma_f32 v[116:117], v[148:149], v[148:149], s[0:1] op_sel_hi:[1,1,0] neg_lo:[1,0,0] neg_hi:[1,0,0]
    v_exp_f32 v115, v115
    v_pk_mul_f32 v[116:117], v[116:117], v[148:149]
    v_exp_f32 v116, v116
    v_pk_fma_f32 v[118:119], v[150:151], v[150:151], s[0:1] op_sel_hi:[1,1,0] neg_lo:[1,0,0] neg_hi:[1,0,0]
    v_exp_f32 v117, v117
    v_pk_mul_f32 v[118:119], v[118:119], v[150:151]
    v_exp_f32 v118, v118
    v_pk_fma_f32 v[112:113], v[112:113], s[0:1], s[0:1] op_sel:[0,1,1] op_sel_hi:[1,1,1]
    v_exp_f32 v119, v119
    v_pk_fma_f32 v[114:115], v[114:115], s[0:1], s[0:1] op_sel:[0,1,1] op_sel_hi:[1,1,1]
    v_rcp_f32 v112, v112
    v_pk_fma_f32 v[116:117], v[116:117], s[0:1], s[0:1] op_sel:[0,1,1] op_sel_hi:[1,1,1]
    v_rcp_f32 v113, v113
    v_pk_fma_f32 v[118:119], v[118:119], s[0:1], s[0:1] op_sel:[0,1,1] op_sel_hi:[1,1,1]
    v_rcp_f32 v114, v114
    v_pk_mul_f32 v[132:133], v[112:113], v[132:133]
    v_rcp_f32 v115, v115
    v_cvt_pk_bf16_f32 v120, v132, v133
    v_rcp_f32 v116, v116
    v_pk_mul_f32 v[134:135], v[114:115], v[134:135]
    v_rcp_f32 v117, v117
    v_cvt_pk_bf16_f32 v121, v134, v135
    v_rcp_f32 v118, v118
    v_pk_mul_f32 v[148:149], v[116:117], v[148:149]
    v_rcp_f32 v119, v119
    v_cvt_pk_bf16_f32 v122, v148, v149
    v_pk_mul_f32 v[150:151], v[118:119], v[150:151]
    v_cvt_pk_bf16_f32 v123, v150, v151
    v_pk_mul_f32 v[112:113], v[132:133], v[132:133]
    v_pk_add_f32 v[114:115], v[132:133], v[134:135]
    v_pk_fma_f32 v[112:113], v[134:135], v[134:135], v[112:113]
    v_pk_fma_f32 v[112:113], v[148:149], v[148:149], v[112:113]
    v_pk_add_f32 v[114:115], v[114:115], v[148:149]
    v_pk_fma_f32 v[112:113], v[150:151], v[150:151], v[112:113]
    v_pk_add_f32 v[114:115], v[114:115], v[150:151]
    v_add_f32 v132, v114, v115
    v_add_f32 v133, v112, v113
    ds_write_b64 v84, v[120:121] offset:0
    s_waitcnt lgkmcnt(14)
    ds_write_b64 v84, v[122:123] offset:32
    s_add_u32 s29, s17, 0
    s_waitcnt lgkmcnt(3)
    buffer_store_dwordx4 v[160:163], v86, s[12:15], s29 offen sc1
    v_pk_fma_f32 v[112:113], v[164:165], v[164:165], s[0:1] op_sel_hi:[1,1,0] neg_lo:[1,0,0] neg_hi:[1,0,0]
    v_pk_mul_f32 v[112:113], v[112:113], v[164:165]
    v_exp_f32 v112, v112
    v_pk_fma_f32 v[114:115], v[166:167], v[166:167], s[0:1] op_sel_hi:[1,1,0] neg_lo:[1,0,0] neg_hi:[1,0,0]
    v_exp_f32 v113, v113
    v_pk_mul_f32 v[114:115], v[114:115], v[166:167]
    v_exp_f32 v114, v114
    v_pk_fma_f32 v[116:117], v[180:181], v[180:181], s[0:1] op_sel_hi:[1,1,0] neg_lo:[1,0,0] neg_hi:[1,0,0]
    v_exp_f32 v115, v115
    v_pk_mul_f32 v[116:117], v[116:117], v[180:181]
    v_exp_f32 v116, v116
    v_pk_fma_f32 v[118:119], v[182:183], v[182:183], s[0:1] op_sel_hi:[1,1,0] neg_lo:[1,0,0] neg_hi:[1,0,0]
    v_exp_f32 v117, v117
    v_pk_mul_f32 v[118:119], v[118:119], v[182:183]
    v_exp_f32 v118, v118
    v_pk_fma_f32 v[112:113], v[112:113], s[0:1], s[0:1] op_sel:[0,1,1] op_sel_hi:[1,1,1]
    v_exp_f32 v119, v119
    v_pk_fma_f32 v[114:115], v[114:115], s[0:1], s[0:1] op_sel:[0,1,1] op_sel_hi:[1,1,1]
    v_rcp_f32 v112, v112
    v_pk_fma_f32 v[116:117], v[116:117], s[0:1], s[0:1] op_sel:[0,1,1] op_sel_hi:[1,1,1]
    v_rcp_f32 v113, v113
    v_pk_fma_f32 v[118:119], v[118:119], s[0:1], s[0:1] op_sel:[0,1,1] op_sel_hi:[1,1,1]
    v_rcp_f32 v114, v114
    v_pk_mul_f32 v[164:165], v[112:113], v[164:165]
    v_rcp_f32 v115, v115
    v_cvt_pk_bf16_f32 v124, v164, v165
    v_rcp_f32 v116, v116
    v_pk_mul_f32 v[166:167], v[114:115], v[166:167]
    v_rcp_f32 v117, v117
    v_cvt_pk_bf16_f32 v125, v166, v167
    v_rcp_f32 v118, v118
    v_pk_mul_f32 v[180:181], v[116:117], v[180:181]
    v_rcp_f32 v119, v119
    v_cvt_pk_bf16_f32 v126, v180, v181
    v_pk_mul_f32 v[182:183], v[118:119], v[182:183]
    v_cvt_pk_bf16_f32 v127, v182, v183
    v_pk_mul_f32 v[112:113], v[164:165], v[164:165]
    v_pk_add_f32 v[114:115], v[164:165], v[166:167]
    v_pk_fma_f32 v[112:113], v[166:167], v[166:167], v[112:113]
    v_pk_fma_f32 v[112:113], v[180:181], v[180:181], v[112:113]
    v_pk_add_f32 v[114:115], v[114:115], v[180:181]
    v_pk_fma_f32 v[112:113], v[182:183], v[182:183], v[112:113]
    v_pk_add_f32 v[114:115], v[114:115], v[182:183]
    v_add_f32 v114, v114, v115
    v_add_f32 v115, v112, v113
    v_pk_add_f32 v[132:133], v[132:133], v[114:115]
    ds_write_b64 v84, v[124:125] offset:64
    ds_write_b64 v84, v[126:127] offset:96
    s_add_u32 s29, s17, 4096
    s_waitcnt lgkmcnt(4)
    buffer_store_dwordx4 v[176:179], v86, s[12:15], s29 offen
    ds_read_b128 v[164:167], v85 offset:0
    ds_read_b128 v[180:183], v85 offset:1152
    v_pk_fma_f32 v[112:113], v[136:137], v[136:137], s[0:1] op_sel_hi:[1,1,0] neg_lo:[1,0,0] neg_hi:[1,0,0]
    v_pk_mul_f32 v[112:113], v[112:113], v[136:137]
    v_exp_f32 v112, v112
    v_pk_fma_f32 v[114:115], v[138:139], v[138:139], s[0:1] op_sel_hi:[1,1,0] neg_lo:[1,0,0] neg_hi:[1,0,0]
    v_exp_f32 v113, v113
    v_pk_mul_f32 v[114:115], v[114:115], v[138:139]
    v_exp_f32 v114, v114
    v_pk_fma_f32 v[116:117], v[152:153], v[152:153], s[0:1] op_sel_hi:[1,1,0] neg_lo:[1,0,0] neg_hi:[1,0,0]
    v_exp_f32 v115, v115
    v_pk_mul_f32 v[116:117], v[116:117], v[152:153]
    v_exp_f32 v116, v116
    v_pk_fma_f32 v[118:119], v[154:155], v[154:155], s[0:1] op_sel_hi:[1,1,0] neg_lo:[1,0,0] neg_hi:[1,0,0]
    v_exp_f32 v117, v117
    v_pk_mul_f32 v[118:119], v[118:119], v[154:155]
    v_exp_f32 v118, v118
    v_pk_fma_f32 v[112:113], v[112:113], s[0:1], s[0:1] op_sel:[0,1,1] op_sel_hi:[1,1,1]
    v_exp_f32 v119, v119
    v_pk_fma_f32 v[114:115], v[114:115], s[0:1], s[0:1] op_sel:[0,1,1] op_sel_hi:[1,1,1]
    v_rcp_f32 v112, v112
    v_pk_fma_f32 v[116:117], v[116:117], s[0:1], s[0:1] op_sel:[0,1,1] op_sel_hi:[1,1,1]
    v_rcp_f32 v113, v113
    v_pk_fma_f32 v[118:119], v[118:119], s[0:1], s[0:1] op_sel:[0,1,1] op_sel_hi:[1,1,1]
    v_rcp_f32 v114, v114
    v_pk_mul_f32 v[136:137], v[112:113], v[136:137]
    v_rcp_f32 v115, v115
    v_cvt_pk_bf16_f32 v120, v136, v137
    v_rcp_f32 v116, v116
    v_pk_mul_f32 v[138:139], v[114:115], v[138:139]
    v_rcp_f32 v117, v117
    v_cvt_pk_bf16_f32 v121, v138, v139
    v_rcp_f32 v118, v118
    v_pk_mul_f32 v[152:153], v[116:117], v[152:153]
    v_rcp_f32 v119, v119
    v_cvt_pk_bf16_f32 v122, v152, v153
    v_pk_mul_f32 v[154:155], v[118:119], v[154:155]
    v_cvt_pk_bf16_f32 v123, v154, v155
    v_pk_mul_f32 v[112:113], v[136:137], v[136:137]
    v_pk_add_f32 v[114:115], v[136:137], v[138:139]
    v_pk_fma_f32 v[112:113], v[138:139], v[138:139], v[112:113]
    v_pk_fma_f32 v[112:113], v[152:153], v[152:153], v[112:113]
    v_pk_add_f32 v[114:115], v[114:115], v[152:153]
    v_pk_fma_f32 v[112:113], v[154:155], v[154:155], v[112:113]
    v_pk_add_f32 v[114:115], v[114:115], v[154:155]
    v_add_f32 v136, v114, v115
    v_add_f32 v137, v112, v113
    ds_write_b64 v84, v[120:121] offset:0
    ds_write_b64 v84, v[122:123] offset:32
    s_add_u32 s29, s17, 8192
    s_waitcnt lgkmcnt(3)
    buffer_store_dwordx4 v[164:167], v86, s[12:15], s29 offen
    v_mfma_f32_16x16x32_bf16 v[192:195], v[16:19], a[0:3], 0
    s_waitcnt vmcnt(15)
    ds_read_b64_tr_b16 v[32:33], v92 offset:8192
    v_mfma_f32_16x16x32_bf16 v[208:211], v[20:23], a[0:3], 0
    ds_read_b64_tr_b16 v[34:35], v92 offset:8704
    v_mfma_f32_16x16x32_bf16 v[196:199], v[16:19], a[64:67], 0
    ds_read_b64_tr_b16 v[36:37], v93 offset:8192
    v_mfma_f32_16x16x32_bf16 v[212:215], v[20:23], a[64:67], 0
    ds_read_b64_tr_b16 v[38:39], v93 offset:8704
    v_fma_f32 v112, -v168, v168, s0
    v_mfma_f32_16x16x32_bf16 v[200:203], v[16:19], a[128:131], 0
    ds_read_b64_tr_b16 v[40:41], v94 offset:8192
    v_fma_f32 v113, -v169, v169, s0
    v_mfma_f32_16x16x32_bf16 v[216:219], v[20:23], a[128:131], 0
    ds_read_b64_tr_b16 v[42:43], v94 offset:8704
    v_fma_f32 v114, -v170, v170, s0
    v_mfma_f32_16x16x32_bf16 v[204:207], v[16:19], a[192:195], 0
    ds_read_b64_tr_b16 v[44:45], v95 offset:8192
    v_fma_f32 v115, -v171, v171, s0
    v_mfma_f32_16x16x32_bf16 v[220:223], v[20:23], a[192:195], 0
    ds_read_b64_tr_b16 v[46:47], v95 offset:8704
    v_fma_f32 v116, -v184, v184, s0
    v_mfma_f32_16x16x32_bf16 v[236:239], v[24:27], a[192:195], 0
    v_fma_f32 v117, -v185, v185, s0
    v_fma_f32 v118, -v186, v186, s0
    v_mfma_f32_16x16x32_bf16 v[252:255], v[28:31], a[192:195], 0
    s_add_u32 m0, s6, 4096
    s_xor_b32 s7, s20, 327680
    buffer_load_dwordx4 v80, s[96:99], s7 offen offset:0 lds
    v_fma_f32 v119, -v187, v187, s0
    v_mfma_f32_16x16x32_bf16 v[232:235], v[24:27], a[128:131], 0
    v_mul_f32 v112, v112, v168
    v_mul_f32 v113, v113, v169
    v_mfma_f32_16x16x32_bf16 v[248:251], v[28:31], a[128:131], 0
    buffer_load_dwordx4 v81, s[96:99], s7 offen offset:1024 lds
    v_mul_f32 v114, v114, v170
    v_mfma_f32_16x16x32_bf16 v[228:231], v[24:27], a[64:67], 0
    v_mul_f32 v115, v115, v171
    v_mfma_f32_16x16x32_bf16 v[244:247], v[28:31], a[64:67], 0
    buffer_load_dwordx4 v82, s[96:99], s7 offen offset:2048 lds
    v_mul_f32 v116, v116, v184
    v_mfma_f32_16x16x32_bf16 v[224:227], v[24:27], a[0:3], 0
    v_mul_f32 v117, v117, v185
    v_mul_f32 v118, v118, v186
    v_mfma_f32_16x16x32_bf16 v[240:243], v[28:31], a[0:3], 0
    buffer_load_dwordx4 v83, s[96:99], s7 offen offset:3072 lds
    v_mul_f32 v119, v119, v187
    s_waitcnt lgkmcnt(0)
    v_mfma_f32_16x16x32_bf16 v[192:195], v[32:35], a[4:7], v[192:195]
    s_waitcnt vmcnt(15)
    ds_read_b64_tr_b16 v[16:17], v92 offset:12288
    v_mfma_f32_16x16x32_bf16 v[208:211], v[36:39], a[4:7], v[208:211]
    ds_read_b64_tr_b16 v[18:19], v92 offset:12800
    v_exp_f32 v112, v112
    v_mfma_f32_16x16x32_bf16 v[196:199], v[32:35], a[68:71], v[196:199]
    ds_read_b64_tr_b16 v[20:21], v93 offset:12288
    v_mfma_f32_16x16x32_bf16 v[212:215], v[36:39], a[68:71], v[212:215]
    ds_read_b64_tr_b16 v[22:23], v93 offset:12800
    v_exp_f32 v113, v113
    v_mfma_f32_16x16x32_bf16 v[200:203], v[32:35], a[132:135], v[200:203]
    ds_read_b64_tr_b16 v[24:25], v94 offset:12288
    v_mfma_f32_16x16x32_bf16 v[216:219], v[36:39], a[132:135], v[216:219]
    ds_read_b64_tr_b16 v[26:27], v94 offset:12800
    v_exp_f32 v114, v114
    v_mfma_f32_16x16x32_bf16 v[204:207], v[32:35], a[196:199], v[204:207]
    ds_read_b64_tr_b16 v[28:29], v95 offset:12288
    v_mfma_f32_16x16x32_bf16 v[220:223], v[36:39], a[196:199], v[220:223]
    ds_read_b64_tr_b16 v[30:31], v95 offset:12800
    v_mfma_f32_16x16x32_bf16 v[236:239], v[40:43], a[196:199], v[236:239]
    v_exp_f32 v115, v115
    v_mfma_f32_16x16x32_bf16 v[252:255], v[44:47], a[196:199], v[252:255]
    s_add_u32 m0, s6, 8192
    s_xor_b32 s7, s20, 393216
    buffer_load_dwordx4 v80, s[96:99], s7 offen offset:0 lds
    v_exp_f32 v116, v116
    v_mfma_f32_16x16x32_bf16 v[232:235], v[40:43], a[132:135], v[232:235]
    v_exp_f32 v117, v117
    v_mfma_f32_16x16x32_bf16 v[248:251], v[44:47], a[132:135], v[248:251]
    buffer_load_dwordx4 v81, s[96:99], s7 offen offset:1024 lds
    v_mfma_f32_16x16x32_bf16 v[228:231], v[40:43], a[68:71], v[228:231]
    v_exp_f32 v118, v118
    v_mfma_f32_16x16x32_bf16 v[244:247], v[44:47], a[68:71], v[244:247]
    buffer_load_dwordx4 v82, s[96:99], s7 offen offset:2048 lds
    v_exp_f32 v119, v119
    v_mfma_f32_16x16x32_bf16 v[224:227], v[40:43], a[4:7], v[224:227]
    v_fma_f32 v112, v112, s1, s1
    v_mfma_f32_16x16x32_bf16 v[240:243], v[44:47], a[4:7], v[240:243]
    buffer_load_dwordx4 v83, s[96:99], s7 offen offset:3072 lds
    v_fma_f32 v113, v113, s1, s1
    s_waitcnt lgkmcnt(0)
    v_mfma_f32_16x16x32_bf16 v[192:195], v[16:19], a[8:11], v[192:195]
    s_waitcnt vmcnt(15)
    ds_read_b64_tr_b16 v[32:33], v92 offset:16384
    v_fma_f32 v114, v114, s1, s1
    v_mfma_f32_16x16x32_bf16 v[208:211], v[20:23], a[8:11], v[208:211]
    ds_read_b64_tr_b16 v[34:35], v92 offset:16896
    v_fma_f32 v115, v115, s1, s1
    v_mfma_f32_16x16x32_bf16 v[196:199], v[16:19], a[72:75], v[196:199]
    ds_read_b64_tr_b16 v[36:37], v93 offset:16384
    v_fma_f32 v116, v116, s1, s1
    v_mfma_f32_16x16x32_bf16 v[212:215], v[20:23], a[72:75], v[212:215]
    ds_read_b64_tr_b16 v[38:39], v93 offset:16896
    v_fma_f32 v117, v117, s1, s1
    v_mfma_f32_16x16x32_bf16 v[200:203], v[16:19], a[136:139], v[200:203]
    ds_read_b64_tr_b16 v[40:41], v94 offset:16384
    v_fma_f32 v118, v118, s1, s1
    v_mfma_f32_16x16x32_bf16 v[216:219], v[20:23], a[136:139], v[216:219]
    ds_read_b64_tr_b16 v[42:43], v94 offset:16896
    v_fma_f32 v119, v119, s1, s1
    v_mfma_f32_16x16x32_bf16 v[204:207], v[16:19], a[200:203], v[204:207]
    ds_read_b64_tr_b16 v[44:45], v95 offset:16384
    v_mfma_f32_16x16x32_bf16 v[220:223], v[20:23], a[200:203], v[220:223]
    ds_read_b64_tr_b16 v[46:47], v95 offset:16896
    v_rcp_f32 v112, v112
    v_mfma_f32_16x16x32_bf16 v[236:239], v[24:27], a[200:203], v[236:239]
    v_rcp_f32 v113, v113
    v_mfma_f32_16x16x32_bf16 v[252:255], v[28:31], a[200:203], v[252:255]
    s_add_u32 m0, s6, 12288
    s_xor_b32 s7, s20, 458752
    buffer_load_dwordx4 v80, s[96:99], s7 offen offset:0 lds
    v_mfma_f32_16x16x32_bf16 v[232:235], v[24:27], a[136:139], v[232:235]
    v_rcp_f32 v114, v114
    v_mfma_f32_16x16x32_bf16 v[248:251], v[28:31], a[136:139], v[248:251]
    buffer_load_dwordx4 v81, s[96:99], s7 offen offset:1024 lds
    v_mfma_f32_16x16x32_bf16 v[228:231], v[24:27], a[72:75], v[228:231]
    v_rcp_f32 v115, v115
    v_mfma_f32_16x16x32_bf16 v[244:247], v[28:31], a[72:75], v[244:247]
    buffer_load_dwordx4 v82, s[96:99], s7 offen offset:2048 lds
    v_rcp_f32 v116, v116
    v_mfma_f32_16x16x32_bf16 v[224:227], v[24:27], a[8:11], v[224:227]
    v_rcp_f32 v117, v117
    v_mfma_f32_16x16x32_bf16 v[240:243], v[28:31], a[8:11], v[240:243]
    buffer_load_dwordx4 v83, s[96:99], s7 offen offset:3072 lds
    s_waitcnt lgkmcnt(0)
    v_mfma_f32_16x16x32_bf16 v[192:195], v[32:35], a[12:15], v[192:195]
    s_waitcnt vmcnt(15)
    ds_read_b64_tr_b16 v[16:17], v92 offset:0
    v_rcp_f32 v118, v118
    v_mfma_f32_16x16x32_bf16 v[208:211], v[36:39], a[12:15], v[208:211]
    ds_read_b64_tr_b16 v[18:19], v92 offset:512
    v_mfma_f32_16x16x32_bf16 v[196:199], v[32:35], a[76:79], v[196:199]
    ds_read_b64_tr_b16 v[20:21], v93 offset:0
    v_mfma_f32_16x16x32_bf16 v[212:215], v[36:39], a[76:79], v[212:215]
    ds_read_b64_tr_b16 v[22:23], v93 offset:512
    v_rcp_f32 v119, v119
    v_mfma_f32_16x16x32_bf16 v[200:203], v[32:35], a[140:143], v[200:203]
    ds_read_b64_tr_b16 v[24:25], v94 offset:0
    v_mul_f32 v168, v112, v168
    v_mfma_f32_16x16x32_bf16 v[216:219], v[36:39], a[140:143], v[216:219]
    ds_read_b64_tr_b16 v[26:27], v94 offset:512
    v_mul_f32 v169, v113, v169
    v_mfma_f32_16x16x32_bf16 v[204:207], v[32:35], a[204:207], v[204:207]
    ds_read_b64_tr_b16 v[28:29], v95 offset:0
    v_mul_f32 v170, v114, v170
    v_mfma_f32_16x16x32_bf16 v[220:223], v[36:39], a[204:207], v[220:223]
    ds_read_b64_tr_b16 v[30:31], v95 offset:512
    v_mul_f32 v171, v115, v171
    v_mfma_f32_16x16x32_bf16 v[236:239], v[40:43], a[204:207], v[236:239]
    v_mul_f32 v184, v116, v184
    v_mul_f32 v185, v117, v185
    v_mfma_f32_16x16x32_bf16 v[252:255], v[44:47], a[204:207], v[252:255]
    s_add_u32 m0, s6, 16384
    s_xor_b32 s7, s20, 524288
    buffer_load_dwordx4 v80, s[96:99], s7 offen offset:0 lds
    v_mul_f32 v186, v118, v186
    v_mfma_f32_16x16x32_bf16 v[232:235], v[40:43], a[140:143], v[232:235]
    v_mul_f32 v187, v119, v187
    v_cvt_pk_bf16_f32 v124, v168, v169
    v_mfma_f32_16x16x32_bf16 v[248:251], v[44:47], a[140:143], v[248:251]
    buffer_load_dwordx4 v81, s[96:99], s7 offen offset:1024 lds
    v_cvt_pk_bf16_f32 v125, v170, v171
    v_mfma_f32_16x16x32_bf16 v[228:231], v[40:43], a[76:79], v[228:231]
    v_cvt_pk_bf16_f32 v126, v184, v185
    v_mfma_f32_16x16x32_bf16 v[244:247], v[44:47], a[76:79], v[244:247]
    buffer_load_dwordx4 v82, s[96:99], s7 offen offset:2048 lds
    v_cvt_pk_bf16_f32 v127, v186, v187
    v_mfma_f32_16x16x32_bf16 v[224:227], v[40:43], a[12:15], v[224:227]
    v_add_f32 v136, v136, v168
    v_fmac_f32 v137, v168, v168
    v_mfma_f32_16x16x32_bf16 v[240:243], v[44:47], a[12:15], v[240:243]
    buffer_load_dwordx4 v83, s[96:99], s7 offen offset:3072 lds
    v_add_f32 v136, v136, v169
    s_waitcnt lgkmcnt(0)
    v_mfma_f32_16x16x32_bf16 v[192:195], v[16:19], a[16:19], v[192:195]
    s_waitcnt vmcnt(12)
    ds_read_b64_tr_b16 v[32:33], v92 offset:4096
    v_fmac_f32 v137, v169, v169
    v_mfma_f32_16x16x32_bf16 v[208:211], v[20:23], a[16:19], v[208:211]
    ds_read_b64_tr_b16 v[34:35], v92 offset:4608
    v_add_f32 v136, v136, v170
    v_mfma_f32_16x16x32_bf16 v[196:199], v[16:19], a[80:83], v[196:199]
    ds_read_b64_tr_b16 v[36:37], v93 offset:4096
    v_fmac_f32 v137, v170, v170
    v_mfma_f32_16x16x32_bf16 v[212:215], v[20:23], a[80:83], v[212:215]
    ds_read_b64_tr_b16 v[38:39], v93 offset:4608
    v_add_f32 v136, v136, v171
    v_mfma_f32_16x16x32_bf16 v[200:203], v[16:19], a[144:147], v[200:203]
    ds_read_b64_tr_b16 v[40:41], v94 offset:4096
    v_fmac_f32 v137, v171, v171
    v_mfma_f32_16x16x32_bf16 v[216:219], v[20:23], a[144:147], v[216:219]
    ds_read_b64_tr_b16 v[42:43], v94 offset:4608
    v_add_f32 v136, v136, v184
    v_mfma_f32_16x16x32_bf16 v[204:207], v[16:19], a[208:211], v[204:207]
    ds_read_b64_tr_b16 v[44:45], v95 offset:4096
    v_mfma_f32_16x16x32_bf16 v[220:223], v[20:23], a[208:211], v[220:223]
    ds_read_b64_tr_b16 v[46:47], v95 offset:4608
    v_fmac_f32 v137, v184, v184
    v_mfma_f32_16x16x32_bf16 v[236:239], v[24:27], a[208:211], v[236:239]
    v_add_f32 v136, v136, v185
    v_fmac_f32 v137, v185, v185
    v_mfma_f32_16x16x32_bf16 v[252:255], v[28:31], a[208:211], v[252:255]
    s_add_u32 m0, s6, 0
    s_xor_b32 s7, s20, 589824
    buffer_load_dwordx4 v80, s[96:99], s7 offen offset:0 lds
    v_add_f32 v136, v136, v186
    v_mfma_f32_16x16x32_bf16 v[232:235], v[24:27], a[144:147], v[232:235]
    v_fmac_f32 v137, v186, v186
    v_add_f32 v136, v136, v187
    v_mfma_f32_16x16x32_bf16 v[248:251], v[28:31], a[144:147], v[248:251]
    buffer_load_dwordx4 v81, s[96:99], s7 offen offset:1024 lds
    v_fmac_f32 v137, v187, v187
    v_mfma_f32_16x16x32_bf16 v[228:231], v[24:27], a[80:83], v[228:231]
    ds_write_b64 v84, v[124:125] offset:64
    ds_write_b64 v84, v[126:127] offset:96
    v_mfma_f32_16x16x32_bf16 v[244:247], v[28:31], a[80:83], v[244:247]
    buffer_load_dwordx4 v82, s[96:99], s7 offen offset:2048 lds
    s_add_u32 s29, s17, 12288
    buffer_store_dwordx4 v[180:183], v86, s[12:15], s29 offen
    v_mfma_f32_16x16x32_bf16 v[224:227], v[24:27], a[16:19], v[224:227]
    ds_read_b128 v[168:171], v85 offset:0
    v_mfma_f32_16x16x32_bf16 v[240:243], v[28:31], a[16:19], v[240:243]
    buffer_load_dwordx4 v83, s[96:99], s7 offen offset:3072 lds
    ds_read_b128 v[184:187], v85 offset:1152
    s_waitcnt lgkmcnt(4)
    v_mfma_f32_16x16x32_bf16 v[192:195], v[32:35], a[20:23], v[192:195]
    s_waitcnt vmcnt(13)
    ds_read_b64_tr_b16 v[16:17], v92 offset:8192
    v_fma_f32 v112, -v140, v140, s0
    v_mfma_f32_16x16x32_bf16 v[208:211], v[36:39], a[20:23], v[208:211]
    ds_read_b64_tr_b16 v[18:19], v92 offset:8704
    v_fma_f32 v113, -v141, v141, s0
    v_mfma_f32_16x16x32_bf16 v[196:199], v[32:35], a[84:87], v[196:199]
    ds_read_b64_tr_b16 v[20:21], v93 offset:8192
    v_fma_f32 v114, -v142, v142, s0
    v_mfma_f32_16x16x32_bf16 v[212:215], v[36:39], a[84:87], v[212:215]
    ds_read_b64_tr_b16 v[22:23], v93 offset:8704
    v_fma_f32 v115, -v143, v143, s0
    v_mfma_f32_16x16x32_bf16 v[200:203], v[32:35], a[148:151], v[200:203]
    ds_read_b64_tr_b16 v[24:25], v94 offset:8192
    v_fma_f32 v116, -v156, v156, s0
    v_mfma_f32_16x16x32_bf16 v[216:219], v[36:39], a[148:151], v[216:219]
    ds_read_b64_tr_b16 v[26:27], v94 offset:8704
    v_fma_f32 v117, -v157, v157, s0
    v_mfma_f32_16x16x32_bf16 v[204:207], v[32:35], a[212:215], v[204:207]
    ds_read_b64_tr_b16 v[28:29], v95 offset:8192
    v_fma_f32 v118, -v158, v158, s0
    v_mfma_f32_16x16x32_bf16 v[220:223], v[36:39], a[212:215], v[220:223]
    ds_read_b64_tr_b16 v[30:31], v95 offset:8704
    v_fma_f32 v119, -v159, v159, s0
    v_mfma_f32_16x16x32_bf16 v[236:239], v[40:43], a[212:215], v[236:239]
    v_mul_f32 v112, v112, v140
    v_mul_f32 v113, v113, v141
    v_mfma_f32_16x16x32_bf16 v[252:255], v[44:47], a[212:215], v[252:255]
    s_add_u32 m0, s6, 4096
    s_xor_b32 s7, s20, 655360
    buffer_load_dwordx4 v80, s[96:99], s7 offen offset:0 lds
    v_mfma_f32_16x16x32_bf16 v[232:235], v[40:43], a[148:151], v[232:235]
    v_mul_f32 v114, v114, v142
    v_mul_f32 v115, v115, v143
    v_mfma_f32_16x16x32_bf16 v[248:251], v[44:47], a[148:151], v[248:251]
    buffer_load_dwordx4 v81, s[96:99], s7 offen offset:1024 lds
    v_mul_f32 v116, v116, v156
    v_mfma_f32_16x16x32_bf16 v[228:231], v[40:43], a[84:87], v[228:231]
    v_mul_f32 v117, v117, v157
    v_mul_f32 v118, v118, v158
    v_mfma_f32_16x16x32_bf16 v[244:247], v[44:47], a[84:87], v[244:247]
    buffer_load_dwordx4 v82, s[96:99], s7 offen offset:2048 lds
    v_mul_f32 v119, v119, v159
    v_mfma_f32_16x16x32_bf16 v[224:227], v[40:43], a[20:23], v[224:227]
    v_exp_f32 v112, v112
    v_mfma_f32_16x16x32_bf16 v[240:243], v[44:47], a[20:23], v[240:243]
    buffer_load_dwordx4 v83, s[96:99], s7 offen offset:3072 lds
    s_waitcnt lgkmcnt(0)
    v_mfma_f32_16x16x32_bf16 v[192:195], v[16:19], a[24:27], v[192:195]
    s_waitcnt vmcnt(13)
    ds_read_b64_tr_b16 v[32:33], v92 offset:12288
    v_exp_f32 v113, v113
    v_mfma_f32_16x16x32_bf16 v[208:211], v[20:23], a[24:27], v[208:211]
    ds_read_b64_tr_b16 v[34:35], v92 offset:12800
    v_mfma_f32_16x16x32_bf16 v[196:199], v[16:19], a[88:91], v[196:199]
    ds_read_b64_tr_b16 v[36:37], v93 offset:12288
    v_mfma_f32_16x16x32_bf16 v[212:215], v[20:23], a[88:91], v[212:215]
    ds_read_b64_tr_b16 v[38:39], v93 offset:12800
    v_exp_f32 v114, v114
    v_mfma_f32_16x16x32_bf16 v[200:203], v[16:19], a[152:155], v[200:203]
    ds_read_b64_tr_b16 v[40:41], v94 offset:12288
    v_mfma_f32_16x16x32_bf16 v[216:219], v[20:23], a[152:155], v[216:219]
    ds_read_b64_tr_b16 v[42:43], v94 offset:12800
    v_exp_f32 v115, v115
    v_mfma_f32_16x16x32_bf16 v[204:207], v[16:19], a[216:219], v[204:207]
    ds_read_b64_tr_b16 v[44:45], v95 offset:12288
    v_mfma_f32_16x16x32_bf16 v[220:223], v[20:23], a[216:219], v[220:223]
    ds_read_b64_tr_b16 v[46:47], v95 offset:12800
    v_exp_f32 v116, v116
    v_mfma_f32_16x16x32_bf16 v[236:239], v[24:27], a[216:219], v[236:239]
    v_exp_f32 v117, v117
    v_mfma_f32_16x16x32_bf16 v[252:255], v[28:31], a[216:219], v[252:255]
    s_add_u32 m0, s6, 8192
    s_xor_b32 s7, s20, 720896
    buffer_load_dwordx4 v80, s[96:99], s7 offen offset:0 lds
    v_mfma_f32_16x16x32_bf16 v[232:235], v[24:27], a[152:155], v[232:235]
    v_exp_f32 v118, v118
    v_mfma_f32_16x16x32_bf16 v[248:251], v[28:31], a[152:155], v[248:251]
    buffer_load_dwordx4 v81, s[96:99], s7 offen offset:1024 lds
    v_exp_f32 v119, v119
    v_mfma_f32_16x16x32_bf16 v[228:231], v[24:27], a[88:91], v[228:231]
    v_fma_f32 v112, v112, s1, s1
    v_mfma_f32_16x16x32_bf16 v[244:247], v[28:31], a[88:91], v[244:247]
    buffer_load_dwordx4 v82, s[96:99], s7 offen offset:2048 lds
    v_fma_f32 v113, v113, s1, s1
    v_mfma_f32_16x16x32_bf16 v[224:227], v[24:27], a[24:27], v[224:227]
    v_fma_f32 v114, v114, s1, s1
    v_fma_f32 v115, v115, s1, s1
    v_mfma_f32_16x16x32_bf16 v[240:243], v[28:31], a[24:27], v[240:243]
    buffer_load_dwordx4 v83, s[96:99], s7 offen offset:3072 lds
    v_fma_f32 v116, v116, s1, s1
    s_waitcnt lgkmcnt(0)
    v_mfma_f32_16x16x32_bf16 v[192:195], v[32:35], a[28:31], v[192:195]
    s_waitcnt vmcnt(13)
    ds_read_b64_tr_b16 v[16:17], v92 offset:16384
    v_fma_f32 v117, v117, s1, s1
    v_mfma_f32_16x16x32_bf16 v[208:211], v[36:39], a[28:31], v[208:211]
    ds_read_b64_tr_b16 v[18:19], v92 offset:16896
    v_fma_f32 v118, v118, s1, s1
    v_mfma_f32_16x16x32_bf16 v[196:199], v[32:35], a[92:95], v[196:199]
    ds_read_b64_tr_b16 v[20:21], v93 offset:16384
    v_fma_f32 v119, v119, s1, s1
    v_mfma_f32_16x16x32_bf16 v[212:215], v[36:39], a[92:95], v[212:215]
    ds_read_b64_tr_b16 v[22:23], v93 offset:16896
    v_mfma_f32_16x16x32_bf16 v[200:203], v[32:35], a[156:159], v[200:203]
    ds_read_b64_tr_b16 v[24:25], v94 offset:16384
    v_rcp_f32 v112, v112
    v_mfma_f32_16x16x32_bf16 v[216:219], v[36:39], a[156:159], v[216:219]
    ds_read_b64_tr_b16 v[26:27], v94 offset:16896
    v_mfma_f32_16x16x32_bf16 v[204:207], v[32:35], a[220:223], v[204:207]
    ds_read_b64_tr_b16 v[28:29], v95 offset:16384
    v_mfma_f32_16x16x32_bf16 v[220:223], v[36:39], a[220:223], v[220:223]
    ds_read_b64_tr_b16 v[30:31], v95 offset:16896
    v_rcp_f32 v113, v113
    v_mfma_f32_16x16x32_bf16 v[236:239], v[40:43], a[220:223], v[236:239]
    v_rcp_f32 v114, v114
    v_mfma_f32_16x16x32_bf16 v[252:255], v[44:47], a[220:223], v[252:255]
    s_add_u32 m0, s6, 12288
    s_xor_b32 s7, s20, 786432
    buffer_load_dwordx4 v80, s[96:99], s7 offen offset:0 lds
    v_mfma_f32_16x16x32_bf16 v[232:235], v[40:43], a[156:159], v[232:235]
    v_rcp_f32 v115, v115
    v_mfma_f32_16x16x32_bf16 v[248:251], v[44:47], a[156:159], v[248:251]
    buffer_load_dwordx4 v81, s[96:99], s7 offen offset:1024 lds
    v_rcp_f32 v116, v116
    v_mfma_f32_16x16x32_bf16 v[228:231], v[40:43], a[92:95], v[228:231]
    v_rcp_f32 v117, v117
    v_mfma_f32_16x16x32_bf16 v[244:247], v[44:47], a[92:95], v[244:247]
    buffer_load_dwordx4 v82, s[96:99], s7 offen offset:2048 lds
    v_mfma_f32_16x16x32_bf16 v[224:227], v[40:43], a[28:31], v[224:227]
    v_rcp_f32 v118, v118
    v_mfma_f32_16x16x32_bf16 v[240:243], v[44:47], a[28:31], v[240:243]
    buffer_load_dwordx4 v83, s[96:99], s7 offen offset:3072 lds
    s_waitcnt lgkmcnt(0)
    v_mfma_f32_16x16x32_bf16 v[192:195], v[16:19], a[32:35], v[192:195]
    s_waitcnt vmcnt(12)
    ds_read_b64_tr_b16 v[32:33], v92 offset:0
    v_rcp_f32 v119, v119
    v_mfma_f32_16x16x32_bf16 v[208:211], v[20:23], a[32:35], v[208:211]
    ds_read_b64_tr_b16 v[34:35], v92 offset:512
    v_mul_f32 v140, v112, v140
    v_mfma_f32_16x16x32_bf16 v[196:199], v[16:19], a[96:99], v[196:199]
    ds_read_b64_tr_b16 v[36:37], v93 offset:0
    v_mul_f32 v141, v113, v141
    v_mfma_f32_16x16x32_bf16 v[212:215], v[20:23], a[96:99], v[212:215]
    ds_read_b64_tr_b16 v[38:39], v93 offset:512
    v_mul_f32 v142, v114, v142
    v_mfma_f32_16x16x32_bf16 v[200:203], v[16:19], a[160:163], v[200:203]
    ds_read_b64_tr_b16 v[40:41], v94 offset:0
    v_mul_f32 v143, v115, v143
    v_mfma_f32_16x16x32_bf16 v[216:219], v[20:23], a[160:163], v[216:219]
    ds_read_b64_tr_b16 v[42:43], v94 offset:512
    v_mul_f32 v156, v116, v156
    v_mfma_f32_16x16x32_bf16 v[204:207], v[16:19], a[224:227], v[204:207]
    ds_read_b64_tr_b16 v[44:45], v95 offset:0
    v_mul_f32 v157, v117, v157
    v_mfma_f32_16x16x32_bf16 v[220:223], v[20:23], a[224:227], v[220:223]
    ds_read_b64_tr_b16 v[46:47], v95 offset:512
    v_mul_f32 v158, v118, v158
    v_mfma_f32_16x16x32_bf16 v[236:239], v[24:27], a[224:227], v[236:239]
    v_mul_f32 v159, v119, v159
    v_cvt_pk_bf16_f32 v120, v140, v141
    v_mfma_f32_16x16x32_bf16 v[252:255], v[28:31], a[224:227], v[252:255]
    s_add_u32 m0, s6, 16384
    s_xor_b32 s7, s20, 851968
    buffer_load_dwordx4 v80, s[96:99], s7 offen offset:0 lds
    v_mfma_f32_16x16x32_bf16 v[232:235], v[24:27], a[160:163], v[232:235]
    v_cvt_pk_bf16_f32 v121, v142, v143
    v_cvt_pk_bf16_f32 v122, v156, v157
    v_mfma_f32_16x16x32_bf16 v[248:251], v[28:31], a[160:163], v[248:251]
    buffer_load_dwordx4 v81, s[96:99], s7 offen offset:1024 lds
    v_cvt_pk_bf16_f32 v123, v158, v159
    v_mfma_f32_16x16x32_bf16 v[228:231], v[24:27], a[96:99], v[228:231]
    v_mul_f32 v112, v140, v140
    v_fmac_f32 v112, v141, v141
    v_mfma_f32_16x16x32_bf16 v[244:247], v[28:31], a[96:99], v[244:247]
    buffer_load_dwordx4 v82, s[96:99], s7 offen offset:2048 lds
    v_fmac_f32 v112, v142, v142
    v_mfma_f32_16x16x32_bf16 v[224:227], v[24:27], a[32:35], v[224:227]
    v_fmac_f32 v112, v143, v143
    v_fmac_f32 v112, v156, v156
    v_mfma_f32_16x16x32_bf16 v[240:243], v[28:31], a[32:35], v[240:243]
    buffer_load_dwordx4 v83, s[96:99], s7 offen offset:3072 lds
    v_fmac_f32 v112, v157, v157
    s_waitcnt lgkmcnt(0)
    v_mfma_f32_16x16x32_bf16 v[192:195], v[32:35], a[36:39], v[192:195]
    s_waitcnt vmcnt(12)
    ds_read_b64_tr_b16 v[16:17], v92 offset:4096
    v_fmac_f32 v112, v158, v158
    v_mfma_f32_16x16x32_bf16 v[208:211], v[36:39], a[36:39], v[208:211]
    ds_read_b64_tr_b16 v[18:19], v92 offset:4608
    v_fmac_f32 v112, v159, v159
    v_mfma_f32_16x16x32_bf16 v[196:199], v[32:35], a[100:103], v[196:199]
    ds_read_b64_tr_b16 v[20:21], v93 offset:4096
    v_mfma_f32_16x16x32_bf16 v[212:215], v[36:39], a[100:103], v[212:215]
    ds_read_b64_tr_b16 v[22:23], v93 offset:4608
    v_add_f32 v140, v140, v141
    v_mfma_f32_16x16x32_bf16 v[200:203], v[32:35], a[164:167], v[200:203]
    ds_read_b64_tr_b16 v[24:25], v94 offset:4096
    v_add_f32 v140, v140, v142
    v_mfma_f32_16x16x32_bf16 v[216:219], v[36:39], a[164:167], v[216:219]
    ds_read_b64_tr_b16 v[26:27], v94 offset:4608
    v_add_f32 v140, v140, v143
    v_mfma_f32_16x16x32_bf16 v[204:207], v[32:35], a[228:231], v[204:207]
    ds_read_b64_tr_b16 v[28:29], v95 offset:4096
    v_add_f32 v140, v140, v156
    v_mfma_f32_16x16x32_bf16 v[220:223], v[36:39], a[228:231], v[220:223]
    ds_read_b64_tr_b16 v[30:31], v95 offset:4608
    v_add_f32 v140, v140, v157
    v_mfma_f32_16x16x32_bf16 v[236:239], v[40:43], a[228:231], v[236:239]
    v_add_f32 v140, v140, v158
    v_add_f32 v140, v140, v159
    v_mfma_f32_16x16x32_bf16 v[252:255], v[44:47], a[228:231], v[252:255]
    s_add_u32 m0, s6, 0
    s_xor_b32 s7, s20, 917504
    buffer_load_dwordx4 v80, s[96:99], s7 offen offset:0 lds
    v_mov_b32 v141, v112
    v_mfma_f32_16x16x32_bf16 v[232:235], v[40:43], a[164:167], v[232:235]
    ds_write_b64 v84, v[120:121] offset:0
    ds_write_b64 v84, v[122:123] offset:32
    v_mfma_f32_16x16x32_bf16 v[248:251], v[44:47], a[164:167], v[248:251]
    buffer_load_dwordx4 v81, s[96:99], s7 offen offset:1024 lds
    s_add_u32 s29, s17, 16384
    buffer_store_dwordx4 v[168:171], v86, s[12:15], s29 offen
    v_mfma_f32_16x16x32_bf16 v[228:231], v[40:43], a[100:103], v[228:231]
    v_fma_f32 v112, -v172, v172, s0
    v_mfma_f32_16x16x32_bf16 v[244:247], v[44:47], a[100:103], v[244:247]
    buffer_load_dwordx4 v82, s[96:99], s7 offen offset:2048 lds
    v_fma_f32 v113, -v173, v173, s0
    v_mfma_f32_16x16x32_bf16 v[224:227], v[40:43], a[36:39], v[224:227]
    v_fma_f32 v114, -v174, v174, s0
    v_fma_f32 v115, -v175, v175, s0
    v_mfma_f32_16x16x32_bf16 v[240:243], v[44:47], a[36:39], v[240:243]
    buffer_load_dwordx4 v83, s[96:99], s7 offen offset:3072 lds
    v_fma_f32 v116, -v188, v188, s0
    s_waitcnt lgkmcnt(2)
    v_mfma_f32_16x16x32_bf16 v[192:195], v[16:19], a[40:43], v[192:195]
    s_waitcnt vmcnt(13)
    ds_read_b64_tr_b16 v[32:33], v92 offset:8192
    v_fma_f32 v117, -v189, v189, s0
    v_mfma_f32_16x16x32_bf16 v[208:211], v[20:23], a[40:43], v[208:211]
    ds_read_b64_tr_b16 v[34:35], v92 offset:8704
    v_fma_f32 v118, -v190, v190, s0
    v_mfma_f32_16x16x32_bf16 v[196:199], v[16:19], a[104:107], v[196:199]
    ds_read_b64_tr_b16 v[36:37], v93 offset:8192
    v_fma_f32 v119, -v191, v191, s0
    v_mfma_f32_16x16x32_bf16 v[212:215], v[20:23], a[104:107], v[212:215]
    ds_read_b64_tr_b16 v[38:39], v93 offset:8704
    v_mul_f32 v112, v112, v172
    v_mfma_f32_16x16x32_bf16 v[200:203], v[16:19], a[168:171], v[200:203]
    ds_read_b64_tr_b16 v[40:41], v94 offset:8192
    v_mul_f32 v113, v113, v173
    v_mfma_f32_16x16x32_bf16 v[216:219], v[20:23], a[168:171], v[216:219]
    ds_read_b64_tr_b16 v[42:43], v94 offset:8704
    v_mul_f32 v114, v114, v174
    v_mfma_f32_16x16x32_bf16 v[204:207], v[16:19], a[232:235], v[204:207]
    ds_read_b64_tr_b16 v[44:45], v95 offset:8192
    v_mfma_f32_16x16x32_bf16 v[220:223], v[20:23], a[232:235], v[220:223]
    ds_read_b64_tr_b16 v[46:47], v95 offset:8704
    v_mul_f32 v115, v115, v175
    v_mfma_f32_16x16x32_bf16 v[236:239], v[24:27], a[232:235], v[236:239]
    v_mul_f32 v116, v116, v188
    v_mul_f32 v117, v117, v189
    v_mfma_f32_16x16x32_bf16 v[252:255], v[28:31], a[232:235], v[252:255]
    s_add_u32 m0, s6, 4096
    s_xor_b32 s7, s20, 983040
    buffer_load_dwordx4 v80, s[96:99], s7 offen offset:0 lds
    v_mul_f32 v118, v118, v190
    v_mfma_f32_16x16x32_bf16 v[232:235], v[24:27], a[168:171], v[232:235]
    v_mul_f32 v119, v119, v191
    v_mfma_f32_16x16x32_bf16 v[248:251], v[28:31], a[168:171], v[248:251]
    buffer_load_dwordx4 v81, s[96:99], s7 offen offset:1024 lds
    v_exp_f32 v112, v112
    v_mfma_f32_16x16x32_bf16 v[228:231], v[24:27], a[104:107], v[228:231]
    v_exp_f32 v113, v113
    v_mfma_f32_16x16x32_bf16 v[244:247], v[28:31], a[104:107], v[244:247]
    buffer_load_dwordx4 v82, s[96:99], s7 offen offset:2048 lds
    v_mfma_f32_16x16x32_bf16 v[224:227], v[24:27], a[40:43], v[224:227]
    v_exp_f32 v114, v114
    v_mfma_f32_16x16x32_bf16 v[240:243], v[28:31], a[40:43], v[240:243]
    buffer_load_dwordx4 v83, s[96:99], s7 offen offset:3072 lds
    s_waitcnt lgkmcnt(0)
    v_mfma_f32_16x16x32_bf16 v[192:195], v[32:35], a[44:47], v[192:195]
    s_waitcnt vmcnt(13)
    ds_read_b64_tr_b16 v[16:17], v92 offset:12288
    v_exp_f32 v115, v115
    v_mfma_f32_16x16x32_bf16 v[208:211], v[36:39], a[44:47], v[208:211]
    ds_read_b64_tr_b16 v[18:19], v92 offset:12800
    v_mfma_f32_16x16x32_bf16 v[196:199], v[32:35], a[108:111], v[196:199]
    ds_read_b64_tr_b16 v[20:21], v93 offset:12288
    v_exp_f32 v116, v116
    v_mfma_f32_16x16x32_bf16 v[212:215], v[36:39], a[108:111], v[212:215]
    ds_read_b64_tr_b16 v[22:23], v93 offset:12800
    v_mfma_f32_16x16x32_bf16 v[200:203], v[32:35], a[172:175], v[200:203]
    ds_read_b64_tr_b16 v[24:25], v94 offset:12288
    v_exp_f32 v117, v117
    v_mfma_f32_16x16x32_bf16 v[216:219], v[36:39], a[172:175], v[216:219]
    ds_read_b64_tr_b16 v[26:27], v94 offset:12800
    v_mfma_f32_16x16x32_bf16 v[204:207], v[32:35], a[236:239], v[204:207]
    ds_read_b64_tr_b16 v[28:29], v95 offset:12288
    v_exp_f32 v118, v118
    v_mfma_f32_16x16x32_bf16 v[220:223], v[36:39], a[236:239], v[220:223]
    ds_read_b64_tr_b16 v[30:31], v95 offset:12800
    v_mfma_f32_16x16x32_bf16 v[236:239], v[40:43], a[236:239], v[236:239]
    v_exp_f32 v119, v119
    v_fma_f32 v112, v112, s1, s1
    v_mfma_f32_16x16x32_bf16 v[252:255], v[44:47], a[236:239], v[252:255]
    s_add_u32 m0, s6, 8192
    s_xor_b32 s7, s20, 128
    buffer_load_dwordx4 v80, s[96:99], s7 offen offset:0 lds
    v_mfma_f32_16x16x32_bf16 v[232:235], v[40:43], a[172:175], v[232:235]
    v_fma_f32 v113, v113, s1, s1
    v_fma_f32 v114, v114, s1, s1
    v_mfma_f32_16x16x32_bf16 v[248:251], v[44:47], a[172:175], v[248:251]
    buffer_load_dwordx4 v81, s[96:99], s7 offen offset:1024 lds
    v_fma_f32 v115, v115, s1, s1
    v_mfma_f32_16x16x32_bf16 v[228:231], v[40:43], a[108:111], v[228:231]
    v_fma_f32 v116, v116, s1, s1
    v_fma_f32 v117, v117, s1, s1
    v_mfma_f32_16x16x32_bf16 v[244:247], v[44:47], a[108:111], v[244:247]
    buffer_load_dwordx4 v82, s[96:99], s7 offen offset:2048 lds
    v_fma_f32 v118, v118, s1, s1
    v_mfma_f32_16x16x32_bf16 v[224:227], v[40:43], a[44:47], v[224:227]
    v_fma_f32 v119, v119, s1, s1
    v_mfma_f32_16x16x32_bf16 v[240:243], v[44:47], a[44:47], v[240:243]
    buffer_load_dwordx4 v83, s[96:99], s7 offen offset:3072 lds
    v_rcp_f32 v112, v112
    s_waitcnt lgkmcnt(0)
    v_mfma_f32_16x16x32_bf16 v[192:195], v[16:19], a[48:51], v[192:195]
    s_waitcnt vmcnt(13)
    ds_read_b64_tr_b16 v[32:33], v92 offset:16384
    v_mfma_f32_16x16x32_bf16 v[208:211], v[20:23], a[48:51], v[208:211]
    ds_read_b64_tr_b16 v[34:35], v92 offset:16896
    v_rcp_f32 v113, v113
    v_mfma_f32_16x16x32_bf16 v[196:199], v[16:19], a[112:115], v[196:199]
    ds_read_b64_tr_b16 v[36:37], v93 offset:16384
    v_mfma_f32_16x16x32_bf16 v[212:215], v[20:23], a[112:115], v[212:215]
    ds_read_b64_tr_b16 v[38:39], v93 offset:16896
    v_mfma_f32_16x16x32_bf16 v[200:203], v[16:19], a[176:179], v[200:203]
    ds_read_b64_tr_b16 v[40:41], v94 offset:16384
    v_rcp_f32 v114, v114
    v_mfma_f32_16x16x32_bf16 v[216:219], v[20:23], a[176:179], v[216:219]
    ds_read_b64_tr_b16 v[42:43], v94 offset:16896
    v_mfma_f32_16x16x32_bf16 v[204:207], v[16:19], a[240:243], v[204:207]
    ds_read_b64_tr_b16 v[44:45], v95 offset:16384
    v_rcp_f32 v115, v115
    v_mfma_f32_16x16x32_bf16 v[220:223], v[20:23], a[240:243], v[220:223]
    ds_read_b64_tr_b16 v[46:47], v95 offset:16896
    v_mfma_f32_16x16x32_bf16 v[236:239], v[24:27], a[240:243], v[236:239]
    v_rcp_f32 v116, v116
    v_mfma_f32_16x16x32_bf16 v[252:255], v[28:31], a[240:243], v[252:255]
    s_add_u32 m0, s6, 12288
    s_xor_b32 s7, s20, 65664
    buffer_load_dwordx4 v80, s[96:99], s7 offen offset:0 lds
    v_rcp_f32 v117, v117
    v_mfma_f32_16x16x32_bf16 v[232:235], v[24:27], a[176:179], v[232:235]
    v_rcp_f32 v118, v118
    v_mfma_f32_16x16x32_bf16 v[248:251], v[28:31], a[176:179], v[248:251]
    buffer_load_dwordx4 v81, s[96:99], s7 offen offset:1024 lds
    v_mfma_f32_16x16x32_bf16 v[228:231], v[24:27], a[112:115], v[228:231]
    v_rcp_f32 v119, v119
    v_mfma_f32_16x16x32_bf16 v[244:247], v[28:31], a[112:115], v[244:247]
    buffer_load_dwordx4 v82, s[96:99], s7 offen offset:2048 lds
    v_mul_f32 v172, v112, v172
    v_mfma_f32_16x16x32_bf16 v[224:227], v[24:27], a[48:51], v[224:227]
    v_mul_f32 v173, v113, v173
    v_mul_f32 v174, v114, v174
    v_mfma_f32_16x16x32_bf16 v[240:243], v[28:31], a[48:51], v[240:243]
    buffer_load_dwordx4 v83, s[96:99], s7 offen offset:3072 lds
    v_mul_f32 v175, v115, v175
    s_waitcnt lgkmcnt(0)
    v_mfma_f32_16x16x32_bf16 v[192:195], v[32:35], a[52:55], v[192:195]
    s_waitcnt vmcnt(12)
    ds_read_b64_tr_b16 v[16:17], v92 offset:0
    v_mul_f32 v188, v116, v188
    v_mfma_f32_16x16x32_bf16 v[208:211], v[36:39], a[52:55], v[208:211]
    ds_read_b64_tr_b16 v[18:19], v92 offset:512
    v_mul_f32 v189, v117, v189
    v_mfma_f32_16x16x32_bf16 v[196:199], v[32:35], a[116:119], v[196:199]
    ds_read_b64_tr_b16 v[20:21], v93 offset:0
    v_mul_f32 v190, v118, v190
    v_mfma_f32_16x16x32_bf16 v[212:215], v[36:39], a[116:119], v[212:215]
    ds_read_b64_tr_b16 v[22:23], v93 offset:512
    v_mul_f32 v191, v119, v191
    v_mfma_f32_16x16x32_bf16 v[200:203], v[32:35], a[180:183], v[200:203]
    ds_read_b64_tr_b16 v[24:25], v94 offset:0
    v_cvt_pk_bf16_f32 v124, v172, v173
    v_mfma_f32_16x16x32_bf16 v[216:219], v[36:39], a[180:183], v[216:219]
    ds_read_b64_tr_b16 v[26:27], v94 offset:512
    v_cvt_pk_bf16_f32 v125, v174, v175
    v_mfma_f32_16x16x32_bf16 v[204:207], v[32:35], a[244:247], v[204:207]
    ds_read_b64_tr_b16 v[28:29], v95 offset:0
    v_mfma_f32_16x16x32_bf16 v[220:223], v[36:39], a[244:247], v[220:223]
    ds_read_b64_tr_b16 v[30:31], v95 offset:512
    v_cvt_pk_bf16_f32 v126, v188, v189
    v_mfma_f32_16x16x32_bf16 v[236:239], v[40:43], a[244:247], v[236:239]
    v_cvt_pk_bf16_f32 v127, v190, v191
    v_add_f32 v140, v140, v172
    v_mfma_f32_16x16x32_bf16 v[252:255], v[44:47], a[244:247], v[252:255]
    s_add_u32 m0, s6, 16384
    s_xor_b32 s7, s20, 131200
    buffer_load_dwordx4 v80, s[96:99], s7 offen offset:0 lds
    v_fmac_f32 v141, v172, v172
    v_mfma_f32_16x16x32_bf16 v[232:235], v[40:43], a[180:183], v[232:235]
    v_add_f32 v140, v140, v173
    v_fmac_f32 v141, v173, v173
    v_mfma_f32_16x16x32_bf16 v[248:251], v[44:47], a[180:183], v[248:251]
    buffer_load_dwordx4 v81, s[96:99], s7 offen offset:1024 lds
    v_add_f32 v140, v140, v174
    v_mfma_f32_16x16x32_bf16 v[228:231], v[40:43], a[116:119], v[228:231]
    v_fmac_f32 v141, v174, v174
    v_add_f32 v140, v140, v175
    v_mfma_f32_16x16x32_bf16 v[244:247], v[44:47], a[116:119], v[244:247]
    buffer_load_dwordx4 v82, s[96:99], s7 offen offset:2048 lds
    v_fmac_f32 v141, v175, v175
    v_mfma_f32_16x16x32_bf16 v[224:227], v[40:43], a[52:55], v[224:227]
    v_add_f32 v140, v140, v188
    v_mfma_f32_16x16x32_bf16 v[240:243], v[44:47], a[52:55], v[240:243]
    buffer_load_dwordx4 v83, s[96:99], s7 offen offset:3072 lds
    v_fmac_f32 v141, v188, v188
    s_waitcnt lgkmcnt(0)
    v_mfma_f32_16x16x32_bf16 v[192:195], v[16:19], a[56:59], v[192:195]
    s_waitcnt vmcnt(12)
    ds_read_b64_tr_b16 v[32:33], v92 offset:4096
    v_add_f32 v140, v140, v189
    v_mfma_f32_16x16x32_bf16 v[208:211], v[20:23], a[56:59], v[208:211]
    ds_read_b64_tr_b16 v[34:35], v92 offset:4608
    v_fmac_f32 v141, v189, v189
    v_mfma_f32_16x16x32_bf16 v[196:199], v[16:19], a[120:123], v[196:199]
    ds_read_b64_tr_b16 v[36:37], v93 offset:4096
    v_add_f32 v140, v140, v190
    v_mfma_f32_16x16x32_bf16 v[212:215], v[20:23], a[120:123], v[212:215]
    ds_read_b64_tr_b16 v[38:39], v93 offset:4608
    v_fmac_f32 v141, v190, v190
    v_mfma_f32_16x16x32_bf16 v[200:203], v[16:19], a[184:187], v[200:203]
    ds_read_b64_tr_b16 v[40:41], v94 offset:4096
    v_add_f32 v140, v140, v191
    v_mfma_f32_16x16x32_bf16 v[216:219], v[20:23], a[184:187], v[216:219]
    ds_read_b64_tr_b16 v[42:43], v94 offset:4608
    v_fmac_f32 v141, v191, v191
    v_mfma_f32_16x16x32_bf16 v[204:207], v[16:19], a[248:251], v[204:207]
    ds_read_b64_tr_b16 v[44:45], v95 offset:4096
    ds_write_b64 v84, v[124:125] offset:64
    v_mfma_f32_16x16x32_bf16 v[220:223], v[20:23], a[248:251], v[220:223]
    ds_read_b64_tr_b16 v[46:47], v95 offset:4608
    ds_write_b64 v84, v[126:127] offset:96
    v_mfma_f32_16x16x32_bf16 v[236:239], v[24:27], a[248:251], v[236:239]
    s_add_u32 s29, s17, 20480
    buffer_store_dwordx4 v[184:187], v86, s[12:15], s29 offen
    ds_read_b128 v[172:175], v85 offset:0
    v_mfma_f32_16x16x32_bf16 v[252:255], v[28:31], a[248:251], v[252:255]
    s_add_u32 m0, s6, 0
    s_xor_b32 s7, s20, 196736
    buffer_load_dwordx4 v80, s[96:99], s7 offen offset:0 lds
    v_mfma_f32_16x16x32_bf16 v[232:235], v[24:27], a[184:187], v[232:235]
    ds_read_b128 v[188:191], v85 offset:1152
    v_permlane16_swap_b32 v128, v132
    v_mfma_f32_16x16x32_bf16 v[248:251], v[28:31], a[184:187], v[248:251]
    buffer_load_dwordx4 v81, s[96:99], s7 offen offset:1024 lds
    v_permlane16_swap_b32 v136, v140
    v_mfma_f32_16x16x32_bf16 v[228:231], v[24:27], a[120:123], v[228:231]
    v_permlane16_swap_b32 v129, v133
    v_permlane16_swap_b32 v137, v141
    v_mfma_f32_16x16x32_bf16 v[244:247], v[28:31], a[120:123], v[244:247]
    buffer_load_dwordx4 v82, s[96:99], s7 offen offset:2048 lds
    s_lshl_b32 s43, s22, 2
    v_mfma_f32_16x16x32_bf16 v[224:227], v[24:27], a[56:59], v[224:227]
    v_add_f32 v128, v128, v132
    v_add_f32 v136, v136, v140
    v_mfma_f32_16x16x32_bf16 v[240:243], v[28:31], a[56:59], v[240:243]
    buffer_load_dwordx4 v83, s[96:99], s7 offen offset:3072 lds
    v_add_f32 v129, v129, v133
    s_waitcnt lgkmcnt(3)
    v_mfma_f32_16x16x32_bf16 v[192:195], v[32:35], a[60:63], v[192:195]
    s_waitcnt vmcnt(13)
    ds_read_b64_tr_b16 v[16:17], v92 offset:8192
    v_add_f32 v137, v137, v141
    v_mfma_f32_16x16x32_bf16 v[208:211], v[36:39], a[60:63], v[208:211]
    ds_read_b64_tr_b16 v[18:19], v92 offset:8704
    s_add_u32 s43, s43, s16
    v_mfma_f32_16x16x32_bf16 v[196:199], v[32:35], a[124:127], v[196:199]
    ds_read_b64_tr_b16 v[20:21], v93 offset:8192
    v_mfma_f32_16x16x32_bf16 v[212:215], v[36:39], a[124:127], v[212:215]
    ds_read_b64_tr_b16 v[22:23], v93 offset:8704
    s_lshl_b32 s43, s43, 9
    v_mfma_f32_16x16x32_bf16 v[200:203], v[32:35], a[188:191], v[200:203]
    ds_read_b64_tr_b16 v[24:25], v94 offset:8192
    v_permlane32_swap_b32 v128, v136
    v_mfma_f32_16x16x32_bf16 v[216:219], v[36:39], a[188:191], v[216:219]
    ds_read_b64_tr_b16 v[26:27], v94 offset:8704
    v_permlane32_swap_b32 v129, v137
    v_mfma_f32_16x16x32_bf16 v[204:207], v[32:35], a[252:255], v[204:207]
    ds_read_b64_tr_b16 v[28:29], v95 offset:8192
    s_lshr_b32 s29, s31, 1
    s_lshl_b32 s29, s29, 12
    s_add_u32 s43, s43, s29
    v_mfma_f32_16x16x32_bf16 v[220:223], v[36:39], a[252:255], v[220:223]
    ds_read_b64_tr_b16 v[30:31], v95 offset:8704
    v_add_f32 v112, v128, v136
    v_mfma_f32_16x16x32_bf16 v[236:239], v[40:43], a[252:255], v[236:239]
    v_add_f32 v113, v129, v137
    s_add_u32 s43, s43, 59244544
    v_mfma_f32_16x16x32_bf16 v[252:255], v[44:47], a[252:255], v[252:255]
    s_add_u32 m0, s6, 4096
    s_xor_b32 s7, s20, 262272
    buffer_load_dwordx4 v80, s[96:99], s7 offen offset:0 lds
    v_lshlrev_b32 v114, 3, v2
    v_mfma_f32_16x16x32_bf16 v[232:235], v[40:43], a[188:191], v[232:235]
    buffer_store_dwordx2 v[112:113], v114, s[12:15], s43 offen sc1
    s_add_u32 s29, s17, 24576
    s_waitcnt lgkmcnt(9)
    buffer_store_dwordx4 v[172:175], v86, s[12:15], s29 offen
    v_mfma_f32_16x16x32_bf16 v[248:251], v[44:47], a[188:191], v[248:251]
    buffer_load_dwordx4 v81, s[96:99], s7 offen offset:1024 lds
    s_add_u32 s29, s17, 28672
    s_waitcnt lgkmcnt(8)
    buffer_store_dwordx4 v[188:191], v86, s[12:15], s29 offen sc1
    v_mfma_f32_16x16x32_bf16 v[228:231], v[40:43], a[124:127], v[228:231]
    v_mfma_f32_16x16x32_bf16 v[244:247], v[44:47], a[124:127], v[244:247]
    buffer_load_dwordx4 v82, s[96:99], s7 offen offset:2048 lds
    v_mfma_f32_16x16x32_bf16 v[224:227], v[40:43], a[60:63], v[224:227]
    v_mfma_f32_16x16x32_bf16 v[240:243], v[44:47], a[60:63], v[240:243]
    buffer_load_dwordx4 v83, s[96:99], s7 offen offset:3072 lds
    s_lshl_b32 s26, s16, 7
    s_add_u32 s17, s17, s26
    s_sub_u32 s17, s17, 512
    s_waitcnt lgkmcnt(0)
    v_mfma_f32_16x16x32_bf16 v[128:131], v[16:19], a[0:3], 0
    s_waitcnt vmcnt(16)
    ds_read_b64_tr_b16 v[32:33], v92 offset:12288
    v_mfma_f32_16x16x32_bf16 v[144:147], v[20:23], a[0:3], 0
    ds_read_b64_tr_b16 v[34:35], v92 offset:12800
    v_mfma_f32_16x16x32_bf16 v[132:135], v[16:19], a[64:67], 0
    ds_read_b64_tr_b16 v[36:37], v93 offset:12288
    v_mfma_f32_16x16x32_bf16 v[148:151], v[20:23], a[64:67], 0
    ds_read_b64_tr_b16 v[38:39], v93 offset:12800
    v_mfma_f32_16x16x32_bf16 v[136:139], v[16:19], a[128:131], 0
    ds_read_b64_tr_b16 v[40:41], v94 offset:12288
    v_mfma_f32_16x16x32_bf16 v[152:155], v[20:23], a[128:131], 0
    ds_read_b64_tr_b16 v[42:43], v94 offset:12800
    v_mfma_f32_16x16x32_bf16 v[140:143], v[16:19], a[192:195], 0
    ds_read_b64_tr_b16 v[44:45], v95 offset:12288
    v_mfma_f32_16x16x32_bf16 v[156:159], v[20:23], a[192:195], 0
    ds_read_b64_tr_b16 v[46:47], v95 offset:12800
    v_mfma_f32_16x16x32_bf16 v[172:175], v[24:27], a[192:195], 0
    v_mfma_f32_16x16x32_bf16 v[188:191], v[28:31], a[192:195], 0
    s_add_u32 m0, s6, 8192
    s_xor_b32 s7, s20, 327808
    buffer_load_dwordx4 v80, s[96:99], s7 offen offset:0 lds
    v_mfma_f32_16x16x32_bf16 v[168:171], v[24:27], a[128:131], 0
    v_fma_f32 v112, -v192, v192, s0
    v_mfma_f32_16x16x32_bf16 v[184:187], v[28:31], a[128:131], 0
    buffer_load_dwordx4 v81, s[96:99], s7 offen offset:1024 lds
    v_fma_f32 v113, -v193, v193, s0
    v_mfma_f32_16x16x32_bf16 v[164:167], v[24:27], a[64:67], 0
    v_fma_f32 v114, -v194, v194, s0
    v_fma_f32 v115, -v195, v195, s0
    v_mfma_f32_16x16x32_bf16 v[180:183], v[28:31], a[64:67], 0
    buffer_load_dwordx4 v82, s[96:99], s7 offen offset:2048 lds
    v_fma_f32 v116, -v208, v208, s0
    v_mfma_f32_16x16x32_bf16 v[160:163], v[24:27], a[0:3], 0
    v_fma_f32 v117, -v209, v209, s0
    v_fma_f32 v118, -v210, v210, s0
    v_mfma_f32_16x16x32_bf16 v[176:179], v[28:31], a[0:3], 0
    buffer_load_dwordx4 v83, s[96:99], s7 offen offset:3072 lds
    v_fma_f32 v119, -v211, v211, s0
    s_waitcnt lgkmcnt(0)
    v_mfma_f32_16x16x32_bf16 v[128:131], v[32:35], a[4:7], v[128:131]
    s_waitcnt vmcnt(16)
    ds_read_b64_tr_b16 v[16:17], v92 offset:16384
    v_mul_f32 v112, v112, v192
    v_mfma_f32_16x16x32_bf16 v[144:147], v[36:39], a[4:7], v[144:147]
    ds_read_b64_tr_b16 v[18:19], v92 offset:16896
    v_mul_f32 v113, v113, v193
    v_mfma_f32_16x16x32_bf16 v[132:135], v[32:35], a[68:71], v[132:135]
    ds_read_b64_tr_b16 v[20:21], v93 offset:16384
    v_mfma_f32_16x16x32_bf16 v[148:151], v[36:39], a[68:71], v[148:151]
    ds_read_b64_tr_b16 v[22:23], v93 offset:16896
    v_mul_f32 v114, v114, v194
    v_mfma_f32_16x16x32_bf16 v[136:139], v[32:35], a[132:135], v[136:139]
    ds_read_b64_tr_b16 v[24:25], v94 offset:16384
    v_mul_f32 v115, v115, v195
    v_mfma_f32_16x16x32_bf16 v[152:155], v[36:39], a[132:135], v[152:155]
    ds_read_b64_tr_b16 v[26:27], v94 offset:16896
    v_mul_f32 v116, v116, v208
    v_mfma_f32_16x16x32_bf16 v[140:143], v[32:35], a[196:199], v[140:143]
    ds_read_b64_tr_b16 v[28:29], v95 offset:16384
    v_mul_f32 v117, v117, v209
    v_mfma_f32_16x16x32_bf16 v[156:159], v[36:39], a[196:199], v[156:159]
    ds_read_b64_tr_b16 v[30:31], v95 offset:16896
    v_mul_f32 v118, v118, v210
    v_mfma_f32_16x16x32_bf16 v[172:175], v[40:43], a[196:199], v[172:175]
    v_mul_f32 v119, v119, v211
    v_mfma_f32_16x16x32_bf16 v[188:191], v[44:47], a[196:199], v[188:191]
    s_add_u32 m0, s6, 12288
    s_xor_b32 s7, s20, 393344
    buffer_load_dwordx4 v80, s[96:99], s7 offen offset:0 lds
    v_exp_f32 v112, v112
    v_mfma_f32_16x16x32_bf16 v[168:171], v[40:43], a[132:135], v[168:171]
    v_exp_f32 v113, v113
    v_mfma_f32_16x16x32_bf16 v[184:187], v[44:47], a[132:135], v[184:187]
    buffer_load_dwordx4 v81, s[96:99], s7 offen offset:1024 lds
    v_mfma_f32_16x16x32_bf16 v[164:167], v[40:43], a[68:71], v[164:167]
    v_exp_f32 v114, v114
    v_mfma_f32_16x16x32_bf16 v[180:183], v[44:47], a[68:71], v[180:183]
    buffer_load_dwordx4 v82, s[96:99], s7 offen offset:2048 lds
    v_mfma_f32_16x16x32_bf16 v[160:163], v[40:43], a[4:7], v[160:163]
    v_exp_f32 v115, v115
    v_mfma_f32_16x16x32_bf16 v[176:179], v[44:47], a[4:7], v[176:179]
    buffer_load_dwordx4 v83, s[96:99], s7 offen offset:3072 lds
    v_exp_f32 v116, v116
    s_waitcnt lgkmcnt(0)
    v_mfma_f32_16x16x32_bf16 v[128:131], v[16:19], a[8:11], v[128:131]
    s_waitcnt vmcnt(15)
    ds_read_b64_tr_b16 v[32:33], v92 offset:0
    v_mfma_f32_16x16x32_bf16 v[144:147], v[20:23], a[8:11], v[144:147]
    ds_read_b64_tr_b16 v[34:35], v92 offset:512
    v_exp_f32 v117, v117
    v_mfma_f32_16x16x32_bf16 v[132:135], v[16:19], a[72:75], v[132:135]
    ds_read_b64_tr_b16 v[36:37], v93 offset:0
    v_mfma_f32_16x16x32_bf16 v[148:151], v[20:23], a[72:75], v[148:151]
    ds_read_b64_tr_b16 v[38:39], v93 offset:512
    v_exp_f32 v118, v118
    v_mfma_f32_16x16x32_bf16 v[136:139], v[16:19], a[136:139], v[136:139]
    ds_read_b64_tr_b16 v[40:41], v94 offset:0
    v_mfma_f32_16x16x32_bf16 v[152:155], v[20:23], a[136:139], v[152:155]
    ds_read_b64_tr_b16 v[42:43], v94 offset:512
    v_mfma_f32_16x16x32_bf16 v[140:143], v[16:19], a[200:203], v[140:143]
    ds_read_b64_tr_b16 v[44:45], v95 offset:0
    v_exp_f32 v119, v119
    v_mfma_f32_16x16x32_bf16 v[156:159], v[20:23], a[200:203], v[156:159]
    ds_read_b64_tr_b16 v[46:47], v95 offset:512
    v_fma_f32 v112, v112, s1, s1
    v_mfma_f32_16x16x32_bf16 v[172:175], v[24:27], a[200:203], v[172:175]
    v_fma_f32 v113, v113, s1, s1
    v_fma_f32 v114, v114, s1, s1
    v_mfma_f32_16x16x32_bf16 v[188:191], v[28:31], a[200:203], v[188:191]
    s_add_u32 m0, s6, 16384
    s_xor_b32 s7, s20, 458880
    buffer_load_dwordx4 v80, s[96:99], s7 offen offset:0 lds
    v_fma_f32 v115, v115, s1, s1
    v_mfma_f32_16x16x32_bf16 v[168:171], v[24:27], a[136:139], v[168:171]
    v_fma_f32 v116, v116, s1, s1
    v_fma_f32 v117, v117, s1, s1
    v_mfma_f32_16x16x32_bf16 v[184:187], v[28:31], a[136:139], v[184:187]
    buffer_load_dwordx4 v81, s[96:99], s7 offen offset:1024 lds
    v_fma_f32 v118, v118, s1, s1
    v_mfma_f32_16x16x32_bf16 v[164:167], v[24:27], a[72:75], v[164:167]
    v_fma_f32 v119, v119, s1, s1
    v_mfma_f32_16x16x32_bf16 v[180:183], v[28:31], a[72:75], v[180:183]
    buffer_load_dwordx4 v82, s[96:99], s7 offen offset:2048 lds
    v_rcp_f32 v112, v112
    v_mfma_f32_16x16x32_bf16 v[160:163], v[24:27], a[8:11], v[160:163]
    v_mfma_f32_16x16x32_bf16 v[176:179], v[28:31], a[8:11], v[176:179]
    buffer_load_dwordx4 v83, s[96:99], s7 offen offset:3072 lds
    v_rcp_f32 v113, v113
    s_waitcnt lgkmcnt(0)
    v_mfma_f32_16x16x32_bf16 v[128:131], v[32:35], a[12:15], v[128:131]
    s_waitcnt vmcnt(12)
    ds_read_b64_tr_b16 v[16:17], v92 offset:4096
    v_mfma_f32_16x16x32_bf16 v[144:147], v[36:39], a[12:15], v[144:147]
    ds_read_b64_tr_b16 v[18:19], v92 offset:4608
    v_rcp_f32 v114, v114
    v_mfma_f32_16x16x32_bf16 v[132:135], v[32:35], a[76:79], v[132:135]
    ds_read_b64_tr_b16 v[20:21], v93 offset:4096
    v_mfma_f32_16x16x32_bf16 v[148:151], v[36:39], a[76:79], v[148:151]
    ds_read_b64_tr_b16 v[22:23], v93 offset:4608
    v_rcp_f32 v115, v115
    v_mfma_f32_16x16x32_bf16 v[136:139], v[32:35], a[140:143], v[136:139]
    ds_read_b64_tr_b16 v[24:25], v94 offset:4096
    v_mfma_f32_16x16x32_bf16 v[152:155], v[36:39], a[140:143], v[152:155]
    ds_read_b64_tr_b16 v[26:27], v94 offset:4608
    v_rcp_f32 v116, v116
    v_mfma_f32_16x16x32_bf16 v[140:143], v[32:35], a[204:207], v[140:143]
    ds_read_b64_tr_b16 v[28:29], v95 offset:4096
    v_mfma_f32_16x16x32_bf16 v[156:159], v[36:39], a[204:207], v[156:159]
    ds_read_b64_tr_b16 v[30:31], v95 offset:4608
    v_rcp_f32 v117, v117
    v_mfma_f32_16x16x32_bf16 v[172:175], v[40:43], a[204:207], v[172:175]
    v_mfma_f32_16x16x32_bf16 v[188:191], v[44:47], a[204:207], v[188:191]
    s_add_u32 m0, s6, 0
    s_xor_b32 s7, s20, 524416
    buffer_load_dwordx4 v80, s[96:99], s7 offen offset:0 lds
    v_rcp_f32 v118, v118
    v_mfma_f32_16x16x32_bf16 v[168:171], v[40:43], a[140:143], v[168:171]
    v_rcp_f32 v119, v119
    v_mfma_f32_16x16x32_bf16 v[184:187], v[44:47], a[140:143], v[184:187]
    buffer_load_dwordx4 v81, s[96:99], s7 offen offset:1024 lds
    v_mul_f32 v192, v112, v192
    v_mfma_f32_16x16x32_bf16 v[164:167], v[40:43], a[76:79], v[164:167]
    v_mul_f32 v193, v113, v193
    v_mul_f32 v194, v114, v194
    v_mfma_f32_16x16x32_bf16 v[180:183], v[44:47], a[76:79], v[180:183]
    buffer_load_dwordx4 v82, s[96:99], s7 offen offset:2048 lds
    v_mul_f32 v195, v115, v195
    v_mfma_f32_16x16x32_bf16 v[160:163], v[40:43], a[12:15], v[160:163]
    v_mul_f32 v208, v116, v208
    v_mul_f32 v209, v117, v209
    v_mfma_f32_16x16x32_bf16 v[176:179], v[44:47], a[12:15], v[176:179]
    buffer_load_dwordx4 v83, s[96:99], s7 offen offset:3072 lds
    v_mul_f32 v210, v118, v210
    s_waitcnt lgkmcnt(0)
    v_mfma_f32_16x16x32_bf16 v[128:131], v[16:19], a[16:19], v[128:131]
    s_waitcnt vmcnt(12)
    ds_read_b64_tr_b16 v[32:33], v92 offset:8192
    v_mfma_f32_16x16x32_bf16 v[144:147], v[20:23], a[16:19], v[144:147]
    ds_read_b64_tr_b16 v[34:35], v92 offset:8704
    v_mul_f32 v211, v119, v211
    v_mfma_f32_16x16x32_bf16 v[132:135], v[16:19], a[80:83], v[132:135]
    ds_read_b64_tr_b16 v[36:37], v93 offset:8192
    v_cvt_pk_bf16_f32 v120, v192, v193
    v_mfma_f32_16x16x32_bf16 v[148:151], v[20:23], a[80:83], v[148:151]
    ds_read_b64_tr_b16 v[38:39], v93 offset:8704
    v_cvt_pk_bf16_f32 v121, v194, v195
    v_mfma_f32_16x16x32_bf16 v[136:139], v[16:19], a[144:147], v[136:139]
    ds_read_b64_tr_b16 v[40:41], v94 offset:8192
    v_cvt_pk_bf16_f32 v122, v208, v209
    v_mfma_f32_16x16x32_bf16 v[152:155], v[20:23], a[144:147], v[152:155]
    ds_read_b64_tr_b16 v[42:43], v94 offset:8704
    v_cvt_pk_bf16_f32 v123, v210, v211
    v_mfma_f32_16x16x32_bf16 v[140:143], v[16:19], a[208:211], v[140:143]
    ds_read_b64_tr_b16 v[44:45], v95 offset:8192
    ds_write_b64 v84, v[120:121] offset:0
    v_mfma_f32_16x16x32_bf16 v[156:159], v[20:23], a[208:211], v[156:159]
    ds_read_b64_tr_b16 v[46:47], v95 offset:8704
    ds_write_b64 v84, v[122:123] offset:32
    v_mfma_f32_16x16x32_bf16 v[172:175], v[24:27], a[208:211], v[172:175]
    v_fma_f32 v112, -v224, v224, s0
    v_fma_f32 v113, -v225, v225, s0
    v_mfma_f32_16x16x32_bf16 v[188:191], v[28:31], a[208:211], v[188:191]
    s_add_u32 m0, s6, 4096
    s_xor_b32 s7, s20, 589952
    buffer_load_dwordx4 v80, s[96:99], s7 offen offset:0 lds
    v_fma_f32 v114, -v226, v226, s0
    v_mfma_f32_16x16x32_bf16 v[168:171], v[24:27], a[144:147], v[168:171]
    v_fma_f32 v115, -v227, v227, s0
    v_mfma_f32_16x16x32_bf16 v[184:187], v[28:31], a[144:147], v[184:187]
    buffer_load_dwordx4 v81, s[96:99], s7 offen offset:1024 lds
    v_fma_f32 v116, -v240, v240, s0
    v_mfma_f32_16x16x32_bf16 v[164:167], v[24:27], a[80:83], v[164:167]
    v_fma_f32 v117, -v241, v241, s0
    v_fma_f32 v118, -v242, v242, s0
    v_mfma_f32_16x16x32_bf16 v[180:183], v[28:31], a[80:83], v[180:183]
    buffer_load_dwordx4 v82, s[96:99], s7 offen offset:2048 lds
    v_fma_f32 v119, -v243, v243, s0
    v_mfma_f32_16x16x32_bf16 v[160:163], v[24:27], a[16:19], v[160:163]
    v_mul_f32 v112, v112, v224
    v_mul_f32 v113, v113, v225
    v_mfma_f32_16x16x32_bf16 v[176:179], v[28:31], a[16:19], v[176:179]
    buffer_load_dwordx4 v83, s[96:99], s7 offen offset:3072 lds
    v_mul_f32 v114, v114, v226
    s_waitcnt lgkmcnt(1)
    v_mfma_f32_16x16x32_bf16 v[128:131], v[32:35], a[20:23], v[128:131]
    s_waitcnt vmcnt(12)
    ds_read_b64_tr_b16 v[16:17], v92 offset:12288
    v_mul_f32 v115, v115, v227
    v_mfma_f32_16x16x32_bf16 v[144:147], v[36:39], a[20:23], v[144:147]
    ds_read_b64_tr_b16 v[18:19], v92 offset:12800
    v_mul_f32 v116, v116, v240
    v_mfma_f32_16x16x32_bf16 v[132:135], v[32:35], a[84:87], v[132:135]
    ds_read_b64_tr_b16 v[20:21], v93 offset:12288
    v_mul_f32 v117, v117, v241
    v_mfma_f32_16x16x32_bf16 v[148:151], v[36:39], a[84:87], v[148:151]
    ds_read_b64_tr_b16 v[22:23], v93 offset:12800
    v_mul_f32 v118, v118, v242
    v_mfma_f32_16x16x32_bf16 v[136:139], v[32:35], a[148:151], v[136:139]
    ds_read_b64_tr_b16 v[24:25], v94 offset:12288
    v_mfma_f32_16x16x32_bf16 v[152:155], v[36:39], a[148:151], v[152:155]
    ds_read_b64_tr_b16 v[26:27], v94 offset:12800
    v_mul_f32 v119, v119, v243
    v_mfma_f32_16x16x32_bf16 v[140:143], v[32:35], a[212:215], v[140:143]
    ds_read_b64_tr_b16 v[28:29], v95 offset:12288
    v_mfma_f32_16x16x32_bf16 v[156:159], v[36:39], a[212:215], v[156:159]
    ds_read_b64_tr_b16 v[30:31], v95 offset:12800
    v_exp_f32 v112, v112
    v_mfma_f32_16x16x32_bf16 v[172:175], v[40:43], a[212:215], v[172:175]
    v_exp_f32 v113, v113
    v_mfma_f32_16x16x32_bf16 v[188:191], v[44:47], a[212:215], v[188:191]
    s_add_u32 m0, s6, 8192
    s_xor_b32 s7, s20, 655488
    buffer_load_dwordx4 v80, s[96:99], s7 offen offset:0 lds
    v_mfma_f32_16x16x32_bf16 v[168:171], v[40:43], a[148:151], v[168:171]
    v_exp_f32 v114, v114
    v_mfma_f32_16x16x32_bf16 v[184:187], v[44:47], a[148:151], v[184:187]
    buffer_load_dwordx4 v81, s[96:99], s7 offen offset:1024 lds
    v_exp_f32 v115, v115
    v_mfma_f32_16x16x32_bf16 v[164:167], v[40:43], a[84:87], v[164:167]
    v_mfma_f32_16x16x32_bf16 v[180:183], v[44:47], a[84:87], v[180:183]
    buffer_load_dwordx4 v82, s[96:99], s7 offen offset:2048 lds
    v_exp_f32 v116, v116
    v_mfma_f32_16x16x32_bf16 v[160:163], v[40:43], a[20:23], v[160:163]
    v_exp_f32 v117, v117
    v_mfma_f32_16x16x32_bf16 v[176:179], v[44:47], a[20:23], v[176:179]
    buffer_load_dwordx4 v83, s[96:99], s7 offen offset:3072 lds
    s_waitcnt lgkmcnt(0)
    v_mfma_f32_16x16x32_bf16 v[128:131], v[16:19], a[24:27], v[128:131]
    s_waitcnt vmcnt(12)
    ds_read_b64_tr_b16 v[32:33], v92 offset:16384
    v_exp_f32 v118, v118
    v_mfma_f32_16x16x32_bf16 v[144:147], v[20:23], a[24:27], v[144:147]
    ds_read_b64_tr_b16 v[34:35], v92 offset:16896
    v_mfma_f32_16x16x32_bf16 v[132:135], v[16:19], a[88:91], v[132:135]
    ds_read_b64_tr_b16 v[36:37], v93 offset:16384
    v_exp_f32 v119, v119
    v_mfma_f32_16x16x32_bf16 v[148:151], v[20:23], a[88:91], v[148:151]
    ds_read_b64_tr_b16 v[38:39], v93 offset:16896
    v_fma_f32 v112, v112, s1, s1
    v_mfma_f32_16x16x32_bf16 v[136:139], v[16:19], a[152:155], v[136:139]
    ds_read_b64_tr_b16 v[40:41], v94 offset:16384
    v_fma_f32 v113, v113, s1, s1
    v_mfma_f32_16x16x32_bf16 v[152:155], v[20:23], a[152:155], v[152:155]
    ds_read_b64_tr_b16 v[42:43], v94 offset:16896
    v_fma_f32 v114, v114, s1, s1
    v_mfma_f32_16x16x32_bf16 v[140:143], v[16:19], a[216:219], v[140:143]
    ds_read_b64_tr_b16 v[44:45], v95 offset:16384
    v_fma_f32 v115, v115, s1, s1
    v_mfma_f32_16x16x32_bf16 v[156:159], v[20:23], a[216:219], v[156:159]
    ds_read_b64_tr_b16 v[46:47], v95 offset:16896
    v_mfma_f32_16x16x32_bf16 v[172:175], v[24:27], a[216:219], v[172:175]
    v_fma_f32 v116, v116, s1, s1
    v_fma_f32 v117, v117, s1, s1
    v_mfma_f32_16x16x32_bf16 v[188:191], v[28:31], a[216:219], v[188:191]
    s_add_u32 m0, s6, 12288
    s_xor_b32 s7, s20, 721024
    buffer_load_dwordx4 v80, s[96:99], s7 offen offset:0 lds
    v_fma_f32 v118, v118, s1, s1
    v_mfma_f32_16x16x32_bf16 v[168:171], v[24:27], a[152:155], v[168:171]
    v_fma_f32 v119, v119, s1, s1
    v_mfma_f32_16x16x32_bf16 v[184:187], v[28:31], a[152:155], v[184:187]
    buffer_load_dwordx4 v81, s[96:99], s7 offen offset:1024 lds
    v_rcp_f32 v112, v112
    v_mfma_f32_16x16x32_bf16 v[164:167], v[24:27], a[88:91], v[164:167]
    v_rcp_f32 v113, v113
    v_mfma_f32_16x16x32_bf16 v[180:183], v[28:31], a[88:91], v[180:183]
    buffer_load_dwordx4 v82, s[96:99], s7 offen offset:2048 lds
    v_mfma_f32_16x16x32_bf16 v[160:163], v[24:27], a[24:27], v[160:163]
    v_rcp_f32 v114, v114
    v_mfma_f32_16x16x32_bf16 v[176:179], v[28:31], a[24:27], v[176:179]
    buffer_load_dwordx4 v83, s[96:99], s7 offen offset:3072 lds
    s_waitcnt lgkmcnt(0)
    v_mfma_f32_16x16x32_bf16 v[128:131], v[32:35], a[28:31], v[128:131]
    s_waitcnt vmcnt(12)
    ds_read_b64_tr_b16 v[16:17], v92 offset:0
    v_rcp_f32 v115, v115
    v_mfma_f32_16x16x32_bf16 v[144:147], v[36:39], a[28:31], v[144:147]
    ds_read_b64_tr_b16 v[18:19], v92 offset:512
    v_mfma_f32_16x16x32_bf16 v[132:135], v[32:35], a[92:95], v[132:135]
    ds_read_b64_tr_b16 v[20:21], v93 offset:0
    v_rcp_f32 v116, v116
    v_mfma_f32_16x16x32_bf16 v[148:151], v[36:39], a[92:95], v[148:151]
    ds_read_b64_tr_b16 v[22:23], v93 offset:512
    v_mfma_f32_16x16x32_bf16 v[136:139], v[32:35], a[156:159], v[136:139]
    ds_read_b64_tr_b16 v[24:25], v94 offset:0
    v_rcp_f32 v117, v117
    v_mfma_f32_16x16x32_bf16 v[152:155], v[36:39], a[156:159], v[152:155]
    ds_read_b64_tr_b16 v[26:27], v94 offset:512
    v_mfma_f32_16x16x32_bf16 v[140:143], v[32:35], a[220:223], v[140:143]
    ds_read_b64_tr_b16 v[28:29], v95 offset:0
    v_rcp_f32 v118, v118
    v_mfma_f32_16x16x32_bf16 v[156:159], v[36:39], a[220:223], v[156:159]
    ds_read_b64_tr_b16 v[30:31], v95 offset:512
    v_mfma_f32_16x16x32_bf16 v[172:175], v[40:43], a[220:223], v[172:175]
    v_rcp_f32 v119, v119
    v_mul_f32 v224, v112, v224
    v_mfma_f32_16x16x32_bf16 v[188:191], v[44:47], a[220:223], v[188:191]
    s_add_u32 m0, s6, 16384
    s_xor_b32 s7, s20, 786560
    buffer_load_dwordx4 v80, s[96:99], s7 offen offset:0 lds
    v_mfma_f32_16x16x32_bf16 v[168:171], v[40:43], a[156:159], v[168:171]
    v_mul_f32 v225, v113, v225
    v_mul_f32 v226, v114, v226
    v_mfma_f32_16x16x32_bf16 v[184:187], v[44:47], a[156:159], v[184:187]
    buffer_load_dwordx4 v81, s[96:99], s7 offen offset:1024 lds
    v_mul_f32 v227, v115, v227
    v_mfma_f32_16x16x32_bf16 v[164:167], v[40:43], a[92:95], v[164:167]
    v_mul_f32 v240, v116, v240
    v_mul_f32 v241, v117, v241
    v_mfma_f32_16x16x32_bf16 v[180:183], v[44:47], a[92:95], v[180:183]
    buffer_load_dwordx4 v82, s[96:99], s7 offen offset:2048 lds
    v_mul_f32 v242, v118, v242
    v_mfma_f32_16x16x32_bf16 v[160:163], v[40:43], a[28:31], v[160:163]
    v_mul_f32 v243, v119, v243
    v_cvt_pk_bf16_f32 v124, v224, v225
    v_mfma_f32_16x16x32_bf16 v[176:179], v[44:47], a[28:31], v[176:179]
    buffer_load_dwordx4 v83, s[96:99], s7 offen offset:3072 lds
    v_cvt_pk_bf16_f32 v125, v226, v227
    s_waitcnt lgkmcnt(0)
    v_mfma_f32_16x16x32_bf16 v[128:131], v[16:19], a[32:35], v[128:131]
    s_waitcnt vmcnt(12)
    ds_read_b64_tr_b16 v[32:33], v92 offset:4096
    v_cvt_pk_bf16_f32 v126, v240, v241
    v_mfma_f32_16x16x32_bf16 v[144:147], v[20:23], a[32:35], v[144:147]
    ds_read_b64_tr_b16 v[34:35], v92 offset:4608
    v_cvt_pk_bf16_f32 v127, v242, v243
    v_mfma_f32_16x16x32_bf16 v[132:135], v[16:19], a[96:99], v[132:135]
    ds_read_b64_tr_b16 v[36:37], v93 offset:4096
    v_mfma_f32_16x16x32_bf16 v[148:151], v[20:23], a[96:99], v[148:151]
    ds_read_b64_tr_b16 v[38:39], v93 offset:4608
    ds_write_b64 v84, v[124:125] offset:64
    v_mfma_f32_16x16x32_bf16 v[136:139], v[16:19], a[160:163], v[136:139]
    ds_read_b64_tr_b16 v[40:41], v94 offset:4096
    ds_write_b64 v84, v[126:127] offset:96
    v_mfma_f32_16x16x32_bf16 v[152:155], v[20:23], a[160:163], v[152:155]
    ds_read_b64_tr_b16 v[42:43], v94 offset:4608
    ds_read_b128 v[224:227], v85 offset:0
    v_mfma_f32_16x16x32_bf16 v[140:143], v[16:19], a[224:227], v[140:143]
    ds_read_b64_tr_b16 v[44:45], v95 offset:4096
    ds_read_b128 v[240:243], v85 offset:1152
    v_mfma_f32_16x16x32_bf16 v[156:159], v[20:23], a[224:227], v[156:159]
    ds_read_b64_tr_b16 v[46:47], v95 offset:4608
    v_fma_f32 v112, -v196, v196, s0
    v_mfma_f32_16x16x32_bf16 v[172:175], v[24:27], a[224:227], v[172:175]
    v_fma_f32 v113, -v197, v197, s0
    v_fma_f32 v114, -v198, v198, s0
    v_mfma_f32_16x16x32_bf16 v[188:191], v[28:31], a[224:227], v[188:191]
    s_add_u32 m0, s6, 0
    s_xor_b32 s7, s20, 852096
    buffer_load_dwordx4 v80, s[96:99], s7 offen offset:0 lds
    v_fma_f32 v115, -v199, v199, s0
    v_mfma_f32_16x16x32_bf16 v[168:171], v[24:27], a[160:163], v[168:171]
    v_fma_f32 v116, -v212, v212, s0
    v_fma_f32 v117, -v213, v213, s0
    v_mfma_f32_16x16x32_bf16 v[184:187], v[28:31], a[160:163], v[184:187]
    buffer_load_dwordx4 v81, s[96:99], s7 offen offset:1024 lds
    v_fma_f32 v118, -v214, v214, s0
    v_mfma_f32_16x16x32_bf16 v[164:167], v[24:27], a[96:99], v[164:167]
    v_fma_f32 v119, -v215, v215, s0
    v_mfma_f32_16x16x32_bf16 v[180:183], v[28:31], a[96:99], v[180:183]
    buffer_load_dwordx4 v82, s[96:99], s7 offen offset:2048 lds
    v_mul_f32 v112, v112, v196
    v_mfma_f32_16x16x32_bf16 v[160:163], v[24:27], a[32:35], v[160:163]
    v_mul_f32 v113, v113, v197
    v_mul_f32 v114, v114, v198
    v_mfma_f32_16x16x32_bf16 v[176:179], v[28:31], a[32:35], v[176:179]
    buffer_load_dwordx4 v83, s[96:99], s7 offen offset:3072 lds
    v_mul_f32 v115, v115, v199
    s_waitcnt lgkmcnt(0)
    v_mfma_f32_16x16x32_bf16 v[128:131], v[32:35], a[36:39], v[128:131]
    s_waitcnt vmcnt(12)
    ds_read_b64_tr_b16 v[16:17], v92 offset:8192
    v_mul_f32 v116, v116, v212
    v_mfma_f32_16x16x32_bf16 v[144:147], v[36:39], a[36:39], v[144:147]
    ds_read_b64_tr_b16 v[18:19], v92 offset:8704
    v_mul_f32 v117, v117, v213
    v_mfma_f32_16x16x32_bf16 v[132:135], v[32:35], a[100:103], v[132:135]
    ds_read_b64_tr_b16 v[20:21], v93 offset:8192
    v_mul_f32 v118, v118, v214
    v_mfma_f32_16x16x32_bf16 v[148:151], v[36:39], a[100:103], v[148:151]
    ds_read_b64_tr_b16 v[22:23], v93 offset:8704
    v_mul_f32 v119, v119, v215
    v_mfma_f32_16x16x32_bf16 v[136:139], v[32:35], a[164:167], v[136:139]
    ds_read_b64_tr_b16 v[24:25], v94 offset:8192
    v_mfma_f32_16x16x32_bf16 v[152:155], v[36:39], a[164:167], v[152:155]
    ds_read_b64_tr_b16 v[26:27], v94 offset:8704
    v_mfma_f32_16x16x32_bf16 v[140:143], v[32:35], a[228:231], v[140:143]
    ds_read_b64_tr_b16 v[28:29], v95 offset:8192
    v_exp_f32 v112, v112
    v_mfma_f32_16x16x32_bf16 v[156:159], v[36:39], a[228:231], v[156:159]
    ds_read_b64_tr_b16 v[30:31], v95 offset:8704
    v_mfma_f32_16x16x32_bf16 v[172:175], v[40:43], a[228:231], v[172:175]
    v_exp_f32 v113, v113
    v_mfma_f32_16x16x32_bf16 v[188:191], v[44:47], a[228:231], v[188:191]
    s_add_u32 m0, s6, 4096
    s_xor_b32 s7, s20, 917632
    buffer_load_dwordx4 v80, s[96:99], s7 offen offset:0 lds
    v_exp_f32 v114, v114
    v_mfma_f32_16x16x32_bf16 v[168:171], v[40:43], a[164:167], v[168:171]
    v_exp_f32 v115, v115
    v_mfma_f32_16x16x32_bf16 v[184:187], v[44:47], a[164:167], v[184:187]
    buffer_load_dwordx4 v81, s[96:99], s7 offen offset:1024 lds
    v_mfma_f32_16x16x32_bf16 v[164:167], v[40:43], a[100:103], v[164:167]
    v_exp_f32 v116, v116
    v_mfma_f32_16x16x32_bf16 v[180:183], v[44:47], a[100:103], v[180:183]
    buffer_load_dwordx4 v82, s[96:99], s7 offen offset:2048 lds
    v_exp_f32 v117, v117
    v_mfma_f32_16x16x32_bf16 v[160:163], v[40:43], a[36:39], v[160:163]
    v_mfma_f32_16x16x32_bf16 v[176:179], v[44:47], a[36:39], v[176:179]
    buffer_load_dwordx4 v83, s[96:99], s7 offen offset:3072 lds
    v_exp_f32 v118, v118
    s_waitcnt lgkmcnt(0)
    v_mfma_f32_16x16x32_bf16 v[128:131], v[16:19], a[40:43], v[128:131]
    s_waitcnt vmcnt(12)
    ds_read_b64_tr_b16 v[32:33], v92 offset:12288
    v_mfma_f32_16x16x32_bf16 v[144:147], v[20:23], a[40:43], v[144:147]
    ds_read_b64_tr_b16 v[34:35], v92 offset:12800
    v_exp_f32 v119, v119
    v_mfma_f32_16x16x32_bf16 v[132:135], v[16:19], a[104:107], v[132:135]
    ds_read_b64_tr_b16 v[36:37], v93 offset:12288
    v_fma_f32 v112, v112, s1, s1
    v_mfma_f32_16x16x32_bf16 v[148:151], v[20:23], a[104:107], v[148:151]
    ds_read_b64_tr_b16 v[38:39], v93 offset:12800
    v_fma_f32 v113, v113, s1, s1
    v_mfma_f32_16x16x32_bf16 v[136:139], v[16:19], a[168:171], v[136:139]
    ds_read_b64_tr_b16 v[40:41], v94 offset:12288
    v_fma_f32 v114, v114, s1, s1
    v_mfma_f32_16x16x32_bf16 v[152:155], v[20:23], a[168:171], v[152:155]
    ds_read_b64_tr_b16 v[42:43], v94 offset:12800
    v_fma_f32 v115, v115, s1, s1
    v_mfma_f32_16x16x32_bf16 v[140:143], v[16:19], a[232:235], v[140:143]
    ds_read_b64_tr_b16 v[44:45], v95 offset:12288
    v_fma_f32 v116, v116, s1, s1
    v_mfma_f32_16x16x32_bf16 v[156:159], v[20:23], a[232:235], v[156:159]
    ds_read_b64_tr_b16 v[46:47], v95 offset:12800
    v_fma_f32 v117, v117, s1, s1
    v_mfma_f32_16x16x32_bf16 v[172:175], v[24:27], a[232:235], v[172:175]
    v_fma_f32 v118, v118, s1, s1
    v_mfma_f32_16x16x32_bf16 v[188:191], v[28:31], a[232:235], v[188:191]
    s_add_u32 m0, s6, 8192
    s_xor_b32 s7, s20, 983168
    buffer_load_dwordx4 v80, s[96:99], s7 offen offset:0 lds
    v_fma_f32 v119, v119, s1, s1
    v_mfma_f32_16x16x32_bf16 v[168:171], v[24:27], a[168:171], v[168:171]
    v_rcp_f32 v112, v112
    v_mfma_f32_16x16x32_bf16 v[184:187], v[28:31], a[168:171], v[184:187]
    buffer_load_dwordx4 v81, s[96:99], s7 offen offset:1024 lds
    v_mfma_f32_16x16x32_bf16 v[164:167], v[24:27], a[104:107], v[164:167]
    v_rcp_f32 v113, v113
    v_mfma_f32_16x16x32_bf16 v[180:183], v[28:31], a[104:107], v[180:183]
    buffer_load_dwordx4 v82, s[96:99], s7 offen offset:2048 lds
    v_rcp_f32 v114, v114
    v_mfma_f32_16x16x32_bf16 v[160:163], v[24:27], a[40:43], v[160:163]
    v_rcp_f32 v115, v115
    v_mfma_f32_16x16x32_bf16 v[176:179], v[28:31], a[40:43], v[176:179]
    buffer_load_dwordx4 v83, s[96:99], s7 offen offset:3072 lds
    s_waitcnt lgkmcnt(0)
    v_mfma_f32_16x16x32_bf16 v[128:131], v[32:35], a[44:47], v[128:131]
    s_waitcnt vmcnt(12)
    ds_read_b64_tr_b16 v[16:17], v92 offset:16384
    v_mfma_f32_16x16x32_bf16 v[144:147], v[36:39], a[44:47], v[144:147]
    ds_read_b64_tr_b16 v[18:19], v92 offset:16896
    v_rcp_f32 v116, v116
    v_mfma_f32_16x16x32_bf16 v[132:135], v[32:35], a[108:111], v[132:135]
    ds_read_b64_tr_b16 v[20:21], v93 offset:16384
    v_mfma_f32_16x16x32_bf16 v[148:151], v[36:39], a[108:111], v[148:151]
    ds_read_b64_tr_b16 v[22:23], v93 offset:16896
    v_rcp_f32 v117, v117
    v_mfma_f32_16x16x32_bf16 v[136:139], v[32:35], a[172:175], v[136:139]
    ds_read_b64_tr_b16 v[24:25], v94 offset:16384
    v_mfma_f32_16x16x32_bf16 v[152:155], v[36:39], a[172:175], v[152:155]
    ds_read_b64_tr_b16 v[26:27], v94 offset:16896
    v_rcp_f32 v118, v118
    v_mfma_f32_16x16x32_bf16 v[140:143], v[32:35], a[236:239], v[140:143]
    ds_read_b64_tr_b16 v[28:29], v95 offset:16384
    v_mfma_f32_16x16x32_bf16 v[156:159], v[36:39], a[236:239], v[156:159]
    ds_read_b64_tr_b16 v[30:31], v95 offset:16896
    v_rcp_f32 v119, v119
    v_mfma_f32_16x16x32_bf16 v[172:175], v[40:43], a[236:239], v[172:175]
    v_mul_f32 v196, v112, v196
    v_mul_f32 v197, v113, v197
    v_mfma_f32_16x16x32_bf16 v[188:191], v[44:47], a[236:239], v[188:191]
    v_mul_f32 v198, v114, v198
    v_mul_f32 v199, v115, v199
    v_mfma_f32_16x16x32_bf16 v[168:171], v[40:43], a[172:175], v[168:171]
    v_mul_f32 v212, v116, v212
    v_mfma_f32_16x16x32_bf16 v[184:187], v[44:47], a[172:175], v[184:187]
    v_mul_f32 v213, v117, v213
    v_mul_f32 v214, v118, v214
    v_mfma_f32_16x16x32_bf16 v[164:167], v[40:43], a[108:111], v[164:167]
    v_mul_f32 v215, v119, v215
    v_cvt_pk_bf16_f32 v120, v196, v197
    v_mfma_f32_16x16x32_bf16 v[180:183], v[44:47], a[108:111], v[180:183]
    v_cvt_pk_bf16_f32 v121, v198, v199
    v_cvt_pk_bf16_f32 v122, v212, v213
    v_mfma_f32_16x16x32_bf16 v[160:163], v[40:43], a[44:47], v[160:163]
    v_cvt_pk_bf16_f32 v123, v214, v215
    ds_write_b64 v84, v[120:121] offset:0
    v_mfma_f32_16x16x32_bf16 v[176:179], v[44:47], a[44:47], v[176:179]
    ds_write_b64 v84, v[122:123] offset:32
    s_add_u32 s29, s17, 32768
    buffer_store_dwordx4 v[224:227], v86, s[12:15], s29 offen
    s_waitcnt lgkmcnt(2)
    v_mfma_f32_16x16x32_bf16 v[128:131], v[16:19], a[48:51], v[128:131]
    s_waitcnt vmcnt(9)
    ds_read_b64_tr_b16 v[32:33], v92 offset:0
    v_mfma_f32_16x16x32_bf16 v[144:147], v[20:23], a[48:51], v[144:147]
    ds_read_b64_tr_b16 v[34:35], v92 offset:512
    s_mul_i32 s28, s22, 2031616
    v_mfma_f32_16x16x32_bf16 v[132:135], v[16:19], a[112:115], v[132:135]
    ds_read_b64_tr_b16 v[36:37], v93 offset:0
    s_add_u32 s28, s28, s24
    v_mfma_f32_16x16x32_bf16 v[148:151], v[20:23], a[112:115], v[148:151]
    ds_read_b64_tr_b16 v[38:39], v93 offset:512
    s_lshl_b32 s26, s25, 15
    v_mfma_f32_16x16x32_bf16 v[136:139], v[16:19], a[176:179], v[136:139]
    ds_read_b64_tr_b16 v[40:41], v94 offset:0
    v_mfma_f32_16x16x32_bf16 v[152:155], v[20:23], a[176:179], v[152:155]
    ds_read_b64_tr_b16 v[42:43], v94 offset:512
    s_add_u32 s8, s4, s28
    v_mfma_f32_16x16x32_bf16 v[140:143], v[16:19], a[240:243], v[140:143]
    ds_read_b64_tr_b16 v[44:45], v95 offset:0
    s_addc_u32 s9, s5, 0
    v_mfma_f32_16x16x32_bf16 v[156:159], v[20:23], a[240:243], v[156:159]
    ds_read_b64_tr_b16 v[46:47], v95 offset:512
    s_and_b32 s9, s9, 0xffff
    v_mfma_f32_16x16x32_bf16 v[172:175], v[24:27], a[240:243], v[172:175]
    s_mov_b32 s10, s26
    v_mfma_f32_16x16x32_bf16 v[188:191], v[28:31], a[240:243], v[188:191]
    s_mov_b32 s11, 0x00020000
    s_sub_u32 s19, s16, 2
    v_mfma_f32_16x16x32_bf16 v[168:171], v[24:27], a[176:179], v[168:171]
    s_lshl_b32 s26, s22, 2
    s_add_u32 s26, s26, s16
    v_mfma_f32_16x16x32_bf16 v[184:187], v[28:31], a[176:179], v[184:187]
    s_lshl_b32 s53, s26, 16
    v_mfma_f32_16x16x32_bf16 v[164:167], v[24:27], a[112:115], v[164:167]
    s_add_u32 s53, s53, 63963136
    s_xor_b32 s52, s53, 0x40000
    v_mfma_f32_16x16x32_bf16 v[180:183], v[28:31], a[112:115], v[180:183]
    s_lshl_b32 s58, s26, 7
    v_mfma_f32_16x16x32_bf16 v[160:163], v[24:27], a[48:51], v[160:163]
    s_add_u32 s58, s58, s27
    s_xor_b32 s54, s31, 1
    v_mfma_f32_16x16x32_bf16 v[176:179], v[28:31], a[48:51], v[176:179]
    s_lshl_b32 s54, s54, 3
    s_add_u32 s54, s54, s16
    s_waitcnt lgkmcnt(0)
    v_mfma_f32_16x16x32_bf16 v[128:131], v[32:35], a[52:55], v[128:131]
    s_waitcnt vmcnt(5)
    ds_read_b64_tr_b16 v[16:17], v92 offset:4096
    v_mfma_f32_16x16x32_bf16 v[144:147], v[36:39], a[52:55], v[144:147]
    ds_read_b64_tr_b16 v[18:19], v92 offset:4608
    s_lshl_b32 s54, s54, 13
    v_mfma_f32_16x16x32_bf16 v[132:135], v[32:35], a[116:119], v[132:135]
    ds_read_b64_tr_b16 v[20:21], v93 offset:4096
    s_add_u32 s54, s54, 33587200
    v_mfma_f32_16x16x32_bf16 v[148:151], v[36:39], a[116:119], v[148:151]
    ds_read_b64_tr_b16 v[22:23], v93 offset:4608
    s_add_u32 s55, s54, 4096
    v_mfma_f32_16x16x32_bf16 v[136:139], v[32:35], a[180:183], v[136:139]
    ds_read_b64_tr_b16 v[24:25], v94 offset:4096
    s_lshl_b32 s26, s22, 15
    v_mfma_f32_16x16x32_bf16 v[152:155], v[36:39], a[180:183], v[152:155]
    ds_read_b64_tr_b16 v[26:27], v94 offset:4608
    v_mfma_f32_16x16x32_bf16 v[140:143], v[32:35], a[244:247], v[140:143]
    ds_read_b64_tr_b16 v[28:29], v95 offset:4096
    s_add_u32 s50, s52, s26
    v_mfma_f32_16x16x32_bf16 v[156:159], v[36:39], a[244:247], v[156:159]
    ds_read_b64_tr_b16 v[30:31], v95 offset:4608
    s_add_u32 s51, s53, s26
    v_mfma_f32_16x16x32_bf16 v[172:175], v[40:43], a[244:247], v[172:175]
    s_lshl_b32 s26, s22, 14
    s_add_u32 s52, s52, s26
    v_mfma_f32_16x16x32_bf16 v[188:191], v[44:47], a[244:247], v[188:191]
    s_add_u32 s53, s53, s26
    v_mfma_f32_16x16x32_bf16 v[168:171], v[40:43], a[180:183], v[168:171]
    s_add_u32 s26, s25, 3
    s_and_b32 s26, s26, 3
    v_mfma_f32_16x16x32_bf16 v[184:187], v[44:47], a[180:183], v[184:187]
    s_lshl_b32 s48, s26, 15
    v_mfma_f32_16x16x32_bf16 v[164:167], v[40:43], a[116:119], v[164:167]
    s_add_u32 s26, s25, 1
    s_and_b32 s26, s26, 3
    v_mfma_f32_16x16x32_bf16 v[180:183], v[44:47], a[116:119], v[180:183]
    s_lshl_b32 s49, s26, 15
    s_lshl_b32 s56, s31, 5
    v_mfma_f32_16x16x32_bf16 v[160:163], v[40:43], a[52:55], v[160:163]
    s_add_u32 s56, s56, s16
    v_mfma_f32_16x16x32_bf16 v[176:179], v[44:47], a[52:55], v[176:179]
    s_lshl_b32 s56, s56, 2
    s_add_u32 s56, s56, 58982400
    s_waitcnt lgkmcnt(0)
    v_mfma_f32_16x16x32_bf16 v[128:131], v[16:19], a[56:59], v[128:131]
    s_waitcnt vmcnt(1)
    ds_read_b64_tr_b16 v[32:33], v92 offset:8192
    s_xor_b32 s57, s56, 128
    v_mfma_f32_16x16x32_bf16 v[144:147], v[20:23], a[56:59], v[144:147]
    ds_read_b64_tr_b16 v[34:35], v92 offset:8704
    v_mfma_f32_16x16x32_bf16 v[132:135], v[16:19], a[120:123], v[132:135]
    ds_read_b64_tr_b16 v[36:37], v93 offset:8192
    v_lshrrev_b32 v4, 5, v2
    v_mfma_f32_16x16x32_bf16 v[148:151], v[20:23], a[120:123], v[148:151]
    ds_read_b64_tr_b16 v[38:39], v93 offset:8704
    v_lshlrev_b32 v4, 8, v4
    v_mfma_f32_16x16x32_bf16 v[136:139], v[16:19], a[184:187], v[136:139]
    ds_read_b64_tr_b16 v[40:41], v94 offset:8192
    v_and_b32 v5, 2, v2
    v_mfma_f32_16x16x32_bf16 v[152:155], v[20:23], a[184:187], v[152:155]
    ds_read_b64_tr_b16 v[42:43], v94 offset:8704
    v_lshl_add_u32 v4, v5, 6, v4
    v_mfma_f32_16x16x32_bf16 v[140:143], v[16:19], a[248:251], v[140:143]
    ds_read_b64_tr_b16 v[44:45], v95 offset:8192
    v_mfma_f32_16x16x32_bf16 v[156:159], v[20:23], a[248:251], v[156:159]
    ds_read_b64_tr_b16 v[46:47], v95 offset:8704
    v_and_b32 v5, 28, v2
    v_mfma_f32_16x16x32_bf16 v[172:175], v[24:27], a[248:251], v[172:175]
    v_lshl_add_u32 v4, v5, 2, v4
    v_and_b32 v5, 1, v2
    v_mfma_f32_16x16x32_bf16 v[188:191], v[28:31], a[248:251], v[188:191]
    v_lshl_add_u32 v4, v5, 3, v4
    v_mfma_f32_16x16x32_bf16 v[168:171], v[24:27], a[184:187], v[168:171]
    s_lshl_b32 s29, s19, 13
    s_lshl_b32 s28, s22, 12
    v_mfma_f32_16x16x32_bf16 v[184:187], v[28:31], a[184:187], v[184:187]
    s_add_u32 s28, s28, s29
    v_add_u32 v11, s28, v4
    v_mfma_f32_16x16x32_bf16 v[164:167], v[24:27], a[120:123], v[164:167]
    v_xor_b32 v8, 0x1000, v11
    v_mfma_f32_16x16x32_bf16 v[180:183], v[28:31], a[120:123], v[180:183]
    s_lshl_b32 s29, s19, 12
    s_add_u32 s29, s29, s48
    v_mfma_f32_16x16x32_bf16 v[160:163], v[24:27], a[56:59], v[160:163]
    v_add_u32 v10, s29, v3
    v_mfma_f32_16x16x32_bf16 v[176:179], v[28:31], a[56:59], v[176:179]
    s_lshl_b32 s40, s31, 2
    s_add_u32 s40, s40, s19
    s_waitcnt lgkmcnt(0)
    v_mfma_f32_16x16x32_bf16 v[128:131], v[32:35], a[60:63], v[128:131]
    s_lshl_b32 s40, s40, 14
    s_add_u32 s40, s40, 33587200
    v_mfma_f32_16x16x32_bf16 v[144:147], v[36:39], a[60:63], v[144:147]
    s_lshl_b32 s28, s31, 16
    v_mfma_f32_16x16x32_bf16 v[132:135], v[32:35], a[124:127], v[132:135]
    s_add_u32 s28, s28, 33554432
    s_sub_u32 s28, s28, s10
    v_mfma_f32_16x16x32_bf16 v[148:151], v[36:39], a[124:127], v[148:151]
    s_add_u32 s98, s4, s28
    v_mfma_f32_16x16x32_bf16 v[136:139], v[32:35], a[188:191], v[136:139]
    s_addc_u32 s99, s5, 0
    s_and_b32 s99, s99, 0xffff
    v_mfma_f32_16x16x32_bf16 v[152:155], v[36:39], a[188:191], v[152:155]
    s_add_u32 s100, s10, 65536
    s_lshl_b32 s28, s22, 15
    v_mfma_f32_16x16x32_bf16 v[140:143], v[32:35], a[252:255], v[140:143]
    s_add_u32 s28, s28, s27
    v_mfma_f32_16x16x32_bf16 v[156:159], v[36:39], a[252:255], v[156:159]
    s_sub_u32 s3, 4096000, s28
    s_add_u32 s3, s3, s100
    v_mfma_f32_16x16x32_bf16 v[172:175], v[40:43], a[252:255], v[172:175]
    s_add_u32 s96, s32, s28
    v_mfma_f32_16x16x32_bf16 v[188:191], v[44:47], a[252:255], v[188:191]
    s_addc_u32 s97, s33, 0
    s_sub_u32 s96, s96, s100
    v_mfma_f32_16x16x32_bf16 v[168:171], v[40:43], a[188:191], v[168:171]
    s_subb_u32 s97, s97, 0
    s_mov_b32 s29, 131072
    v_mfma_f32_16x16x32_bf16 v[184:187], v[44:47], a[188:191], v[184:187]
    v_lshl_add_u32 v9, v2, 3, s29
    v_mfma_f32_16x16x32_bf16 v[164:167], v[40:43], a[124:127], v[164:167]
    v_add_u32 v1, 9220, v9
    v_add_u32 v5, 4096, v3
    v_mfma_f32_16x16x32_bf16 v[180:183], v[44:47], a[124:127], v[180:183]
    v_add_u32 v6, 8192, v3
    v_mfma_f32_16x16x32_bf16 v[160:163], v[40:43], a[60:63], v[160:163]
    v_add_u32 v7, 12288, v3
    s_mov_b32 s101, 0xf1800000
    v_mfma_f32_16x16x32_bf16 v[176:179], v[44:47], a[60:63], v[176:179]
    s_lshl_b32 s6, s19, 14
    s_lshl_b32 s20, s19, 13
    v_pk_fma_f32 v[112:113], v[228:229], v[228:229], s[0:1] op_sel_hi:[1,1,0] neg_lo:[1,0,0] neg_hi:[1,0,0]
    v_pk_mul_f32 v[112:113], v[112:113], v[228:229]
    v_exp_f32 v112, v112
    v_pk_fma_f32 v[114:115], v[230:231], v[230:231], s[0:1] op_sel_hi:[1,1,0] neg_lo:[1,0,0] neg_hi:[1,0,0]
    v_exp_f32 v113, v113
    v_pk_mul_f32 v[114:115], v[114:115], v[230:231]
    v_exp_f32 v114, v114
    v_pk_fma_f32 v[116:117], v[244:245], v[244:245], s[0:1] op_sel_hi:[1,1,0] neg_lo:[1,0,0] neg_hi:[1,0,0]
    v_exp_f32 v115, v115
    v_pk_mul_f32 v[116:117], v[116:117], v[244:245]
    v_exp_f32 v116, v116
    v_pk_fma_f32 v[118:119], v[246:247], v[246:247], s[0:1] op_sel_hi:[1,1,0] neg_lo:[1,0,0] neg_hi:[1,0,0]
    v_exp_f32 v117, v117
    v_pk_mul_f32 v[118:119], v[118:119], v[246:247]
    v_exp_f32 v118, v118
    v_pk_fma_f32 v[112:113], v[112:113], s[0:1], s[0:1] op_sel:[0,1,1] op_sel_hi:[1,1,1]
    v_exp_f32 v119, v119
    v_pk_fma_f32 v[114:115], v[114:115], s[0:1], s[0:1] op_sel:[0,1,1] op_sel_hi:[1,1,1]
    v_rcp_f32 v112, v112
    v_pk_fma_f32 v[116:117], v[116:117], s[0:1], s[0:1] op_sel:[0,1,1] op_sel_hi:[1,1,1]
    v_rcp_f32 v113, v113
    v_pk_fma_f32 v[118:119], v[118:119], s[0:1], s[0:1] op_sel:[0,1,1] op_sel_hi:[1,1,1]
    v_rcp_f32 v114, v114
    v_pk_mul_f32 v[228:229], v[112:113], v[228:229]
    v_rcp_f32 v115, v115
    v_cvt_pk_bf16_f32 v124, v228, v229
    v_rcp_f32 v116, v116
    v_pk_mul_f32 v[230:231], v[114:115], v[230:231]
    v_rcp_f32 v117, v117
    v_cvt_pk_bf16_f32 v125, v230, v231
    v_rcp_f32 v118, v118
    v_pk_mul_f32 v[244:245], v[116:117], v[244:245]
    v_rcp_f32 v119, v119
    v_cvt_pk_bf16_f32 v126, v244, v245
    v_pk_mul_f32 v[246:247], v[118:119], v[246:247]
    v_cvt_pk_bf16_f32 v127, v246, v247
    ds_write_b64 v84, v[124:125] offset:64
    ds_write_b64 v84, v[126:127] offset:96
    s_add_u32 s29, s17, 36864
    buffer_store_dwordx4 v[240:243], v86, s[12:15], s29 offen
    ds_read_b128 v[228:231], v85 offset:0
    ds_read_b128 v[244:247], v85 offset:1152
    v_pk_fma_f32 v[112:113], v[200:201], v[200:201], s[0:1] op_sel_hi:[1,1,0] neg_lo:[1,0,0] neg_hi:[1,0,0]
    v_pk_mul_f32 v[112:113], v[112:113], v[200:201]
    v_exp_f32 v112, v112
    v_pk_fma_f32 v[114:115], v[202:203], v[202:203], s[0:1] op_sel_hi:[1,1,0] neg_lo:[1,0,0] neg_hi:[1,0,0]
    v_exp_f32 v113, v113
    v_pk_mul_f32 v[114:115], v[114:115], v[202:203]
    v_exp_f32 v114, v114
    v_pk_fma_f32 v[116:117], v[216:217], v[216:217], s[0:1] op_sel_hi:[1,1,0] neg_lo:[1,0,0] neg_hi:[1,0,0]
    v_exp_f32 v115, v115
    v_pk_mul_f32 v[116:117], v[116:117], v[216:217]
    v_exp_f32 v116, v116
    v_pk_fma_f32 v[118:119], v[218:219], v[218:219], s[0:1] op_sel_hi:[1,1,0] neg_lo:[1,0,0] neg_hi:[1,0,0]
    v_exp_f32 v117, v117
    v_pk_mul_f32 v[118:119], v[118:119], v[218:219]
    v_exp_f32 v118, v118
    v_pk_fma_f32 v[112:113], v[112:113], s[0:1], s[0:1] op_sel:[0,1,1] op_sel_hi:[1,1,1]
    v_exp_f32 v119, v119
    v_pk_fma_f32 v[114:115], v[114:115], s[0:1], s[0:1] op_sel:[0,1,1] op_sel_hi:[1,1,1]
    v_rcp_f32 v112, v112
    v_pk_fma_f32 v[116:117], v[116:117], s[0:1], s[0:1] op_sel:[0,1,1] op_sel_hi:[1,1,1]
    v_rcp_f32 v113, v113
    v_pk_fma_f32 v[118:119], v[118:119], s[0:1], s[0:1] op_sel:[0,1,1] op_sel_hi:[1,1,1]
    v_rcp_f32 v114, v114
    v_pk_mul_f32 v[200:201], v[112:113], v[200:201]
    v_rcp_f32 v115, v115
    v_cvt_pk_bf16_f32 v120, v200, v201
    v_rcp_f32 v116, v116
    v_pk_mul_f32 v[202:203], v[114:115], v[202:203]
    v_rcp_f32 v117, v117
    v_cvt_pk_bf16_f32 v121, v202, v203
    v_rcp_f32 v118, v118
    v_pk_mul_f32 v[216:217], v[116:117], v[216:217]
    v_rcp_f32 v119, v119
    v_cvt_pk_bf16_f32 v122, v216, v217
    v_pk_mul_f32 v[218:219], v[118:119], v[218:219]
    v_cvt_pk_bf16_f32 v123, v218, v219
    ds_write_b64 v84, v[120:121] offset:0
    ds_write_b64 v84, v[122:123] offset:32
    s_add_u32 s29, s17, 40960
    s_waitcnt lgkmcnt(3)
    buffer_store_dwordx4 v[228:231], v86, s[12:15], s29 offen
    v_pk_fma_f32 v[112:113], v[232:233], v[232:233], s[0:1] op_sel_hi:[1,1,0] neg_lo:[1,0,0] neg_hi:[1,0,0]
    v_pk_mul_f32 v[112:113], v[112:113], v[232:233]
    v_exp_f32 v112, v112
    v_pk_fma_f32 v[114:115], v[234:235], v[234:235], s[0:1] op_sel_hi:[1,1,0] neg_lo:[1,0,0] neg_hi:[1,0,0]
    v_exp_f32 v113, v113
    v_pk_mul_f32 v[114:115], v[114:115], v[234:235]
    v_exp_f32 v114, v114
    v_pk_fma_f32 v[116:117], v[248:249], v[248:249], s[0:1] op_sel_hi:[1,1,0] neg_lo:[1,0,0] neg_hi:[1,0,0]
    v_exp_f32 v115, v115
    v_pk_mul_f32 v[116:117], v[116:117], v[248:249]
    v_exp_f32 v116, v116
    v_pk_fma_f32 v[118:119], v[250:251], v[250:251], s[0:1] op_sel_hi:[1,1,0] neg_lo:[1,0,0] neg_hi:[1,0,0]
    v_exp_f32 v117, v117
    v_pk_mul_f32 v[118:119], v[118:119], v[250:251]
    v_exp_f32 v118, v118
    v_pk_fma_f32 v[112:113], v[112:113], s[0:1], s[0:1] op_sel:[0,1,1] op_sel_hi:[1,1,1]
    v_exp_f32 v119, v119
    v_pk_fma_f32 v[114:115], v[114:115], s[0:1], s[0:1] op_sel:[0,1,1] op_sel_hi:[1,1,1]
    v_rcp_f32 v112, v112
    v_pk_fma_f32 v[116:117], v[116:117], s[0:1], s[0:1] op_sel:[0,1,1] op_sel_hi:[1,1,1]
    v_rcp_f32 v113, v113
    v_pk_fma_f32 v[118:119], v[118:119], s[0:1], s[0:1] op_sel:[0,1,1] op_sel_hi:[1,1,1]
    v_rcp_f32 v114, v114
    v_pk_mul_f32 v[232:233], v[112:113], v[232:233]
    v_rcp_f32 v115, v115
    v_cvt_pk_bf16_f32 v124, v232, v233
    v_rcp_f32 v116, v116
    v_pk_mul_f32 v[234:235], v[114:115], v[234:235]
    v_rcp_f32 v117, v117
    v_cvt_pk_bf16_f32 v125, v234, v235
    v_rcp_f32 v118, v118
    v_pk_mul_f32 v[248:249], v[116:117], v[248:249]
    v_rcp_f32 v119, v119
    v_cvt_pk_bf16_f32 v126, v248, v249
    v_pk_mul_f32 v[250:251], v[118:119], v[250:251]
    v_cvt_pk_bf16_f32 v127, v250, v251
    ds_write_b64 v84, v[124:125] offset:64
    ds_write_b64 v84, v[126:127] offset:96
    s_add_u32 s29, s17, 45056
    s_waitcnt lgkmcnt(4)
    buffer_store_dwordx4 v[244:247], v86, s[12:15], s29 offen
    ds_read_b128 v[232:235], v85 offset:0
    ds_read_b128 v[248:251], v85 offset:1152
    v_pk_fma_f32 v[112:113], v[204:205], v[204:205], s[0:1] op_sel_hi:[1,1,0] neg_lo:[1,0,0] neg_hi:[1,0,0]
    v_pk_mul_f32 v[112:113], v[112:113], v[204:205]
    v_exp_f32 v112, v112
    v_pk_fma_f32 v[114:115], v[206:207], v[206:207], s[0:1] op_sel_hi:[1,1,0] neg_lo:[1,0,0] neg_hi:[1,0,0]
    v_exp_f32 v113, v113
    v_pk_mul_f32 v[114:115], v[114:115], v[206:207]
    v_exp_f32 v114, v114
    v_pk_fma_f32 v[116:117], v[220:221], v[220:221], s[0:1] op_sel_hi:[1,1,0] neg_lo:[1,0,0] neg_hi:[1,0,0]
    v_exp_f32 v115, v115
    v_pk_mul_f32 v[116:117], v[116:117], v[220:221]
    v_exp_f32 v116, v116
    v_pk_fma_f32 v[118:119], v[222:223], v[222:223], s[0:1] op_sel_hi:[1,1,0] neg_lo:[1,0,0] neg_hi:[1,0,0]
    v_exp_f32 v117, v117
    v_pk_mul_f32 v[118:119], v[118:119], v[222:223]
    v_exp_f32 v118, v118
    v_pk_fma_f32 v[112:113], v[112:113], s[0:1], s[0:1] op_sel:[0,1,1] op_sel_hi:[1,1,1]
    v_exp_f32 v119, v119
    v_pk_fma_f32 v[114:115], v[114:115], s[0:1], s[0:1] op_sel:[0,1,1] op_sel_hi:[1,1,1]
    v_rcp_f32 v112, v112
    v_pk_fma_f32 v[116:117], v[116:117], s[0:1], s[0:1] op_sel:[0,1,1] op_sel_hi:[1,1,1]
    v_rcp_f32 v113, v113
    v_pk_fma_f32 v[118:119], v[118:119], s[0:1], s[0:1] op_sel:[0,1,1] op_sel_hi:[1,1,1]
    v_rcp_f32 v114, v114
    v_pk_mul_f32 v[204:205], v[112:113], v[204:205]
    v_rcp_f32 v115, v115
    v_cvt_pk_bf16_f32 v120, v204, v205
    v_rcp_f32 v116, v116
    v_pk_mul_f32 v[206:207], v[114:115], v[206:207]
    v_rcp_f32 v117, v117
    v_cvt_pk_bf16_f32 v121, v206, v207
    v_rcp_f32 v118, v118
    v_pk_mul_f32 v[220:221], v[116:117], v[220:221]
    v_rcp_f32 v119, v119
    v_cvt_pk_bf16_f32 v122, v220, v221
    v_pk_mul_f32 v[222:223], v[118:119], v[222:223]
    v_cvt_pk_bf16_f32 v123, v222, v223
    ds_write_b64 v84, v[120:121] offset:0
    ds_write_b64 v84, v[122:123] offset:32
    s_add_u32 s29, s17, 49152
    s_waitcnt lgkmcnt(3)
    buffer_store_dwordx4 v[232:235], v86, s[12:15], s29 offen
    v_pk_fma_f32 v[112:113], v[236:237], v[236:237], s[0:1] op_sel_hi:[1,1,0] neg_lo:[1,0,0] neg_hi:[1,0,0]
    v_pk_mul_f32 v[112:113], v[112:113], v[236:237]
    v_exp_f32 v112, v112
    v_pk_fma_f32 v[114:115], v[238:239], v[238:239], s[0:1] op_sel_hi:[1,1,0] neg_lo:[1,0,0] neg_hi:[1,0,0]
    v_exp_f32 v113, v113
    v_pk_mul_f32 v[114:115], v[114:115], v[238:239]
    v_exp_f32 v114, v114
    v_pk_fma_f32 v[116:117], v[252:253], v[252:253], s[0:1] op_sel_hi:[1,1,0] neg_lo:[1,0,0] neg_hi:[1,0,0]
    v_exp_f32 v115, v115
    v_pk_mul_f32 v[116:117], v[116:117], v[252:253]
    v_exp_f32 v116, v116
    v_pk_fma_f32 v[118:119], v[254:255], v[254:255], s[0:1] op_sel_hi:[1,1,0] neg_lo:[1,0,0] neg_hi:[1,0,0]
    v_exp_f32 v117, v117
    v_pk_mul_f32 v[118:119], v[118:119], v[254:255]
    v_exp_f32 v118, v118
    v_pk_fma_f32 v[112:113], v[112:113], s[0:1], s[0:1] op_sel:[0,1,1] op_sel_hi:[1,1,1]
    v_exp_f32 v119, v119
    v_pk_fma_f32 v[114:115], v[114:115], s[0:1], s[0:1] op_sel:[0,1,1] op_sel_hi:[1,1,1]
    v_rcp_f32 v112, v112
    v_pk_fma_f32 v[116:117], v[116:117], s[0:1], s[0:1] op_sel:[0,1,1] op_sel_hi:[1,1,1]
    v_rcp_f32 v113, v113
    v_pk_fma_f32 v[118:119], v[118:119], s[0:1], s[0:1] op_sel:[0,1,1] op_sel_hi:[1,1,1]
    v_rcp_f32 v114, v114
    v_pk_mul_f32 v[236:237], v[112:113], v[236:237]
    v_rcp_f32 v115, v115
    v_cvt_pk_bf16_f32 v124, v236, v237
    v_rcp_f32 v116, v116
    v_pk_mul_f32 v[238:239], v[114:115], v[238:239]
    v_rcp_f32 v117, v117
    v_cvt_pk_bf16_f32 v125, v238, v239
    v_rcp_f32 v118, v118
    v_pk_mul_f32 v[252:253], v[116:117], v[252:253]
    v_rcp_f32 v119, v119
    v_cvt_pk_bf16_f32 v126, v252, v253
    v_pk_mul_f32 v[254:255], v[118:119], v[254:255]
    v_cvt_pk_bf16_f32 v127, v254, v255
    ds_write_b64 v84, v[124:125] offset:64
    ds_write_b64 v84, v[126:127] offset:96
    s_add_u32 s29, s17, 53248
    s_waitcnt lgkmcnt(4)
    buffer_store_dwordx4 v[248:251], v86, s[12:15], s29 offen
    ds_read_b128 v[236:239], v85 offset:0
    ds_read_b128 v[252:255], v85 offset:1152
    s_add_u32 s29, s17, 57344
    s_waitcnt lgkmcnt(1)
    buffer_store_dwordx4 v[236:239], v86, s[12:15], s29 offen
    s_add_u32 s29, s17, 61440
    s_waitcnt lgkmcnt(0)
    buffer_store_dwordx4 v[252:255], v86, s[12:15], s29 offen
    v_pk_fma_f32 v[112:113], v[128:129], v[128:129], s[0:1] op_sel_hi:[1,1,0] neg_lo:[1,0,0] neg_hi:[1,0,0]
    v_pk_mul_f32 v[112:113], v[112:113], v[128:129]
    v_exp_f32 v112, v112
    v_pk_fma_f32 v[114:115], v[130:131], v[130:131], s[0:1] op_sel_hi:[1,1,0] neg_lo:[1,0,0] neg_hi:[1,0,0]
    v_exp_f32 v113, v113
    v_pk_mul_f32 v[114:115], v[114:115], v[130:131]
    v_exp_f32 v114, v114
    v_pk_fma_f32 v[116:117], v[144:145], v[144:145], s[0:1] op_sel_hi:[1,1,0] neg_lo:[1,0,0] neg_hi:[1,0,0]
    v_exp_f32 v115, v115
    v_pk_mul_f32 v[116:117], v[116:117], v[144:145]
    v_exp_f32 v116, v116
    v_pk_fma_f32 v[118:119], v[146:147], v[146:147], s[0:1] op_sel_hi:[1,1,0] neg_lo:[1,0,0] neg_hi:[1,0,0]
    v_exp_f32 v117, v117
    v_pk_mul_f32 v[118:119], v[118:119], v[146:147]
    v_exp_f32 v118, v118
    v_pk_fma_f32 v[112:113], v[112:113], s[0:1], s[0:1] op_sel:[0,1,1] op_sel_hi:[1,1,1]
    v_exp_f32 v119, v119
    v_pk_fma_f32 v[114:115], v[114:115], s[0:1], s[0:1] op_sel:[0,1,1] op_sel_hi:[1,1,1]
    v_rcp_f32 v112, v112
    v_pk_fma_f32 v[116:117], v[116:117], s[0:1], s[0:1] op_sel:[0,1,1] op_sel_hi:[1,1,1]
    v_rcp_f32 v113, v113
    v_pk_fma_f32 v[118:119], v[118:119], s[0:1], s[0:1] op_sel:[0,1,1] op_sel_hi:[1,1,1]
    v_rcp_f32 v114, v114
    v_pk_mul_f32 v[128:129], v[112:113], v[128:129]
    v_rcp_f32 v115, v115
    v_cvt_pk_bf16_f32 v120, v128, v129
    v_rcp_f32 v116, v116
    v_pk_mul_f32 v[130:131], v[114:115], v[130:131]
    v_rcp_f32 v117, v117
    v_cvt_pk_bf16_f32 v121, v130, v131
    v_rcp_f32 v118, v118
    v_pk_mul_f32 v[144:145], v[116:117], v[144:145]
    v_rcp_f32 v119, v119
    v_cvt_pk_bf16_f32 v122, v144, v145
    v_pk_mul_f32 v[146:147], v[118:119], v[146:147]
    v_cvt_pk_bf16_f32 v123, v146, v147
    ds_write_b64 v84, v[120:121] offset:0
    ds_write_b64 v84, v[122:123] offset:32
    s_barrier
    s_add_u32 m0, s6, 32768
    s_add_u32 s7, s6, 32768
    buffer_load_dwordx4 v3, s[8:11], s7 offen offset:0 sc1 lds
    buffer_load_dwordx4 v3, s[8:11], s7 offen offset:1024 sc1 lds
    buffer_load_dwordx4 v3, s[8:11], s7 offen offset:2048 sc1 lds
    buffer_load_dwordx4 v3, s[8:11], s7 offen offset:3072 sc1 lds
    ds_read_b64_tr_b16 a[16:17], v8 offset:0
    ds_read_b64_tr_b16 a[18:19], v8 offset:16384
    ds_read_b64_tr_b16 a[20:21], v8 offset:512
    ds_read_b64_tr_b16 a[22:23], v8 offset:16896
    v_pk_fma_f32 v[112:113], v[160:161], v[160:161], s[0:1] op_sel_hi:[1,1,0] neg_lo:[1,0,0] neg_hi:[1,0,0]
    v_pk_mul_f32 v[112:113], v[112:113], v[160:161]
    v_exp_f32 v112, v112
    v_pk_fma_f32 v[114:115], v[162:163], v[162:163], s[0:1] op_sel_hi:[1,1,0] neg_lo:[1,0,0] neg_hi:[1,0,0]
    v_exp_f32 v113, v113
    v_pk_mul_f32 v[114:115], v[114:115], v[162:163]
    v_exp_f32 v114, v114
    v_pk_fma_f32 v[116:117], v[176:177], v[176:177], s[0:1] op_sel_hi:[1,1,0] neg_lo:[1,0,0] neg_hi:[1,0,0]
    v_exp_f32 v115, v115
    v_pk_mul_f32 v[116:117], v[116:117], v[176:177]
    v_exp_f32 v116, v116
    v_pk_fma_f32 v[118:119], v[178:179], v[178:179], s[0:1] op_sel_hi:[1,1,0] neg_lo:[1,0,0] neg_hi:[1,0,0]
    v_exp_f32 v117, v117
    v_pk_mul_f32 v[118:119], v[118:119], v[178:179]
    v_exp_f32 v118, v118
    v_pk_fma_f32 v[112:113], v[112:113], s[0:1], s[0:1] op_sel:[0,1,1] op_sel_hi:[1,1,1]
    s_add_u32 m0, s6, 36864
    s_add_u32 s7, s6, 36864
    buffer_load_dwordx4 v3, s[8:11], s7 offen offset:0 sc1 lds
    buffer_load_dwordx4 v3, s[8:11], s7 offen offset:1024 sc1 lds
    buffer_load_dwordx4 v3, s[8:11], s7 offen offset:2048 sc1 lds
    buffer_load_dwordx4 v3, s[8:11], s7 offen offset:3072 sc1 lds
    ds_read_b64_tr_b16 a[24:25], v8 offset:1024
    ds_read_b64_tr_b16 a[26:27], v8 offset:17408
    ds_read_b64_tr_b16 a[28:29], v8 offset:1536
    ds_read_b64_tr_b16 a[30:31], v8 offset:17920
    v_exp_f32 v119, v119
    v_pk_fma_f32 v[114:115], v[114:115], s[0:1], s[0:1] op_sel:[0,1,1] op_sel_hi:[1,1,1]
    v_rcp_f32 v112, v112
    v_pk_fma_f32 v[116:117], v[116:117], s[0:1], s[0:1] op_sel:[0,1,1] op_sel_hi:[1,1,1]
    v_rcp_f32 v113, v113
    v_pk_fma_f32 v[118:119], v[118:119], s[0:1], s[0:1] op_sel:[0,1,1] op_sel_hi:[1,1,1]
    v_rcp_f32 v114, v114
    v_pk_mul_f32 v[160:161], v[112:113], v[160:161]
    v_rcp_f32 v115, v115
    v_cvt_pk_bf16_f32 v124, v160, v161
    v_rcp_f32 v116, v116
    v_pk_mul_f32 v[162:163], v[114:115], v[162:163]
    v_rcp_f32 v117, v117
    v_cvt_pk_bf16_f32 v125, v162, v163
    v_rcp_f32 v118, v118
    v_pk_mul_f32 v[176:177], v[116:117], v[176:177]
    v_rcp_f32 v119, v119
    v_cvt_pk_bf16_f32 v126, v176, v177
    v_pk_mul_f32 v[178:179], v[118:119], v[178:179]
    v_cvt_pk_bf16_f32 v127, v178, v179
    ds_write_b64 v84, v[124:125] offset:64
    ds_write_b64 v84, v[126:127] offset:96
    ds_read_b128 v[160:163], v85 offset:0
    ds_read_b128 v[176:179], v85 offset:1152
    s_add_u32 m0, s6, 40960
    s_add_u32 s7, s6, 40960
    buffer_load_dwordx4 v3, s[8:11], s7 offen offset:0 sc1 lds
    buffer_load_dwordx4 v3, s[8:11], s7 offen offset:1024 sc1 lds
    buffer_load_dwordx4 v3, s[8:11], s7 offen offset:2048 sc1 lds
    buffer_load_dwordx4 v3, s[8:11], s7 offen offset:3072 sc1 lds
    ds_read_b64_tr_b16 a[32:33], v8 offset:2048
    s_waitcnt lgkmcnt(14)
    ds_read_b64_tr_b16 a[34:35], v8 offset:18432
    s_waitcnt lgkmcnt(14)
    ds_read_b64_tr_b16 a[36:37], v8 offset:2560
    s_waitcnt lgkmcnt(14)
    ds_read_b64_tr_b16 a[38:39], v8 offset:18944
    v_pk_fma_f32 v[112:113], v[132:133], v[132:133], s[0:1] op_sel_hi:[1,1,0] neg_lo:[1,0,0] neg_hi:[1,0,0]
    v_pk_mul_f32 v[112:113], v[112:113], v[132:133]
    v_exp_f32 v112, v112
    v_pk_fma_f32 v[114:115], v[134:135], v[134:135], s[0:1] op_sel_hi:[1,1,0] neg_lo:[1,0,0] neg_hi:[1,0,0]
    v_exp_f32 v113, v113
    v_pk_mul_f32 v[114:115], v[114:115], v[134:135]
    v_exp_f32 v114, v114
    v_pk_fma_f32 v[116:117], v[148:149], v[148:149], s[0:1] op_sel_hi:[1,1,0] neg_lo:[1,0,0] neg_hi:[1,0,0]
    v_exp_f32 v115, v115
    v_pk_mul_f32 v[116:117], v[116:117], v[148:149]
    v_exp_f32 v116, v116
    v_pk_fma_f32 v[118:119], v[150:151], v[150:151], s[0:1] op_sel_hi:[1,1,0] neg_lo:[1,0,0] neg_hi:[1,0,0]
    v_exp_f32 v117, v117
    v_pk_mul_f32 v[118:119], v[118:119], v[150:151]
    v_exp_f32 v118, v118
    v_pk_fma_f32 v[112:113], v[112:113], s[0:1], s[0:1] op_sel:[0,1,1] op_sel_hi:[1,1,1]
    s_add_u32 m0, s6, 45056
    s_add_u32 s7, s6, 45056
    buffer_load_dwordx4 v3, s[8:11], s7 offen offset:0 sc1 lds
    buffer_load_dwordx4 v3, s[8:11], s7 offen offset:1024 sc1 lds
    buffer_load_dwordx4 v3, s[8:11], s7 offen offset:2048 sc1 lds
    buffer_load_dwordx4 v3, s[8:11], s7 offen offset:3072 sc1 lds
    s_waitcnt lgkmcnt(14)
    ds_read_b64_tr_b16 a[40:41], v8 offset:3072
    s_waitcnt lgkmcnt(14)
    ds_read_b64_tr_b16 a[42:43], v8 offset:19456
    s_waitcnt lgkmcnt(14)
    ds_read_b64_tr_b16 a[44:45], v8 offset:3584
    s_waitcnt lgkmcnt(14)
    ds_read_b64_tr_b16 a[46:47], v8 offset:19968
    v_exp_f32 v119, v119
    v_pk_fma_f32 v[114:115], v[114:115], s[0:1], s[0:1] op_sel:[0,1,1] op_sel_hi:[1,1,1]
    v_rcp_f32 v112, v112
    v_pk_fma_f32 v[116:117], v[116:117], s[0:1], s[0:1] op_sel:[0,1,1] op_sel_hi:[1,1,1]
    v_rcp_f32 v113, v113
    v_pk_fma_f32 v[118:119], v[118:119], s[0:1], s[0:1] op_sel:[0,1,1] op_sel_hi:[1,1,1]
    v_rcp_f32 v114, v114
    v_pk_mul_f32 v[132:133], v[112:113], v[132:133]
    v_rcp_f32 v115, v115
    v_cvt_pk_bf16_f32 v120, v132, v133
    v_rcp_f32 v116, v116
    v_pk_mul_f32 v[134:135], v[114:115], v[134:135]
    v_rcp_f32 v117, v117
    v_cvt_pk_bf16_f32 v121, v134, v135
    v_rcp_f32 v118, v118
    v_pk_mul_f32 v[148:149], v[116:117], v[148:149]
    v_rcp_f32 v119, v119
    v_cvt_pk_bf16_f32 v122, v148, v149
    v_pk_mul_f32 v[150:151], v[118:119], v[150:151]
    v_cvt_pk_bf16_f32 v123, v150, v151
    s_waitcnt lgkmcnt(14)
    ds_write_b64 v84, v[120:121] offset:0
    s_waitcnt lgkmcnt(14)
    ds_write_b64 v84, v[122:123] offset:32
    s_add_u32 s29, s17, 32896
    s_waitcnt lgkmcnt(11)
    buffer_store_dwordx4 v[160:163], v86, s[12:15], s29 offen
    s_add_u32 m0, s20, 65536
    s_add_u32 s7, s20, 65536
    buffer_load_dwordx4 v3, s[8:11], s7 offen offset:0 sc1 lds
    buffer_load_dwordx4 v3, s[8:11], s7 offen offset:1024 sc1 lds
    buffer_load_dwordx4 v3, s[8:11], s7 offen offset:2048 sc1 lds
    buffer_load_dwordx4 v3, s[8:11], s7 offen offset:3072 sc1 lds
    ds_read_b64_tr_b16 a[48:49], v11 offset:0
    ds_read_b64_tr_b16 a[50:51], v11 offset:16384
    ds_read_b64_tr_b16 a[52:53], v11 offset:512
    ds_read_b64_tr_b16 a[54:55], v11 offset:16896
    v_pk_fma_f32 v[112:113], v[164:165], v[164:165], s[0:1] op_sel_hi:[1,1,0] neg_lo:[1,0,0] neg_hi:[1,0,0]
    v_pk_mul_f32 v[112:113], v[112:113], v[164:165]
    v_exp_f32 v112, v112
    v_pk_fma_f32 v[114:115], v[166:167], v[166:167], s[0:1] op_sel_hi:[1,1,0] neg_lo:[1,0,0] neg_hi:[1,0,0]
    v_exp_f32 v113, v113
    v_pk_mul_f32 v[114:115], v[114:115], v[166:167]
    v_exp_f32 v114, v114
    v_pk_fma_f32 v[116:117], v[180:181], v[180:181], s[0:1] op_sel_hi:[1,1,0] neg_lo:[1,0,0] neg_hi:[1,0,0]
    v_exp_f32 v115, v115
    v_pk_mul_f32 v[116:117], v[116:117], v[180:181]
    v_exp_f32 v116, v116
    v_pk_fma_f32 v[118:119], v[182:183], v[182:183], s[0:1] op_sel_hi:[1,1,0] neg_lo:[1,0,0] neg_hi:[1,0,0]
    v_exp_f32 v117, v117
    v_pk_mul_f32 v[118:119], v[118:119], v[182:183]
    v_exp_f32 v118, v118
    v_pk_fma_f32 v[112:113], v[112:113], s[0:1], s[0:1] op_sel:[0,1,1] op_sel_hi:[1,1,1]
    s_add_u32 m0, s20, 69632
    s_add_u32 s7, s20, 69632
    buffer_load_dwordx4 v3, s[8:11], s7 offen offset:0 sc1 lds
    buffer_load_dwordx4 v3, s[8:11], s7 offen offset:1024 sc1 lds
    buffer_load_dwordx4 v3, s[8:11], s7 offen offset:2048 sc1 lds
    buffer_load_dwordx4 v3, s[8:11], s7 offen offset:3072 sc1 lds
    s_waitcnt lgkmcnt(14)
    ds_read_b64_tr_b16 a[56:57], v11 offset:1024
    s_waitcnt lgkmcnt(14)
    ds_read_b64_tr_b16 a[58:59], v11 offset:17408
    s_waitcnt lgkmcnt(14)
    ds_read_b64_tr_b16 a[60:61], v11 offset:1536
    s_waitcnt lgkmcnt(14)
    ds_read_b64_tr_b16 a[62:63], v11 offset:17920
    v_exp_f32 v119, v119
    v_pk_fma_f32 v[114:115], v[114:115], s[0:1], s[0:1] op_sel:[0,1,1] op_sel_hi:[1,1,1]
    v_rcp_f32 v112, v112
    v_pk_fma_f32 v[116:117], v[116:117], s[0:1], s[0:1] op_sel:[0,1,1] op_sel_hi:[1,1,1]
    v_rcp_f32 v113, v113
    v_pk_fma_f32 v[118:119], v[118:119], s[0:1], s[0:1] op_sel:[0,1,1] op_sel_hi:[1,1,1]
    v_rcp_f32 v114, v114
    v_pk_mul_f32 v[164:165], v[112:113], v[164:165]
    v_rcp_f32 v115, v115
    v_cvt_pk_bf16_f32 v124, v164, v165
    v_rcp_f32 v116, v116
    v_pk_mul_f32 v[166:167], v[114:115], v[166:167]
    v_rcp_f32 v117, v117
    v_cvt_pk_bf16_f32 v125, v166, v167
    v_rcp_f32 v118, v118
    v_pk_mul_f32 v[180:181], v[116:117], v[180:181]
    v_rcp_f32 v119, v119
    v_cvt_pk_bf16_f32 v126, v180, v181
    v_pk_mul_f32 v[182:183], v[118:119], v[182:183]
    v_cvt_pk_bf16_f32 v127, v182, v183
    s_waitcnt lgkmcnt(14)
    ds_write_b64 v84, v[124:125] offset:64
    s_waitcnt lgkmcnt(14)
    ds_write_b64 v84, v[126:127] offset:96
    s_add_u32 s29, s17, 36992
    buffer_store_dwordx4 v[176:179], v86, s[12:15], s29 offen
    s_waitcnt lgkmcnt(14)
    ds_read_b128 v[164:167], v85 offset:0
    s_waitcnt lgkmcnt(14)
    ds_read_b128 v[180:183], v85 offset:1152
    s_waitcnt lgkmcnt(0)
    s_barrier
    s_mul_i32 s26, s19, -5888
    s_add_u32 s26, s26, 65536
    v_add_u32 v84, s26, v84
    v_add_u32 v85, s26, v85
    s_add_u32 m0, s20, 81920
    s_add_u32 s7, s20, 81920
    buffer_load_dwordx4 v3, s[8:11], s7 offen offset:0 sc1 lds
    buffer_load_dwordx4 v3, s[8:11], s7 offen offset:1024 sc1 lds
    buffer_load_dwordx4 v3, s[8:11], s7 offen offset:2048 sc1 lds
    buffer_load_dwordx4 v3, s[8:11], s7 offen offset:3072 sc1 lds
    ds_read_b64_tr_b16 a[64:65], v11 offset:2048
    ds_read_b64_tr_b16 a[66:67], v11 offset:18432
    ds_read_b64_tr_b16 a[68:69], v11 offset:2560
    ds_read_b64_tr_b16 a[70:71], v11 offset:18944
    v_pk_fma_f32 v[112:113], v[136:137], v[136:137], s[0:1] op_sel_hi:[1,1,0] neg_lo:[1,0,0] neg_hi:[1,0,0]
    v_pk_mul_f32 v[112:113], v[112:113], v[136:137]
    v_exp_f32 v112, v112
    v_pk_fma_f32 v[114:115], v[138:139], v[138:139], s[0:1] op_sel_hi:[1,1,0] neg_lo:[1,0,0] neg_hi:[1,0,0]
    v_exp_f32 v113, v113
    v_pk_mul_f32 v[114:115], v[114:115], v[138:139]
    v_exp_f32 v114, v114
    v_pk_fma_f32 v[116:117], v[152:153], v[152:153], s[0:1] op_sel_hi:[1,1,0] neg_lo:[1,0,0] neg_hi:[1,0,0]
    v_exp_f32 v115, v115
    v_pk_mul_f32 v[116:117], v[116:117], v[152:153]
    v_exp_f32 v116, v116
    v_pk_fma_f32 v[118:119], v[154:155], v[154:155], s[0:1] op_sel_hi:[1,1,0] neg_lo:[1,0,0] neg_hi:[1,0,0]
    v_exp_f32 v117, v117
    v_pk_mul_f32 v[118:119], v[118:119], v[154:155]
    v_exp_f32 v118, v118
    v_pk_fma_f32 v[112:113], v[112:113], s[0:1], s[0:1] op_sel:[0,1,1] op_sel_hi:[1,1,1]
    s_add_u32 m0, s20, 86016
    s_add_u32 s7, s20, 86016
    buffer_load_dwordx4 v3, s[8:11], s7 offen offset:0 sc1 lds
    buffer_load_dwordx4 v3, s[8:11], s7 offen offset:1024 sc1 lds
    buffer_load_dwordx4 v3, s[8:11], s7 offen offset:2048 sc1 lds
    buffer_load_dwordx4 v3, s[8:11], s7 offen offset:3072 sc1 lds
    ds_read_b64_tr_b16 a[72:73], v11 offset:3072
    ds_read_b64_tr_b16 a[74:75], v11 offset:19456
    ds_read_b64_tr_b16 a[76:77], v11 offset:3584
    ds_read_b64_tr_b16 a[78:79], v11 offset:19968
    v_exp_f32 v119, v119
    v_pk_fma_f32 v[114:115], v[114:115], s[0:1], s[0:1] op_sel:[0,1,1] op_sel_hi:[1,1,1]
    v_rcp_f32 v112, v112
    v_pk_fma_f32 v[116:117], v[116:117], s[0:1], s[0:1] op_sel:[0,1,1] op_sel_hi:[1,1,1]
    v_rcp_f32 v113, v113
    v_pk_fma_f32 v[118:119], v[118:119], s[0:1], s[0:1] op_sel:[0,1,1] op_sel_hi:[1,1,1]
    v_rcp_f32 v114, v114
    v_pk_mul_f32 v[136:137], v[112:113], v[136:137]
    v_rcp_f32 v115, v115
    v_cvt_pk_bf16_f32 v120, v136, v137
    v_rcp_f32 v116, v116
    v_pk_mul_f32 v[138:139], v[114:115], v[138:139]
    v_rcp_f32 v117, v117
    v_cvt_pk_bf16_f32 v121, v138, v139
    v_rcp_f32 v118, v118
    v_pk_mul_f32 v[152:153], v[116:117], v[152:153]
    v_rcp_f32 v119, v119
    v_cvt_pk_bf16_f32 v122, v152, v153
    v_pk_mul_f32 v[154:155], v[118:119], v[154:155]
    v_cvt_pk_bf16_f32 v123, v154, v155
    ds_write_b64 v84, v[120:121] offset:0
    ds_write_b64 v84, v[122:123] offset:32
    s_add_u32 s29, s17, 41088
    buffer_store_dwordx4 v[164:167], v86, s[12:15], s29 offen
    s_add_u32 m0, s6, 98304
    s_add_u32 s7, s6, 98304
    buffer_load_dwordx4 v3, s[8:11], s7 offen offset:0 sc1 lds
    buffer_load_dwordx4 v3, s[8:11], s7 offen offset:1024 sc1 lds
    buffer_load_dwordx4 v3, s[8:11], s7 offen offset:2048 sc1 lds
    buffer_load_dwordx4 v3, s[8:11], s7 offen offset:3072 sc1 lds
    v_pk_fma_f32 v[112:113], v[168:169], v[168:169], s[0:1] op_sel_hi:[1,1,0] neg_lo:[1,0,0] neg_hi:[1,0,0]
    v_pk_mul_f32 v[112:113], v[112:113], v[168:169]
    v_exp_f32 v112, v112
    v_pk_fma_f32 v[114:115], v[170:171], v[170:171], s[0:1] op_sel_hi:[1,1,0] neg_lo:[1,0,0] neg_hi:[1,0,0]
    v_exp_f32 v113, v113
    v_pk_mul_f32 v[114:115], v[114:115], v[170:171]
    v_exp_f32 v114, v114
    v_pk_fma_f32 v[116:117], v[184:185], v[184:185], s[0:1] op_sel_hi:[1,1,0] neg_lo:[1,0,0] neg_hi:[1,0,0]
    v_exp_f32 v115, v115
    v_pk_mul_f32 v[116:117], v[116:117], v[184:185]
    v_exp_f32 v116, v116
    v_pk_fma_f32 v[118:119], v[186:187], v[186:187], s[0:1] op_sel_hi:[1,1,0] neg_lo:[1,0,0] neg_hi:[1,0,0]
    v_exp_f32 v117, v117
    v_pk_mul_f32 v[118:119], v[118:119], v[186:187]
    v_exp_f32 v118, v118
    v_pk_fma_f32 v[112:113], v[112:113], s[0:1], s[0:1] op_sel:[0,1,1] op_sel_hi:[1,1,1]
    s_add_u32 m0, s6, 102400
    s_add_u32 s7, s6, 102400
    buffer_load_dwordx4 v3, s[8:11], s7 offen offset:0 sc1 lds
    buffer_load_dwordx4 v3, s[8:11], s7 offen offset:1024 sc1 lds
    buffer_load_dwordx4 v3, s[8:11], s7 offen offset:2048 sc1 lds
    buffer_load_dwordx4 v3, s[8:11], s7 offen offset:3072 sc1 lds
    v_exp_f32 v119, v119
    v_pk_fma_f32 v[114:115], v[114:115], s[0:1], s[0:1] op_sel:[0,1,1] op_sel_hi:[1,1,1]
    v_rcp_f32 v112, v112
    v_pk_fma_f32 v[116:117], v[116:117], s[0:1], s[0:1] op_sel:[0,1,1] op_sel_hi:[1,1,1]
    v_rcp_f32 v113, v113
    v_pk_fma_f32 v[118:119], v[118:119], s[0:1], s[0:1] op_sel:[0,1,1] op_sel_hi:[1,1,1]
    v_rcp_f32 v114, v114
    v_pk_mul_f32 v[168:169], v[112:113], v[168:169]
    v_rcp_f32 v115, v115
    v_cvt_pk_bf16_f32 v124, v168, v169
    v_rcp_f32 v116, v116
    v_pk_mul_f32 v[170:171], v[114:115], v[170:171]
    v_rcp_f32 v117, v117
    v_cvt_pk_bf16_f32 v125, v170, v171
    v_rcp_f32 v118, v118
    v_pk_mul_f32 v[184:185], v[116:117], v[184:185]
    v_rcp_f32 v119, v119
    v_cvt_pk_bf16_f32 v126, v184, v185
    v_pk_mul_f32 v[186:187], v[118:119], v[186:187]
    v_cvt_pk_bf16_f32 v127, v186, v187
    ds_write_b64 v84, v[124:125] offset:64
    ds_write_b64 v84, v[126:127] offset:96
    s_add_u32 s29, s17, 45184
    buffer_store_dwordx4 v[180:183], v86, s[12:15], s29 offen
    ds_read_b128 v[168:171], v85 offset:0
    ds_read_b128 v[184:187], v85 offset:1152
    s_waitcnt vmcnt(28)
    s_barrier
    s_cmp_lg_u32 s16, 2
    s_cbranch_scc1 L_sig3
    v_mov_b32 v14, 1
    s_and_b32 s26, s2, 3
    s_lshl_b32 s26, s26, 6
    s_mov_b64 exec, 1
    buffer_atomic_add v14, off, s[92:95], s26 offset:4
    s_mov_b64 exec, -1
L_sig3:
    s_add_u32 m0, s6, 106496
    s_add_u32 s7, s6, 106496
    buffer_load_dwordx4 v3, s[8:11], s7 offen offset:0 sc1 lds
    buffer_load_dwordx4 v3, s[8:11], s7 offen offset:1024 sc1 lds
    buffer_load_dwordx4 v3, s[8:11], s7 offen offset:2048 sc1 lds
    buffer_load_dwordx4 v3, s[8:11], s7 offen offset:3072 sc1 lds
    v_pk_fma_f32 v[112:113], v[140:141], v[140:141], s[0:1] op_sel_hi:[1,1,0] neg_lo:[1,0,0] neg_hi:[1,0,0]
    v_pk_mul_f32 v[112:113], v[112:113], v[140:141]
    v_exp_f32 v112, v112
    v_pk_fma_f32 v[114:115], v[142:143], v[142:143], s[0:1] op_sel_hi:[1,1,0] neg_lo:[1,0,0] neg_hi:[1,0,0]
    v_exp_f32 v113, v113
    v_pk_mul_f32 v[114:115], v[114:115], v[142:143]
    v_exp_f32 v114, v114
    v_pk_fma_f32 v[116:117], v[156:157], v[156:157], s[0:1] op_sel_hi:[1,1,0] neg_lo:[1,0,0] neg_hi:[1,0,0]
    v_exp_f32 v115, v115
    v_pk_mul_f32 v[116:117], v[116:117], v[156:157]
    v_exp_f32 v116, v116
    v_pk_fma_f32 v[118:119], v[158:159], v[158:159], s[0:1] op_sel_hi:[1,1,0] neg_lo:[1,0,0] neg_hi:[1,0,0]
    v_exp_f32 v117, v117
    v_pk_mul_f32 v[118:119], v[118:119], v[158:159]
    v_exp_f32 v118, v118
    v_pk_fma_f32 v[112:113], v[112:113], s[0:1], s[0:1] op_sel:[0,1,1] op_sel_hi:[1,1,1]
    s_add_u32 m0, s6, 110592
    s_add_u32 s7, s6, 110592
    buffer_load_dwordx4 v3, s[8:11], s7 offen offset:0 sc1 lds
    buffer_load_dwordx4 v3, s[8:11], s7 offen offset:1024 sc1 lds
    buffer_load_dwordx4 v3, s[8:11], s7 offen offset:2048 sc1 lds
    buffer_load_dwordx4 v3, s[8:11], s7 offen offset:3072 sc1 lds
    v_exp_f32 v119, v119
    v_pk_fma_f32 v[114:115], v[114:115], s[0:1], s[0:1] op_sel:[0,1,1] op_sel_hi:[1,1,1]
    v_rcp_f32 v112, v112
    v_pk_fma_f32 v[116:117], v[116:117], s[0:1], s[0:1] op_sel:[0,1,1] op_sel_hi:[1,1,1]
    v_rcp_f32 v113, v113
    v_pk_fma_f32 v[118:119], v[118:119], s[0:1], s[0:1] op_sel:[0,1,1] op_sel_hi:[1,1,1]
    v_rcp_f32 v114, v114
    v_pk_mul_f32 v[140:141], v[112:113], v[140:141]
    v_rcp_f32 v115, v115
    v_cvt_pk_bf16_f32 v120, v140, v141
    v_rcp_f32 v116, v116
    v_pk_mul_f32 v[142:143], v[114:115], v[142:143]
    v_rcp_f32 v117, v117
    v_cvt_pk_bf16_f32 v121, v142, v143
    v_rcp_f32 v118, v118
    v_pk_mul_f32 v[156:157], v[116:117], v[156:157]
    v_rcp_f32 v119, v119
    v_cvt_pk_bf16_f32 v122, v156, v157
    v_pk_mul_f32 v[158:159], v[118:119], v[158:159]
    v_cvt_pk_bf16_f32 v123, v158, v159
    ds_write_b64 v84, v[120:121] offset:0
    s_waitcnt lgkmcnt(14)
    ds_write_b64 v84, v[122:123] offset:32
    s_add_u32 s29, s17, 49280
    s_waitcnt lgkmcnt(3)
    buffer_store_dwordx4 v[168:171], v86, s[12:15], s29 offen
    v_pk_fma_f32 v[112:113], v[172:173], v[172:173], s[0:1] op_sel_hi:[1,1,0] neg_lo:[1,0,0] neg_hi:[1,0,0]
    v_pk_mul_f32 v[112:113], v[112:113], v[172:173]
    v_exp_f32 v112, v112
    v_pk_fma_f32 v[114:115], v[174:175], v[174:175], s[0:1] op_sel_hi:[1,1,0] neg_lo:[1,0,0] neg_hi:[1,0,0]
    v_exp_f32 v113, v113
    v_pk_mul_f32 v[114:115], v[114:115], v[174:175]
    v_exp_f32 v114, v114
    v_pk_fma_f32 v[116:117], v[188:189], v[188:189], s[0:1] op_sel_hi:[1,1,0] neg_lo:[1,0,0] neg_hi:[1,0,0]
    v_exp_f32 v115, v115
    v_pk_mul_f32 v[116:117], v[116:117], v[188:189]
    v_exp_f32 v116, v116
    v_pk_fma_f32 v[118:119], v[190:191], v[190:191], s[0:1] op_sel_hi:[1,1,0] neg_lo:[1,0,0] neg_hi:[1,0,0]
    v_exp_f32 v117, v117
    v_pk_mul_f32 v[118:119], v[118:119], v[190:191]
    v_exp_f32 v118, v118
    v_pk_fma_f32 v[112:113], v[112:113], s[0:1], s[0:1] op_sel:[0,1,1] op_sel_hi:[1,1,1]
    v_exp_f32 v119, v119
    v_pk_fma_f32 v[114:115], v[114:115], s[0:1], s[0:1] op_sel:[0,1,1] op_sel_hi:[1,1,1]
    v_rcp_f32 v112, v112
    v_pk_fma_f32 v[116:117], v[116:117], s[0:1], s[0:1] op_sel:[0,1,1] op_sel_hi:[1,1,1]
    v_rcp_f32 v113, v113
    v_pk_fma_f32 v[118:119], v[118:119], s[0:1], s[0:1] op_sel:[0,1,1] op_sel_hi:[1,1,1]
    v_rcp_f32 v114, v114
    v_pk_mul_f32 v[172:173], v[112:113], v[172:173]
    v_rcp_f32 v115, v115
    v_cvt_pk_bf16_f32 v124, v172, v173
    v_rcp_f32 v116, v116
    v_pk_mul_f32 v[174:175], v[114:115], v[174:175]
    v_rcp_f32 v117, v117
    v_cvt_pk_bf16_f32 v125, v174, v175
    v_rcp_f32 v118, v118
    v_pk_mul_f32 v[188:189], v[116:117], v[188:189]
    v_rcp_f32 v119, v119
    v_cvt_pk_bf16_f32 v126, v188, v189
    v_pk_mul_f32 v[190:191], v[118:119], v[190:191]
    v_cvt_pk_bf16_f32 v127, v190, v191
    ds_write_b64 v84, v[124:125] offset:64
    ds_write_b64 v84, v[126:127] offset:96
    s_add_u32 s29, s17, 53376
    s_waitcnt lgkmcnt(4)
    buffer_store_dwordx4 v[184:187], v86, s[12:15], s29 offen
    ds_read_b128 v[172:175], v85 offset:0
    ds_read_b128 v[188:191], v85 offset:1152
    s_add_u32 s29, s17, 57472
    s_waitcnt lgkmcnt(1)
    buffer_store_dwordx4 v[172:175], v86, s[12:15], s29 offen
    s_add_u32 s29, s17, 61568
    s_waitcnt lgkmcnt(0)
    buffer_store_dwordx4 v[188:191], v86, s[12:15], s29 offen
    v_lshrrev_b32 v12, 5, v2
    v_lshl_add_u32 v12, v12, 9, v3
    s_lshl_b32 s28, s22, 9
    s_mov_b32 m0, 143360
    s_add_u32 s29, s28, 0
    buffer_load_dwordx4 v12, s[44:47], s29 offen lds
    s_mov_b32 m0, 144384
    s_add_u32 s29, s28, 2048
    buffer_load_dwordx4 v12, s[44:47], s29 offen lds
    s_mov_b32 m0, 145408
    s_add_u32 s29, s28, 4096
    buffer_load_dwordx4 v12, s[44:47], s29 offen lds
    s_cmp_eq_u32 s21, 0
    s_cselect_b32 s46, s14, 0
    s_mov_b64 s[44:45], s[12:13]
    s_waitcnt vmcnt(25)
    s_waitcnt lgkmcnt(0)
L_pv_go:
    s_lshl_b32 s18, s19, 14
    s_add_u32 s18, s18, 131072
    s_sub_u32 s17, s25, 1
    s_barrier
    v_pk_mul_f32 v[224:225], 0, 0
    v_pk_mul_f32 v[226:227], 0, 0
    ds_read2st64_b64 a[144:147], v9 offset0:0 offset1:4
    ds_read2st64_b64 a[148:151], v9 offset0:1 offset1:5
    v_pk_mul_f32 v[228:229], 0, 0
    v_pk_mul_f32 v[230:231], 0, 0
    ds_read2st64_b64 a[152:155], v9 offset0:2 offset1:6
    ds_read2st64_b64 a[156:159], v9 offset0:3 offset1:7
    v_pk_mul_f32 v[232:233], 0, 0
    v_pk_mul_f32 v[234:235], 0, 0
    s_and_b32 m0, s18, 0x1ffff
    v_pk_mul_f32 v[236:237], 0, 0
    v_pk_mul_f32 v[238:239], 0, 0
    buffer_load_dwordx4 v3, s[8:11], s18 offen offset:0 sc1 lds
    v_pk_mul_f32 v[240:241], 0, 0
    v_pk_mul_f32 v[242:243], 0, 0
    v_pk_mul_f32 v[244:245], 0, 0
    v_pk_mul_f32 v[246:247], 0, 0
    v_pk_mul_f32 v[248:249], 0, 0
    v_pk_mul_f32 v[250:251], 0, 0
    buffer_load_dwordx4 v3, s[8:11], s18 offen offset:1024 sc1 lds
    v_pk_mul_f32 v[252:253], 0, 0
    v_pk_mul_f32 v[254:255], 0, 0
    s_waitcnt lgkmcnt(0)
    v_mfma_f32_16x16x32_bf16 a[0:3], a[16:19], a[144:147], 0
    ds_read_b64_tr_b16 a[80:81], v8 offset:32768
    v_mfma_f32_16x16x32_bf16 v[16:19], a[20:23], a[144:147], 0
    ds_read_b64_tr_b16 a[82:83], v8 offset:49152
    v_mfma_f32_16x16x32_bf16 a[4:7], a[16:19], a[148:151], 0
    buffer_load_dwordx4 v3, s[8:11], s18 offen offset:2048 sc1 lds
    v_mfma_f32_16x16x32_bf16 v[20:23], a[20:23], a[148:151], 0
    ds_read_b64_tr_b16 a[84:85], v8 offset:33280
    v_mfma_f32_16x16x32_bf16 a[8:11], a[16:19], a[152:155], 0
    ds_read_b64_tr_b16 a[86:87], v8 offset:49664
    v_mfma_f32_16x16x32_bf16 v[24:27], a[20:23], a[152:155], 0
    ds_read_b64_tr_b16 a[88:89], v8 offset:33792
    v_mfma_f32_16x16x32_bf16 a[12:15], a[16:19], a[156:159], 0
    buffer_load_dwordx4 v3, s[8:11], s18 offen offset:3072 sc1 lds
    v_mfma_f32_16x16x32_bf16 v[28:31], a[20:23], a[156:159], 0
    ds_read_b64_tr_b16 a[90:91], v8 offset:50176
    v_mfma_f32_16x16x32_bf16 v[44:47], a[24:27], a[156:159], 0
    ds_read_b64_tr_b16 a[92:93], v8 offset:34304
    v_mfma_f32_16x16x32_bf16 v[60:63], a[28:31], a[156:159], 0
    ds_read_b64_tr_b16 a[94:95], v8 offset:50688
    s_add_u32 m0, m0, 4096
    v_mfma_f32_16x16x32_bf16 v[40:43], a[24:27], a[152:155], 0
    buffer_load_dwordx4 v5, s[8:11], s18 offen offset:0 sc1 lds
    v_mfma_f32_16x16x32_bf16 v[56:59], a[28:31], a[152:155], 0
    ds_read_b64_tr_b16 a[96:97], v8 offset:34816
    v_mfma_f32_16x16x32_bf16 v[36:39], a[24:27], a[148:151], 0
    ds_read_b64_tr_b16 a[98:99], v8 offset:51200
    v_mfma_f32_16x16x32_bf16 v[52:55], a[28:31], a[148:151], 0
    buffer_load_dwordx4 v5, s[8:11], s18 offen offset:1024 sc1 lds
    v_mfma_f32_16x16x32_bf16 v[32:35], a[24:27], a[144:147], 0
    ds_read_b64_tr_b16 a[100:101], v8 offset:35328
    v_mfma_f32_16x16x32_bf16 v[48:51], a[28:31], a[144:147], 0
    ds_read_b64_tr_b16 a[102:103], v8 offset:51712
    v_mfma_f32_16x16x32_bf16 v[64:67], a[32:35], a[144:147], 0
    ds_read_b64_tr_b16 a[104:105], v8 offset:35840
    v_mfma_f32_16x16x32_bf16 v[80:83], a[36:39], a[144:147], 0
    buffer_load_dwordx4 v5, s[8:11], s18 offen offset:2048 sc1 lds
    v_mfma_f32_16x16x32_bf16 v[68:71], a[32:35], a[148:151], 0
    ds_read_b64_tr_b16 a[106:107], v8 offset:52224
    v_mfma_f32_16x16x32_bf16 v[84:87], a[36:39], a[148:151], 0
    ds_read_b64_tr_b16 a[108:109], v8 offset:36352
    v_mfma_f32_16x16x32_bf16 v[72:75], a[32:35], a[152:155], 0
    ds_read_b64_tr_b16 a[110:111], v8 offset:52736
    v_mfma_f32_16x16x32_bf16 v[88:91], a[36:39], a[152:155], 0
    buffer_load_dwordx4 v5, s[8:11], s18 offen offset:3072 sc1 lds
    v_mfma_f32_16x16x32_bf16 v[76:79], a[32:35], a[156:159], 0
    ds_read_b64_tr_b16 a[112:113], v11 offset:32768
    v_mfma_f32_16x16x32_bf16 v[92:95], a[36:39], a[156:159], 0
    ds_read_b64_tr_b16 a[114:115], v11 offset:49152
    v_mfma_f32_16x16x32_bf16 v[108:111], a[40:43], a[156:159], 0
    ds_read_b64_tr_b16 a[116:117], v11 offset:33280
    s_add_u32 m0, m0, 4096
    v_mfma_f32_16x16x32_bf16 v[124:127], a[44:47], a[156:159], 0
    buffer_load_dwordx4 v6, s[8:11], s18 offen offset:0 sc1 lds
    v_mfma_f32_16x16x32_bf16 v[104:107], a[40:43], a[152:155], 0
    ds_read_b64_tr_b16 a[118:119], v11 offset:49664
    v_mfma_f32_16x16x32_bf16 v[120:123], a[44:47], a[152:155], 0
    ds_read_b64_tr_b16 a[120:121], v11 offset:33792
    v_mfma_f32_16x16x32_bf16 v[100:103], a[40:43], a[148:151], 0
    buffer_load_dwordx4 v6, s[8:11], s18 offen offset:1024 sc1 lds
    v_mfma_f32_16x16x32_bf16 v[116:119], a[44:47], a[148:151], 0
    ds_read_b64_tr_b16 a[122:123], v11 offset:50176
    v_mfma_f32_16x16x32_bf16 v[96:99], a[40:43], a[144:147], 0
    ds_read_b64_tr_b16 a[124:125], v11 offset:34304
    v_mfma_f32_16x16x32_bf16 v[112:115], a[44:47], a[144:147], 0
    ds_read_b64_tr_b16 a[126:127], v11 offset:50688
    v_mfma_f32_16x16x32_bf16 v[128:131], a[48:51], a[144:147], 0
    buffer_load_dwordx4 v6, s[8:11], s18 offen offset:2048 sc1 lds
    v_mfma_f32_16x16x32_bf16 v[144:147], a[52:55], a[144:147], 0
    ds_read_b64_tr_b16 a[128:129], v11 offset:34816
    v_mfma_f32_16x16x32_bf16 v[132:135], a[48:51], a[148:151], 0
    ds_read_b64_tr_b16 a[130:131], v11 offset:51200
    v_mfma_f32_16x16x32_bf16 v[148:151], a[52:55], a[148:151], 0
    ds_read_b64_tr_b16 a[132:133], v11 offset:35328
    v_mfma_f32_16x16x32_bf16 v[136:139], a[48:51], a[152:155], 0
    buffer_load_dwordx4 v6, s[8:11], s18 offen offset:3072 sc1 lds
    v_mfma_f32_16x16x32_bf16 v[152:155], a[52:55], a[152:155], 0
    ds_read_b64_tr_b16 a[134:135], v11 offset:51712
    v_mfma_f32_16x16x32_bf16 v[140:143], a[48:51], a[156:159], 0
    ds_read_b64_tr_b16 a[136:137], v11 offset:35840
    v_mfma_f32_16x16x32_bf16 v[156:159], a[52:55], a[156:159], 0
    ds_read_b64_tr_b16 a[138:139], v11 offset:52224
    s_add_u32 m0, m0, 4096
    v_mfma_f32_16x16x32_bf16 v[172:175], a[56:59], a[156:159], 0
    buffer_load_dwordx4 v7, s[8:11], s18 offen offset:0 sc1 lds
    v_mfma_f32_16x16x32_bf16 v[188:191], a[60:63], a[156:159], 0
    ds_read_b64_tr_b16 a[140:141], v11 offset:36352
    v_mfma_f32_16x16x32_bf16 v[168:171], a[56:59], a[152:155], 0
    ds_read_b64_tr_b16 a[142:143], v11 offset:52736
    v_mfma_f32_16x16x32_bf16 v[184:187], a[60:63], a[152:155], 0
    buffer_load_dwordx4 v7, s[8:11], s18 offen offset:1024 sc1 lds
    v_mfma_f32_16x16x32_bf16 v[164:167], a[56:59], a[148:151], 0
    v_mfma_f32_16x16x32_bf16 v[180:183], a[60:63], a[148:151], 0
    v_mfma_f32_16x16x32_bf16 v[160:163], a[56:59], a[144:147], 0
    v_mfma_f32_16x16x32_bf16 v[176:179], a[60:63], a[144:147], 0
    buffer_load_dwordx4 v7, s[8:11], s18 offen offset:2048 sc1 lds
    v_mfma_f32_16x16x32_bf16 v[192:195], a[64:67], a[144:147], 0
    v_mfma_f32_16x16x32_bf16 v[208:211], a[68:71], a[144:147], 0
    s_sub_u32 s17, s17, 1
    v_mfma_f32_16x16x32_bf16 v[196:199], a[64:67], a[148:151], 0
    v_mfma_f32_16x16x32_bf16 v[212:215], a[68:71], a[148:151], 0
    buffer_load_dwordx4 v7, s[8:11], s18 offen offset:3072 sc1 lds
    v_mfma_f32_16x16x32_bf16 v[200:203], a[64:67], a[152:155], 0
    s_add_u32 s18, s18, 32768
    s_cmp_eq_u32 s17, 3
    s_cselect_b64 s[8:9], s[98:99], s[8:9]
    s_cselect_b32 s10, s100, s10
    v_mfma_f32_16x16x32_bf16 v[216:219], a[68:71], a[152:155], 0
    s_cmp_eq_u32 s17, 1
    s_cselect_b64 s[8:9], s[96:97], s[8:9]
    s_cselect_b32 s10, s3, s10
    s_cmp_eq_u32 s17, 0
    v_mfma_f32_16x16x32_bf16 v[204:207], a[64:67], a[156:159], 0
    v_mfma_f32_16x16x32_bf16 v[220:223], a[68:71], a[156:159], 0
    s_waitcnt vmcnt(16) lgkmcnt(0)
    s_barrier
    s_branch L_pv_in
.p2align 6
L_pv_loop:
    v_mfma_f32_16x16x32_bf16 v[196:199], a[128:131], a[164:167], v[196:199]
    v_mfma_f32_16x16x32_bf16 v[212:215], a[132:135], a[164:167], v[212:215]
    buffer_load_dwordx4 v7, s[8:11], s18 offen offset:3072 sc1 lds
    v_mfma_f32_16x16x32_bf16 v[200:203], a[128:131], a[168:171], v[200:203]
    s_add_u32 s18, s18, 32768
    s_cmp_eq_u32 s17, 3
    s_cselect_b64 s[8:9], s[98:99], s[8:9]
    s_cselect_b32 s10, s100, s10
    v_mfma_f32_16x16x32_bf16 v[216:219], a[132:135], a[168:171], v[216:219]
    s_cmp_eq_u32 s17, 1
    s_cselect_b64 s[8:9], s[96:97], s[8:9]
    s_cselect_b32 s10, s3, s10
    s_cmp_eq_u32 s17, 0
    v_mfma_f32_16x16x32_bf16 v[204:207], a[128:131], a[172:175], v[204:207]
    s_cbranch_scc1 L_pv_exit0
    v_mfma_f32_16x16x32_bf16 v[220:223], a[132:135], a[172:175], v[220:223]
    s_waitcnt vmcnt(16) lgkmcnt(0)
    s_barrier
    v_mfma_f32_16x16x32_bf16 v[236:239], a[136:139], a[172:175], v[236:239]
    ds_read2st64_b64 a[144:147], v9 offset0:0 offset1:4
    ds_read2st64_b64 a[148:151], v9 offset0:1 offset1:5
    v_mfma_f32_16x16x32_bf16 v[252:255], a[140:143], a[172:175], v[252:255]
    ds_read2st64_b64 a[152:155], v9 offset0:2 offset1:6
    ds_read2st64_b64 a[156:159], v9 offset0:3 offset1:7
    v_mfma_f32_16x16x32_bf16 v[232:235], a[136:139], a[168:171], v[232:235]
    s_and_b32 m0, s18, 0x1ffff
    v_mfma_f32_16x16x32_bf16 v[248:251], a[140:143], a[168:171], v[248:251]
    buffer_load_dwordx4 v3, s[8:11], s18 offen offset:0 sc1 lds
    v_mfma_f32_16x16x32_bf16 v[228:231], a[136:139], a[164:167], v[228:231]
    v_mfma_f32_16x16x32_bf16 v[244:247], a[140:143], a[164:167], v[244:247]
    v_mfma_f32_16x16x32_bf16 v[224:227], a[136:139], a[160:163], v[224:227]
    buffer_load_dwordx4 v3, s[8:11], s18 offen offset:1024 sc1 lds
    v_mfma_f32_16x16x32_bf16 v[240:243], a[140:143], a[160:163], v[240:243]
    s_waitcnt lgkmcnt(0)
    v_mfma_f32_16x16x32_bf16 a[0:3], a[16:19], a[144:147], a[0:3]
    ds_read_b64_tr_b16 a[80:81], v8 offset:32768
    v_mfma_f32_16x16x32_bf16 v[16:19], a[20:23], a[144:147], v[16:19]
    ds_read_b64_tr_b16 a[82:83], v8 offset:49152
    v_mfma_f32_16x16x32_bf16 a[4:7], a[16:19], a[148:151], a[4:7]
    buffer_load_dwordx4 v3, s[8:11], s18 offen offset:2048 sc1 lds
    v_mfma_f32_16x16x32_bf16 v[20:23], a[20:23], a[148:151], v[20:23]
    ds_read_b64_tr_b16 a[84:85], v8 offset:33280
    v_mfma_f32_16x16x32_bf16 a[8:11], a[16:19], a[152:155], a[8:11]
    ds_read_b64_tr_b16 a[86:87], v8 offset:49664
    v_mfma_f32_16x16x32_bf16 v[24:27], a[20:23], a[152:155], v[24:27]
    ds_read_b64_tr_b16 a[88:89], v8 offset:33792
    v_mfma_f32_16x16x32_bf16 a[12:15], a[16:19], a[156:159], a[12:15]
    buffer_load_dwordx4 v3, s[8:11], s18 offen offset:3072 sc1 lds
    v_mfma_f32_16x16x32_bf16 v[28:31], a[20:23], a[156:159], v[28:31]
    ds_read_b64_tr_b16 a[90:91], v8 offset:50176
    v_mfma_f32_16x16x32_bf16 v[44:47], a[24:27], a[156:159], v[44:47]
    ds_read_b64_tr_b16 a[92:93], v8 offset:34304
    v_mfma_f32_16x16x32_bf16 v[60:63], a[28:31], a[156:159], v[60:63]
    ds_read_b64_tr_b16 a[94:95], v8 offset:50688
    s_add_u32 m0, m0, 4096
    v_mfma_f32_16x16x32_bf16 v[40:43], a[24:27], a[152:155], v[40:43]
    buffer_load_dwordx4 v5, s[8:11], s18 offen offset:0 sc1 lds
    v_mfma_f32_16x16x32_bf16 v[56:59], a[28:31], a[152:155], v[56:59]
    ds_read_b64_tr_b16 a[96:97], v8 offset:34816
    v_mfma_f32_16x16x32_bf16 v[36:39], a[24:27], a[148:151], v[36:39]
    ds_read_b64_tr_b16 a[98:99], v8 offset:51200
    v_mfma_f32_16x16x32_bf16 v[52:55], a[28:31], a[148:151], v[52:55]
    buffer_load_dwordx4 v5, s[8:11], s18 offen offset:1024 sc1 lds
    v_mfma_f32_16x16x32_bf16 v[32:35], a[24:27], a[144:147], v[32:35]
    ds_read_b64_tr_b16 a[100:101], v8 offset:35328
    v_mfma_f32_16x16x32_bf16 v[48:51], a[28:31], a[144:147], v[48:51]
    ds_read_b64_tr_b16 a[102:103], v8 offset:51712
    v_mfma_f32_16x16x32_bf16 v[64:67], a[32:35], a[144:147], v[64:67]
    ds_read_b64_tr_b16 a[104:105], v8 offset:35840
    v_mfma_f32_16x16x32_bf16 v[80:83], a[36:39], a[144:147], v[80:83]
    buffer_load_dwordx4 v5, s[8:11], s18 offen offset:2048 sc1 lds
    v_mfma_f32_16x16x32_bf16 v[68:71], a[32:35], a[148:151], v[68:71]
    ds_read_b64_tr_b16 a[106:107], v8 offset:52224
    v_mfma_f32_16x16x32_bf16 v[84:87], a[36:39], a[148:151], v[84:87]
    ds_read_b64_tr_b16 a[108:109], v8 offset:36352
    v_mfma_f32_16x16x32_bf16 v[72:75], a[32:35], a[152:155], v[72:75]
    ds_read_b64_tr_b16 a[110:111], v8 offset:52736
    v_mfma_f32_16x16x32_bf16 v[88:91], a[36:39], a[152:155], v[88:91]
    buffer_load_dwordx4 v5, s[8:11], s18 offen offset:3072 sc1 lds
    v_mfma_f32_16x16x32_bf16 v[76:79], a[32:35], a[156:159], v[76:79]
    ds_read_b64_tr_b16 a[112:113], v11 offset:32768
    v_mfma_f32_16x16x32_bf16 v[92:95], a[36:39], a[156:159], v[92:95]
    ds_read_b64_tr_b16 a[114:115], v11 offset:49152
    v_mfma_f32_16x16x32_bf16 v[108:111], a[40:43], a[156:159], v[108:111]
    ds_read_b64_tr_b16 a[116:117], v11 offset:33280
    s_add_u32 m0, m0, 4096
    v_mfma_f32_16x16x32_bf16 v[124:127], a[44:47], a[156:159], v[124:127]
    buffer_load_dwordx4 v6, s[8:11], s18 offen offset:0 sc1 lds
    v_mfma_f32_16x16x32_bf16 v[104:107], a[40:43], a[152:155], v[104:107]
    ds_read_b64_tr_b16 a[118:119], v11 offset:49664
    v_mfma_f32_16x16x32_bf16 v[120:123], a[44:47], a[152:155], v[120:123]
    ds_read_b64_tr_b16 a[120:121], v11 offset:33792
    v_mfma_f32_16x16x32_bf16 v[100:103], a[40:43], a[148:151], v[100:103]
    buffer_load_dwordx4 v6, s[8:11], s18 offen offset:1024 sc1 lds
    v_mfma_f32_16x16x32_bf16 v[116:119], a[44:47], a[148:151], v[116:119]
    ds_read_b64_tr_b16 a[122:123], v11 offset:50176
    v_mfma_f32_16x16x32_bf16 v[96:99], a[40:43], a[144:147], v[96:99]
    ds_read_b64_tr_b16 a[124:125], v11 offset:34304
    v_mfma_f32_16x16x32_bf16 v[112:115], a[44:47], a[144:147], v[112:115]
    ds_read_b64_tr_b16 a[126:127], v11 offset:50688
    v_mfma_f32_16x16x32_bf16 v[128:131], a[48:51], a[144:147], v[128:131]
    buffer_load_dwordx4 v6, s[8:11], s18 offen offset:2048 sc1 lds
    v_mfma_f32_16x16x32_bf16 v[144:147], a[52:55], a[144:147], v[144:147]
    ds_read_b64_tr_b16 a[128:129], v11 offset:34816
    v_mfma_f32_16x16x32_bf16 v[132:135], a[48:51], a[148:151], v[132:135]
    ds_read_b64_tr_b16 a[130:131], v11 offset:51200
    v_mfma_f32_16x16x32_bf16 v[148:151], a[52:55], a[148:151], v[148:151]
    ds_read_b64_tr_b16 a[132:133], v11 offset:35328
    v_mfma_f32_16x16x32_bf16 v[136:139], a[48:51], a[152:155], v[136:139]
    buffer_load_dwordx4 v6, s[8:11], s18 offen offset:3072 sc1 lds
    v_mfma_f32_16x16x32_bf16 v[152:155], a[52:55], a[152:155], v[152:155]
    ds_read_b64_tr_b16 a[134:135], v11 offset:51712
    v_mfma_f32_16x16x32_bf16 v[140:143], a[48:51], a[156:159], v[140:143]
    ds_read_b64_tr_b16 a[136:137], v11 offset:35840
    v_mfma_f32_16x16x32_bf16 v[156:159], a[52:55], a[156:159], v[156:159]
    ds_read_b64_tr_b16 a[138:139], v11 offset:52224
    s_add_u32 m0, m0, 4096
    v_mfma_f32_16x16x32_bf16 v[172:175], a[56:59], a[156:159], v[172:175]
    buffer_load_dwordx4 v7, s[8:11], s18 offen offset:0 sc1 lds
    v_mfma_f32_16x16x32_bf16 v[188:191], a[60:63], a[156:159], v[188:191]
    ds_read_b64_tr_b16 a[140:141], v11 offset:36352
    v_mfma_f32_16x16x32_bf16 v[168:171], a[56:59], a[152:155], v[168:171]
    ds_read_b64_tr_b16 a[142:143], v11 offset:52736
    v_mfma_f32_16x16x32_bf16 v[184:187], a[60:63], a[152:155], v[184:187]
    buffer_load_dwordx4 v7, s[8:11], s18 offen offset:1024 sc1 lds
    v_mfma_f32_16x16x32_bf16 v[164:167], a[56:59], a[148:151], v[164:167]
    v_mfma_f32_16x16x32_bf16 v[180:183], a[60:63], a[148:151], v[180:183]
    v_mfma_f32_16x16x32_bf16 v[160:163], a[56:59], a[144:147], v[160:163]
    v_mfma_f32_16x16x32_bf16 v[176:179], a[60:63], a[144:147], v[176:179]
    buffer_load_dwordx4 v7, s[8:11], s18 offen offset:2048 sc1 lds
    v_mfma_f32_16x16x32_bf16 v[192:195], a[64:67], a[144:147], v[192:195]
    v_mfma_f32_16x16x32_bf16 v[208:211], a[68:71], a[144:147], v[208:211]
    s_sub_u32 s17, s17, 1
    v_mfma_f32_16x16x32_bf16 v[196:199], a[64:67], a[148:151], v[196:199]
    v_mfma_f32_16x16x32_bf16 v[212:215], a[68:71], a[148:151], v[212:215]
    buffer_load_dwordx4 v7, s[8:11], s18 offen offset:3072 sc1 lds
    v_mfma_f32_16x16x32_bf16 v[200:203], a[64:67], a[152:155], v[200:203]
    s_add_u32 s18, s18, 32768
    s_cmp_eq_u32 s17, 3
    s_cselect_b64 s[8:9], s[98:99], s[8:9]
    s_cselect_b32 s10, s100, s10
    v_mfma_f32_16x16x32_bf16 v[216:219], a[68:71], a[152:155], v[216:219]
    s_cmp_eq_u32 s17, 1
    s_cselect_b64 s[8:9], s[96:97], s[8:9]
    s_cselect_b32 s10, s3, s10
    s_cmp_eq_u32 s17, 0
    v_mfma_f32_16x16x32_bf16 v[204:207], a[64:67], a[156:159], v[204:207]
    s_cbranch_scc1 L_pv_exit1
    v_mfma_f32_16x16x32_bf16 v[220:223], a[68:71], a[156:159], v[220:223]
    s_waitcnt vmcnt(16) lgkmcnt(0)
    s_barrier
L_pv_in:
    v_mfma_f32_16x16x32_bf16 v[236:239], a[72:75], a[156:159], v[236:239]
    ds_read2st64_b64 a[160:163], v9 offset0:8 offset1:12
    ds_read2st64_b64 a[164:167], v9 offset0:9 offset1:13
    v_mfma_f32_16x16x32_bf16 v[252:255], a[76:79], a[156:159], v[252:255]
    ds_read2st64_b64 a[168:171], v9 offset0:10 offset1:14
    ds_read2st64_b64 a[172:175], v9 offset0:11 offset1:15
    v_mfma_f32_16x16x32_bf16 v[232:235], a[72:75], a[152:155], v[232:235]
    s_and_b32 m0, s18, 0x1ffff
    v_mfma_f32_16x16x32_bf16 v[248:251], a[76:79], a[152:155], v[248:251]
    buffer_load_dwordx4 v3, s[8:11], s18 offen offset:0 sc1 lds
    v_mfma_f32_16x16x32_bf16 v[228:231], a[72:75], a[148:151], v[228:231]
    v_xor_b32 v8, 0x10000, v8
    v_xor_b32 v11, 0x10000, v11
    v_mfma_f32_16x16x32_bf16 v[244:247], a[76:79], a[148:151], v[244:247]
    v_mfma_f32_16x16x32_bf16 v[224:227], a[72:75], a[144:147], v[224:227]
    buffer_load_dwordx4 v3, s[8:11], s18 offen offset:1024 sc1 lds
    v_mfma_f32_16x16x32_bf16 v[240:243], a[76:79], a[144:147], v[240:243]
    s_waitcnt lgkmcnt(0)
    v_mfma_f32_16x16x32_bf16 a[0:3], a[80:83], a[160:163], a[0:3]
    ds_read_b64_tr_b16 a[16:17], v8 offset:0
    v_mfma_f32_16x16x32_bf16 v[16:19], a[84:87], a[160:163], v[16:19]
    ds_read_b64_tr_b16 a[18:19], v8 offset:16384
    v_mfma_f32_16x16x32_bf16 a[4:7], a[80:83], a[164:167], a[4:7]
    buffer_load_dwordx4 v3, s[8:11], s18 offen offset:2048 sc1 lds
    v_mfma_f32_16x16x32_bf16 v[20:23], a[84:87], a[164:167], v[20:23]
    ds_read_b64_tr_b16 a[20:21], v8 offset:512
    v_mfma_f32_16x16x32_bf16 a[8:11], a[80:83], a[168:171], a[8:11]
    ds_read_b64_tr_b16 a[22:23], v8 offset:16896
    v_mfma_f32_16x16x32_bf16 v[24:27], a[84:87], a[168:171], v[24:27]
    ds_read_b64_tr_b16 a[24:25], v8 offset:1024
    v_mfma_f32_16x16x32_bf16 a[12:15], a[80:83], a[172:175], a[12:15]
    buffer_load_dwordx4 v3, s[8:11], s18 offen offset:3072 sc1 lds
    v_mfma_f32_16x16x32_bf16 v[28:31], a[84:87], a[172:175], v[28:31]
    ds_read_b64_tr_b16 a[26:27], v8 offset:17408
    v_mfma_f32_16x16x32_bf16 v[44:47], a[88:91], a[172:175], v[44:47]
    ds_read_b64_tr_b16 a[28:29], v8 offset:1536
    v_mfma_f32_16x16x32_bf16 v[60:63], a[92:95], a[172:175], v[60:63]
    ds_read_b64_tr_b16 a[30:31], v8 offset:17920
    s_add_u32 m0, m0, 4096
    v_mfma_f32_16x16x32_bf16 v[40:43], a[88:91], a[168:171], v[40:43]
    buffer_load_dwordx4 v5, s[8:11], s18 offen offset:0 sc1 lds
    v_mfma_f32_16x16x32_bf16 v[56:59], a[92:95], a[168:171], v[56:59]
    ds_read_b64_tr_b16 a[32:33], v8 offset:2048
    v_mfma_f32_16x16x32_bf16 v[36:39], a[88:91], a[164:167], v[36:39]
    ds_read_b64_tr_b16 a[34:35], v8 offset:18432
    v_mfma_f32_16x16x32_bf16 v[52:55], a[92:95], a[164:167], v[52:55]
    buffer_load_dwordx4 v5, s[8:11], s18 offen offset:1024 sc1 lds
    v_mfma_f32_16x16x32_bf16 v[32:35], a[88:91], a[160:163], v[32:35]
    ds_read_b64_tr_b16 a[36:37], v8 offset:2560
    v_mfma_f32_16x16x32_bf16 v[48:51], a[92:95], a[160:163], v[48:51]
    ds_read_b64_tr_b16 a[38:39], v8 offset:18944
    v_mfma_f32_16x16x32_bf16 v[64:67], a[96:99], a[160:163], v[64:67]
    ds_read_b64_tr_b16 a[40:41], v8 offset:3072
    v_mfma_f32_16x16x32_bf16 v[80:83], a[100:103], a[160:163], v[80:83]
    buffer_load_dwordx4 v5, s[8:11], s18 offen offset:2048 sc1 lds
    v_mfma_f32_16x16x32_bf16 v[68:71], a[96:99], a[164:167], v[68:71]
    ds_read_b64_tr_b16 a[42:43], v8 offset:19456
    v_mfma_f32_16x16x32_bf16 v[84:87], a[100:103], a[164:167], v[84:87]
    ds_read_b64_tr_b16 a[44:45], v8 offset:3584
    v_mfma_f32_16x16x32_bf16 v[72:75], a[96:99], a[168:171], v[72:75]
    ds_read_b64_tr_b16 a[46:47], v8 offset:19968
    v_mfma_f32_16x16x32_bf16 v[88:91], a[100:103], a[168:171], v[88:91]
    buffer_load_dwordx4 v5, s[8:11], s18 offen offset:3072 sc1 lds
    v_mfma_f32_16x16x32_bf16 v[76:79], a[96:99], a[172:175], v[76:79]
    ds_read_b64_tr_b16 a[48:49], v11 offset:0
    v_mfma_f32_16x16x32_bf16 v[92:95], a[100:103], a[172:175], v[92:95]
    ds_read_b64_tr_b16 a[50:51], v11 offset:16384
    v_mfma_f32_16x16x32_bf16 v[108:111], a[104:107], a[172:175], v[108:111]
    ds_read_b64_tr_b16 a[52:53], v11 offset:512
    s_add_u32 m0, m0, 4096
    v_mfma_f32_16x16x32_bf16 v[124:127], a[108:111], a[172:175], v[124:127]
    buffer_load_dwordx4 v6, s[8:11], s18 offen offset:0 sc1 lds
    v_mfma_f32_16x16x32_bf16 v[104:107], a[104:107], a[168:171], v[104:107]
    ds_read_b64_tr_b16 a[54:55], v11 offset:16896
    v_mfma_f32_16x16x32_bf16 v[120:123], a[108:111], a[168:171], v[120:123]
    ds_read_b64_tr_b16 a[56:57], v11 offset:1024
    v_mfma_f32_16x16x32_bf16 v[100:103], a[104:107], a[164:167], v[100:103]
    buffer_load_dwordx4 v6, s[8:11], s18 offen offset:1024 sc1 lds
    v_mfma_f32_16x16x32_bf16 v[116:119], a[108:111], a[164:167], v[116:119]
    ds_read_b64_tr_b16 a[58:59], v11 offset:17408
    v_mfma_f32_16x16x32_bf16 v[96:99], a[104:107], a[160:163], v[96:99]
    ds_read_b64_tr_b16 a[60:61], v11 offset:1536
    v_mfma_f32_16x16x32_bf16 v[112:115], a[108:111], a[160:163], v[112:115]
    ds_read_b64_tr_b16 a[62:63], v11 offset:17920
    v_mfma_f32_16x16x32_bf16 v[128:131], a[112:115], a[160:163], v[128:131]
    buffer_load_dwordx4 v6, s[8:11], s18 offen offset:2048 sc1 lds
    v_mfma_f32_16x16x32_bf16 v[144:147], a[116:119], a[160:163], v[144:147]
    ds_read_b64_tr_b16 a[64:65], v11 offset:2048
    v_mfma_f32_16x16x32_bf16 v[132:135], a[112:115], a[164:167], v[132:135]
    ds_read_b64_tr_b16 a[66:67], v11 offset:18432
    v_mfma_f32_16x16x32_bf16 v[148:151], a[116:119], a[164:167], v[148:151]
    ds_read_b64_tr_b16 a[68:69], v11 offset:2560
    v_mfma_f32_16x16x32_bf16 v[136:139], a[112:115], a[168:171], v[136:139]
    buffer_load_dwordx4 v6, s[8:11], s18 offen offset:3072 sc1 lds
    v_mfma_f32_16x16x32_bf16 v[152:155], a[116:119], a[168:171], v[152:155]
    ds_read_b64_tr_b16 a[70:71], v11 offset:18944
    v_mfma_f32_16x16x32_bf16 v[140:143], a[112:115], a[172:175], v[140:143]
    ds_read_b64_tr_b16 a[72:73], v11 offset:3072
    v_mfma_f32_16x16x32_bf16 v[156:159], a[116:119], a[172:175], v[156:159]
    ds_read_b64_tr_b16 a[74:75], v11 offset:19456
    s_add_u32 m0, m0, 4096
    v_mfma_f32_16x16x32_bf16 v[172:175], a[120:123], a[172:175], v[172:175]
    buffer_load_dwordx4 v7, s[8:11], s18 offen offset:0 sc1 lds
    v_mfma_f32_16x16x32_bf16 v[188:191], a[124:127], a[172:175], v[188:191]
    ds_read_b64_tr_b16 a[76:77], v11 offset:3584
    v_mfma_f32_16x16x32_bf16 v[168:171], a[120:123], a[168:171], v[168:171]
    ds_read_b64_tr_b16 a[78:79], v11 offset:19968
    v_mfma_f32_16x16x32_bf16 v[184:187], a[124:127], a[168:171], v[184:187]
    buffer_load_dwordx4 v7, s[8:11], s18 offen offset:1024 sc1 lds
    v_mfma_f32_16x16x32_bf16 v[164:167], a[120:123], a[164:167], v[164:167]
    v_mfma_f32_16x16x32_bf16 v[180:183], a[124:127], a[164:167], v[180:183]
    v_mfma_f32_16x16x32_bf16 v[160:163], a[120:123], a[160:163], v[160:163]
    v_mfma_f32_16x16x32_bf16 v[176:179], a[124:127], a[160:163], v[176:179]
    buffer_load_dwordx4 v7, s[8:11], s18 offen offset:2048 sc1 lds
    v_mfma_f32_16x16x32_bf16 v[192:195], a[128:131], a[160:163], v[192:195]
    v_mfma_f32_16x16x32_bf16 v[208:211], a[132:135], a[160:163], v[208:211]
    s_sub_u32 s17, s17, 1
    s_branch L_pv_loop
.p2align 2
L_pv_exit0:
    v_mfma_f32_16x16x32_bf16 v[220:223], a[132:135], a[172:175], v[220:223]
    s_waitcnt vmcnt(16) lgkmcnt(0)
    s_barrier
L_pv_last1:
    v_mfma_f32_16x16x32_bf16 v[236:239], a[136:139], a[172:175], v[236:239]
    ds_read2st64_b64 a[144:147], v9 offset0:0 offset1:4
    ds_read2st64_b64 a[148:151], v9 offset0:1 offset1:5
    v_mfma_f32_16x16x32_bf16 v[252:255], a[140:143], a[172:175], v[252:255]
    ds_read2st64_b64 a[152:155], v9 offset0:2 offset1:6
    ds_read2st64_b64 a[156:159], v9 offset0:3 offset1:7
    v_mfma_f32_16x16x32_bf16 v[232:235], a[136:139], a[168:171], v[232:235]
    ds_read2st64_b32 v[4:5], v1 offset0:0 offset1:2
    v_mfma_f32_16x16x32_bf16 v[248:251], a[140:143], a[168:171], v[248:251]
    v_mfma_f32_16x16x32_bf16 v[228:231], a[136:139], a[164:167], v[228:231]
    v_mfma_f32_16x16x32_bf16 v[244:247], a[140:143], a[164:167], v[244:247]
    v_mfma_f32_16x16x32_bf16 v[224:227], a[136:139], a[160:163], v[224:227]
    v_mfma_f32_16x16x32_bf16 v[240:243], a[140:143], a[160:163], v[240:243]
    s_waitcnt lgkmcnt(0)
    v_mfma_f32_16x16x32_bf16 a[0:3], a[16:19], a[144:147], a[0:3]
    v_mfma_f32_16x16x32_bf16 v[16:19], a[20:23], a[144:147], v[16:19]
    s_waitcnt lgkmcnt(0)
    v_add_f32 v4, v4, v5
    v_cmp_nle_f32 vcc, s101, v4
    s_cmp_eq_u32 s101, 0
    s_cselect_b64 s[28:29], 0, vcc
    s_cmp_lg_u64 s[28:29], 0
    s_cbranch_scc1 L_redo
    v_mfma_f32_16x16x32_bf16 a[4:7], a[16:19], a[148:151], a[4:7]
    v_mfma_f32_16x16x32_bf16 v[20:23], a[20:23], a[148:151], v[20:23]
    v_mfma_f32_16x16x32_bf16 a[8:11], a[16:19], a[152:155], a[8:11]
    v_mfma_f32_16x16x32_bf16 v[24:27], a[20:23], a[152:155], v[24:27]
    s_nop 0
    v_mfma_f32_16x16x32_bf16 a[12:15], a[16:19], a[156:159], a[12:15]
    s_nop 0
    v_mfma_f32_16x16x32_bf16 v[28:31], a[20:23], a[156:159], v[28:31]
    v_accvgpr_read_b32 v4, a0
    v_accvgpr_read_b32 v5, a1
    v_accvgpr_read_b32 v6, a2
    v_mfma_f32_16x16x32_bf16 v[44:47], a[24:27], a[156:159], v[44:47]
    v_accvgpr_read_b32 v7, a3
    v_cvt_pk_bf16_f32 v19, v18, v19
    v_cvt_pk_bf16_f32 v18, v16, v17
    v_mfma_f32_16x16x32_bf16 v[60:63], a[28:31], a[156:159], v[60:63]
    v_cvt_pk_bf16_f32 v16, v4, v5
    v_cvt_pk_bf16_f32 v17, v6, v7
    s_add_u32 s41, s40, 0
    v_mfma_f32_16x16x32_bf16 v[40:43], a[24:27], a[152:155], v[40:43]
    buffer_store_dwordx4 v[16:19], v3, s[44:47], s41 offen offset:0 nt
    v_accvgpr_read_b32 v4, a4
    v_accvgpr_read_b32 v5, a5
    v_mfma_f32_16x16x32_bf16 v[56:59], a[28:31], a[152:155], v[56:59]
    v_accvgpr_read_b32 v6, a6
    v_accvgpr_read_b32 v7, a7
    v_cvt_pk_bf16_f32 v23, v22, v23
    v_mfma_f32_16x16x32_bf16 v[36:39], a[24:27], a[148:151], v[36:39]
    v_cvt_pk_bf16_f32 v22, v20, v21
    v_cvt_pk_bf16_f32 v20, v4, v5
    v_cvt_pk_bf16_f32 v21, v6, v7
    v_mfma_f32_16x16x32_bf16 v[52:55], a[28:31], a[148:151], v[52:55]
    buffer_store_dwordx4 v[20:23], v3, s[44:47], s41 offen offset:1024 nt
    v_accvgpr_read_b32 v4, a8
    v_accvgpr_read_b32 v5, a9
    v_mfma_f32_16x16x32_bf16 v[32:35], a[24:27], a[144:147], v[32:35]
    v_accvgpr_read_b32 v6, a10
    v_accvgpr_read_b32 v7, a11
    v_cvt_pk_bf16_f32 v27, v26, v27
    v_mfma_f32_16x16x32_bf16 v[48:51], a[28:31], a[144:147], v[48:51]
    v_cvt_pk_bf16_f32 v26, v24, v25
    v_cvt_pk_bf16_f32 v24, v4, v5
    v_cvt_pk_bf16_f32 v25, v6, v7
    v_mfma_f32_16x16x32_bf16 v[64:67], a[32:35], a[144:147], v[64:67]
    buffer_store_dwordx4 v[24:27], v3, s[44:47], s41 offen offset:2048 nt
    v_accvgpr_read_b32 v4, a12
    v_accvgpr_read_b32 v5, a13
    v_mfma_f32_16x16x32_bf16 v[80:83], a[36:39], a[144:147], v[80:83]
    v_accvgpr_read_b32 v6, a14
    v_accvgpr_read_b32 v7, a15
    v_cvt_pk_bf16_f32 v31, v30, v31
    v_mfma_f32_16x16x32_bf16 v[68:71], a[32:35], a[148:151], v[68:71]
    v_cvt_pk_bf16_f32 v30, v28, v29
    v_cvt_pk_bf16_f32 v28, v4, v5
    v_cvt_pk_bf16_f32 v29, v6, v7
    v_mfma_f32_16x16x32_bf16 v[84:87], a[36:39], a[148:151], v[84:87]
    buffer_store_dwordx4 v[28:31], v3, s[44:47], s41 offen offset:3072 nt
    v_cvt_pk_bf16_f32 v63, v62, v63
    v_cvt_pk_bf16_f32 v62, v60, v61
    v_mfma_f32_16x16x32_bf16 v[72:75], a[32:35], a[152:155], v[72:75]
    v_cvt_pk_bf16_f32 v60, v44, v45
    v_cvt_pk_bf16_f32 v61, v46, v47
    s_add_u32 s41, s40, 4096
    v_mfma_f32_16x16x32_bf16 v[88:91], a[36:39], a[152:155], v[88:91]
    buffer_store_dwordx4 v[60:63], v3, s[44:47], s41 offen offset:3072 nt
    v_cvt_pk_bf16_f32 v59, v58, v59
    v_cvt_pk_bf16_f32 v58, v56, v57
    v_mfma_f32_16x16x32_bf16 v[76:79], a[32:35], a[156:159], v[76:79]
    v_cvt_pk_bf16_f32 v56, v40, v41
    v_cvt_pk_bf16_f32 v57, v42, v43
    v_mfma_f32_16x16x32_bf16 v[92:95], a[36:39], a[156:159], v[92:95]
    buffer_store_dwordx4 v[56:59], v3, s[44:47], s41 offen offset:2048 nt
    v_cvt_pk_bf16_f32 v55, v54, v55
    v_cvt_pk_bf16_f32 v54, v52, v53
    v_mfma_f32_16x16x32_bf16 v[108:111], a[40:43], a[156:159], v[108:111]
    v_cvt_pk_bf16_f32 v52, v36, v37
    v_cvt_pk_bf16_f32 v53, v38, v39
    v_mfma_f32_16x16x32_bf16 v[124:127], a[44:47], a[156:159], v[124:127]
    buffer_store_dwordx4 v[52:55], v3, s[44:47], s41 offen offset:1024 nt
    v_cvt_pk_bf16_f32 v51, v50, v51
    v_cvt_pk_bf16_f32 v50, v48, v49
    v_mfma_f32_16x16x32_bf16 v[104:107], a[40:43], a[152:155], v[104:107]
    v_cvt_pk_bf16_f32 v48, v32, v33
    v_cvt_pk_bf16_f32 v49, v34, v35
    v_mfma_f32_16x16x32_bf16 v[120:123], a[44:47], a[152:155], v[120:123]
    buffer_store_dwordx4 v[48:51], v3, s[44:47], s41 offen offset:0 nt
    v_cvt_pk_bf16_f32 v83, v82, v83
    v_cvt_pk_bf16_f32 v82, v80, v81
    v_mfma_f32_16x16x32_bf16 v[100:103], a[40:43], a[148:151], v[100:103]
    v_cvt_pk_bf16_f32 v80, v64, v65
    v_cvt_pk_bf16_f32 v81, v66, v67
    s_add_u32 s41, s40, 8192
    v_mfma_f32_16x16x32_bf16 v[116:119], a[44:47], a[148:151], v[116:119]
    buffer_store_dwordx4 v[80:83], v3, s[44:47], s41 offen offset:0 nt
    v_cvt_pk_bf16_f32 v87, v86, v87
    v_cvt_pk_bf16_f32 v86, v84, v85
    v_mfma_f32_16x16x32_bf16 v[96:99], a[40:43], a[144:147], v[96:99]
    v_cvt_pk_bf16_f32 v84, v68, v69
    v_cvt_pk_bf16_f32 v85, v70, v71
    v_mfma_f32_16x16x32_bf16 v[112:115], a[44:47], a[144:147], v[112:115]
    buffer_store_dwordx4 v[84:87], v3, s[44:47], s41 offen offset:1024 nt
    v_cvt_pk_bf16_f32 v91, v90, v91
    v_cvt_pk_bf16_f32 v90, v88, v89
    v_mfma_f32_16x16x32_bf16 v[128:131], a[48:51], a[144:147], v[128:131]
    v_cvt_pk_bf16_f32 v88, v72, v73
    v_cvt_pk_bf16_f32 v89, v74, v75
    v_mfma_f32_16x16x32_bf16 v[144:147], a[52:55], a[144:147], v[144:147]
    buffer_store_dwordx4 v[88:91], v3, s[44:47], s41 offen offset:2048 nt
    v_cvt_pk_bf16_f32 v95, v94, v95
    v_cvt_pk_bf16_f32 v94, v92, v93
    v_mfma_f32_16x16x32_bf16 v[132:135], a[48:51], a[148:151], v[132:135]
    v_cvt_pk_bf16_f32 v92, v76, v77
    v_cvt_pk_bf16_f32 v93, v78, v79
    v_mfma_f32_16x16x32_bf16 v[148:151], a[52:55], a[148:151], v[148:151]
    buffer_store_dwordx4 v[92:95], v3, s[44:47], s41 offen offset:3072 nt
    v_cvt_pk_bf16_f32 v127, v126, v127
    v_cvt_pk_bf16_f32 v126, v124, v125
    v_mfma_f32_16x16x32_bf16 v[136:139], a[48:51], a[152:155], v[136:139]
    v_cvt_pk_bf16_f32 v124, v108, v109
    v_cvt_pk_bf16_f32 v125, v110, v111
    s_add_u32 s41, s40, 12288
    v_mfma_f32_16x16x32_bf16 v[152:155], a[52:55], a[152:155], v[152:155]
    buffer_store_dwordx4 v[124:127], v3, s[44:47], s41 offen offset:3072 nt
    v_cvt_pk_bf16_f32 v123, v122, v123
    v_cvt_pk_bf16_f32 v122, v120, v121
    v_mfma_f32_16x16x32_bf16 v[140:143], a[48:51], a[156:159], v[140:143]
    v_cvt_pk_bf16_f32 v120, v104, v105
    v_cvt_pk_bf16_f32 v121, v106, v107
    v_mfma_f32_16x16x32_bf16 v[156:159], a[52:55], a[156:159], v[156:159]
    buffer_store_dwordx4 v[120:123], v3, s[44:47], s41 offen offset:2048 nt
    v_cvt_pk_bf16_f32 v119, v118, v119
    v_cvt_pk_bf16_f32 v118, v116, v117
    v_mfma_f32_16x16x32_bf16 v[172:175], a[56:59], a[156:159], v[172:175]
    v_cvt_pk_bf16_f32 v116, v100, v101
    v_cvt_pk_bf16_f32 v117, v102, v103
    v_mfma_f32_16x16x32_bf16 v[188:191], a[60:63], a[156:159], v[188:191]
    buffer_store_dwordx4 v[116:119], v3, s[44:47], s41 offen offset:1024 nt
    v_cvt_pk_bf16_f32 v115, v114, v115
    v_cvt_pk_bf16_f32 v114, v112, v113
    v_mfma_f32_16x16x32_bf16 v[168:171], a[56:59], a[152:155], v[168:171]
    v_cvt_pk_bf16_f32 v112, v96, v97
    v_cvt_pk_bf16_f32 v113, v98, v99
    v_mfma_f32_16x16x32_bf16 v[184:187], a[60:63], a[152:155], v[184:187]
    buffer_store_dwordx4 v[112:115], v3, s[44:47], s41 offen offset:0 nt
    v_mfma_f32_16x16x32_bf16 v[164:167], a[56:59], a[148:151], v[164:167]
    v_lshlrev_b32 v9, 3, v2
    v_mfma_f32_16x16x32_bf16 v[180:183], a[60:63], a[148:151], v[180:183]
    s_xor_b32 s26, s31, 1
    v_mfma_f32_16x16x32_bf16 v[160:163], a[56:59], a[144:147], v[160:163]
    s_lshl_b32 s26, s26, 10
    v_mfma_f32_16x16x32_bf16 v[176:179], a[60:63], a[144:147], v[176:179]
    s_add_u32 s42, s26, 58720256
    v_mfma_f32_16x16x32_bf16 v[192:195], a[64:67], a[144:147], v[192:195]
    buffer_load_dwordx2 v[12:13], v9, s[12:15], s42 offen offset:0 sc1
    v_mfma_f32_16x16x32_bf16 v[208:211], a[68:71], a[144:147], v[208:211]
    buffer_load_dwordx2 v[14:15], v9, s[12:15], s42 offen offset:512 sc1
    v_mfma_f32_16x16x32_bf16 v[196:199], a[64:67], a[148:151], v[196:199]
    v_subrev_u32 v8, 4, v1
    v_mfma_f32_16x16x32_bf16 v[212:215], a[68:71], a[148:151], v[212:215]
    ds_read2st64_b64 v[4:7], v8 offset0:0 offset1:1
    v_mfma_f32_16x16x32_bf16 v[200:203], a[64:67], a[152:155], v[200:203]
    v_and_b32 v1, 15, v2
    v_mfma_f32_16x16x32_bf16 v[216:219], a[68:71], a[152:155], v[216:219]
    v_lshlrev_b32 v1, 2, v1
    v_mfma_f32_16x16x32_bf16 v[204:207], a[64:67], a[156:159], v[204:207]
    s_xor_b32 s40, s40, 0x10000
    v_mfma_f32_16x16x32_bf16 v[220:223], a[68:71], a[156:159], v[220:223]
    s_mov_b32 s43, 0xffff0000
    v_mfma_f32_16x16x32_bf16 v[236:239], a[72:75], a[156:159], v[236:239]
    v_mov_b32 v0, 1
    v_mfma_f32_16x16x32_bf16 v[252:255], a[76:79], a[156:159], v[252:255]
    s_nop 0
    v_mfma_f32_16x16x32_bf16 v[232:235], a[72:75], a[152:155], v[232:235]
    s_nop 0
    v_mfma_f32_16x16x32_bf16 v[248:251], a[76:79], a[152:155], v[248:251]
    s_nop 0
    v_mfma_f32_16x16x32_bf16 v[228:231], a[72:75], a[148:151], v[228:231]
    s_nop 0
    v_mfma_f32_16x16x32_bf16 v[244:247], a[76:79], a[148:151], v[244:247]
    s_nop 0
    v_mfma_f32_16x16x32_bf16 v[224:227], a[72:75], a[144:147], v[224:227]
    s_nop 0
    v_mfma_f32_16x16x32_bf16 v[240:243], a[76:79], a[144:147], v[240:243]
    s_nop 0
    s_branch L_pv_stage
.p2align 2
L_pv_exit1:
    v_mfma_f32_16x16x32_bf16 v[220:223], a[68:71], a[156:159], v[220:223]
    s_waitcnt vmcnt(16) lgkmcnt(0)
    s_barrier
L_pv_last0:
    v_mfma_f32_16x16x32_bf16 v[236:239], a[72:75], a[156:159], v[236:239]
    ds_read2st64_b64 a[160:163], v9 offset0:8 offset1:12
    ds_read2st64_b64 a[164:167], v9 offset0:9 offset1:13
    v_mfma_f32_16x16x32_bf16 v[252:255], a[76:79], a[156:159], v[252:255]
    ds_read2st64_b64 a[168:171], v9 offset0:10 offset1:14
    ds_read2st64_b64 a[172:175], v9 offset0:11 offset1:15
    v_mfma_f32_16x16x32_bf16 v[232:235], a[72:75], a[152:155], v[232:235]
    ds_read2st64_b32 v[4:5], v1 offset0:0 offset1:2
    v_mfma_f32_16x16x32_bf16 v[248:251], a[76:79], a[152:155], v[248:251]
    v_mfma_f32_16x16x32_bf16 v[228:231], a[72:75], a[148:151], v[228:231]
    v_mfma_f32_16x16x32_bf16 v[244:247], a[76:79], a[148:151], v[244:247]
    v_mfma_f32_16x16x32_bf16 v[224:227], a[72:75], a[144:147], v[224:227]
    v_mfma_f32_16x16x32_bf16 v[240:243], a[76:79], a[144:147], v[240:243]
    s_waitcnt lgkmcnt(0)
    v_mfma_f32_16x16x32_bf16 a[0:3], a[80:83], a[160:163], a[0:3]
    v_mfma_f32_16x16x32_bf16 v[16:19], a[84:87], a[160:163], v[16:19]
    s_waitcnt lgkmcnt(0)
    v_add_f32 v4, v4, v5
    v_cmp_nle_f32 vcc, s101, v4
    s_cmp_eq_u32 s101, 0
    s_cselect_b64 s[28:29], 0, vcc
    s_cmp_lg_u64 s[28:29], 0
    s_cbranch_scc1 L_redo
    v_mfma_f32_16x16x32_bf16 a[4:7], a[80:83], a[164:167], a[4:7]
    v_mfma_f32_16x16x32_bf16 v[20:23], a[84:87], a[164:167], v[20:23]
    v_mfma_f32_16x16x32_bf16 a[8:11], a[80:83], a[168:171], a[8:11]
    v_mfma_f32_16x16x32_bf16 v[24:27], a[84:87], a[168:171], v[24:27]
    s_nop 0
    v_mfma_f32_16x16x32_bf16 a[12:15], a[80:83], a[172:175], a[12:15]
    s_nop 0
    v_mfma_f32_16x16x32_bf16 v[28:31], a[84:87], a[172:175], v[28:31]
    v_accvgpr_read_b32 v4, a0
    v_accvgpr_read_b32 v5, a1
    v_accvgpr_read_b32 v6, a2
    v_mfma_f32_16x16x32_bf16 v[44:47], a[88:91], a[172:175], v[44:47]
    v_accvgpr_read_b32 v7, a3
    v_cvt_pk_bf16_f32 v19, v18, v19
    v_cvt_pk_bf16_f32 v18, v16, v17
    v_mfma_f32_16x16x32_bf16 v[60:63], a[92:95], a[172:175], v[60:63]
    v_cvt_pk_bf16_f32 v16, v4, v5
    v_cvt_pk_bf16_f32 v17, v6, v7
    s_add_u32 s41, s40, 0
    v_mfma_f32_16x16x32_bf16 v[40:43], a[88:91], a[168:171], v[40:43]
    buffer_store_dwordx4 v[16:19], v3, s[44:47], s41 offen offset:0 nt
    v_accvgpr_read_b32 v4, a4
    v_accvgpr_read_b32 v5, a5
    v_mfma_f32_16x16x32_bf16 v[56:59], a[92:95], a[168:171], v[56:59]
    v_accvgpr_read_b32 v6, a6
    v_accvgpr_read_b32 v7, a7
    v_cvt_pk_bf16_f32 v23, v22, v23
    v_mfma_f32_16x16x32_bf16 v[36:39], a[88:91], a[164:167], v[36:39]
    v_cvt_pk_bf16_f32 v22, v20, v21
    v_cvt_pk_bf16_f32 v20, v4, v5
    v_cvt_pk_bf16_f32 v21, v6, v7
    v_mfma_f32_16x16x32_bf16 v[52:55], a[92:95], a[164:167], v[52:55]
    buffer_store_dwordx4 v[20:23], v3, s[44:47], s41 offen offset:1024 nt
    v_accvgpr_read_b32 v4, a8
    v_accvgpr_read_b32 v5, a9
    v_mfma_f32_16x16x32_bf16 v[32:35], a[88:91], a[160:163], v[32:35]
    v_accvgpr_read_b32 v6, a10
    v_accvgpr_read_b32 v7, a11
    v_cvt_pk_bf16_f32 v27, v26, v27
    v_mfma_f32_16x16x32_bf16 v[48:51], a[92:95], a[160:163], v[48:51]
    v_cvt_pk_bf16_f32 v26, v24, v25
    v_cvt_pk_bf16_f32 v24, v4, v5
    v_cvt_pk_bf16_f32 v25, v6, v7
    v_mfma_f32_16x16x32_bf16 v[64:67], a[96:99], a[160:163], v[64:67]
    buffer_store_dwordx4 v[24:27], v3, s[44:47], s41 offen offset:2048 nt
    v_accvgpr_read_b32 v4, a12
    v_accvgpr_read_b32 v5, a13
    v_mfma_f32_16x16x32_bf16 v[80:83], a[100:103], a[160:163], v[80:83]
    v_accvgpr_read_b32 v6, a14
    v_accvgpr_read_b32 v7, a15
    v_cvt_pk_bf16_f32 v31, v30, v31
    v_mfma_f32_16x16x32_bf16 v[68:71], a[96:99], a[164:167], v[68:71]
    v_cvt_pk_bf16_f32 v30, v28, v29
    v_cvt_pk_bf16_f32 v28, v4, v5
    v_cvt_pk_bf16_f32 v29, v6, v7
    v_mfma_f32_16x16x32_bf16 v[84:87], a[100:103], a[164:167], v[84:87]
    buffer_store_dwordx4 v[28:31], v3, s[44:47], s41 offen offset:3072 nt
    v_cvt_pk_bf16_f32 v63, v62, v63
    v_cvt_pk_bf16_f32 v62, v60, v61
    v_mfma_f32_16x16x32_bf16 v[72:75], a[96:99], a[168:171], v[72:75]
    v_cvt_pk_bf16_f32 v60, v44, v45
    v_cvt_pk_bf16_f32 v61, v46, v47
    s_add_u32 s41, s40, 4096
    v_mfma_f32_16x16x32_bf16 v[88:91], a[100:103], a[168:171], v[88:91]
    buffer_store_dwordx4 v[60:63], v3, s[44:47], s41 offen offset:3072 nt
    v_cvt_pk_bf16_f32 v59, v58, v59
    v_cvt_pk_bf16_f32 v58, v56, v57
    v_mfma_f32_16x16x32_bf16 v[76:79], a[96:99], a[172:175], v[76:79]
    v_cvt_pk_bf16_f32 v56, v40, v41
    v_cvt_pk_bf16_f32 v57, v42, v43
    v_mfma_f32_16x16x32_bf16 v[92:95], a[100:103], a[172:175], v[92:95]
    buffer_store_dwordx4 v[56:59], v3, s[44:47], s41 offen offset:2048 nt
    v_cvt_pk_bf16_f32 v55, v54, v55
    v_cvt_pk_bf16_f32 v54, v52, v53
    v_mfma_f32_16x16x32_bf16 v[108:111], a[104:107], a[172:175], v[108:111]
    v_cvt_pk_bf16_f32 v52, v36, v37
    v_cvt_pk_bf16_f32 v53, v38, v39
    v_mfma_f32_16x16x32_bf16 v[124:127], a[108:111], a[172:175], v[124:127]
    buffer_store_dwordx4 v[52:55], v3, s[44:47], s41 offen offset:1024 nt
    v_cvt_pk_bf16_f32 v51, v50, v51
    v_cvt_pk_bf16_f32 v50, v48, v49
    v_mfma_f32_16x16x32_bf16 v[104:107], a[104:107], a[168:171], v[104:107]
    v_cvt_pk_bf16_f32 v48, v32, v33
    v_cvt_pk_bf16_f32 v49, v34, v35
    v_mfma_f32_16x16x32_bf16 v[120:123], a[108:111], a[168:171], v[120:123]
    buffer_store_dwordx4 v[48:51], v3, s[44:47], s41 offen offset:0 nt
    v_cvt_pk_bf16_f32 v83, v82, v83
    v_cvt_pk_bf16_f32 v82, v80, v81
    v_mfma_f32_16x16x32_bf16 v[100:103], a[104:107], a[164:167], v[100:103]
    v_cvt_pk_bf16_f32 v80, v64, v65
    v_cvt_pk_bf16_f32 v81, v66, v67
    s_add_u32 s41, s40, 8192
    v_mfma_f32_16x16x32_bf16 v[116:119], a[108:111], a[164:167], v[116:119]
    buffer_store_dwordx4 v[80:83], v3, s[44:47], s41 offen offset:0 nt
    v_cvt_pk_bf16_f32 v87, v86, v87
    v_cvt_pk_bf16_f32 v86, v84, v85
    v_mfma_f32_16x16x32_bf16 v[96:99], a[104:107], a[160:163], v[96:99]
    v_cvt_pk_bf16_f32 v84, v68, v69
    v_cvt_pk_bf16_f32 v85, v70, v71
    v_mfma_f32_16x16x32_bf16 v[112:115], a[108:111], a[160:163], v[112:115]
    buffer_store_dwordx4 v[84:87], v3, s[44:47], s41 offen offset:1024 nt
    v_cvt_pk_bf16_f32 v91, v90, v91
    v_cvt_pk_bf16_f32 v90, v88, v89
    v_mfma_f32_16x16x32_bf16 v[128:131], a[112:115], a[160:163], v[128:131]
    v_cvt_pk_bf16_f32 v88, v72, v73
    v_cvt_pk_bf16_f32 v89, v74, v75
    v_mfma_f32_16x16x32_bf16 v[144:147], a[116:119], a[160:163], v[144:147]
    buffer_store_dwordx4 v[88:91], v3, s[44:47], s41 offen offset:2048 nt
    v_cvt_pk_bf16_f32 v95, v94, v95
    v_cvt_pk_bf16_f32 v94, v92, v93
    v_mfma_f32_16x16x32_bf16 v[132:135], a[112:115], a[164:167], v[132:135]
    v_cvt_pk_bf16_f32 v92, v76, v77
    v_cvt_pk_bf16_f32 v93, v78, v79
    v_mfma_f32_16x16x32_bf16 v[148:151], a[116:119], a[164:167], v[148:151]
    buffer_store_dwordx4 v[92:95], v3, s[44:47], s41 offen offset:3072 nt
    v_cvt_pk_bf16_f32 v127, v126, v127
    v_cvt_pk_bf16_f32 v126, v124, v125
    v_mfma_f32_16x16x32_bf16 v[136:139], a[112:115], a[168:171], v[136:139]
    v_cvt_pk_bf16_f32 v124, v108, v109
    v_cvt_pk_bf16_f32 v125, v110, v111
    s_add_u32 s41, s40, 12288
    v_mfma_f32_16x16x32_bf16 v[152:155], a[116:119], a[168:171], v[152:155]
    buffer_store_dwordx4 v[124:127], v3, s[44:47], s41 offen offset:3072 nt
    v_cvt_pk_bf16_f32 v123, v122, v123
    v_cvt_pk_bf16_f32 v122, v120, v121
    v_mfma_f32_16x16x32_bf16 v[140:143], a[112:115], a[172:175], v[140:143]
    v_cvt_pk_bf16_f32 v120, v104, v105
    v_cvt_pk_bf16_f32 v121, v106, v107
    v_mfma_f32_16x16x32_bf16 v[156:159], a[116:119], a[172:175], v[156:159]
    buffer_store_dwordx4 v[120:123], v3, s[44:47], s41 offen offset:2048 nt
    v_cvt_pk_bf16_f32 v119, v118, v119
    v_cvt_pk_bf16_f32 v118, v116, v117
    v_mfma_f32_16x16x32_bf16 v[172:175], a[120:123], a[172:175], v[172:175]
    v_cvt_pk_bf16_f32 v116, v100, v101
    v_cvt_pk_bf16_f32 v117, v102, v103
    v_mfma_f32_16x16x32_bf16 v[188:191], a[124:127], a[172:175], v[188:191]
    buffer_store_dwordx4 v[116:119], v3, s[44:47], s41 offen offset:1024 nt
    v_cvt_pk_bf16_f32 v115, v114, v115
    v_cvt_pk_bf16_f32 v114, v112, v113
    v_mfma_f32_16x16x32_bf16 v[168:171], a[120:123], a[168:171], v[168:171]
    v_cvt_pk_bf16_f32 v112, v96, v97
    v_cvt_pk_bf16_f32 v113, v98, v99
    v_mfma_f32_16x16x32_bf16 v[184:187], a[124:127], a[168:171], v[184:187]
    buffer_store_dwordx4 v[112:115], v3, s[44:47], s41 offen offset:0 nt
    v_mfma_f32_16x16x32_bf16 v[164:167], a[120:123], a[164:167], v[164:167]
    v_lshlrev_b32 v9, 3, v2
    v_mfma_f32_16x16x32_bf16 v[180:183], a[124:127], a[164:167], v[180:183]
    s_xor_b32 s26, s31, 1
    v_mfma_f32_16x16x32_bf16 v[160:163], a[120:123], a[160:163], v[160:163]
    s_lshl_b32 s26, s26, 10
    v_mfma_f32_16x16x32_bf16 v[176:179], a[124:127], a[160:163], v[176:179]
    s_add_u32 s42, s26, 58720256
    v_mfma_f32_16x16x32_bf16 v[192:195], a[128:131], a[160:163], v[192:195]
    buffer_load_dwordx2 v[12:13], v9, s[12:15], s42 offen offset:0 sc1
    v_mfma_f32_16x16x32_bf16 v[208:211], a[132:135], a[160:163], v[208:211]
    buffer_load_dwordx2 v[14:15], v9, s[12:15], s42 offen offset:512 sc1
    v_mfma_f32_16x16x32_bf16 v[196:199], a[128:131], a[164:167], v[196:199]
    v_subrev_u32 v8, 4, v1
    v_mfma_f32_16x16x32_bf16 v[212:215], a[132:135], a[164:167], v[212:215]
    ds_read2st64_b64 v[4:7], v8 offset0:0 offset1:1
    v_mfma_f32_16x16x32_bf16 v[200:203], a[128:131], a[168:171], v[200:203]
    v_and_b32 v1, 15, v2
    v_mfma_f32_16x16x32_bf16 v[216:219], a[132:135], a[168:171], v[216:219]
    v_lshlrev_b32 v1, 2, v1
    v_mfma_f32_16x16x32_bf16 v[204:207], a[128:131], a[172:175], v[204:207]
    s_xor_b32 s40, s40, 0x10000
    v_mfma_f32_16x16x32_bf16 v[220:223], a[132:135], a[172:175], v[220:223]
    s_mov_b32 s43, 0xffff0000
    v_mfma_f32_16x16x32_bf16 v[236:239], a[136:139], a[172:175], v[236:239]
    v_mov_b32 v0, 1
    v_mfma_f32_16x16x32_bf16 v[252:255], a[140:143], a[172:175], v[252:255]
    s_nop 0
    v_mfma_f32_16x16x32_bf16 v[232:235], a[136:139], a[168:171], v[232:235]
    s_nop 0
    v_mfma_f32_16x16x32_bf16 v[248:251], a[140:143], a[168:171], v[248:251]
    s_nop 0
    v_mfma_f32_16x16x32_bf16 v[228:231], a[136:139], a[164:167], v[228:231]
    s_nop 0
    v_mfma_f32_16x16x32_bf16 v[244:247], a[140:143], a[164:167], v[244:247]
    s_nop 0
    v_mfma_f32_16x16x32_bf16 v[224:227], a[136:139], a[160:163], v[224:227]
    s_nop 0
    v_mfma_f32_16x16x32_bf16 v[240:243], a[140:143], a[160:163], v[240:243]
    s_nop 0
.p2align 2
L_pv_stage:
    s_waitcnt vmcnt(2)
    s_cmp_lg_u32 s21, 0
    s_cbranch_scc1 L_ro_far
    buffer_store_dword v0, off, s[12:15], s56 offset:24
L_ro_back:
    s_waitcnt vmcnt(1)
    v_and_b32 v8, v13, v15
    v_cmp_gt_i32 vcc, 0, v8
    s_nop 1
    s_cmp_eq_u64 vcc, -1
    s_cbranch_scc0 L_ml_retry
L_ml_ok:
    s_waitcnt lgkmcnt(0)
    v_add_f32 v13, v13, v15
    v_add_f32 v5, v5, v7
    v_min_f32 v8, v12, v4
    v_sub_f32 v12, v8, v12
    v_sub_f32 v4, v8, v4
    v_exp_f32 v12, v12
    v_exp_f32 v4, v4
    v_mul_f32 v13, v13, v12
    v_fmac_f32 v13, v5, v4
    v_mul_f32 v13, 0x3eeff558, v13
    v_rcp_f32 v13, v13
    s_nop 0
    v_mul_f32 v4, v4, -v13
    v_mul_f32 v12, v12, -v13
    ds_bpermute_b32 v88, v1, v4 offset:0
    ds_bpermute_b32 v89, v1, v12 offset:0
    ds_bpermute_b32 v90, v1, v4 offset:64
    ds_bpermute_b32 v91, v1, v12 offset:64
    ds_bpermute_b32 v92, v1, v4 offset:128
    ds_bpermute_b32 v93, v1, v12 offset:128
    ds_bpermute_b32 v94, v1, v4 offset:192
    ds_bpermute_b32 v95, v1, v12 offset:192
    s_waitcnt lgkmcnt(0)
    v_pk_mul_f32 v[128:129], v[128:129], v[88:89] op_sel_hi:[1,0]
    v_pk_mul_f32 v[130:131], v[130:131], v[88:89] op_sel_hi:[1,0]
    v_pk_mul_f32 v[132:133], v[132:133], v[90:91] op_sel_hi:[1,0]
    v_pk_mul_f32 v[134:135], v[134:135], v[90:91] op_sel_hi:[1,0]
    v_pk_mul_f32 v[136:137], v[136:137], v[92:93] op_sel_hi:[1,0]
    v_pk_mul_f32 v[138:139], v[138:139], v[92:93] op_sel_hi:[1,0]
    v_pk_mul_f32 v[140:141], v[140:141], v[94:95] op_sel_hi:[1,0]
    v_pk_mul_f32 v[142:143], v[142:143], v[94:95] op_sel_hi:[1,0]
    s_add_u32 s59, s52, 524288
    buffer_load_dwordx4 a[176:179], v3, s[12:15], s59 offen offset:0 sc1
    buffer_load_dwordx4 a[180:183], v3, s[12:15], s59 offen offset:1024 sc1
    v_pk_mul_f32 v[144:145], v[144:145], v[88:89] op_sel_hi:[1,0]
    v_pk_mul_f32 v[146:147], v[146:147], v[88:89] op_sel_hi:[1,0]
    v_pk_mul_f32 v[148:149], v[148:149], v[90:91] op_sel_hi:[1,0]
    v_pk_mul_f32 v[150:151], v[150:151], v[90:91] op_sel_hi:[1,0]
    v_pk_mul_f32 v[152:153], v[152:153], v[92:93] op_sel_hi:[1,0]
    v_pk_mul_f32 v[154:155], v[154:155], v[92:93] op_sel_hi:[1,0]
    v_pk_mul_f32 v[156:157], v[156:157], v[94:95] op_sel_hi:[1,0]
    v_pk_mul_f32 v[158:159], v[158:159], v[94:95] op_sel_hi:[1,0]
    buffer_load_dwordx4 a[184:187], v3, s[12:15], s59 offen offset:2048 sc1
    buffer_load_dwordx4 a[188:191], v3, s[12:15], s59 offen offset:3072 sc1
    v_pk_mul_f32 v[160:161], v[160:161], v[88:89] op_sel_hi:[1,0]
    v_pk_mul_f32 v[162:163], v[162:163], v[88:89] op_sel_hi:[1,0]
    v_pk_mul_f32 v[164:165], v[164:165], v[90:91] op_sel_hi:[1,0]
    v_pk_mul_f32 v[166:167], v[166:167], v[90:91] op_sel_hi:[1,0]
    v_pk_mul_f32 v[168:169], v[168:169], v[92:93] op_sel_hi:[1,0]
    v_pk_mul_f32 v[170:171], v[170:171], v[92:93] op_sel_hi:[1,0]
    v_pk_mul_f32 v[172:173], v[172:173], v[94:95] op_sel_hi:[1,0]
    v_pk_mul_f32 v[174:175], v[174:175], v[94:95] op_sel_hi:[1,0]
    s_add_u32 s59, s52, 528384
    buffer_load_dwordx4 a[192:195], v3, s[12:15], s59 offen offset:0 sc1
    buffer_load_dwordx4 a[196:199], v3, s[12:15], s59 offen offset:1024 sc1
    v_pk_mul_f32 v[176:177], v[176:177], v[88:89] op_sel_hi:[1,0]
    v_pk_mul_f32 v[178:179], v[178:179], v[88:89] op_sel_hi:[1,0]
    v_pk_mul_f32 v[180:181], v[180:181], v[90:91] op_sel_hi:[1,0]
    v_pk_mul_f32 v[182:183], v[182:183], v[90:91] op_sel_hi:[1,0]
    v_pk_mul_f32 v[184:185], v[184:185], v[92:93] op_sel_hi:[1,0]
    v_pk_mul_f32 v[186:187], v[186:187], v[92:93] op_sel_hi:[1,0]
    v_pk_mul_f32 v[188:189], v[188:189], v[94:95] op_sel_hi:[1,0]
    v_pk_mul_f32 v[190:191], v[190:191], v[94:95] op_sel_hi:[1,0]
    buffer_load_dwordx4 a[200:203], v3, s[12:15], s59 offen offset:2048 sc1
    buffer_load_dwordx4 a[204:207], v3, s[12:15], s59 offen offset:3072 sc1
    v_pk_mul_f32 v[192:193], v[192:193], v[88:89] op_sel_hi:[1,0]
    v_pk_mul_f32 v[194:195], v[194:195], v[88:89] op_sel_hi:[1,0]
    v_pk_mul_f32 v[196:197], v[196:197], v[90:91] op_sel_hi:[1,0]
    v_pk_mul_f32 v[198:199], v[198:199], v[90:91] op_sel_hi:[1,0]
    v_pk_mul_f32 v[200:201], v[200:201], v[92:93] op_sel_hi:[1,0]
    v_pk_mul_f32 v[202:203], v[202:203], v[92:93] op_sel_hi:[1,0]
    v_pk_mul_f32 v[204:205], v[204:205], v[94:95] op_sel_hi:[1,0]
    v_pk_mul_f32 v[206:207], v[206:207], v[94:95] op_sel_hi:[1,0]
    buffer_load_dword v11, off, s[12:15], s57 offset:24 sc1
    v_pk_mul_f32 v[208:209], v[208:209], v[88:89] op_sel_hi:[1,0]
    v_pk_mul_f32 v[210:211], v[210:211], v[88:89] op_sel_hi:[1,0]
    v_pk_mul_f32 v[212:213], v[212:213], v[90:91] op_sel_hi:[1,0]
    v_pk_mul_f32 v[214:215], v[214:215], v[90:91] op_sel_hi:[1,0]
    v_pk_mul_f32 v[216:217], v[216:217], v[92:93] op_sel_hi:[1,0]
    v_pk_mul_f32 v[218:219], v[218:219], v[92:93] op_sel_hi:[1,0]
    v_pk_mul_f32 v[220:221], v[220:221], v[94:95] op_sel_hi:[1,0]
    v_pk_mul_f32 v[222:223], v[222:223], v[94:95] op_sel_hi:[1,0]
    v_pk_mul_f32 v[224:225], v[224:225], v[88:89] op_sel_hi:[1,0]
    v_pk_mul_f32 v[226:227], v[226:227], v[88:89] op_sel_hi:[1,0]
    v_pk_mul_f32 v[228:229], v[228:229], v[90:91] op_sel_hi:[1,0]
    v_pk_mul_f32 v[230:231], v[230:231], v[90:91] op_sel_hi:[1,0]
    v_pk_mul_f32 v[232:233], v[232:233], v[92:93] op_sel_hi:[1,0]
    v_pk_mul_f32 v[234:235], v[234:235], v[92:93] op_sel_hi:[1,0]
    v_pk_mul_f32 v[236:237], v[236:237], v[94:95] op_sel_hi:[1,0]
    v_pk_mul_f32 v[238:239], v[238:239], v[94:95] op_sel_hi:[1,0]
    v_pk_mul_f32 v[240:241], v[240:241], v[88:89] op_sel_hi:[1,0]
    v_pk_mul_f32 v[242:243], v[242:243], v[88:89] op_sel_hi:[1,0]
    v_pk_mul_f32 v[244:245], v[244:245], v[90:91] op_sel_hi:[1,0]
    v_pk_mul_f32 v[246:247], v[246:247], v[90:91] op_sel_hi:[1,0]
    v_pk_mul_f32 v[248:249], v[248:249], v[92:93] op_sel_hi:[1,0]
    v_pk_mul_f32 v[250:251], v[250:251], v[92:93] op_sel_hi:[1,0]
    v_pk_mul_f32 v[252:253], v[252:253], v[94:95] op_sel_hi:[1,0]
    v_pk_mul_f32 v[254:255], v[254:255], v[94:95] op_sel_hi:[1,0]
    s_waitcnt vmcnt(0)
    v_readfirstlane_b32 s26, v11
    s_cmp_eq_u32 s26, 1
    s_cbranch_scc0 L_o_retry
L_o_ok:
    s_add_u32 s41, s40, 0
    buffer_load_dwordx4 v[16:19], v3, s[12:15], s41 offen offset:0 sc1
    buffer_load_dwordx4 v[20:23], v3, s[12:15], s41 offen offset:1024 sc1
    buffer_load_dwordx4 v[24:27], v3, s[12:15], s41 offen offset:2048 sc1
    buffer_load_dwordx4 v[28:31], v3, s[12:15], s41 offen offset:3072 sc1
    s_add_u32 s41, s40, 4096
    buffer_load_dwordx4 v[32:35], v3, s[12:15], s41 offen offset:0 sc1
    buffer_load_dwordx4 v[36:39], v3, s[12:15], s41 offen offset:1024 sc1
    buffer_load_dwordx4 v[40:43], v3, s[12:15], s41 offen offset:2048 sc1
    buffer_load_dwordx4 v[44:47], v3, s[12:15], s41 offen offset:3072 sc1
    s_add_u32 s41, s40, 8192
    buffer_load_dwordx4 v[48:51], v3, s[12:15], s41 offen offset:0 sc1
    buffer_load_dwordx4 v[52:55], v3, s[12:15], s41 offen offset:1024 sc1
    buffer_load_dwordx4 v[56:59], v3, s[12:15], s41 offen offset:2048 sc1
    buffer_load_dwordx4 v[60:63], v3, s[12:15], s41 offen offset:3072 sc1
    s_add_u32 s41, s40, 12288
    buffer_load_dwordx4 v[64:67], v3, s[12:15], s41 offen offset:0 sc1
    buffer_load_dwordx4 v[68:71], v3, s[12:15], s41 offen offset:1024 sc1
    buffer_load_dwordx4 v[72:75], v3, s[12:15], s41 offen offset:2048 sc1
    buffer_load_dwordx4 v[76:79], v3, s[12:15], s41 offen offset:3072 sc1
    s_waitcnt vmcnt(15)
    v_lshlrev_b32 v96, 16, v16
    v_and_b32 v97, s43, v16
    v_lshlrev_b32 v98, 16, v17
    v_and_b32 v99, s43, v17
    v_lshlrev_b32 v100, 16, v18
    v_and_b32 v101, s43, v18
    v_lshlrev_b32 v102, 16, v19
    v_and_b32 v103, s43, v19
    v_pk_fma_f32 v[96:97], v[96:97], v[88:89], v[128:129] op_sel:[0,1,0] op_sel_hi:[1,1,1]
    v_pk_fma_f32 v[98:99], v[98:99], v[88:89], v[130:131] op_sel:[0,1,0] op_sel_hi:[1,1,1]
    v_pk_fma_f32 v[100:101], v[100:101], v[88:89], v[144:145] op_sel:[0,1,0] op_sel_hi:[1,1,1]
    v_pk_fma_f32 v[102:103], v[102:103], v[88:89], v[146:147] op_sel:[0,1,0] op_sel_hi:[1,1,1]
    v_cvt_pk_bf16_f32 v16, v96, v97
    v_cvt_pk_bf16_f32 v17, v98, v99
    v_cvt_pk_bf16_f32 v18, v100, v101
    v_cvt_pk_bf16_f32 v19, v102, v103
    ds_write_b128 v10, v[16:19] offset:0
    s_add_u32 s59, s52, 532480
    buffer_load_dwordx4 a[208:211], v3, s[12:15], s59 offen offset:0 sc1
    buffer_load_dwordx4 a[212:215], v3, s[12:15], s59 offen offset:1024 sc1
    s_waitcnt vmcnt(16)
    v_lshlrev_b32 v96, 16, v20
    v_and_b32 v97, s43, v20
    v_lshlrev_b32 v98, 16, v21
    v_and_b32 v99, s43, v21
    v_lshlrev_b32 v100, 16, v22
    v_and_b32 v101, s43, v22
    v_lshlrev_b32 v102, 16, v23
    v_and_b32 v103, s43, v23
    v_pk_fma_f32 v[96:97], v[96:97], v[90:91], v[132:133] op_sel:[0,1,0] op_sel_hi:[1,1,1]
    v_pk_fma_f32 v[98:99], v[98:99], v[90:91], v[134:135] op_sel:[0,1,0] op_sel_hi:[1,1,1]
    v_pk_fma_f32 v[100:101], v[100:101], v[90:91], v[148:149] op_sel:[0,1,0] op_sel_hi:[1,1,1]
    v_pk_fma_f32 v[102:103], v[102:103], v[90:91], v[150:151] op_sel:[0,1,0] op_sel_hi:[1,1,1]
    v_cvt_pk_bf16_f32 v20, v96, v97
    v_cvt_pk_bf16_f32 v21, v98, v99
    v_cvt_pk_bf16_f32 v22, v100, v101
    v_cvt_pk_bf16_f32 v23, v102, v103
    ds_write_b128 v10, v[20:23] offset:8192
    buffer_load_dwordx4 a[216:219], v3, s[12:15], s59 offen offset:2048 sc1
    buffer_load_dwordx4 a[220:223], v3, s[12:15], s59 offen offset:3072 sc1
    s_waitcnt vmcnt(17)
    v_lshlrev_b32 v96, 16, v24
    v_and_b32 v97, s43, v24
    v_lshlrev_b32 v98, 16, v25
    v_and_b32 v99, s43, v25
    v_lshlrev_b32 v100, 16, v26
    v_and_b32 v101, s43, v26
    v_lshlrev_b32 v102, 16, v27
    v_and_b32 v103, s43, v27
    v_pk_fma_f32 v[96:97], v[96:97], v[92:93], v[136:137] op_sel:[0,1,0] op_sel_hi:[1,1,1]
    v_pk_fma_f32 v[98:99], v[98:99], v[92:93], v[138:139] op_sel:[0,1,0] op_sel_hi:[1,1,1]
    v_pk_fma_f32 v[100:101], v[100:101], v[92:93], v[152:153] op_sel:[0,1,0] op_sel_hi:[1,1,1]
    v_pk_fma_f32 v[102:103], v[102:103], v[92:93], v[154:155] op_sel:[0,1,0] op_sel_hi:[1,1,1]
    v_cvt_pk_bf16_f32 v24, v96, v97
    v_cvt_pk_bf16_f32 v25, v98, v99
    v_cvt_pk_bf16_f32 v26, v100, v101
    v_cvt_pk_bf16_f32 v27, v102, v103
    ds_write_b128 v10, v[24:27] offset:16384
    s_add_u32 s59, s52, 536576
    buffer_load_dwordx4 a[224:227], v3, s[12:15], s59 offen offset:0 sc1
    buffer_load_dwordx4 a[228:231], v3, s[12:15], s59 offen offset:1024 sc1
    s_waitcnt vmcnt(18)
    v_lshlrev_b32 v96, 16, v28
    v_and_b32 v97, s43, v28
    v_lshlrev_b32 v98, 16, v29
    v_and_b32 v99, s43, v29
    v_lshlrev_b32 v100, 16, v30
    v_and_b32 v101, s43, v30
    v_lshlrev_b32 v102, 16, v31
    v_and_b32 v103, s43, v31
    v_pk_fma_f32 v[96:97], v[96:97], v[94:95], v[140:141] op_sel:[0,1,0] op_sel_hi:[1,1,1]
    v_pk_fma_f32 v[98:99], v[98:99], v[94:95], v[142:143] op_sel:[0,1,0] op_sel_hi:[1,1,1]
    v_pk_fma_f32 v[100:101], v[100:101], v[94:95], v[156:157] op_sel:[0,1,0] op_sel_hi:[1,1,1]
    v_pk_fma_f32 v[102:103], v[102:103], v[94:95], v[158:159] op_sel:[0,1,0] op_sel_hi:[1,1,1]
    v_cvt_pk_bf16_f32 v28, v96, v97
    v_cvt_pk_bf16_f32 v29, v98, v99
    v_cvt_pk_bf16_f32 v30, v100, v101
    v_cvt_pk_bf16_f32 v31, v102, v103
    ds_write_b128 v10, v[28:31] offset:24576
    buffer_load_dwordx4 a[232:235], v3, s[12:15], s59 offen offset:2048 sc1
    buffer_load_dwordx4 a[236:239], v3, s[12:15], s59 offen offset:3072 sc1
    s_waitcnt vmcnt(19)
    v_lshlrev_b32 v96, 16, v32
    v_and_b32 v97, s43, v32
    v_lshlrev_b32 v98, 16, v33
    v_and_b32 v99, s43, v33
    v_lshlrev_b32 v100, 16, v34
    v_and_b32 v101, s43, v34
    v_lshlrev_b32 v102, 16, v35
    v_and_b32 v103, s43, v35
    v_pk_fma_f32 v[96:97], v[96:97], v[88:89], v[160:161] op_sel:[0,1,0] op_sel_hi:[1,1,1]
    v_pk_fma_f32 v[98:99], v[98:99], v[88:89], v[162:163] op_sel:[0,1,0] op_sel_hi:[1,1,1]
    v_pk_fma_f32 v[100:101], v[100:101], v[88:89], v[176:177] op_sel:[0,1,0] op_sel_hi:[1,1,1]
    v_pk_fma_f32 v[102:103], v[102:103], v[88:89], v[178:179] op_sel:[0,1,0] op_sel_hi:[1,1,1]
    v_cvt_pk_bf16_f32 v32, v96, v97
    v_cvt_pk_bf16_f32 v33, v98, v99
    v_cvt_pk_bf16_f32 v34, v100, v101
    v_cvt_pk_bf16_f32 v35, v102, v103
    ds_write_b128 v10, v[32:35] offset:1024
    s_add_u32 s59, s52, 557056
    buffer_load_dwordx4 a[240:243], v3, s[12:15], s59 offen offset:0 sc1
    buffer_load_dwordx4 a[244:247], v3, s[12:15], s59 offen offset:1024 sc1
    s_waitcnt vmcnt(20)
    v_lshlrev_b32 v96, 16, v36
    v_and_b32 v97, s43, v36
    v_lshlrev_b32 v98, 16, v37
    v_and_b32 v99, s43, v37
    v_lshlrev_b32 v100, 16, v38
    v_and_b32 v101, s43, v38
    v_lshlrev_b32 v102, 16, v39
    v_and_b32 v103, s43, v39
    v_pk_fma_f32 v[96:97], v[96:97], v[90:91], v[164:165] op_sel:[0,1,0] op_sel_hi:[1,1,1]
    v_pk_fma_f32 v[98:99], v[98:99], v[90:91], v[166:167] op_sel:[0,1,0] op_sel_hi:[1,1,1]
    v_pk_fma_f32 v[100:101], v[100:101], v[90:91], v[180:181] op_sel:[0,1,0] op_sel_hi:[1,1,1]
    v_pk_fma_f32 v[102:103], v[102:103], v[90:91], v[182:183] op_sel:[0,1,0] op_sel_hi:[1,1,1]
    v_cvt_pk_bf16_f32 v36, v96, v97
    v_cvt_pk_bf16_f32 v37, v98, v99
    v_cvt_pk_bf16_f32 v38, v100, v101
    v_cvt_pk_bf16_f32 v39, v102, v103
    ds_write_b128 v10, v[36:39] offset:9216
    buffer_load_dwordx4 a[248:251], v3, s[12:15], s59 offen offset:2048 sc1
    buffer_load_dwordx4 a[252:255], v3, s[12:15], s59 offen offset:3072 sc1
    s_waitcnt vmcnt(21)
    v_lshlrev_b32 v96, 16, v40
    v_and_b32 v97, s43, v40
    v_lshlrev_b32 v98, 16, v41
    v_and_b32 v99, s43, v41
    v_lshlrev_b32 v100, 16, v42
    v_and_b32 v101, s43, v42
    v_lshlrev_b32 v102, 16, v43
    v_and_b32 v103, s43, v43
    v_pk_fma_f32 v[96:97], v[96:97], v[92:93], v[168:169] op_sel:[0,1,0] op_sel_hi:[1,1,1]
    v_pk_fma_f32 v[98:99], v[98:99], v[92:93], v[170:171] op_sel:[0,1,0] op_sel_hi:[1,1,1]
    v_pk_fma_f32 v[100:101], v[100:101], v[92:93], v[184:185] op_sel:[0,1,0] op_sel_hi:[1,1,1]
    v_pk_fma_f32 v[102:103], v[102:103], v[92:93], v[186:187] op_sel:[0,1,0] op_sel_hi:[1,1,1]
    v_cvt_pk_bf16_f32 v40, v96, v97
    v_cvt_pk_bf16_f32 v41, v98, v99
    v_cvt_pk_bf16_f32 v42, v100, v101
    v_cvt_pk_bf16_f32 v43, v102, v103
    ds_write_b128 v10, v[40:43] offset:17408
    s_add_u32 s59, s52, 561152
    buffer_load_dwordx4 a[0:3], v3, s[12:15], s59 offen offset:0 sc1
    buffer_load_dwordx4 a[4:7], v3, s[12:15], s59 offen offset:1024 sc1
    s_waitcnt vmcnt(22)
    v_lshlrev_b32 v96, 16, v44
    v_and_b32 v97, s43, v44
    v_lshlrev_b32 v98, 16, v45
    v_and_b32 v99, s43, v45
    v_lshlrev_b32 v100, 16, v46
    v_and_b32 v101, s43, v46
    v_lshlrev_b32 v102, 16, v47
    v_and_b32 v103, s43, v47
    v_pk_fma_f32 v[96:97], v[96:97], v[94:95], v[172:173] op_sel:[0,1,0] op_sel_hi:[1,1,1]
    v_pk_fma_f32 v[98:99], v[98:99], v[94:95], v[174:175] op_sel:[0,1,0] op_sel_hi:[1,1,1]
    v_pk_fma_f32 v[100:101], v[100:101], v[94:95], v[188:189] op_sel:[0,1,0] op_sel_hi:[1,1,1]
    v_pk_fma_f32 v[102:103], v[102:103], v[94:95], v[190:191] op_sel:[0,1,0] op_sel_hi:[1,1,1]
    v_cvt_pk_bf16_f32 v44, v96, v97
    v_cvt_pk_bf16_f32 v45, v98, v99
    v_cvt_pk_bf16_f32 v46, v100, v101
    v_cvt_pk_bf16_f32 v47, v102, v103
    ds_write_b128 v10, v[44:47] offset:25600
    buffer_load_dwordx4 a[8:11], v3, s[12:15], s59 offen offset:2048 sc1
    buffer_load_dwordx4 a[12:15], v3, s[12:15], s59 offen offset:3072 sc1
    s_waitcnt vmcnt(23)
    v_lshlrev_b32 v96, 16, v48
    v_and_b32 v97, s43, v48
    v_lshlrev_b32 v98, 16, v49
    v_and_b32 v99, s43, v49
    v_lshlrev_b32 v100, 16, v50
    v_and_b32 v101, s43, v50
    v_lshlrev_b32 v102, 16, v51
    v_and_b32 v103, s43, v51
    v_pk_fma_f32 v[96:97], v[96:97], v[88:89], v[192:193] op_sel:[0,1,0] op_sel_hi:[1,1,1]
    v_pk_fma_f32 v[98:99], v[98:99], v[88:89], v[194:195] op_sel:[0,1,0] op_sel_hi:[1,1,1]
    v_pk_fma_f32 v[100:101], v[100:101], v[88:89], v[208:209] op_sel:[0,1,0] op_sel_hi:[1,1,1]
    v_pk_fma_f32 v[102:103], v[102:103], v[88:89], v[210:211] op_sel:[0,1,0] op_sel_hi:[1,1,1]
    v_cvt_pk_bf16_f32 v48, v96, v97
    v_cvt_pk_bf16_f32 v49, v98, v99
    v_cvt_pk_bf16_f32 v50, v100, v101
    v_cvt_pk_bf16_f32 v51, v102, v103
    ds_write_b128 v10, v[48:51] offset:2048
    s_add_u32 s59, s52, 565248
    buffer_load_dwordx4 a[16:19], v3, s[12:15], s59 offen offset:0 sc1
    buffer_load_dwordx4 a[20:23], v3, s[12:15], s59 offen offset:1024 sc1
    s_waitcnt vmcnt(24)
    v_lshlrev_b32 v96, 16, v52
    v_and_b32 v97, s43, v52
    v_lshlrev_b32 v98, 16, v53
    v_and_b32 v99, s43, v53
    v_lshlrev_b32 v100, 16, v54
    v_and_b32 v101, s43, v54
    v_lshlrev_b32 v102, 16, v55
    v_and_b32 v103, s43, v55
    v_pk_fma_f32 v[96:97], v[96:97], v[90:91], v[196:197] op_sel:[0,1,0] op_sel_hi:[1,1,1]
    v_pk_fma_f32 v[98:99], v[98:99], v[90:91], v[198:199] op_sel:[0,1,0] op_sel_hi:[1,1,1]
    v_pk_fma_f32 v[100:101], v[100:101], v[90:91], v[212:213] op_sel:[0,1,0] op_sel_hi:[1,1,1]
    v_pk_fma_f32 v[102:103], v[102:103], v[90:91], v[214:215] op_sel:[0,1,0] op_sel_hi:[1,1,1]
    v_cvt_pk_bf16_f32 v52, v96, v97
    v_cvt_pk_bf16_f32 v53, v98, v99
    v_cvt_pk_bf16_f32 v54, v100, v101
    v_cvt_pk_bf16_f32 v55, v102, v103
    ds_write_b128 v10, v[52:55] offset:10240
    buffer_load_dwordx4 a[24:27], v3, s[12:15], s59 offen offset:2048 sc1
    buffer_load_dwordx4 a[28:31], v3, s[12:15], s59 offen offset:3072 sc1
    s_waitcnt vmcnt(25)
    v_lshlrev_b32 v96, 16, v56
    v_and_b32 v97, s43, v56
    v_lshlrev_b32 v98, 16, v57
    v_and_b32 v99, s43, v57
    v_lshlrev_b32 v100, 16, v58
    v_and_b32 v101, s43, v58
    v_lshlrev_b32 v102, 16, v59
    v_and_b32 v103, s43, v59
    v_pk_fma_f32 v[96:97], v[96:97], v[92:93], v[200:201] op_sel:[0,1,0] op_sel_hi:[1,1,1]
    v_pk_fma_f32 v[98:99], v[98:99], v[92:93], v[202:203] op_sel:[0,1,0] op_sel_hi:[1,1,1]
    v_pk_fma_f32 v[100:101], v[100:101], v[92:93], v[216:217] op_sel:[0,1,0] op_sel_hi:[1,1,1]
    v_pk_fma_f32 v[102:103], v[102:103], v[92:93], v[218:219] op_sel:[0,1,0] op_sel_hi:[1,1,1]
    v_cvt_pk_bf16_f32 v56, v96, v97
    v_cvt_pk_bf16_f32 v57, v98, v99
    v_cvt_pk_bf16_f32 v58, v100, v101
    v_cvt_pk_bf16_f32 v59, v102, v103
    ds_write_b128 v10, v[56:59] offset:18432
    s_add_u32 s59, s52, 569344
    buffer_load_dwordx4 a[32:35], v3, s[12:15], s59 offen offset:0 sc1
    buffer_load_dwordx4 a[36:39], v3, s[12:15], s59 offen offset:1024 sc1
    s_waitcnt vmcnt(26)
    v_lshlrev_b32 v96, 16, v60
    v_and_b32 v97, s43, v60
    v_lshlrev_b32 v98, 16, v61
    v_and_b32 v99, s43, v61
    v_lshlrev_b32 v100, 16, v62
    v_and_b32 v101, s43, v62
    v_lshlrev_b32 v102, 16, v63
    v_and_b32 v103, s43, v63
    v_pk_fma_f32 v[96:97], v[96:97], v[94:95], v[204:205] op_sel:[0,1,0] op_sel_hi:[1,1,1]
    v_pk_fma_f32 v[98:99], v[98:99], v[94:95], v[206:207] op_sel:[0,1,0] op_sel_hi:[1,1,1]
    v_pk_fma_f32 v[100:101], v[100:101], v[94:95], v[220:221] op_sel:[0,1,0] op_sel_hi:[1,1,1]
    v_pk_fma_f32 v[102:103], v[102:103], v[94:95], v[222:223] op_sel:[0,1,0] op_sel_hi:[1,1,1]
    v_cvt_pk_bf16_f32 v60, v96, v97
    v_cvt_pk_bf16_f32 v61, v98, v99
    v_cvt_pk_bf16_f32 v62, v100, v101
    v_cvt_pk_bf16_f32 v63, v102, v103
    ds_write_b128 v10, v[60:63] offset:26624
    buffer_load_dwordx4 a[40:43], v3, s[12:15], s59 offen offset:2048 sc1
    buffer_load_dwordx4 a[44:47], v3, s[12:15], s59 offen offset:3072 sc1
    s_waitcnt vmcnt(27)
    v_lshlrev_b32 v96, 16, v64
    v_and_b32 v97, s43, v64
    v_lshlrev_b32 v98, 16, v65
    v_and_b32 v99, s43, v65
    v_lshlrev_b32 v100, 16, v66
    v_and_b32 v101, s43, v66
    v_lshlrev_b32 v102, 16, v67
    v_and_b32 v103, s43, v67
    v_pk_fma_f32 v[96:97], v[96:97], v[88:89], v[224:225] op_sel:[0,1,0] op_sel_hi:[1,1,1]
    v_pk_fma_f32 v[98:99], v[98:99], v[88:89], v[226:227] op_sel:[0,1,0] op_sel_hi:[1,1,1]
    v_pk_fma_f32 v[100:101], v[100:101], v[88:89], v[240:241] op_sel:[0,1,0] op_sel_hi:[1,1,1]
    v_pk_fma_f32 v[102:103], v[102:103], v[88:89], v[242:243] op_sel:[0,1,0] op_sel_hi:[1,1,1]
    v_cvt_pk_bf16_f32 v64, v96, v97
    v_cvt_pk_bf16_f32 v65, v98, v99
    v_cvt_pk_bf16_f32 v66, v100, v101
    v_cvt_pk_bf16_f32 v67, v102, v103
    ds_write_b128 v10, v[64:67] offset:3072
    s_add_u32 s59, s50, 0
    buffer_load_dwordx4 a[48:51], v3, s[12:15], s59 offen offset:0 sc1
    buffer_load_dwordx4 a[52:55], v3, s[12:15], s59 offen offset:1024 sc1
    s_waitcnt vmcnt(28)
    v_lshlrev_b32 v96, 16, v68
    v_and_b32 v97, s43, v68
    v_lshlrev_b32 v98, 16, v69
    v_and_b32 v99, s43, v69
    v_lshlrev_b32 v100, 16, v70
    v_and_b32 v101, s43, v70
    v_lshlrev_b32 v102, 16, v71
    v_and_b32 v103, s43, v71
    v_pk_fma_f32 v[96:97], v[96:97], v[90:91], v[228:229] op_sel:[0,1,0] op_sel_hi:[1,1,1]
    v_pk_fma_f32 v[98:99], v[98:99], v[90:91], v[230:231] op_sel:[0,1,0] op_sel_hi:[1,1,1]
    v_pk_fma_f32 v[100:101], v[100:101], v[90:91], v[244:245] op_sel:[0,1,0] op_sel_hi:[1,1,1]
    v_pk_fma_f32 v[102:103], v[102:103], v[90:91], v[246:247] op_sel:[0,1,0] op_sel_hi:[1,1,1]
    v_cvt_pk_bf16_f32 v68, v96, v97
    v_cvt_pk_bf16_f32 v69, v98, v99
    v_cvt_pk_bf16_f32 v70, v100, v101
    v_cvt_pk_bf16_f32 v71, v102, v103
    ds_write_b128 v10, v[68:71] offset:11264
    buffer_load_dwordx4 a[56:59], v3, s[12:15], s59 offen offset:2048 sc1
    buffer_load_dwordx4 a[60:63], v3, s[12:15], s59 offen offset:3072 sc1
    s_waitcnt vmcnt(29)
    v_lshlrev_b32 v96, 16, v72
    v_and_b32 v97, s43, v72
    v_lshlrev_b32 v98, 16, v73
    v_and_b32 v99, s43, v73
    v_lshlrev_b32 v100, 16, v74
    v_and_b32 v101, s43, v74
    v_lshlrev_b32 v102, 16, v75
    v_and_b32 v103, s43, v75
    v_pk_fma_f32 v[96:97], v[96:97], v[92:93], v[232:233] op_sel:[0,1,0] op_sel_hi:[1,1,1]
    v_pk_fma_f32 v[98:99], v[98:99], v[92:93], v[234:235] op_sel:[0,1,0] op_sel_hi:[1,1,1]
    v_pk_fma_f32 v[100:101], v[100:101], v[92:93], v[248:249] op_sel:[0,1,0] op_sel_hi:[1,1,1]
    v_pk_fma_f32 v[102:103], v[102:103], v[92:93], v[250:251] op_sel:[0,1,0] op_sel_hi:[1,1,1]
    v_cvt_pk_bf16_f32 v72, v96, v97
    v_cvt_pk_bf16_f32 v73, v98, v99
    v_cvt_pk_bf16_f32 v74, v100, v101
    v_cvt_pk_bf16_f32 v75, v102, v103
    ds_write_b128 v10, v[72:75] offset:19456
    s_add_u32 s59, s50, 4096
    buffer_load_dwordx4 a[64:67], v3, s[12:15], s59 offen offset:0 sc1
    buffer_load_dwordx4 a[68:71], v3, s[12:15], s59 offen offset:1024 sc1
    s_waitcnt vmcnt(30)
    v_lshlrev_b32 v96, 16, v76
    v_and_b32 v97, s43, v76
    v_lshlrev_b32 v98, 16, v77
    v_and_b32 v99, s43, v77
    v_lshlrev_b32 v100, 16, v78
    v_and_b32 v101, s43, v78
    v_lshlrev_b32 v102, 16, v79
    v_and_b32 v103, s43, v79
    v_pk_fma_f32 v[96:97], v[96:97], v[94:95], v[236:237] op_sel:[0,1,0] op_sel_hi:[1,1,1]
    v_pk_fma_f32 v[98:99], v[98:99], v[94:95], v[238:239] op_sel:[0,1,0] op_sel_hi:[1,1,1]
    v_pk_fma_f32 v[100:101], v[100:101], v[94:95], v[252:253] op_sel:[0,1,0] op_sel_hi:[1,1,1]
    v_pk_fma_f32 v[102:103], v[102:103], v[94:95], v[254:255] op_sel:[0,1,0] op_sel_hi:[1,1,1]
    v_cvt_pk_bf16_f32 v76, v96, v97
    v_cvt_pk_bf16_f32 v77, v98, v99
    v_cvt_pk_bf16_f32 v78, v100, v101
    v_cvt_pk_bf16_f32 v79, v102, v103
    s_waitcnt lgkmcnt(14)
    ds_write_b128 v10, v[76:79] offset:27648
    buffer_load_dwordx4 a[72:75], v3, s[12:15], s59 offen offset:2048 sc1
    buffer_load_dwordx4 a[76:79], v3, s[12:15], s59 offen offset:3072 sc1
.p2align 2
L_tail:
    v_add_u32 v6, s48, v3
    s_waitcnt lgkmcnt(0)
    s_barrier
    ds_read_b128 v[32:35], v6 offset:0
    ds_read_b128 v[36:39], v6 offset:8192
    ds_read_b128 v[40:43], v6 offset:16384
    ds_read_b128 v[44:47], v6 offset:24576
    v_and_b32 v4, 15, v2
    v_lshrrev_b32 v5, 4, v2
    v_mov_b32 v12, 1
    v_mov_b32 v15, 0x3f80
    s_waitcnt vmcnt(36) lgkmcnt(0)
    v_mfma_f32_16x16x32_bf16 v[128:131], a[176:179], v[32:35], 0
    ds_read_b128 v[48:51], v6 offset:1024
    v_mfma_f32_16x16x32_bf16 v[144:147], a[180:183], v[32:35], 0
    s_add_u32 s59, s50, 8192
    buffer_load_dwordx4 a[80:83], v3, s[12:15], s59 offen offset:0 sc1
    v_mfma_f32_16x16x32_bf16 v[132:135], a[176:179], v[36:39], 0
    ds_read_b128 v[52:55], v6 offset:9216
    v_mfma_f32_16x16x32_bf16 v[148:151], a[180:183], v[36:39], 0
    v_mfma_f32_16x16x32_bf16 v[136:139], a[176:179], v[40:43], 0
    ds_read_b128 v[56:59], v6 offset:17408
    v_mfma_f32_16x16x32_bf16 v[152:155], a[180:183], v[40:43], 0
    buffer_load_dwordx4 a[84:87], v3, s[12:15], s59 offen offset:1024 sc1
    v_mfma_f32_16x16x32_bf16 v[140:143], a[176:179], v[44:47], 0
    ds_read_b128 v[60:63], v6 offset:25600
    v_mfma_f32_16x16x32_bf16 v[156:159], a[180:183], v[44:47], 0
    v_mfma_f32_16x16x32_bf16 v[172:175], a[184:187], v[44:47], 0
    v_and_b32 v13, 7, v4
    v_lshlrev_b32 v13, 1, v13
    v_mfma_f32_16x16x32_bf16 v[188:191], a[188:191], v[44:47], 0
    buffer_load_dwordx4 a[88:91], v3, s[12:15], s59 offen offset:2048 sc1
    v_xor_b32 v13, v13, v5
    v_lshlrev_b32 v13, 4, v13
    v_mfma_f32_16x16x32_bf16 v[168:171], a[184:187], v[40:43], 0
    v_lshl_add_u32 v13, v4, 9, v13
    v_add_u32 v28, s49, v13
    v_mfma_f32_16x16x32_bf16 v[184:187], a[188:191], v[40:43], 0
    v_xor_b32 v29, 64, v28
    v_xor_b32 v30, 128, v28
    v_mfma_f32_16x16x32_bf16 v[164:167], a[184:187], v[36:39], 0
    v_xor_b32 v31, 192, v28
    s_and_b32 s26, s16, 2
    v_mfma_f32_16x16x32_bf16 v[180:183], a[188:191], v[36:39], 0
    buffer_load_dwordx4 a[92:95], v3, s[12:15], s59 offen offset:3072 sc1
    s_add_u32 s26, s26, s25
    s_and_b32 s26, s26, 3
    v_mfma_f32_16x16x32_bf16 v[160:163], a[184:187], v[32:35], 0
    s_lshl_b32 s26, s26, 1
    s_and_b32 s28, s16, 1
    v_mfma_f32_16x16x32_bf16 v[176:179], a[188:191], v[32:35], 0
    s_add_u32 s26, s26, s28
    s_lshl_b32 s42, s26, 14
    s_waitcnt vmcnt(36) lgkmcnt(0)
    v_mfma_f32_16x16x32_bf16 v[128:131], a[192:195], v[48:51], v[128:131]
    ds_read_b128 v[32:35], v6 offset:2048
    v_mfma_f32_16x16x32_bf16 v[144:147], a[196:199], v[48:51], v[144:147]
    s_add_u32 s59, s50, 12288
    buffer_load_dwordx4 a[96:99], v3, s[12:15], s59 offen offset:0 sc1
    v_mfma_f32_16x16x32_bf16 v[132:135], a[192:195], v[52:55], v[132:135]
    ds_read_b128 v[36:39], v6 offset:10240
    v_mfma_f32_16x16x32_bf16 v[148:151], a[196:199], v[52:55], v[148:151]
    v_mfma_f32_16x16x32_bf16 v[136:139], a[192:195], v[56:59], v[136:139]
    ds_read_b128 v[40:43], v6 offset:18432
    v_mfma_f32_16x16x32_bf16 v[152:155], a[196:199], v[56:59], v[152:155]
    buffer_load_dwordx4 a[100:103], v3, s[12:15], s59 offen offset:1024 sc1
    v_mfma_f32_16x16x32_bf16 v[140:143], a[192:195], v[60:63], v[140:143]
    ds_read_b128 v[44:47], v6 offset:26624
    v_mfma_f32_16x16x32_bf16 v[156:159], a[196:199], v[60:63], v[156:159]
    v_mfma_f32_16x16x32_bf16 v[172:175], a[200:203], v[60:63], v[172:175]
    v_lshrrev_b32 v13, 1, v4
    v_xor_b32 v13, v13, v5
    v_mfma_f32_16x16x32_bf16 v[188:191], a[204:207], v[60:63], v[188:191]
    buffer_load_dwordx4 a[104:107], v3, s[12:15], s59 offen offset:2048 sc1
    v_lshlrev_b32 v13, 4, v13
    v_lshl_add_u32 v13, v4, 7, v13
    v_mfma_f32_16x16x32_bf16 v[168:171], a[200:203], v[56:59], v[168:171]
    v_add_u32 v8, s42, v13
    v_xor_b32 v9, 64, v8
    v_mfma_f32_16x16x32_bf16 v[184:187], a[204:207], v[56:59], v[184:187]
    v_add_u32 v7, s42, v3
    v_lshrrev_b32 v13, 3, v2
    v_mfma_f32_16x16x32_bf16 v[164:167], a[200:203], v[52:55], v[164:167]
    v_lshrrev_b32 v14, 4, v2
    v_xor_b32 v14, v14, v2
    v_mfma_f32_16x16x32_bf16 v[180:183], a[204:207], v[52:55], v[180:183]
    buffer_load_dwordx4 a[108:111], v3, s[12:15], s59 offen offset:3072 sc1
    v_and_b32 v14, 7, v14
    v_lshlrev_b32 v14, 4, v14
    v_mfma_f32_16x16x32_bf16 v[160:163], a[200:203], v[48:51], v[160:163]
    v_lshl_add_u32 v10, v13, 10, v14
    v_xor_b32 v11, 64, v10
    v_mfma_f32_16x16x32_bf16 v[176:179], a[204:207], v[48:51], v[176:179]
    v_lshrrev_b32 v13, 2, v4
    v_cmp_eq_u32 vcc, v13, v5
    s_waitcnt vmcnt(36) lgkmcnt(0)
    v_mfma_f32_16x16x32_bf16 v[128:131], a[208:211], v[32:35], v[128:131]
    ds_read_b128 v[48:51], v6 offset:3072
    v_mfma_f32_16x16x32_bf16 v[144:147], a[212:215], v[32:35], v[144:147]
    s_add_u32 s59, s50, 16384
    buffer_load_dwordx4 a[112:115], v3, s[12:15], s59 offen offset:0 sc1
    v_mfma_f32_16x16x32_bf16 v[132:135], a[208:211], v[36:39], v[132:135]
    ds_read_b128 v[52:55], v6 offset:11264
    v_mfma_f32_16x16x32_bf16 v[148:151], a[212:215], v[36:39], v[148:151]
    v_mfma_f32_16x16x32_bf16 v[136:139], a[208:211], v[40:43], v[136:139]
    ds_read_b128 v[56:59], v6 offset:19456
    v_mfma_f32_16x16x32_bf16 v[152:155], a[212:215], v[40:43], v[152:155]
    buffer_load_dwordx4 a[116:119], v3, s[12:15], s59 offen offset:1024 sc1
    v_mfma_f32_16x16x32_bf16 v[140:143], a[208:211], v[44:47], v[140:143]
    ds_read_b128 v[60:63], v6 offset:27648
    v_mfma_f32_16x16x32_bf16 v[156:159], a[212:215], v[44:47], v[156:159]
    v_mfma_f32_16x16x32_bf16 v[172:175], a[216:219], v[44:47], v[172:175]
    v_and_b32 v13, 1, v4
    v_lshlrev_b32 v13, 4, v13
    v_mfma_f32_16x16x32_bf16 v[188:191], a[220:223], v[44:47], v[188:191]
    buffer_load_dwordx4 a[120:123], v3, s[12:15], s59 offen offset:2048 sc1
    v_lshlrev_b32 v13, v13, v15
    v_cndmask_b32 v13, 0, v13, vcc
    v_mfma_f32_16x16x32_bf16 v[168:171], a[216:219], v[40:43], v[168:171]
    v_and_b32 v14, 2, v4
    v_cmp_eq_u32 vcc, 0, v14
    v_mfma_f32_16x16x32_bf16 v[184:187], a[220:223], v[40:43], v[184:187]
    v_mov_b32 v18, 0
    v_mov_b32 v19, 0
    v_mfma_f32_16x16x32_bf16 v[164:167], a[216:219], v[36:39], v[164:167]
    v_cndmask_b32 v16, 0, v13, vcc
    v_sub_u32 v17, v13, v16
    v_mfma_f32_16x16x32_bf16 v[180:183], a[220:223], v[36:39], v[180:183]
    buffer_load_dwordx4 a[124:127], v3, s[12:15], s59 offen offset:3072 sc1
    v_mov_b32 v20, v16
    v_mov_b32 v21, v17
    v_mfma_f32_16x16x32_bf16 v[160:163], a[216:219], v[32:35], v[160:163]
    v_mfma_f32_16x16x32_bf16 v[176:179], a[220:223], v[32:35], v[176:179]
    s_waitcnt vmcnt(36) lgkmcnt(0)
    v_mfma_f32_16x16x32_bf16 v[128:131], a[224:227], v[48:51], v[128:131]
    ds_read_b128 v[32:35], v6 offset:4096
    v_mfma_f32_16x16x32_bf16 v[144:147], a[228:231], v[48:51], v[144:147]
    s_add_u32 s59, s50, 20480
    buffer_load_dwordx4 a[128:131], v3, s[12:15], s59 offen offset:0 sc1
    v_mfma_f32_16x16x32_bf16 v[132:135], a[224:227], v[52:55], v[132:135]
    ds_read_b128 v[36:39], v6 offset:12288
    v_mfma_f32_16x16x32_bf16 v[148:151], a[228:231], v[52:55], v[148:151]
    v_mfma_f32_16x16x32_bf16 v[136:139], a[224:227], v[56:59], v[136:139]
    ds_read_b128 v[40:43], v6 offset:20480
    v_mfma_f32_16x16x32_bf16 v[152:155], a[228:231], v[56:59], v[152:155]
    buffer_load_dwordx4 a[132:135], v3, s[12:15], s59 offen offset:1024 sc1
    v_mfma_f32_16x16x32_bf16 v[140:143], a[224:227], v[60:63], v[140:143]
    ds_read_b128 v[44:47], v6 offset:28672
    v_mfma_f32_16x16x32_bf16 v[156:159], a[228:231], v[60:63], v[156:159]
    v_mfma_f32_16x16x32_bf16 v[172:175], a[232:235], v[60:63], v[172:175]
    v_mfma_f32_16x16x32_bf16 v[188:191], a[236:239], v[60:63], v[188:191]
    buffer_load_dwordx4 a[136:139], v3, s[12:15], s59 offen offset:2048 sc1
    v_mfma_f32_16x16x32_bf16 v[168:171], a[232:235], v[56:59], v[168:171]
    v_mfma_f32_16x16x32_bf16 v[184:187], a[236:239], v[56:59], v[184:187]
    v_mfma_f32_16x16x32_bf16 v[164:167], a[232:235], v[52:55], v[164:167]
    v_mfma_f32_16x16x32_bf16 v[180:183], a[236:239], v[52:55], v[180:183]
    buffer_load_dwordx4 a[140:143], v3, s[12:15], s59 offen offset:3072 sc1
    v_mfma_f32_16x16x32_bf16 v[160:163], a[232:235], v[48:51], v[160:163]
    v_mfma_f32_16x16x32_bf16 v[176:179], a[236:239], v[48:51], v[176:179]
    s_waitcnt vmcnt(36) lgkmcnt(0)
    v_mfma_f32_16x16x32_bf16 v[128:131], a[240:243], v[32:35], v[128:131]
    ds_read_b128 v[48:51], v6 offset:5120
    v_mfma_f32_16x16x32_bf16 v[144:147], a[244:247], v[32:35], v[144:147]
    s_add_u32 s59, s50, 24576
    buffer_load_dwordx4 a[144:147], v3, s[12:15], s59 offen offset:0 sc1
    v_mfma_f32_16x16x32_bf16 v[132:135], a[240:243], v[36:39], v[132:135]
    ds_read_b128 v[52:55], v6 offset:13312
    v_mfma_f32_16x16x32_bf16 v[148:151], a[244:247], v[36:39], v[148:151]
    v_mfma_f32_16x16x32_bf16 v[136:139], a[240:243], v[40:43], v[136:139]
    ds_read_b128 v[56:59], v6 offset:21504
    v_mfma_f32_16x16x32_bf16 v[152:155], a[244:247], v[40:43], v[152:155]
    buffer_load_dwordx4 a[148:151], v3, s[12:15], s59 offen offset:1024 sc1
    v_mfma_f32_16x16x32_bf16 v[140:143], a[240:243], v[44:47], v[140:143]
    ds_read_b128 v[60:63], v6 offset:29696
    v_mfma_f32_16x16x32_bf16 v[156:159], a[244:247], v[44:47], v[156:159]
    v_mfma_f32_16x16x32_bf16 v[172:175], a[248:251], v[44:47], v[172:175]
    v_mfma_f32_16x16x32_bf16 v[188:191], a[252:255], v[44:47], v[188:191]
    buffer_load_dwordx4 a[152:155], v3, s[12:15], s59 offen offset:2048 sc1
    v_mfma_f32_16x16x32_bf16 v[168:171], a[248:251], v[40:43], v[168:171]
    v_mfma_f32_16x16x32_bf16 v[184:187], a[252:255], v[40:43], v[184:187]
    v_mfma_f32_16x16x32_bf16 v[164:167], a[248:251], v[36:39], v[164:167]
    v_mfma_f32_16x16x32_bf16 v[180:183], a[252:255], v[36:39], v[180:183]
    buffer_load_dwordx4 a[156:159], v3, s[12:15], s59 offen offset:3072 sc1
    v_mfma_f32_16x16x32_bf16 v[160:163], a[248:251], v[32:35], v[160:163]
    v_mfma_f32_16x16x32_bf16 v[176:179], a[252:255], v[32:35], v[176:179]
    s_waitcnt vmcnt(36) lgkmcnt(0)
    v_mfma_f32_16x16x32_bf16 v[128:131], a[0:3], v[48:51], v[128:131]
    ds_read_b128 v[32:35], v6 offset:6144
    v_mfma_f32_16x16x32_bf16 v[144:147], a[4:7], v[48:51], v[144:147]
    s_add_u32 s59, s50, 28672
    buffer_load_dwordx4 a[160:163], v3, s[12:15], s59 offen offset:0 sc1
    v_mfma_f32_16x16x32_bf16 v[132:135], a[0:3], v[52:55], v[132:135]
    ds_read_b128 v[36:39], v6 offset:14336
    v_mfma_f32_16x16x32_bf16 v[148:151], a[4:7], v[52:55], v[148:151]
    v_mfma_f32_16x16x32_bf16 v[136:139], a[0:3], v[56:59], v[136:139]
    ds_read_b128 v[40:43], v6 offset:22528
    v_mfma_f32_16x16x32_bf16 v[152:155], a[4:7], v[56:59], v[152:155]
    buffer_load_dwordx4 a[164:167], v3, s[12:15], s59 offen offset:1024 sc1
    v_mfma_f32_16x16x32_bf16 v[140:143], a[0:3], v[60:63], v[140:143]
    ds_read_b128 v[44:47], v6 offset:30720
    v_mfma_f32_16x16x32_bf16 v[156:159], a[4:7], v[60:63], v[156:159]
    v_mfma_f32_16x16x32_bf16 v[172:175], a[8:11], v[60:63], v[172:175]
    v_mfma_f32_16x16x32_bf16 v[188:191], a[12:15], v[60:63], v[188:191]
    buffer_load_dwordx4 a[168:171], v3, s[12:15], s59 offen offset:2048 sc1
    v_mfma_f32_16x16x32_bf16 v[168:171], a[8:11], v[56:59], v[168:171]
    v_mfma_f32_16x16x32_bf16 v[184:187], a[12:15], v[56:59], v[184:187]
    v_mfma_f32_16x16x32_bf16 v[164:167], a[8:11], v[52:55], v[164:167]
    v_mfma_f32_16x16x32_bf16 v[180:183], a[12:15], v[52:55], v[180:183]
    buffer_load_dwordx4 a[172:175], v3, s[12:15], s59 offen offset:3072 sc1
    v_mfma_f32_16x16x32_bf16 v[160:163], a[8:11], v[48:51], v[160:163]
    v_mfma_f32_16x16x32_bf16 v[176:179], a[12:15], v[48:51], v[176:179]
    s_waitcnt vmcnt(36) lgkmcnt(0)
    v_mfma_f32_16x16x32_bf16 v[128:131], a[16:19], v[32:35], v[128:131]
    ds_read_b128 v[48:51], v6 offset:7168
    v_mfma_f32_16x16x32_bf16 v[144:147], a[20:23], v[32:35], v[144:147]
    s_add_u32 s59, s53, 524288
    buffer_load_dwordx4 a[176:179], v3, s[12:15], s59 offen offset:0 sc1
    v_mfma_f32_16x16x32_bf16 v[132:135], a[16:19], v[36:39], v[132:135]
    ds_read_b128 v[52:55], v6 offset:15360
    v_mfma_f32_16x16x32_bf16 v[148:151], a[20:23], v[36:39], v[148:151]
    v_mfma_f32_16x16x32_bf16 v[136:139], a[16:19], v[40:43], v[136:139]
    ds_read_b128 v[56:59], v6 offset:23552
    v_mfma_f32_16x16x32_bf16 v[152:155], a[20:23], v[40:43], v[152:155]
    buffer_load_dwordx4 a[180:183], v3, s[12:15], s59 offen offset:1024 sc1
    v_mfma_f32_16x16x32_bf16 v[140:143], a[16:19], v[44:47], v[140:143]
    ds_read_b128 v[60:63], v6 offset:31744
    v_mfma_f32_16x16x32_bf16 v[156:159], a[20:23], v[44:47], v[156:159]
    v_mfma_f32_16x16x32_bf16 v[172:175], a[24:27], v[44:47], v[172:175]
    v_mfma_f32_16x16x32_bf16 v[188:191], a[28:31], v[44:47], v[188:191]
    buffer_load_dwordx4 a[184:187], v3, s[12:15], s59 offen offset:2048 sc1
    v_mfma_f32_16x16x32_bf16 v[168:171], a[24:27], v[40:43], v[168:171]
    v_mfma_f32_16x16x32_bf16 v[184:187], a[28:31], v[40:43], v[184:187]
    v_mfma_f32_16x16x32_bf16 v[164:167], a[24:27], v[36:39], v[164:167]
    v_mfma_f32_16x16x32_bf16 v[180:183], a[28:31], v[36:39], v[180:183]
    buffer_load_dwordx4 a[188:191], v3, s[12:15], s59 offen offset:3072 sc1
    v_mfma_f32_16x16x32_bf16 v[160:163], a[24:27], v[32:35], v[160:163]
    v_mfma_f32_16x16x32_bf16 v[176:179], a[28:31], v[32:35], v[176:179]
    s_waitcnt vmcnt(36) lgkmcnt(0)
    v_mfma_f32_16x16x32_bf16 v[128:131], a[32:35], v[48:51], v[128:131]
    ds_read_b128 v[32:35], v28 offset:0
    v_mfma_f32_16x16x32_bf16 v[144:147], a[36:39], v[48:51], v[144:147]
    s_add_u32 s59, s53, 528384
    buffer_load_dwordx4 a[192:195], v3, s[12:15], s59 offen offset:0 sc1
    v_mfma_f32_16x16x32_bf16 v[132:135], a[32:35], v[52:55], v[132:135]
    ds_read_b128 v[36:39], v28 offset:8192
    v_mfma_f32_16x16x32_bf16 v[148:151], a[36:39], v[52:55], v[148:151]
    v_mfma_f32_16x16x32_bf16 v[136:139], a[32:35], v[56:59], v[136:139]
    ds_read_b128 v[40:43], v28 offset:16384
    v_mfma_f32_16x16x32_bf16 v[152:155], a[36:39], v[56:59], v[152:155]
    buffer_load_dwordx4 a[196:199], v3, s[12:15], s59 offen offset:1024 sc1
    v_mfma_f32_16x16x32_bf16 v[140:143], a[32:35], v[60:63], v[140:143]
    ds_read_b128 v[44:47], v28 offset:24576
    v_mfma_f32_16x16x32_bf16 v[156:159], a[36:39], v[60:63], v[156:159]
    v_mfma_f32_16x16x32_bf16 v[172:175], a[40:43], v[60:63], v[172:175]
    v_mfma_f32_16x16x32_bf16 v[188:191], a[44:47], v[60:63], v[188:191]
    buffer_load_dwordx4 a[200:203], v3, s[12:15], s59 offen offset:2048 sc1
    v_mfma_f32_16x16x32_bf16 v[168:171], a[40:43], v[56:59], v[168:171]
    v_mfma_f32_16x16x32_bf16 v[184:187], a[44:47], v[56:59], v[184:187]
    v_mfma_f32_16x16x32_bf16 v[164:167], a[40:43], v[52:55], v[164:167]
    v_mfma_f32_16x16x32_bf16 v[180:183], a[44:47], v[52:55], v[180:183]
    buffer_load_dwordx4 a[204:207], v3, s[12:15], s59 offen offset:3072 sc1
    v_mfma_f32_16x16x32_bf16 v[160:163], a[40:43], v[48:51], v[160:163]
    v_mfma_f32_16x16x32_bf16 v[176:179], a[44:47], v[48:51], v[176:179]
    s_waitcnt vmcnt(36) lgkmcnt(0)
    v_mfma_f32_16x16x32_bf16 v[128:131], a[48:51], v[32:35], v[128:131]
    ds_read_b128 v[48:51], v29 offset:0
    v_mfma_f32_16x16x32_bf16 v[144:147], a[52:55], v[32:35], v[144:147]
    s_add_u32 s59, s53, 532480
    buffer_load_dwordx4 a[208:211], v3, s[12:15], s59 offen offset:0 sc1
    v_mfma_f32_16x16x32_bf16 v[132:135], a[48:51], v[36:39], v[132:135]
    ds_read_b128 v[52:55], v29 offset:8192
    v_mfma_f32_16x16x32_bf16 v[148:151], a[52:55], v[36:39], v[148:151]
    v_mfma_f32_16x16x32_bf16 v[136:139], a[48:51], v[40:43], v[136:139]
    ds_read_b128 v[56:59], v29 offset:16384
    v_mfma_f32_16x16x32_bf16 v[152:155], a[52:55], v[40:43], v[152:155]
    buffer_load_dwordx4 a[212:215], v3, s[12:15], s59 offen offset:1024 sc1
    v_mfma_f32_16x16x32_bf16 v[140:143], a[48:51], v[44:47], v[140:143]
    ds_read_b128 v[60:63], v29 offset:24576
    v_mfma_f32_16x16x32_bf16 v[156:159], a[52:55], v[44:47], v[156:159]
    v_mfma_f32_16x16x32_bf16 v[172:175], a[56:59], v[44:47], v[172:175]
    v_mfma_f32_16x16x32_bf16 v[188:191], a[60:63], v[44:47], v[188:191]
    buffer_load_dwordx4 a[216:219], v3, s[12:15], s59 offen offset:2048 sc1
    v_mfma_f32_16x16x32_bf16 v[168:171], a[56:59], v[40:43], v[168:171]
    v_mfma_f32_16x16x32_bf16 v[184:187], a[60:63], v[40:43], v[184:187]
    v_mfma_f32_16x16x32_bf16 v[164:167], a[56:59], v[36:39], v[164:167]
    v_mfma_f32_16x16x32_bf16 v[180:183], a[60:63], v[36:39], v[180:183]
    buffer_load_dwordx4 a[220:223], v3, s[12:15], s59 offen offset:3072 sc1
    v_mfma_f32_16x16x32_bf16 v[160:163], a[56:59], v[32:35], v[160:163]
    v_mfma_f32_16x16x32_bf16 v[176:179], a[60:63], v[32:35], v[176:179]
    s_waitcnt vmcnt(36) lgkmcnt(0)
    v_mfma_f32_16x16x32_bf16 v[128:131], a[64:67], v[48:51], v[128:131]
    ds_read_b128 v[32:35], v30 offset:0
    v_mfma_f32_16x16x32_bf16 v[144:147], a[68:71], v[48:51], v[144:147]
    s_add_u32 s59, s53, 536576
    buffer_load_dwordx4 a[224:227], v3, s[12:15], s59 offen offset:0 sc1
    v_mfma_f32_16x16x32_bf16 v[132:135], a[64:67], v[52:55], v[132:135]
    ds_read_b128 v[36:39], v30 offset:8192
    v_mfma_f32_16x16x32_bf16 v[148:151], a[68:71], v[52:55], v[148:151]
    v_mfma_f32_16x16x32_bf16 v[136:139], a[64:67], v[56:59], v[136:139]
    ds_read_b128 v[40:43], v30 offset:16384
    v_mfma_f32_16x16x32_bf16 v[152:155], a[68:71], v[56:59], v[152:155]
    buffer_load_dwordx4 a[228:231], v3, s[12:15], s59 offen offset:1024 sc1
    v_mfma_f32_16x16x32_bf16 v[140:143], a[64:67], v[60:63], v[140:143]
    ds_read_b128 v[44:47], v30 offset:24576
    v_mfma_f32_16x16x32_bf16 v[156:159], a[68:71], v[60:63], v[156:159]
    v_mfma_f32_16x16x32_bf16 v[172:175], a[72:75], v[60:63], v[172:175]
    v_mfma_f32_16x16x32_bf16 v[188:191], a[76:79], v[60:63], v[188:191]
    buffer_load_dwordx4 a[232:235], v3, s[12:15], s59 offen offset:2048 sc1
    v_mfma_f32_16x16x32_bf16 v[168:171], a[72:75], v[56:59], v[168:171]
    v_mfma_f32_16x16x32_bf16 v[184:187], a[76:79], v[56:59], v[184:187]
    v_mfma_f32_16x16x32_bf16 v[164:167], a[72:75], v[52:55], v[164:167]
    v_mfma_f32_16x16x32_bf16 v[180:183], a[76:79], v[52:55], v[180:183]
    buffer_load_dwordx4 a[236:239], v3, s[12:15], s59 offen offset:3072 sc1
    v_mfma_f32_16x16x32_bf16 v[160:163], a[72:75], v[48:51], v[160:163]
    v_mfma_f32_16x16x32_bf16 v[176:179], a[76:79], v[48:51], v[176:179]
    s_waitcnt vmcnt(36) lgkmcnt(0)
    v_mfma_f32_16x16x32_bf16 v[128:131], a[80:83], v[32:35], v[128:131]
    ds_read_b128 v[48:51], v31 offset:0
    v_mfma_f32_16x16x32_bf16 v[144:147], a[84:87], v[32:35], v[144:147]
    s_add_u32 s59, s53, 557056
    buffer_load_dwordx4 a[240:243], v3, s[12:15], s59 offen offset:0 sc1
    v_mfma_f32_16x16x32_bf16 v[132:135], a[80:83], v[36:39], v[132:135]
    ds_read_b128 v[52:55], v31 offset:8192
    v_mfma_f32_16x16x32_bf16 v[148:151], a[84:87], v[36:39], v[148:151]
    v_mfma_f32_16x16x32_bf16 v[136:139], a[80:83], v[40:43], v[136:139]
    ds_read_b128 v[56:59], v31 offset:16384
    v_mfma_f32_16x16x32_bf16 v[152:155], a[84:87], v[40:43], v[152:155]
    buffer_load_dwordx4 a[244:247], v3, s[12:15], s59 offen offset:1024 sc1
    v_mfma_f32_16x16x32_bf16 v[140:143], a[80:83], v[44:47], v[140:143]
    ds_read_b128 v[60:63], v31 offset:24576
    v_mfma_f32_16x16x32_bf16 v[156:159], a[84:87], v[44:47], v[156:159]
    v_mfma_f32_16x16x32_bf16 v[172:175], a[88:91], v[44:47], v[172:175]
    v_mfma_f32_16x16x32_bf16 v[188:191], a[92:95], v[44:47], v[188:191]
    buffer_load_dwordx4 a[248:251], v3, s[12:15], s59 offen offset:2048 sc1
    v_mfma_f32_16x16x32_bf16 v[168:171], a[88:91], v[40:43], v[168:171]
    v_mfma_f32_16x16x32_bf16 v[184:187], a[92:95], v[40:43], v[184:187]
    v_mfma_f32_16x16x32_bf16 v[164:167], a[88:91], v[36:39], v[164:167]
    v_mfma_f32_16x16x32_bf16 v[180:183], a[92:95], v[36:39], v[180:183]
    buffer_load_dwordx4 a[252:255], v3, s[12:15], s59 offen offset:3072 sc1
    v_mfma_f32_16x16x32_bf16 v[160:163], a[88:91], v[32:35], v[160:163]
    v_mfma_f32_16x16x32_bf16 v[176:179], a[92:95], v[32:35], v[176:179]
    s_waitcnt vmcnt(36) lgkmcnt(0)
    v_mfma_f32_16x16x32_bf16 v[128:131], a[96:99], v[48:51], v[128:131]
    ds_read_b128 v[32:35], v28 offset:256
    v_mfma_f32_16x16x32_bf16 v[144:147], a[100:103], v[48:51], v[144:147]
    s_add_u32 s59, s53, 561152
    buffer_load_dwordx4 a[0:3], v3, s[12:15], s59 offen offset:0 sc1
    v_mfma_f32_16x16x32_bf16 v[132:135], a[96:99], v[52:55], v[132:135]
    ds_read_b128 v[36:39], v28 offset:8448
    v_mfma_f32_16x16x32_bf16 v[148:151], a[100:103], v[52:55], v[148:151]
    v_mfma_f32_16x16x32_bf16 v[136:139], a[96:99], v[56:59], v[136:139]
    ds_read_b128 v[40:43], v28 offset:16640
    v_mfma_f32_16x16x32_bf16 v[152:155], a[100:103], v[56:59], v[152:155]
    buffer_load_dwordx4 a[4:7], v3, s[12:15], s59 offen offset:1024 sc1
    v_mfma_f32_16x16x32_bf16 v[140:143], a[96:99], v[60:63], v[140:143]
    ds_read_b128 v[44:47], v28 offset:24832
    v_mfma_f32_16x16x32_bf16 v[156:159], a[100:103], v[60:63], v[156:159]
    v_mfma_f32_16x16x32_bf16 v[172:175], a[104:107], v[60:63], v[172:175]
    v_mfma_f32_16x16x32_bf16 v[188:191], a[108:111], v[60:63], v[188:191]
    buffer_load_dwordx4 a[8:11], v3, s[12:15], s59 offen offset:2048 sc1
    v_mfma_f32_16x16x32_bf16 v[168:171], a[104:107], v[56:59], v[168:171]
    v_mfma_f32_16x16x32_bf16 v[184:187], a[108:111], v[56:59], v[184:187]
    v_mfma_f32_16x16x32_bf16 v[164:167], a[104:107], v[52:55], v[164:167]
    v_mfma_f32_16x16x32_bf16 v[180:183], a[108:111], v[52:55], v[180:183]
    buffer_load_dwordx4 a[12:15], v3, s[12:15], s59 offen offset:3072 sc1
    v_mfma_f32_16x16x32_bf16 v[160:163], a[104:107], v[48:51], v[160:163]
    v_mfma_f32_16x16x32_bf16 v[176:179], a[108:111], v[48:51], v[176:179]
    s_waitcnt vmcnt(36) lgkmcnt(0)
    v_mfma_f32_16x16x32_bf16 v[128:131], a[112:115], v[32:35], v[128:131]
    ds_read_b128 v[48:51], v29 offset:256
    v_mfma_f32_16x16x32_bf16 v[144:147], a[116:119], v[32:35], v[144:147]
    s_add_u32 s59, s53, 565248
    buffer_load_dwordx4 a[16:19], v3, s[12:15], s59 offen offset:0 sc1
    v_mfma_f32_16x16x32_bf16 v[132:135], a[112:115], v[36:39], v[132:135]
    ds_read_b128 v[52:55], v29 offset:8448
    v_mfma_f32_16x16x32_bf16 v[148:151], a[116:119], v[36:39], v[148:151]
    v_mfma_f32_16x16x32_bf16 v[136:139], a[112:115], v[40:43], v[136:139]
    ds_read_b128 v[56:59], v29 offset:16640
    v_mfma_f32_16x16x32_bf16 v[152:155], a[116:119], v[40:43], v[152:155]
    buffer_load_dwordx4 a[20:23], v3, s[12:15], s59 offen offset:1024 sc1
    v_mfma_f32_16x16x32_bf16 v[140:143], a[112:115], v[44:47], v[140:143]
    ds_read_b128 v[60:63], v29 offset:24832
    v_mfma_f32_16x16x32_bf16 v[156:159], a[116:119], v[44:47], v[156:159]
    v_mfma_f32_16x16x32_bf16 v[172:175], a[120:123], v[44:47], v[172:175]
    v_mfma_f32_16x16x32_bf16 v[188:191], a[124:127], v[44:47], v[188:191]
    buffer_load_dwordx4 a[24:27], v3, s[12:15], s59 offen offset:2048 sc1
    v_mfma_f32_16x16x32_bf16 v[168:171], a[120:123], v[40:43], v[168:171]
    v_mfma_f32_16x16x32_bf16 v[184:187], a[124:127], v[40:43], v[184:187]
    v_mfma_f32_16x16x32_bf16 v[164:167], a[120:123], v[36:39], v[164:167]
    v_mfma_f32_16x16x32_bf16 v[180:183], a[124:127], v[36:39], v[180:183]
    buffer_load_dwordx4 a[28:31], v3, s[12:15], s59 offen offset:3072 sc1
    v_mfma_f32_16x16x32_bf16 v[160:163], a[120:123], v[32:35], v[160:163]
    v_mfma_f32_16x16x32_bf16 v[176:179], a[124:127], v[32:35], v[176:179]
    s_waitcnt vmcnt(36) lgkmcnt(0)
    v_mfma_f32_16x16x32_bf16 v[128:131], a[128:131], v[48:51], v[128:131]
    ds_read_b128 v[32:35], v30 offset:256
    v_mfma_f32_16x16x32_bf16 v[144:147], a[132:135], v[48:51], v[144:147]
    s_add_u32 s59, s53, 569344
    buffer_load_dwordx4 a[32:35], v3, s[12:15], s59 offen offset:0 sc1
    v_mfma_f32_16x16x32_bf16 v[132:135], a[128:131], v[52:55], v[132:135]
    ds_read_b128 v[36:39], v30 offset:8448
    v_mfma_f32_16x16x32_bf16 v[148:151], a[132:135], v[52:55], v[148:151]
    v_mfma_f32_16x16x32_bf16 v[136:139], a[128:131], v[56:59], v[136:139]
    ds_read_b128 v[40:43], v30 offset:16640
    v_mfma_f32_16x16x32_bf16 v[152:155], a[132:135], v[56:59], v[152:155]
    buffer_load_dwordx4 a[36:39], v3, s[12:15], s59 offen offset:1024 sc1
    v_mfma_f32_16x16x32_bf16 v[140:143], a[128:131], v[60:63], v[140:143]
    ds_read_b128 v[44:47], v30 offset:24832
    v_mfma_f32_16x16x32_bf16 v[156:159], a[132:135], v[60:63], v[156:159]
    v_mfma_f32_16x16x32_bf16 v[172:175], a[136:139], v[60:63], v[172:175]
    v_mfma_f32_16x16x32_bf16 v[188:191], a[140:143], v[60:63], v[188:191]
    buffer_load_dwordx4 a[40:43], v3, s[12:15], s59 offen offset:2048 sc1
    v_mfma_f32_16x16x32_bf16 v[168:171], a[136:139], v[56:59], v[168:171]
    v_mfma_f32_16x16x32_bf16 v[184:187], a[140:143], v[56:59], v[184:187]
    v_mfma_f32_16x16x32_bf16 v[164:167], a[136:139], v[52:55], v[164:167]
    v_mfma_f32_16x16x32_bf16 v[180:183], a[140:143], v[52:55], v[180:183]
    buffer_load_dwordx4 a[44:47], v3, s[12:15], s59 offen offset:3072 sc1
    v_mfma_f32_16x16x32_bf16 v[160:163], a[136:139], v[48:51], v[160:163]
    v_mfma_f32_16x16x32_bf16 v[176:179], a[140:143], v[48:51], v[176:179]
    s_waitcnt vmcnt(36) lgkmcnt(0)
    v_mfma_f32_16x16x32_bf16 v[128:131], a[144:147], v[32:35], v[128:131]
    ds_read_b128 v[48:51], v31 offset:256
    v_mfma_f32_16x16x32_bf16 v[144:147], a[148:151], v[32:35], v[144:147]
    s_add_u32 s59, s51, 0
    buffer_load_dwordx4 a[48:51], v3, s[12:15], s59 offen offset:0 sc1
    v_mfma_f32_16x16x32_bf16 v[132:135], a[144:147], v[36:39], v[132:135]
    ds_read_b128 v[52:55], v31 offset:8448
    v_mfma_f32_16x16x32_bf16 v[148:151], a[148:151], v[36:39], v[148:151]
    v_mfma_f32_16x16x32_bf16 v[136:139], a[144:147], v[40:43], v[136:139]
    ds_read_b128 v[56:59], v31 offset:16640
    v_mfma_f32_16x16x32_bf16 v[152:155], a[148:151], v[40:43], v[152:155]
    buffer_load_dwordx4 a[52:55], v3, s[12:15], s59 offen offset:1024 sc1
    v_mfma_f32_16x16x32_bf16 v[140:143], a[144:147], v[44:47], v[140:143]
    ds_read_b128 v[60:63], v31 offset:24832
    v_mfma_f32_16x16x32_bf16 v[156:159], a[148:151], v[44:47], v[156:159]
    v_mfma_f32_16x16x32_bf16 v[172:175], a[152:155], v[44:47], v[172:175]
    v_mfma_f32_16x16x32_bf16 v[188:191], a[156:159], v[44:47], v[188:191]
    buffer_load_dwordx4 a[56:59], v3, s[12:15], s59 offen offset:2048 sc1
    v_mfma_f32_16x16x32_bf16 v[168:171], a[152:155], v[40:43], v[168:171]
    v_mfma_f32_16x16x32_bf16 v[184:187], a[156:159], v[40:43], v[184:187]
    v_mfma_f32_16x16x32_bf16 v[164:167], a[152:155], v[36:39], v[164:167]
    v_mfma_f32_16x16x32_bf16 v[180:183], a[156:159], v[36:39], v[180:183]
    buffer_load_dwordx4 a[60:63], v3, s[12:15], s59 offen offset:3072 sc1
    v_mfma_f32_16x16x32_bf16 v[160:163], a[152:155], v[32:35], v[160:163]
    v_mfma_f32_16x16x32_bf16 v[176:179], a[156:159], v[32:35], v[176:179]
    s_waitcnt vmcnt(36) lgkmcnt(0)
    v_mfma_f32_16x16x32_bf16 v[128:131], a[160:163], v[48:51], v[128:131]
    ds_read_b128 v[32:35], v6 offset:0
    v_mfma_f32_16x16x32_bf16 v[144:147], a[164:167], v[48:51], v[144:147]
    s_add_u32 s59, s51, 4096
    buffer_load_dwordx4 a[64:67], v3, s[12:15], s59 offen offset:0 sc1
    v_mfma_f32_16x16x32_bf16 v[132:135], a[160:163], v[52:55], v[132:135]
    ds_read_b128 v[36:39], v6 offset:8192
    v_mfma_f32_16x16x32_bf16 v[148:151], a[164:167], v[52:55], v[148:151]
    v_mfma_f32_16x16x32_bf16 v[136:139], a[160:163], v[56:59], v[136:139]
    ds_read_b128 v[40:43], v6 offset:16384
    v_mfma_f32_16x16x32_bf16 v[152:155], a[164:167], v[56:59], v[152:155]
    buffer_load_dwordx4 a[68:71], v3, s[12:15], s59 offen offset:1024 sc1
    v_mfma_f32_16x16x32_bf16 v[140:143], a[160:163], v[60:63], v[140:143]
    ds_read_b128 v[44:47], v6 offset:24576
    v_mfma_f32_16x16x32_bf16 v[156:159], a[164:167], v[60:63], v[156:159]
    v_mfma_f32_16x16x32_bf16 v[172:175], a[168:171], v[60:63], v[172:175]
    v_mfma_f32_16x16x32_bf16 v[188:191], a[172:175], v[60:63], v[188:191]
    buffer_load_dwordx4 a[72:75], v3, s[12:15], s59 offen offset:2048 sc1
    v_mfma_f32_16x16x32_bf16 v[168:171], a[168:171], v[56:59], v[168:171]
    v_mfma_f32_16x16x32_bf16 v[184:187], a[172:175], v[56:59], v[184:187]
    v_mfma_f32_16x16x32_bf16 v[164:167], a[168:171], v[52:55], v[164:167]
    v_mfma_f32_16x16x32_bf16 v[180:183], a[172:175], v[52:55], v[180:183]
    buffer_load_dwordx4 a[76:79], v3, s[12:15], s59 offen offset:3072 sc1
    v_mfma_f32_16x16x32_bf16 v[160:163], a[168:171], v[48:51], v[160:163]
    v_mfma_f32_16x16x32_bf16 v[176:179], a[172:175], v[48:51], v[176:179]
    s_waitcnt vmcnt(36) lgkmcnt(0)
    v_mfma_f32_16x16x32_bf16 v[192:195], a[176:179], v[32:35], 0
    ds_read_b128 v[48:51], v6 offset:1024
    v_mfma_f32_16x16x32_bf16 v[208:211], a[180:183], v[32:35], 0
    v_mfma_f32_16x16x32_bf16 v[196:199], a[176:179], v[36:39], 0
    ds_read_b128 v[52:55], v6 offset:9216
    v_mfma_f32_16x16x32_bf16 v[212:215], a[180:183], v[36:39], 0
    v_mfma_f32_16x16x32_bf16 v[200:203], a[176:179], v[40:43], 0
    ds_read_b128 v[56:59], v6 offset:17408
    v_mfma_f32_16x16x32_bf16 v[216:219], a[180:183], v[40:43], 0
    v_mfma_f32_16x16x32_bf16 v[204:207], a[176:179], v[44:47], 0
    ds_read_b128 v[60:63], v6 offset:25600
    v_mfma_f32_16x16x32_bf16 v[220:223], a[180:183], v[44:47], 0
    v_mfma_f32_16x16x32_bf16 v[236:239], a[184:187], v[44:47], 0
    v_cvt_pk_bf16_f32 v64, v128, v129
    v_cvt_pk_bf16_f32 v65, v130, v131
    v_mfma_f32_16x16x32_bf16 v[252:255], a[188:191], v[44:47], 0
    v_cvt_pk_bf16_f32 v66, v144, v145
    v_cvt_pk_bf16_f32 v67, v146, v147
    v_mfma_f32_16x16x32_bf16 v[232:235], a[184:187], v[40:43], 0
    buffer_store_dwordx4 v[64:67], v3, s[44:47], s54 offen offset:0 nt
    v_mfma_f32_16x16x32_bf16 v[248:251], a[188:191], v[40:43], 0
    v_mfma_f32_16x16x32_bf16 v[228:231], a[184:187], v[36:39], 0
    v_cvt_pk_bf16_f32 v68, v160, v161
    v_cvt_pk_bf16_f32 v69, v162, v163
    v_mfma_f32_16x16x32_bf16 v[244:247], a[188:191], v[36:39], 0
    v_cvt_pk_bf16_f32 v70, v176, v177
    v_cvt_pk_bf16_f32 v71, v178, v179
    v_mfma_f32_16x16x32_bf16 v[224:227], a[184:187], v[32:35], 0
    buffer_store_dwordx4 v[68:71], v3, s[44:47], s54 offen offset:1024 nt
    v_mfma_f32_16x16x32_bf16 v[240:243], a[188:191], v[32:35], 0
    s_waitcnt vmcnt(34) lgkmcnt(0)
    v_mfma_f32_16x16x32_bf16 v[192:195], a[192:195], v[48:51], v[192:195]
    ds_read_b128 v[32:35], v6 offset:2048
    v_mfma_f32_16x16x32_bf16 v[208:211], a[196:199], v[48:51], v[208:211]
    v_mfma_f32_16x16x32_bf16 v[196:199], a[192:195], v[52:55], v[196:199]
    ds_read_b128 v[36:39], v6 offset:10240
    v_mfma_f32_16x16x32_bf16 v[212:215], a[196:199], v[52:55], v[212:215]
    v_mfma_f32_16x16x32_bf16 v[200:203], a[192:195], v[56:59], v[200:203]
    ds_read_b128 v[40:43], v6 offset:18432
    v_mfma_f32_16x16x32_bf16 v[216:219], a[196:199], v[56:59], v[216:219]
    v_mfma_f32_16x16x32_bf16 v[204:207], a[192:195], v[60:63], v[204:207]
    ds_read_b128 v[44:47], v6 offset:26624
    v_mfma_f32_16x16x32_bf16 v[220:223], a[196:199], v[60:63], v[220:223]
    v_mfma_f32_16x16x32_bf16 v[236:239], a[200:203], v[60:63], v[236:239]
    v_cvt_pk_bf16_f32 v72, v132, v133
    v_cvt_pk_bf16_f32 v73, v134, v135
    v_mfma_f32_16x16x32_bf16 v[252:255], a[204:207], v[60:63], v[252:255]
    v_cvt_pk_bf16_f32 v74, v148, v149
    v_cvt_pk_bf16_f32 v75, v150, v151
    v_mfma_f32_16x16x32_bf16 v[232:235], a[200:203], v[56:59], v[232:235]
    buffer_store_dwordx4 v[72:75], v3, s[44:47], s54 offen offset:2048 nt
    v_mfma_f32_16x16x32_bf16 v[248:251], a[204:207], v[56:59], v[248:251]
    v_mfma_f32_16x16x32_bf16 v[228:231], a[200:203], v[52:55], v[228:231]
    v_cvt_pk_bf16_f32 v76, v164, v165
    v_cvt_pk_bf16_f32 v77, v166, v167
    v_mfma_f32_16x16x32_bf16 v[244:247], a[204:207], v[52:55], v[244:247]
    v_cvt_pk_bf16_f32 v78, v180, v181
    v_cvt_pk_bf16_f32 v79, v182, v183
    v_mfma_f32_16x16x32_bf16 v[224:227], a[200:203], v[48:51], v[224:227]
    buffer_store_dwordx4 v[76:79], v3, s[44:47], s54 offen offset:3072 nt
    v_mfma_f32_16x16x32_bf16 v[240:243], a[204:207], v[48:51], v[240:243]
    s_waitcnt vmcnt(32) lgkmcnt(0)
    v_mfma_f32_16x16x32_bf16 v[192:195], a[208:211], v[32:35], v[192:195]
    ds_read_b128 v[48:51], v6 offset:3072
    v_mfma_f32_16x16x32_bf16 v[208:211], a[212:215], v[32:35], v[208:211]
    v_mfma_f32_16x16x32_bf16 v[196:199], a[208:211], v[36:39], v[196:199]
    ds_read_b128 v[52:55], v6 offset:11264
    v_mfma_f32_16x16x32_bf16 v[212:215], a[212:215], v[36:39], v[212:215]
    v_mfma_f32_16x16x32_bf16 v[200:203], a[208:211], v[40:43], v[200:203]
    ds_read_b128 v[56:59], v6 offset:19456
    v_mfma_f32_16x16x32_bf16 v[216:219], a[212:215], v[40:43], v[216:219]
    v_mfma_f32_16x16x32_bf16 v[204:207], a[208:211], v[44:47], v[204:207]
    ds_read_b128 v[60:63], v6 offset:27648
    v_mfma_f32_16x16x32_bf16 v[220:223], a[212:215], v[44:47], v[220:223]
    v_mfma_f32_16x16x32_bf16 v[236:239], a[216:219], v[44:47], v[236:239]
    v_cvt_pk_bf16_f32 v80, v136, v137
    v_cvt_pk_bf16_f32 v81, v138, v139
    v_mfma_f32_16x16x32_bf16 v[252:255], a[220:223], v[44:47], v[252:255]
    v_cvt_pk_bf16_f32 v82, v152, v153
    v_cvt_pk_bf16_f32 v83, v154, v155
    v_mfma_f32_16x16x32_bf16 v[232:235], a[216:219], v[40:43], v[232:235]
    buffer_store_dwordx4 v[80:83], v3, s[44:47], s55 offen offset:0 nt
    v_mfma_f32_16x16x32_bf16 v[248:251], a[220:223], v[40:43], v[248:251]
    v_mfma_f32_16x16x32_bf16 v[228:231], a[216:219], v[36:39], v[228:231]
    v_cvt_pk_bf16_f32 v84, v168, v169
    v_cvt_pk_bf16_f32 v85, v170, v171
    v_mfma_f32_16x16x32_bf16 v[244:247], a[220:223], v[36:39], v[244:247]
    v_cvt_pk_bf16_f32 v86, v184, v185
    v_cvt_pk_bf16_f32 v87, v186, v187
    v_mfma_f32_16x16x32_bf16 v[224:227], a[216:219], v[32:35], v[224:227]
    buffer_store_dwordx4 v[84:87], v3, s[44:47], s55 offen offset:1024 nt
    v_mfma_f32_16x16x32_bf16 v[240:243], a[220:223], v[32:35], v[240:243]
    s_waitcnt vmcnt(30) lgkmcnt(0)
    v_mfma_f32_16x16x32_bf16 v[192:195], a[224:227], v[48:51], v[192:195]
    ds_read_b128 v[32:35], v6 offset:4096
    v_mfma_f32_16x16x32_bf16 v[208:211], a[228:231], v[48:51], v[208:211]
    v_mfma_f32_16x16x32_bf16 v[196:199], a[224:227], v[52:55], v[196:199]
    ds_read_b128 v[36:39], v6 offset:12288
    v_mfma_f32_16x16x32_bf16 v[212:215], a[228:231], v[52:55], v[212:215]
    v_mfma_f32_16x16x32_bf16 v[200:203], a[224:227], v[56:59], v[200:203]
    ds_read_b128 v[40:43], v6 offset:20480
    v_mfma_f32_16x16x32_bf16 v[216:219], a[228:231], v[56:59], v[216:219]
    v_mfma_f32_16x16x32_bf16 v[204:207], a[224:227], v[60:63], v[204:207]
    ds_read_b128 v[44:47], v6 offset:28672
    v_mfma_f32_16x16x32_bf16 v[220:223], a[228:231], v[60:63], v[220:223]
    v_mfma_f32_16x16x32_bf16 v[236:239], a[232:235], v[60:63], v[236:239]
    v_cvt_pk_bf16_f32 v88, v140, v141
    v_cvt_pk_bf16_f32 v89, v142, v143
    v_mfma_f32_16x16x32_bf16 v[252:255], a[236:239], v[60:63], v[252:255]
    v_cvt_pk_bf16_f32 v90, v156, v157
    v_cvt_pk_bf16_f32 v91, v158, v159
    v_mfma_f32_16x16x32_bf16 v[232:235], a[232:235], v[56:59], v[232:235]
    buffer_store_dwordx4 v[88:91], v3, s[44:47], s55 offen offset:2048 nt
    v_mfma_f32_16x16x32_bf16 v[248:251], a[236:239], v[56:59], v[248:251]
    v_mfma_f32_16x16x32_bf16 v[228:231], a[232:235], v[52:55], v[228:231]
    v_cvt_pk_bf16_f32 v92, v172, v173
    v_cvt_pk_bf16_f32 v93, v174, v175
    v_mfma_f32_16x16x32_bf16 v[244:247], a[236:239], v[52:55], v[244:247]
    v_cvt_pk_bf16_f32 v94, v188, v189
    v_cvt_pk_bf16_f32 v95, v190, v191
    v_mfma_f32_16x16x32_bf16 v[224:227], a[232:235], v[48:51], v[224:227]
    buffer_store_dwordx4 v[92:95], v3, s[44:47], s55 offen offset:3072 nt
    v_mfma_f32_16x16x32_bf16 v[240:243], a[236:239], v[48:51], v[240:243]
    s_waitcnt vmcnt(28) lgkmcnt(0)
    v_mfma_f32_16x16x32_bf16 v[192:195], a[240:243], v[32:35], v[192:195]
    ds_read_b128 v[48:51], v6 offset:5120
    v_mfma_f32_16x16x32_bf16 v[208:211], a[244:247], v[32:35], v[208:211]
    s_add_u32 s59, s51, 8192
    buffer_load_dwordx4 a[80:83], v3, s[12:15], s59 offen offset:0 sc1
    v_mfma_f32_16x16x32_bf16 v[196:199], a[240:243], v[36:39], v[196:199]
    ds_read_b128 v[52:55], v6 offset:13312
    v_mfma_f32_16x16x32_bf16 v[212:215], a[244:247], v[36:39], v[212:215]
    v_mfma_f32_16x16x32_bf16 v[200:203], a[240:243], v[40:43], v[200:203]
    ds_read_b128 v[56:59], v6 offset:21504
    v_mfma_f32_16x16x32_bf16 v[216:219], a[244:247], v[40:43], v[216:219]
    buffer_load_dwordx4 a[84:87], v3, s[12:15], s59 offen offset:1024 sc1
    v_mfma_f32_16x16x32_bf16 v[204:207], a[240:243], v[44:47], v[204:207]
    ds_read_b128 v[60:63], v6 offset:29696
    v_mfma_f32_16x16x32_bf16 v[220:223], a[244:247], v[44:47], v[220:223]
    v_mfma_f32_16x16x32_bf16 v[236:239], a[248:251], v[44:47], v[236:239]
    v_mfma_f32_16x16x32_bf16 v[252:255], a[252:255], v[44:47], v[252:255]
    buffer_load_dwordx4 a[88:91], v3, s[12:15], s59 offen offset:2048 sc1
    v_mfma_f32_16x16x32_bf16 v[232:235], a[248:251], v[40:43], v[232:235]
    v_mfma_f32_16x16x32_bf16 v[248:251], a[252:255], v[40:43], v[248:251]
    v_mfma_f32_16x16x32_bf16 v[228:231], a[248:251], v[36:39], v[228:231]
    v_mfma_f32_16x16x32_bf16 v[244:247], a[252:255], v[36:39], v[244:247]
    buffer_load_dwordx4 a[92:95], v3, s[12:15], s59 offen offset:3072 sc1
    v_mfma_f32_16x16x32_bf16 v[224:227], a[248:251], v[32:35], v[224:227]
    v_mfma_f32_16x16x32_bf16 v[240:243], a[252:255], v[32:35], v[240:243]
    s_waitcnt vmcnt(28) lgkmcnt(0)
    v_mfma_f32_16x16x32_bf16 v[192:195], a[0:3], v[48:51], v[192:195]
    ds_read_b128 v[32:35], v6 offset:6144
    v_mfma_f32_16x16x32_bf16 v[208:211], a[4:7], v[48:51], v[208:211]
    s_add_u32 s59, s51, 12288
    buffer_load_dwordx4 a[96:99], v3, s[12:15], s59 offen offset:0 sc1
    v_mfma_f32_16x16x32_bf16 v[196:199], a[0:3], v[52:55], v[196:199]
    ds_read_b128 v[36:39], v6 offset:14336
    v_mfma_f32_16x16x32_bf16 v[212:215], a[4:7], v[52:55], v[212:215]
    v_mfma_f32_16x16x32_bf16 v[200:203], a[0:3], v[56:59], v[200:203]
    ds_read_b128 v[40:43], v6 offset:22528
    v_mfma_f32_16x16x32_bf16 v[216:219], a[4:7], v[56:59], v[216:219]
    buffer_load_dwordx4 a[100:103], v3, s[12:15], s59 offen offset:1024 sc1
    v_mfma_f32_16x16x32_bf16 v[204:207], a[0:3], v[60:63], v[204:207]
    ds_read_b128 v[44:47], v6 offset:30720
    v_mfma_f32_16x16x32_bf16 v[220:223], a[4:7], v[60:63], v[220:223]
    v_mfma_f32_16x16x32_bf16 v[236:239], a[8:11], v[60:63], v[236:239]
    v_mfma_f32_16x16x32_bf16 v[252:255], a[12:15], v[60:63], v[252:255]
    buffer_load_dwordx4 a[104:107], v3, s[12:15], s59 offen offset:2048 sc1
    v_mfma_f32_16x16x32_bf16 v[232:235], a[8:11], v[56:59], v[232:235]
    v_mfma_f32_16x16x32_bf16 v[248:251], a[12:15], v[56:59], v[248:251]
    v_mfma_f32_16x16x32_bf16 v[228:231], a[8:11], v[52:55], v[228:231]
    v_mfma_f32_16x16x32_bf16 v[244:247], a[12:15], v[52:55], v[244:247]
    buffer_load_dwordx4 a[108:111], v3, s[12:15], s59 offen offset:3072 sc1
    v_mfma_f32_16x16x32_bf16 v[224:227], a[8:11], v[48:51], v[224:227]
    v_mfma_f32_16x16x32_bf16 v[240:243], a[12:15], v[48:51], v[240:243]
    s_waitcnt vmcnt(28) lgkmcnt(0)
    v_mfma_f32_16x16x32_bf16 v[192:195], a[16:19], v[32:35], v[192:195]
    ds_read_b128 v[48:51], v6 offset:7168
    v_mfma_f32_16x16x32_bf16 v[208:211], a[20:23], v[32:35], v[208:211]
    s_add_u32 s59, s51, 16384
    buffer_load_dwordx4 a[112:115], v3, s[12:15], s59 offen offset:0 sc1
    v_mfma_f32_16x16x32_bf16 v[196:199], a[16:19], v[36:39], v[196:199]
    ds_read_b128 v[52:55], v6 offset:15360
    v_mfma_f32_16x16x32_bf16 v[212:215], a[20:23], v[36:39], v[212:215]
    v_mfma_f32_16x16x32_bf16 v[200:203], a[16:19], v[40:43], v[200:203]
    ds_read_b128 v[56:59], v6 offset:23552
    v_mfma_f32_16x16x32_bf16 v[216:219], a[20:23], v[40:43], v[216:219]
    buffer_load_dwordx4 a[116:119], v3, s[12:15], s59 offen offset:1024 sc1
    v_mfma_f32_16x16x32_bf16 v[204:207], a[16:19], v[44:47], v[204:207]
    ds_read_b128 v[60:63], v6 offset:31744
    v_mfma_f32_16x16x32_bf16 v[220:223], a[20:23], v[44:47], v[220:223]
    v_mfma_f32_16x16x32_bf16 v[236:239], a[24:27], v[44:47], v[236:239]
    v_mfma_f32_16x16x32_bf16 v[252:255], a[28:31], v[44:47], v[252:255]
    buffer_load_dwordx4 a[120:123], v3, s[12:15], s59 offen offset:2048 sc1
    v_mfma_f32_16x16x32_bf16 v[232:235], a[24:27], v[40:43], v[232:235]
    v_mfma_f32_16x16x32_bf16 v[248:251], a[28:31], v[40:43], v[248:251]
    v_mfma_f32_16x16x32_bf16 v[228:231], a[24:27], v[36:39], v[228:231]
    v_mfma_f32_16x16x32_bf16 v[244:247], a[28:31], v[36:39], v[244:247]
    buffer_load_dwordx4 a[124:127], v3, s[12:15], s59 offen offset:3072 sc1
    v_mfma_f32_16x16x32_bf16 v[224:227], a[24:27], v[32:35], v[224:227]
    v_mfma_f32_16x16x32_bf16 v[240:243], a[28:31], v[32:35], v[240:243]
    s_waitcnt vmcnt(28) lgkmcnt(0)
    v_mfma_f32_16x16x32_bf16 v[192:195], a[32:35], v[48:51], v[192:195]
    ds_read_b128 v[32:35], v28 offset:0
    v_mfma_f32_16x16x32_bf16 v[208:211], a[36:39], v[48:51], v[208:211]
    s_add_u32 s59, s51, 20480
    buffer_load_dwordx4 a[128:131], v3, s[12:15], s59 offen offset:0 sc1
    v_mfma_f32_16x16x32_bf16 v[196:199], a[32:35], v[52:55], v[196:199]
    ds_read_b128 v[36:39], v28 offset:8192
    v_mfma_f32_16x16x32_bf16 v[212:215], a[36:39], v[52:55], v[212:215]
    v_mfma_f32_16x16x32_bf16 v[200:203], a[32:35], v[56:59], v[200:203]
    ds_read_b128 v[40:43], v28 offset:16384
    v_mfma_f32_16x16x32_bf16 v[216:219], a[36:39], v[56:59], v[216:219]
    buffer_load_dwordx4 a[132:135], v3, s[12:15], s59 offen offset:1024 sc1
    v_mfma_f32_16x16x32_bf16 v[204:207], a[32:35], v[60:63], v[204:207]
    ds_read_b128 v[44:47], v28 offset:24576
    v_mfma_f32_16x16x32_bf16 v[220:223], a[36:39], v[60:63], v[220:223]
    v_mfma_f32_16x16x32_bf16 v[236:239], a[40:43], v[60:63], v[236:239]
    v_mfma_f32_16x16x32_bf16 v[252:255], a[44:47], v[60:63], v[252:255]
    buffer_load_dwordx4 a[136:139], v3, s[12:15], s59 offen offset:2048 sc1
    v_mfma_f32_16x16x32_bf16 v[232:235], a[40:43], v[56:59], v[232:235]
    v_mfma_f32_16x16x32_bf16 v[248:251], a[44:47], v[56:59], v[248:251]
    v_mfma_f32_16x16x32_bf16 v[228:231], a[40:43], v[52:55], v[228:231]
    v_mfma_f32_16x16x32_bf16 v[244:247], a[44:47], v[52:55], v[244:247]
    buffer_load_dwordx4 a[140:143], v3, s[12:15], s59 offen offset:3072 sc1
    v_mfma_f32_16x16x32_bf16 v[224:227], a[40:43], v[48:51], v[224:227]
    v_mfma_f32_16x16x32_bf16 v[240:243], a[44:47], v[48:51], v[240:243]
    s_waitcnt vmcnt(28) lgkmcnt(0)
    v_mfma_f32_16x16x32_bf16 v[192:195], a[48:51], v[32:35], v[192:195]
    ds_read_b128 v[48:51], v29 offset:0
    v_mfma_f32_16x16x32_bf16 v[208:211], a[52:55], v[32:35], v[208:211]
    s_add_u32 s59, s51, 24576
    buffer_load_dwordx4 a[144:147], v3, s[12:15], s59 offen offset:0 sc1
    v_mfma_f32_16x16x32_bf16 v[196:199], a[48:51], v[36:39], v[196:199]
    ds_read_b128 v[52:55], v29 offset:8192
    v_mfma_f32_16x16x32_bf16 v[212:215], a[52:55], v[36:39], v[212:215]
    v_mfma_f32_16x16x32_bf16 v[200:203], a[48:51], v[40:43], v[200:203]
    ds_read_b128 v[56:59], v29 offset:16384
    v_mfma_f32_16x16x32_bf16 v[216:219], a[52:55], v[40:43], v[216:219]
    buffer_load_dwordx4 a[148:151], v3, s[12:15], s59 offen offset:1024 sc1
    v_mfma_f32_16x16x32_bf16 v[204:207], a[48:51], v[44:47], v[204:207]
    ds_read_b128 v[60:63], v29 offset:24576
    v_mfma_f32_16x16x32_bf16 v[220:223], a[52:55], v[44:47], v[220:223]
    v_mfma_f32_16x16x32_bf16 v[236:239], a[56:59], v[44:47], v[236:239]
    v_mfma_f32_16x16x32_bf16 v[252:255], a[60:63], v[44:47], v[252:255]
    buffer_load_dwordx4 a[152:155], v3, s[12:15], s59 offen offset:2048 sc1
    s_waitcnt vmcnt(19)
    s_cmp_lg_u32 s21, 0
    s_cbranch_scc1 L_ry_far
    buffer_store_dword v12, off, s[12:15], s56
L_ry_back:
    v_mfma_f32_16x16x32_bf16 v[232:235], a[56:59], v[40:43], v[232:235]
    v_mfma_f32_16x16x32_bf16 v[248:251], a[60:63], v[40:43], v[248:251]
    v_mfma_f32_16x16x32_bf16 v[228:231], a[56:59], v[36:39], v[228:231]
    v_mfma_f32_16x16x32_bf16 v[244:247], a[60:63], v[36:39], v[244:247]
    buffer_load_dwordx4 a[156:159], v3, s[12:15], s59 offen offset:3072 sc1
    v_mfma_f32_16x16x32_bf16 v[224:227], a[56:59], v[32:35], v[224:227]
    v_mfma_f32_16x16x32_bf16 v[240:243], a[60:63], v[32:35], v[240:243]
    s_waitcnt lgkmcnt(0)
    v_mfma_f32_16x16x32_bf16 v[192:195], a[64:67], v[48:51], v[192:195]
    ds_read_b128 v[32:35], v30 offset:0
    v_mfma_f32_16x16x32_bf16 v[208:211], a[68:71], v[48:51], v[208:211]
    s_add_u32 s59, s51, 28672
    buffer_load_dwordx4 a[160:163], v3, s[12:15], s59 offen offset:0 sc1
    v_mfma_f32_16x16x32_bf16 v[196:199], a[64:67], v[52:55], v[196:199]
    ds_read_b128 v[36:39], v30 offset:8192
    v_mfma_f32_16x16x32_bf16 v[212:215], a[68:71], v[52:55], v[212:215]
    v_mfma_f32_16x16x32_bf16 v[200:203], a[64:67], v[56:59], v[200:203]
    ds_read_b128 v[40:43], v30 offset:16384
    v_mfma_f32_16x16x32_bf16 v[216:219], a[68:71], v[56:59], v[216:219]
    buffer_load_dwordx4 a[164:167], v3, s[12:15], s59 offen offset:1024 sc1
    v_mfma_f32_16x16x32_bf16 v[204:207], a[64:67], v[60:63], v[204:207]
    ds_read_b128 v[44:47], v30 offset:24576
    v_mfma_f32_16x16x32_bf16 v[220:223], a[68:71], v[60:63], v[220:223]
    v_mfma_f32_16x16x32_bf16 v[236:239], a[72:75], v[60:63], v[236:239]
    v_mfma_f32_16x16x32_bf16 v[252:255], a[76:79], v[60:63], v[252:255]
    buffer_load_dwordx4 a[168:171], v3, s[12:15], s59 offen offset:2048 sc1
    v_mfma_f32_16x16x32_bf16 v[232:235], a[72:75], v[56:59], v[232:235]
    v_mfma_f32_16x16x32_bf16 v[248:251], a[76:79], v[56:59], v[248:251]
    v_mfma_f32_16x16x32_bf16 v[228:231], a[72:75], v[52:55], v[228:231]
    v_mfma_f32_16x16x32_bf16 v[244:247], a[76:79], v[52:55], v[244:247]
    buffer_load_dwordx4 a[172:175], v3, s[12:15], s59 offen offset:3072 sc1
    v_mfma_f32_16x16x32_bf16 v[224:227], a[72:75], v[48:51], v[224:227]
    v_mfma_f32_16x16x32_bf16 v[240:243], a[76:79], v[48:51], v[240:243]
    s_waitcnt vmcnt(21) lgkmcnt(0)
    v_mfma_f32_16x16x32_bf16 v[192:195], a[80:83], v[32:35], v[192:195]
    ds_read_b128 v[48:51], v31 offset:0
    v_mfma_f32_16x16x32_bf16 v[208:211], a[84:87], v[32:35], v[208:211]
    s_add_u32 m0, s42, 0
    s_add_u32 s26, s58, 0
    buffer_load_dwordx4 v10, s[32:35], s26 offen lds
    v_mfma_f32_16x16x32_bf16 v[196:199], a[80:83], v[36:39], v[196:199]
    ds_read_b128 v[52:55], v31 offset:8192
    v_mfma_f32_16x16x32_bf16 v[212:215], a[84:87], v[36:39], v[212:215]
    v_mfma_f32_16x16x32_bf16 v[200:203], a[80:83], v[40:43], v[200:203]
    ds_read_b128 v[56:59], v31 offset:16384
    v_mfma_f32_16x16x32_bf16 v[216:219], a[84:87], v[40:43], v[216:219]
    s_add_u32 m0, s42, 1024
    s_add_u32 s26, s58, 8192
    buffer_load_dwordx4 v11, s[32:35], s26 offen lds
    v_mfma_f32_16x16x32_bf16 v[204:207], a[80:83], v[44:47], v[204:207]
    ds_read_b128 v[60:63], v31 offset:24576
    v_mfma_f32_16x16x32_bf16 v[220:223], a[84:87], v[44:47], v[220:223]
    v_mfma_f32_16x16x32_bf16 v[236:239], a[88:91], v[44:47], v[236:239]
    v_mfma_f32_16x16x32_bf16 v[252:255], a[92:95], v[44:47], v[252:255]
    s_add_u32 m0, s42, 2048
    s_add_u32 s26, s58, 16384
    buffer_load_dwordx4 v10, s[32:35], s26 offen lds
    v_mfma_f32_16x16x32_bf16 v[232:235], a[88:91], v[40:43], v[232:235]
    v_mfma_f32_16x16x32_bf16 v[248:251], a[92:95], v[40:43], v[248:251]
    v_mfma_f32_16x16x32_bf16 v[228:231], a[88:91], v[36:39], v[228:231]
    v_mfma_f32_16x16x32_bf16 v[244:247], a[92:95], v[36:39], v[244:247]
    s_add_u32 m0, s42, 3072
    s_add_u32 s26, s58, 24576
    buffer_load_dwordx4 v11, s[32:35], s26 offen lds
    v_mfma_f32_16x16x32_bf16 v[224:227], a[88:91], v[32:35], v[224:227]
    v_mfma_f32_16x16x32_bf16 v[240:243], a[92:95], v[32:35], v[240:243]
    s_waitcnt vmcnt(21) lgkmcnt(0)
    v_mfma_f32_16x16x32_bf16 v[192:195], a[96:99], v[48:51], v[192:195]
    ds_read_b128 v[32:35], v28 offset:256
    v_mfma_f32_16x16x32_bf16 v[208:211], a[100:103], v[48:51], v[208:211]
    s_add_u32 m0, s42, 4096
    s_add_u32 s26, s58, 32768
    buffer_load_dwordx4 v10, s[32:35], s26 offen lds
    v_mfma_f32_16x16x32_bf16 v[196:199], a[96:99], v[52:55], v[196:199]
    ds_read_b128 v[36:39], v28 offset:8448
    v_mfma_f32_16x16x32_bf16 v[212:215], a[100:103], v[52:55], v[212:215]
    v_mfma_f32_16x16x32_bf16 v[200:203], a[96:99], v[56:59], v[200:203]
    ds_read_b128 v[40:43], v28 offset:16640
    v_mfma_f32_16x16x32_bf16 v[216:219], a[100:103], v[56:59], v[216:219]
    s_add_u32 m0, s42, 5120
    s_add_u32 s26, s58, 40960
    buffer_load_dwordx4 v11, s[32:35], s26 offen lds
    v_mfma_f32_16x16x32_bf16 v[204:207], a[96:99], v[60:63], v[204:207]
    ds_read_b128 v[44:47], v28 offset:24832
    v_mfma_f32_16x16x32_bf16 v[220:223], a[100:103], v[60:63], v[220:223]
    v_mfma_f32_16x16x32_bf16 v[236:239], a[104:107], v[60:63], v[236:239]
    v_mfma_f32_16x16x32_bf16 v[252:255], a[108:111], v[60:63], v[252:255]
    s_add_u32 m0, s42, 6144
    s_add_u32 s26, s58, 49152
    buffer_load_dwordx4 v10, s[32:35], s26 offen lds
    buffer_load_dword v14, off, s[12:15], s57 sc1
    v_mfma_f32_16x16x32_bf16 v[232:235], a[104:107], v[56:59], v[232:235]
    v_mfma_f32_16x16x32_bf16 v[248:251], a[108:111], v[56:59], v[248:251]
    v_mfma_f32_16x16x32_bf16 v[228:231], a[104:107], v[52:55], v[228:231]
    v_mfma_f32_16x16x32_bf16 v[244:247], a[108:111], v[52:55], v[244:247]
    s_add_u32 m0, s42, 7168
    s_add_u32 s26, s58, 57344
    buffer_load_dwordx4 v11, s[32:35], s26 offen lds
    v_mfma_f32_16x16x32_bf16 v[224:227], a[104:107], v[48:51], v[224:227]
    v_mfma_f32_16x16x32_bf16 v[240:243], a[108:111], v[48:51], v[240:243]
    s_waitcnt vmcnt(22) lgkmcnt(0)
    v_mfma_f32_16x16x32_bf16 v[192:195], a[112:115], v[32:35], v[192:195]
    ds_read_b128 v[48:51], v29 offset:256
    v_mfma_f32_16x16x32_bf16 v[208:211], a[116:119], v[32:35], v[208:211]
    v_mfma_f32_16x16x32_bf16 v[196:199], a[112:115], v[36:39], v[196:199]
    ds_read_b128 v[52:55], v29 offset:8448
    v_mfma_f32_16x16x32_bf16 v[212:215], a[116:119], v[36:39], v[212:215]
    v_mfma_f32_16x16x32_bf16 v[200:203], a[112:115], v[40:43], v[200:203]
    ds_read_b128 v[56:59], v29 offset:16640
    v_mfma_f32_16x16x32_bf16 v[216:219], a[116:119], v[40:43], v[216:219]
    v_mfma_f32_16x16x32_bf16 v[204:207], a[112:115], v[44:47], v[204:207]
    ds_read_b128 v[60:63], v29 offset:24832
    v_mfma_f32_16x16x32_bf16 v[220:223], a[116:119], v[44:47], v[220:223]
    v_mfma_f32_16x16x32_bf16 v[236:239], a[120:123], v[44:47], v[236:239]
    v_mfma_f32_16x16x32_bf16 v[252:255], a[124:127], v[44:47], v[252:255]
    v_mfma_f32_16x16x32_bf16 v[232:235], a[120:123], v[40:43], v[232:235]
    v_mfma_f32_16x16x32_bf16 v[248:251], a[124:127], v[40:43], v[248:251]
    v_mfma_f32_16x16x32_bf16 v[228:231], a[120:123], v[36:39], v[228:231]
    v_mfma_f32_16x16x32_bf16 v[244:247], a[124:127], v[36:39], v[244:247]
    v_mfma_f32_16x16x32_bf16 v[224:227], a[120:123], v[32:35], v[224:227]
    v_mfma_f32_16x16x32_bf16 v[240:243], a[124:127], v[32:35], v[240:243]
    s_waitcnt vmcnt(18) lgkmcnt(0)
    v_mfma_f32_16x16x32_bf16 v[192:195], a[128:131], v[48:51], v[192:195]
    ds_read_b128 v[32:35], v30 offset:256
    v_mfma_f32_16x16x32_bf16 v[208:211], a[132:135], v[48:51], v[208:211]
    v_mfma_f32_16x16x32_bf16 v[196:199], a[128:131], v[52:55], v[196:199]
    ds_read_b128 v[36:39], v30 offset:8448
    v_mfma_f32_16x16x32_bf16 v[212:215], a[132:135], v[52:55], v[212:215]
    v_mfma_f32_16x16x32_bf16 v[200:203], a[128:131], v[56:59], v[200:203]
    ds_read_b128 v[40:43], v30 offset:16640
    v_mfma_f32_16x16x32_bf16 v[216:219], a[132:135], v[56:59], v[216:219]
    v_mfma_f32_16x16x32_bf16 v[204:207], a[128:131], v[60:63], v[204:207]
    ds_read_b128 v[44:47], v30 offset:24832
    v_mfma_f32_16x16x32_bf16 v[220:223], a[132:135], v[60:63], v[220:223]
    s_waitcnt vmcnt(1)
    v_readfirstlane_b32 s26, v14
    s_cmp_eq_u32 s26, 1
    s_cbranch_scc0 L_y_retry
L_y_ok:
    s_xor_b32 s54, s54, 0x10000
    s_xor_b32 s55, s55, 0x10000
    v_mfma_f32_16x16x32_bf16 v[236:239], a[136:139], v[60:63], v[236:239]
    buffer_load_dwordx4 v[64:67], v3, s[12:15], s54 offen offset:0 sc1
    v_mfma_f32_16x16x32_bf16 v[252:255], a[140:143], v[60:63], v[252:255]
    buffer_load_dwordx4 v[68:71], v3, s[12:15], s54 offen offset:1024 sc1
    v_mfma_f32_16x16x32_bf16 v[232:235], a[136:139], v[56:59], v[232:235]
    buffer_load_dwordx4 v[72:75], v3, s[12:15], s54 offen offset:2048 sc1
    v_mfma_f32_16x16x32_bf16 v[248:251], a[140:143], v[56:59], v[248:251]
    buffer_load_dwordx4 v[76:79], v3, s[12:15], s54 offen offset:3072 sc1
    v_mfma_f32_16x16x32_bf16 v[228:231], a[136:139], v[52:55], v[228:231]
    buffer_load_dwordx4 v[80:83], v3, s[12:15], s55 offen offset:0 sc1
    v_mfma_f32_16x16x32_bf16 v[244:247], a[140:143], v[52:55], v[244:247]
    buffer_load_dwordx4 v[84:87], v3, s[12:15], s55 offen offset:1024 sc1
    v_mfma_f32_16x16x32_bf16 v[224:227], a[136:139], v[48:51], v[224:227]
    buffer_load_dwordx4 v[88:91], v3, s[12:15], s55 offen offset:2048 sc1
    v_mfma_f32_16x16x32_bf16 v[240:243], a[140:143], v[48:51], v[240:243]
    buffer_load_dwordx4 v[92:95], v3, s[12:15], s55 offen offset:3072 sc1
    s_waitcnt lgkmcnt(0)
    v_mfma_f32_16x16x32_bf16 v[192:195], a[144:147], v[32:35], v[192:195]
    ds_read_b128 v[48:51], v31 offset:256
    v_mfma_f32_16x16x32_bf16 v[208:211], a[148:151], v[32:35], v[208:211]
    v_mfma_f32_16x16x32_bf16 v[196:199], a[144:147], v[36:39], v[196:199]
    ds_read_b128 v[52:55], v31 offset:8448
    v_mfma_f32_16x16x32_bf16 v[212:215], a[148:151], v[36:39], v[212:215]
    v_mfma_f32_16x16x32_bf16 v[200:203], a[144:147], v[40:43], v[200:203]
    ds_read_b128 v[56:59], v31 offset:16640
    v_mfma_f32_16x16x32_bf16 v[216:219], a[148:151], v[40:43], v[216:219]
    v_mfma_f32_16x16x32_bf16 v[204:207], a[144:147], v[44:47], v[204:207]
    ds_read_b128 v[60:63], v31 offset:24832
    v_mfma_f32_16x16x32_bf16 v[220:223], a[148:151], v[44:47], v[220:223]
    v_mfma_f32_16x16x32_bf16 v[236:239], a[152:155], v[44:47], v[236:239]
    s_waitcnt vmcnt(8)
    ds_read_b128 v[96:99], v8 offset:0
    v_mfma_f32_16x16x32_bf16 v[252:255], a[156:159], v[44:47], v[252:255]
    ds_read_b128 v[100:103], v9 offset:0
    v_mfma_f32_16x16x32_bf16 v[232:235], a[152:155], v[40:43], v[232:235]
    ds_read_b128 v[104:107], v8 offset:2048
    v_mfma_f32_16x16x32_bf16 v[248:251], a[156:159], v[40:43], v[248:251]
    ds_read_b128 v[108:111], v9 offset:2048
    v_mfma_f32_16x16x32_bf16 v[228:231], a[152:155], v[36:39], v[228:231]
    ds_read_b128 v[112:115], v8 offset:4096
    v_mfma_f32_16x16x32_bf16 v[244:247], a[156:159], v[36:39], v[244:247]
    ds_read_b128 v[116:119], v9 offset:4096
    v_mfma_f32_16x16x32_bf16 v[224:227], a[152:155], v[32:35], v[224:227]
    ds_read_b128 v[120:123], v8 offset:6144
    v_mfma_f32_16x16x32_bf16 v[240:243], a[156:159], v[32:35], v[240:243]
    ds_read_b128 v[124:127], v9 offset:6144
    s_waitcnt lgkmcnt(8)
    v_mfma_f32_16x16x32_bf16 v[192:195], a[160:163], v[48:51], v[192:195]
    v_mfma_f32_16x16x32_bf16 v[208:211], a[164:167], v[48:51], v[208:211]
    v_mfma_f32_16x16x32_bf16 v[196:199], a[160:163], v[52:55], v[196:199]
    v_mfma_f32_16x16x32_bf16 v[212:215], a[164:167], v[52:55], v[212:215]
    v_mfma_f32_16x16x32_bf16 v[200:203], a[160:163], v[56:59], v[200:203]
    v_mfma_f32_16x16x32_bf16 v[216:219], a[164:167], v[56:59], v[216:219]
    v_mfma_f32_16x16x32_bf16 v[204:207], a[160:163], v[60:63], v[204:207]
    v_mfma_f32_16x16x32_bf16 v[220:223], a[164:167], v[60:63], v[220:223]
    v_mfma_f32_16x16x32_bf16 v[236:239], a[168:171], v[60:63], v[236:239]
    v_mfma_f32_16x16x32_bf16 v[252:255], a[172:175], v[60:63], v[252:255]
    v_mfma_f32_16x16x32_bf16 v[232:235], a[168:171], v[56:59], v[232:235]
    v_mfma_f32_16x16x32_bf16 v[248:251], a[172:175], v[56:59], v[248:251]
    v_mfma_f32_16x16x32_bf16 v[228:231], a[168:171], v[52:55], v[228:231]
    v_mfma_f32_16x16x32_bf16 v[244:247], a[172:175], v[52:55], v[244:247]
    v_mfma_f32_16x16x32_bf16 v[224:227], a[168:171], v[48:51], v[224:227]
    v_mfma_f32_16x16x32_bf16 v[240:243], a[172:175], v[48:51], v[240:243]
    s_waitcnt lgkmcnt(0)
    v_mfma_f32_16x16x32_bf16 v[192:195], v[16:19], v[96:99], v[192:195]
    v_mfma_f32_16x16x32_bf16 v[208:211], v[18:21], v[96:99], v[208:211]
    v_mfma_f32_16x16x32_bf16 v[224:227], v[16:19], v[100:103], v[224:227]
    v_mfma_f32_16x16x32_bf16 v[240:243], v[18:21], v[100:103], v[240:243]
    v_mfma_f32_16x16x32_bf16 v[196:199], v[16:19], v[104:107], v[196:199]
    v_mfma_f32_16x16x32_bf16 v[212:215], v[18:21], v[104:107], v[212:215]
    v_mfma_f32_16x16x32_bf16 v[228:231], v[16:19], v[108:111], v[228:231]
    v_mfma_f32_16x16x32_bf16 v[244:247], v[18:21], v[108:111], v[244:247]
    v_mfma_f32_16x16x32_bf16 v[200:203], v[16:19], v[112:115], v[200:203]
    v_mfma_f32_16x16x32_bf16 v[216:219], v[18:21], v[112:115], v[216:219]
    v_mfma_f32_16x16x32_bf16 v[232:235], v[16:19], v[116:119], v[232:235]
    v_mfma_f32_16x16x32_bf16 v[248:251], v[18:21], v[116:119], v[248:251]
    v_mfma_f32_16x16x32_bf16 v[204:207], v[16:19], v[120:123], v[204:207]
    v_mfma_f32_16x16x32_bf16 v[220:223], v[18:21], v[120:123], v[220:223]
    v_mfma_f32_16x16x32_bf16 v[236:239], v[16:19], v[124:127], v[236:239]
    v_mfma_f32_16x16x32_bf16 v[252:255], v[18:21], v[124:127], v[252:255]
    s_waitcnt vmcnt(7)
    v_mfma_f32_16x16x32_bf16 v[192:195], v[16:19], v[64:67], v[192:195]
    v_mfma_f32_16x16x32_bf16 v[208:211], v[18:21], v[64:67], v[208:211]
    s_waitcnt vmcnt(6)
    v_mfma_f32_16x16x32_bf16 v[224:227], v[16:19], v[68:71], v[224:227]
    v_mfma_f32_16x16x32_bf16 v[240:243], v[18:21], v[68:71], v[240:243]
    s_waitcnt vmcnt(5)
    v_mfma_f32_16x16x32_bf16 v[196:199], v[16:19], v[72:75], v[196:199]
    v_mfma_f32_16x16x32_bf16 v[212:215], v[18:21], v[72:75], v[212:215]
    s_waitcnt vmcnt(4)
    v_mfma_f32_16x16x32_bf16 v[228:231], v[16:19], v[76:79], v[228:231]
    v_mfma_f32_16x16x32_bf16 v[244:247], v[18:21], v[76:79], v[244:247]
    s_waitcnt vmcnt(3)
    v_mfma_f32_16x16x32_bf16 v[200:203], v[16:19], v[80:83], v[200:203]
    v_cvt_pk_bf16_f32 v128, v192, v193
    v_cvt_pk_bf16_f32 v129, v194, v195
    v_mfma_f32_16x16x32_bf16 v[216:219], v[18:21], v[80:83], v[216:219]
    v_cvt_pk_bf16_f32 v130, v208, v209
    v_cvt_pk_bf16_f32 v131, v210, v211
    ds_write_b128 v8, v[128:131] offset:8192
    s_waitcnt vmcnt(2)
    v_mfma_f32_16x16x32_bf16 v[232:235], v[16:19], v[84:87], v[232:235]
    v_cvt_pk_bf16_f32 v132, v224, v225
    v_cvt_pk_bf16_f32 v133, v226, v227
    v_mfma_f32_16x16x32_bf16 v[248:251], v[18:21], v[84:87], v[248:251]
    v_cvt_pk_bf16_f32 v134, v240, v241
    v_cvt_pk_bf16_f32 v135, v242, v243
    ds_write_b128 v9, v[132:135] offset:8192
    ds_read_b128 v[160:163], v7 offset:8192
    ds_read_b128 v[164:167], v7 offset:9216
    s_waitcnt vmcnt(1)
    v_mfma_f32_16x16x32_bf16 v[204:207], v[16:19], v[88:91], v[204:207]
    v_cvt_pk_bf16_f32 v136, v196, v197
    v_cvt_pk_bf16_f32 v137, v198, v199
    v_mfma_f32_16x16x32_bf16 v[220:223], v[18:21], v[88:91], v[220:223]
    v_cvt_pk_bf16_f32 v138, v212, v213
    v_cvt_pk_bf16_f32 v139, v214, v215
    ds_write_b128 v8, v[136:139] offset:10240
    s_waitcnt vmcnt(0)
    v_mfma_f32_16x16x32_bf16 v[236:239], v[16:19], v[92:95], v[236:239]
    v_cvt_pk_bf16_f32 v140, v228, v229
    v_cvt_pk_bf16_f32 v141, v230, v231
    v_mfma_f32_16x16x32_bf16 v[252:255], v[18:21], v[92:95], v[252:255]
    v_cvt_pk_bf16_f32 v142, v244, v245
    v_cvt_pk_bf16_f32 v143, v246, v247
    ds_write_b128 v9, v[140:143] offset:10240
    ds_read_b128 v[168:171], v7 offset:10240
    ds_read_b128 v[172:175], v7 offset:11264
    v_cvt_pk_bf16_f32 v144, v200, v201
    v_cvt_pk_bf16_f32 v145, v202, v203
    v_cvt_pk_bf16_f32 v146, v216, v217
    v_cvt_pk_bf16_f32 v147, v218, v219
    ds_write_b128 v8, v[144:147] offset:12288
    s_add_u32 s26, s58, 0
    s_waitcnt lgkmcnt(6)
    buffer_store_dwordx4 v[160:163], v10, s[36:39], s26 offen nt
    v_cvt_pk_bf16_f32 v148, v232, v233
    v_cvt_pk_bf16_f32 v149, v234, v235
    v_cvt_pk_bf16_f32 v150, v248, v249
    v_cvt_pk_bf16_f32 v151, v250, v251
    ds_write_b128 v9, v[148:151] offset:12288
    ds_read_b128 v[176:179], v7 offset:12288
    ds_read_b128 v[180:183], v7 offset:13312
    s_add_u32 s26, s58, 8192
    s_waitcnt lgkmcnt(8)
    buffer_store_dwordx4 v[164:167], v11, s[36:39], s26 offen nt
    v_cvt_pk_bf16_f32 v152, v204, v205
    v_cvt_pk_bf16_f32 v153, v206, v207
    v_cvt_pk_bf16_f32 v154, v220, v221
    v_cvt_pk_bf16_f32 v155, v222, v223
    ds_write_b128 v8, v[152:155] offset:14336
    s_add_u32 s26, s58, 16384
    s_waitcnt lgkmcnt(6)
    buffer_store_dwordx4 v[168:171], v10, s[36:39], s26 offen nt
    v_cvt_pk_bf16_f32 v156, v236, v237
    v_cvt_pk_bf16_f32 v157, v238, v239
    v_cvt_pk_bf16_f32 v158, v252, v253
    v_cvt_pk_bf16_f32 v159, v254, v255
    ds_write_b128 v9, v[156:159] offset:14336
    ds_read_b128 v[184:187], v7 offset:14336
    ds_read_b128 v[188:191], v7 offset:15360
    s_add_u32 s26, s58, 24576
    s_waitcnt lgkmcnt(8)
    buffer_store_dwordx4 v[172:175], v11, s[36:39], s26 offen nt
    s_add_u32 s26, s58, 32768
    s_waitcnt lgkmcnt(5)
    buffer_store_dwordx4 v[176:179], v10, s[36:39], s26 offen nt
    s_add_u32 s26, s58, 40960
    s_waitcnt lgkmcnt(4)
    buffer_store_dwordx4 v[180:183], v11, s[36:39], s26 offen nt
    s_add_u32 s26, s58, 49152
    s_waitcnt lgkmcnt(1)
    buffer_store_dwordx4 v[184:187], v10, s[36:39], s26 offen nt
    s_add_u32 s26, s58, 57344
    s_waitcnt lgkmcnt(0)
    buffer_store_dwordx4 v[188:191], v11, s[36:39], s26 offen nt
L_fin:
L_end:
    s_endpgm
L_redo:
    s_waitcnt vmcnt(0) lgkmcnt(0)
    s_mov_b32 s101, 0
    s_mul_i32 s28, s22, 2031616
    s_add_u32 s28, s28, s24
    s_lshl_b32 s26, s25, 15
    s_add_u32 s8, s4, s28
    s_addc_u32 s9, s5, 0
    s_and_b32 s9, s9, 0xffff
    s_mov_b32 s10, s26
    s_mov_b32 s11, 0x00020000
    s_lshl_b32 s19, s16, 13
    v_and_b32 v4, 15, v2
    v_lshrrev_b32 v5, 4, v2
    v_and_b32 v6, 0x27, v2
    v_and_b32 v7, 8, v2
    v_lshl_add_u32 v6, v7, 1, v6
    v_and_b32 v7, 16, v2
    v_lshrrev_b32 v7, 1, v7
    v_add_lshl_u32 v6, v6, v7, 4
    s_lshl_b32 s29, s16, 14
    v_add_u32 v8, s29, v6
    s_lshl_b32 s29, s16, 11
    s_add_u32 s29, s29, 131072
    v_lshl_add_u32 v9, v2, 3, s29
    v_mov_b32 v204, 0
    v_mov_b32 v205, 0
    v_mov_b32 v206, 0
    v_mov_b32 v207, 0
    v_mov_b32 v208, 0xff800000
    v_mov_b32 v209, 0xff800000
    v_mov_b32 v210, 0xff800000
    v_mov_b32 v211, 0xff800000
    s_mov_b32 s17, s25
L_redo_loop:
    s_sub_u32 s17, s17, 1
    s_lshl_b32 s18, s17, 15
    s_add_u32 s18, s18, s19
    s_barrier
    s_add_u32 m0, s19, 0
    s_add_u32 s29, s18, 0
    buffer_load_dwordx4 v3, s[8:11], s29 offen offset:0 sc1 lds
    buffer_load_dwordx4 v3, s[8:11], s29 offen offset:1024 sc1 lds
    buffer_load_dwordx4 v3, s[8:11], s29 offen offset:2048 sc1 lds
    buffer_load_dwordx4 v3, s[8:11], s29 offen offset:3072 sc1 lds
    s_add_u32 m0, s19, 4096
    s_add_u32 s29, s18, 4096
    buffer_load_dwordx4 v3, s[8:11], s29 offen offset:0 sc1 lds
    buffer_load_dwordx4 v3, s[8:11], s29 offen offset:1024 sc1 lds
    buffer_load_dwordx4 v3, s[8:11], s29 offen offset:2048 sc1 lds
    buffer_load_dwordx4 v3, s[8:11], s29 offen offset:3072 sc1 lds
    s_waitcnt vmcnt(0)
    s_barrier
    s_cmp_ge_u32 s16, 2
    s_cbranch_scc1 L_redo_next
    ds_read_b128 v[32:35], v8 offset:0
    ds_read_b128 v[36:39], v8 offset:1024
    ds_read_b128 v[40:43], v8 offset:2048
    ds_read_b128 v[44:47], v8 offset:3072
    ds_read_b128 v[48:51], v8 offset:4096
    ds_read_b128 v[52:55], v8 offset:5120
    ds_read_b128 v[56:59], v8 offset:6144
    ds_read_b128 v[60:63], v8 offset:7168
    ds_read_b128 v[64:67], v8 offset:8192
    ds_read_b128 v[68:71], v8 offset:9216
    ds_read_b128 v[72:75], v8 offset:10240
    ds_read_b128 v[76:79], v8 offset:11264
    s_waitcnt lgkmcnt(4)
    ds_read_b128 v[80:83], v8 offset:12288
    ds_read_b128 v[84:87], v8 offset:13312
    ds_read_b128 v[88:91], v8 offset:14336
    ds_read_b128 v[92:95], v8 offset:15360
    s_waitcnt lgkmcnt(0)
    v_mfma_f32_16x16x32_bf16 v[160:163], v[32:35], a[0:3], 0
    v_mfma_f32_16x16x32_bf16 v[160:163], v[36:39], a[4:7], v[160:163]
    v_mfma_f32_16x16x32_bf16 v[160:163], v[40:43], a[8:11], v[160:163]
    v_mfma_f32_16x16x32_bf16 v[160:163], v[44:47], a[12:15], v[160:163]
    v_mfma_f32_16x16x32_bf16 v[160:163], v[48:51], a[16:19], v[160:163]
    v_mfma_f32_16x16x32_bf16 v[160:163], v[52:55], a[20:23], v[160:163]
    v_mfma_f32_16x16x32_bf16 v[160:163], v[56:59], a[24:27], v[160:163]
    v_mfma_f32_16x16x32_bf16 v[160:163], v[60:63], a[28:31], v[160:163]
    v_mfma_f32_16x16x32_bf16 v[160:163], v[64:67], a[32:35], v[160:163]
    v_mfma_f32_16x16x32_bf16 v[160:163], v[68:71], a[36:39], v[160:163]
    v_mfma_f32_16x16x32_bf16 v[160:163], v[72:75], a[40:43], v[160:163]
    v_mfma_f32_16x16x32_bf16 v[160:163], v[76:79], a[44:47], v[160:163]
    v_mfma_f32_16x16x32_bf16 v[160:163], v[80:83], a[48:51], v[160:163]
    v_mfma_f32_16x16x32_bf16 v[160:163], v[84:87], a[52:55], v[160:163]
    v_mfma_f32_16x16x32_bf16 v[160:163], v[88:91], a[56:59], v[160:163]
    v_mfma_f32_16x16x32_bf16 v[160:163], v[92:95], a[60:63], v[160:163]
    v_mfma_f32_16x16x32_bf16 v[164:167], v[32:35], a[64:67], 0
    v_mfma_f32_16x16x32_bf16 v[164:167], v[36:39], a[68:71], v[164:167]
    v_mfma_f32_16x16x32_bf16 v[164:167], v[40:43], a[72:75], v[164:167]
    v_mfma_f32_16x16x32_bf16 v[164:167], v[44:47], a[76:79], v[164:167]
    v_mfma_f32_16x16x32_bf16 v[164:167], v[48:51], a[80:83], v[164:167]
    v_mfma_f32_16x16x32_bf16 v[164:167], v[52:55], a[84:87], v[164:167]
    v_mfma_f32_16x16x32_bf16 v[164:167], v[56:59], a[88:91], v[164:167]
    v_mfma_f32_16x16x32_bf16 v[164:167], v[60:63], a[92:95], v[164:167]
    v_mfma_f32_16x16x32_bf16 v[164:167], v[64:67], a[96:99], v[164:167]
    v_mfma_f32_16x16x32_bf16 v[164:167], v[68:71], a[100:103], v[164:167]
    v_mfma_f32_16x16x32_bf16 v[164:167], v[72:75], a[104:107], v[164:167]
    v_mfma_f32_16x16x32_bf16 v[164:167], v[76:79], a[108:111], v[164:167]
    v_mfma_f32_16x16x32_bf16 v[164:167], v[80:83], a[112:115], v[164:167]
    v_mfma_f32_16x16x32_bf16 v[164:167], v[84:87], a[116:119], v[164:167]
    v_mfma_f32_16x16x32_bf16 v[164:167], v[88:91], a[120:123], v[164:167]
    v_mfma_f32_16x16x32_bf16 v[164:167], v[92:95], a[124:127], v[164:167]
    v_mfma_f32_16x16x32_bf16 v[168:171], v[32:35], a[128:131], 0
    v_mfma_f32_16x16x32_bf16 v[168:171], v[36:39], a[132:135], v[168:171]
    v_mfma_f32_16x16x32_bf16 v[168:171], v[40:43], a[136:139], v[168:171]
    v_mfma_f32_16x16x32_bf16 v[168:171], v[44:47], a[140:143], v[168:171]
    v_mfma_f32_16x16x32_bf16 v[168:171], v[48:51], a[144:147], v[168:171]
    v_mfma_f32_16x16x32_bf16 v[168:171], v[52:55], a[148:151], v[168:171]
    v_mfma_f32_16x16x32_bf16 v[168:171], v[56:59], a[152:155], v[168:171]
    v_mfma_f32_16x16x32_bf16 v[168:171], v[60:63], a[156:159], v[168:171]
    v_mfma_f32_16x16x32_bf16 v[168:171], v[64:67], a[160:163], v[168:171]
    v_mfma_f32_16x16x32_bf16 v[168:171], v[68:71], a[164:167], v[168:171]
    v_mfma_f32_16x16x32_bf16 v[168:171], v[72:75], a[168:171], v[168:171]
    v_mfma_f32_16x16x32_bf16 v[168:171], v[76:79], a[172:175], v[168:171]
    v_mfma_f32_16x16x32_bf16 v[168:171], v[80:83], a[176:179], v[168:171]
    v_mfma_f32_16x16x32_bf16 v[168:171], v[84:87], a[180:183], v[168:171]
    v_mfma_f32_16x16x32_bf16 v[168:171], v[88:91], a[184:187], v[168:171]
    v_mfma_f32_16x16x32_bf16 v[168:171], v[92:95], a[188:191], v[168:171]
    v_mfma_f32_16x16x32_bf16 v[172:175], v[32:35], a[192:195], 0
    v_mfma_f32_16x16x32_bf16 v[172:175], v[36:39], a[196:199], v[172:175]
    v_mfma_f32_16x16x32_bf16 v[172:175], v[40:43], a[200:203], v[172:175]
    v_mfma_f32_16x16x32_bf16 v[172:175], v[44:47], a[204:207], v[172:175]
    v_mfma_f32_16x16x32_bf16 v[172:175], v[48:51], a[208:211], v[172:175]
    v_mfma_f32_16x16x32_bf16 v[172:175], v[52:55], a[212:215], v[172:175]
    v_mfma_f32_16x16x32_bf16 v[172:175], v[56:59], a[216:219], v[172:175]
    v_mfma_f32_16x16x32_bf16 v[172:175], v[60:63], a[220:223], v[172:175]
    v_mfma_f32_16x16x32_bf16 v[172:175], v[64:67], a[224:227], v[172:175]
    v_mfma_f32_16x16x32_bf16 v[172:175], v[68:71], a[228:231], v[172:175]
    v_mfma_f32_16x16x32_bf16 v[172:175], v[72:75], a[232:235], v[172:175]
    v_mfma_f32_16x16x32_bf16 v[172:175], v[76:79], a[236:239], v[172:175]
    v_mfma_f32_16x16x32_bf16 v[172:175], v[80:83], a[240:243], v[172:175]
    v_mfma_f32_16x16x32_bf16 v[172:175], v[84:87], a[244:247], v[172:175]
    v_mfma_f32_16x16x32_bf16 v[172:175], v[88:91], a[248:251], v[172:175]
    v_mfma_f32_16x16x32_bf16 v[172:175], v[92:95], a[252:255], v[172:175]
    s_nop 7
    v_max3_f32 v208, v208, v160, v161
    v_max3_f32 v208, v208, v162, v163
    v_max3_f32 v209, v209, v164, v165
    v_max3_f32 v209, v209, v166, v167
    v_max3_f32 v210, v210, v168, v169
    v_max3_f32 v210, v210, v170, v171
    v_max3_f32 v211, v211, v172, v173
    v_max3_f32 v211, v211, v174, v175
L_redo_next:
    s_cmp_lg_u32 s17, 0
    s_cbranch_scc1 L_redo_loop
    s_add_u32 s18, s19, 32768
    s_add_u32 m0, s19, 32768
    s_add_u32 s29, s18, 0
    buffer_load_dwordx4 v3, s[8:11], s29 offen offset:0 sc1 lds
    buffer_load_dwordx4 v3, s[8:11], s29 offen offset:1024 sc1 lds
    buffer_load_dwordx4 v3, s[8:11], s29 offen offset:2048 sc1 lds
    buffer_load_dwordx4 v3, s[8:11], s29 offen offset:3072 sc1 lds
    s_add_u32 m0, s19, 36864
    s_add_u32 s29, s18, 4096
    buffer_load_dwordx4 v3, s[8:11], s29 offen offset:0 sc1 lds
    buffer_load_dwordx4 v3, s[8:11], s29 offen offset:1024 sc1 lds
    buffer_load_dwordx4 v3, s[8:11], s29 offen offset:2048 sc1 lds
    buffer_load_dwordx4 v3, s[8:11], s29 offen offset:3072 sc1 lds
    s_mov_b32 s17, s25
    s_cmp_ge_u32 s16, 2
    s_cbranch_scc1 L_pv
    s_branch L_qk_again
L_pv:
    s_sub_u32 s19, s16, 2
    s_lshl_b32 s26, s22, 2
    s_add_u32 s26, s26, s16
    s_lshl_b32 s53, s26, 16
    s_add_u32 s53, s53, 63963136
    s_xor_b32 s52, s53, 0x40000
    s_lshl_b32 s58, s26, 7
    s_add_u32 s58, s58, s27
    s_xor_b32 s54, s31, 1
    s_lshl_b32 s54, s54, 3
    s_add_u32 s54, s54, s16
    s_lshl_b32 s54, s54, 13
    s_add_u32 s54, s54, 33587200
    s_add_u32 s55, s54, 4096
    s_lshl_b32 s26, s22, 15
    s_add_u32 s50, s52, s26
    s_add_u32 s51, s53, s26
    s_lshl_b32 s26, s22, 14
    s_add_u32 s52, s52, s26
    s_add_u32 s53, s53, s26
    s_add_u32 s26, s25, 3
    s_and_b32 s26, s26, 3
    s_lshl_b32 s48, s26, 15
    s_add_u32 s26, s25, 1
    s_and_b32 s26, s26, 3
    s_lshl_b32 s49, s26, 15
    s_lshl_b32 s56, s31, 5
    s_add_u32 s56, s56, s16
    s_lshl_b32 s56, s56, 2
    s_add_u32 s56, s56, 58982400
    s_xor_b32 s57, s56, 128
    v_lshrrev_b32 v4, 5, v2
    v_lshlrev_b32 v4, 8, v4
    v_and_b32 v5, 2, v2
    v_lshl_add_u32 v4, v5, 6, v4
    v_and_b32 v5, 28, v2
    v_lshl_add_u32 v4, v5, 2, v4
    v_and_b32 v5, 1, v2
    v_lshl_add_u32 v4, v5, 3, v4
    s_lshl_b32 s29, s19, 13
    s_lshl_b32 s28, s22, 12
    s_add_u32 s28, s28, s29
    v_add_u32 v11, s28, v4
    v_xor_b32 v8, 0x1000, v11
    s_lshl_b32 s29, s19, 12
    s_add_u32 s29, s29, s48
    v_add_u32 v10, s29, v3
    s_lshl_b32 s40, s31, 2
    s_add_u32 s40, s40, s19
    s_lshl_b32 s40, s40, 14
    s_add_u32 s40, s40, 33587200
    s_lshl_b32 s28, s31, 16
    s_add_u32 s28, s28, 33554432
    s_sub_u32 s28, s28, s10
    s_add_u32 s98, s4, s28
    s_addc_u32 s99, s5, 0
    s_and_b32 s99, s99, 0xffff
    s_add_u32 s100, s10, 65536
    s_lshl_b32 s28, s22, 15
    s_add_u32 s28, s28, s27
    s_sub_u32 s3, 4096000, s28
    s_add_u32 s3, s3, s100
    s_add_u32 s96, s32, s28
    s_addc_u32 s97, s33, 0
    s_sub_u32 s96, s96, s100
    s_subb_u32 s97, s97, 0
    s_mov_b32 s29, 131072
    v_lshl_add_u32 v9, v2, 3, s29
    v_add_u32 v1, 9220, v9
    v_add_u32 v5, 4096, v3
    v_add_u32 v6, 8192, v3
    v_add_u32 v7, 12288, v3
    s_lshl_b32 s18, s19, 14
    s_add_u32 s18, s18, 65536
    s_and_b32 m0, s18, 0x1ffff
    s_nop 0
    buffer_load_dwordx4 v3, s[8:11], s18 offen offset:0 sc1 lds
    buffer_load_dwordx4 v3, s[8:11], s18 offen offset:1024 sc1 lds
    buffer_load_dwordx4 v3, s[8:11], s18 offen offset:2048 sc1 lds
    buffer_load_dwordx4 v3, s[8:11], s18 offen offset:3072 sc1 lds
    s_add_u32 s18, s18, 4096
    s_and_b32 m0, s18, 0x1ffff
    s_nop 0
    buffer_load_dwordx4 v3, s[8:11], s18 offen offset:0 sc1 lds
    buffer_load_dwordx4 v3, s[8:11], s18 offen offset:1024 sc1 lds
    buffer_load_dwordx4 v3, s[8:11], s18 offen offset:2048 sc1 lds
    buffer_load_dwordx4 v3, s[8:11], s18 offen offset:3072 sc1 lds
    s_add_u32 s18, s18, 4096
    s_and_b32 m0, s18, 0x1ffff
    s_nop 0
    buffer_load_dwordx4 v3, s[8:11], s18 offen offset:0 sc1 lds
    buffer_load_dwordx4 v3, s[8:11], s18 offen offset:1024 sc1 lds
    buffer_load_dwordx4 v3, s[8:11], s18 offen offset:2048 sc1 lds
    buffer_load_dwordx4 v3, s[8:11], s18 offen offset:3072 sc1 lds
    s_add_u32 s18, s18, 4096
    s_and_b32 m0, s18, 0x1ffff
    s_nop 0
    buffer_load_dwordx4 v3, s[8:11], s18 offen offset:0 sc1 lds
    buffer_load_dwordx4 v3, s[8:11], s18 offen offset:1024 sc1 lds
    buffer_load_dwordx4 v3, s[8:11], s18 offen offset:2048 sc1 lds
    buffer_load_dwordx4 v3, s[8:11], s18 offen offset:3072 sc1 lds
    s_add_u32 s18, s18, 20480
    s_barrier
    s_waitcnt vmcnt(16)
    s_barrier
    s_and_b32 m0, s18, 0x1ffff
    s_nop 0
    buffer_load_dwordx4 v3, s[8:11], s18 offen offset:0 sc1 lds
    buffer_load_dwordx4 v3, s[8:11], s18 offen offset:1024 sc1 lds
    buffer_load_dwordx4 v3, s[8:11], s18 offen offset:2048 sc1 lds
    buffer_load_dwordx4 v3, s[8:11], s18 offen offset:3072 sc1 lds
    s_add_u32 s18, s18, 4096
    s_and_b32 m0, s18, 0x1ffff
    s_nop 0
    buffer_load_dwordx4 v3, s[8:11], s18 offen offset:0 sc1 lds
    buffer_load_dwordx4 v3, s[8:11], s18 offen offset:1024 sc1 lds
    buffer_load_dwordx4 v3, s[8:11], s18 offen offset:2048 sc1 lds
    buffer_load_dwordx4 v3, s[8:11], s18 offen offset:3072 sc1 lds
    s_add_u32 s18, s18, 4096
    s_and_b32 m0, s18, 0x1ffff
    s_nop 0
    buffer_load_dwordx4 v3, s[8:11], s18 offen offset:0 sc1 lds
    buffer_load_dwordx4 v3, s[8:11], s18 offen offset:1024 sc1 lds
    buffer_load_dwordx4 v3, s[8:11], s18 offen offset:2048 sc1 lds
    buffer_load_dwordx4 v3, s[8:11], s18 offen offset:3072 sc1 lds
    s_add_u32 s18, s18, 4096
    s_and_b32 m0, s18, 0x1ffff
    s_nop 0
    buffer_load_dwordx4 v3, s[8:11], s18 offen offset:0 sc1 lds
    buffer_load_dwordx4 v3, s[8:11], s18 offen offset:1024 sc1 lds
    buffer_load_dwordx4 v3, s[8:11], s18 offen offset:2048 sc1 lds
    buffer_load_dwordx4 v3, s[8:11], s18 offen offset:3072 sc1 lds
    s_add_u32 s18, s18, 20480
    ds_read_b64_tr_b16 a[16:17], v8 offset:0
    ds_read_b64_tr_b16 a[18:19], v8 offset:16384
    ds_read_b64_tr_b16 a[20:21], v8 offset:512
    ds_read_b64_tr_b16 a[22:23], v8 offset:16896
    ds_read_b64_tr_b16 a[24:25], v8 offset:1024
    ds_read_b64_tr_b16 a[26:27], v8 offset:17408
    ds_read_b64_tr_b16 a[28:29], v8 offset:1536
    ds_read_b64_tr_b16 a[30:31], v8 offset:17920
    s_waitcnt lgkmcnt(4)
    ds_read_b64_tr_b16 a[32:33], v8 offset:2048
    ds_read_b64_tr_b16 a[34:35], v8 offset:18432
    ds_read_b64_tr_b16 a[36:37], v8 offset:2560
    ds_read_b64_tr_b16 a[38:39], v8 offset:18944
    ds_read_b64_tr_b16 a[40:41], v8 offset:3072
    ds_read_b64_tr_b16 a[42:43], v8 offset:19456
    ds_read_b64_tr_b16 a[44:45], v8 offset:3584
    ds_read_b64_tr_b16 a[46:47], v8 offset:19968
    s_waitcnt lgkmcnt(4)
    ds_read_b64_tr_b16 a[48:49], v11 offset:0
    ds_read_b64_tr_b16 a[50:51], v11 offset:16384
    ds_read_b64_tr_b16 a[52:53], v11 offset:512
    ds_read_b64_tr_b16 a[54:55], v11 offset:16896
    ds_read_b64_tr_b16 a[56:57], v11 offset:1024
    ds_read_b64_tr_b16 a[58:59], v11 offset:17408
    ds_read_b64_tr_b16 a[60:61], v11 offset:1536
    ds_read_b64_tr_b16 a[62:63], v11 offset:17920
    s_waitcnt lgkmcnt(4)
    ds_read_b64_tr_b16 a[64:65], v11 offset:2048
    ds_read_b64_tr_b16 a[66:67], v11 offset:18432
    ds_read_b64_tr_b16 a[68:69], v11 offset:2560
    ds_read_b64_tr_b16 a[70:71], v11 offset:18944
    ds_read_b64_tr_b16 a[72:73], v11 offset:3072
    ds_read_b64_tr_b16 a[74:75], v11 offset:19456
    ds_read_b64_tr_b16 a[76:77], v11 offset:3584
    ds_read_b64_tr_b16 a[78:79], v11 offset:19968
    s_waitcnt lgkmcnt(4)
    s_waitcnt vmcnt(0) lgkmcnt(0)
    s_branch L_pv_go
L_c1_retry:
    s_mov_b32 s30, 400000
L_c1_spin:
    s_sleep 8
    buffer_load_dword v14, v12, s[92:95], 0 offen offset:0 sc1
    s_waitcnt vmcnt(0)
    v_cmp_le_u32 vcc, 64, v14
    s_nop 1
    s_cmp_eq_u64 vcc, -1
    s_cbranch_scc1 L_c1_ok
    s_sub_u32 s30, s30, 1
    s_cbranch_scc0 L_c1_spin
    s_branch L_c1_ok
L_c2_retry:
    s_mov_b32 s30, 400000
L_c2_spin:
    s_sleep 8
    buffer_load_dword v14, v13, s[92:95], 0 offen offset:8 sc1
    s_waitcnt vmcnt(0)
    v_cmp_le_u32 vcc, 64, v14
    s_nop 1
    s_cmp_eq_u64 vcc, -1
    s_cbranch_scc1 L_c2_ok
    s_sub_u32 s30, s30, 1
    s_cbranch_scc0 L_c2_spin
    s_branch L_c2_ok
L_qa_retry:
    s_mov_b32 s30, 400000
L_qa_spin:
    s_sleep 1
    buffer_load_dword v15, off, s[12:15], s6 sc1
    s_waitcnt vmcnt(0)
    v_readfirstlane_b32 s26, v15
    s_cmp_eq_u32 s26, 1
    s_cbranch_scc1 L_qa_ok
    s_sub_u32 s30, s30, 1
    s_cbranch_scc0 L_qa_spin
    s_branch L_qa_ok
L_rq_far:
    buffer_store_dwordx4 v[192:195], v3, s[12:15], s40 offen offset:0 sc1
    buffer_store_dwordx4 v[224:227], v3, s[12:15], s40 offen offset:1024 sc1
    buffer_store_dwordx4 v[196:199], v3, s[12:15], s40 offen offset:2048 sc1
    buffer_store_dwordx4 v[228:231], v3, s[12:15], s40 offen offset:3072 sc1
    buffer_store_dwordx4 v[200:203], v3, s[12:15], s7 offen offset:0 sc1
    buffer_store_dwordx4 v[232:235], v3, s[12:15], s7 offen offset:1024 sc1
    buffer_store_dwordx4 v[204:207], v3, s[12:15], s7 offen offset:2048 sc1
    buffer_store_dwordx4 v[236:239], v3, s[12:15], s7 offen offset:3072 sc1
    s_waitcnt vmcnt(0)
    buffer_store_dword v12, off, s[12:15], s41 offset:8 sc1
    s_branch L_rq_back
L_q_retry:
    s_mov_b32 s30, 400000
L_q_spin:
    s_sleep 1
    buffer_load_dword v15, off, s[12:15], s6 offset:8 sc1
    s_waitcnt vmcnt(0)
    v_readfirstlane_b32 s26, v15
    s_cmp_eq_u32 s26, 1
    s_cbranch_scc1 L_q_ok
    s_sub_u32 s30, s30, 1
    s_cbranch_scc0 L_q_spin
    s_branch L_q_ok
L_rm_far:
    buffer_store_dwordx2 v[242:243], v244, s[12:15], s41 offen sc1
    s_branch L_rm_back
L_qk_c3_retry:
    s_mov_b32 s30, 400000
L_qk_c3_spin:
    s_sleep 16
    buffer_load_dword v14, v11, s[92:95], 0 offen offset:4 sc1
    s_waitcnt vmcnt(0)
    v_cmp_le_u32 vcc, v7, v14
    s_nop 1
    s_cmp_eq_u64 vcc, -1
    s_cbranch_scc1 L_qk_c3_ok
    s_sub_u32 s30, s30, 1
    s_cbranch_scc0 L_qk_c3_spin
    s_branch L_qk_c3_ok
L_ro_far:
    s_xor_b32 s41, s40, 65536
    buffer_store_dwordx4 v[16:19], v3, s[12:15], s41 offen offset:0 sc1
    buffer_store_dwordx4 v[20:23], v3, s[12:15], s41 offen offset:1024 sc1
    buffer_store_dwordx4 v[24:27], v3, s[12:15], s41 offen offset:2048 sc1
    buffer_store_dwordx4 v[28:31], v3, s[12:15], s41 offen offset:3072 sc1
    s_xor_b32 s41, s40, 69632
    buffer_store_dwordx4 v[48:51], v3, s[12:15], s41 offen offset:0 sc1
    buffer_store_dwordx4 v[52:55], v3, s[12:15], s41 offen offset:1024 sc1
    buffer_store_dwordx4 v[56:59], v3, s[12:15], s41 offen offset:2048 sc1
    buffer_store_dwordx4 v[60:63], v3, s[12:15], s41 offen offset:3072 sc1
    s_xor_b32 s41, s40, 73728
    buffer_store_dwordx4 v[80:83], v3, s[12:15], s41 offen offset:0 sc1
    buffer_store_dwordx4 v[84:87], v3, s[12:15], s41 offen offset:1024 sc1
    buffer_store_dwordx4 v[88:91], v3, s[12:15], s41 offen offset:2048 sc1
    buffer_store_dwordx4 v[92:95], v3, s[12:15], s41 offen offset:3072 sc1
    s_xor_b32 s41, s40, 77824
    buffer_store_dwordx4 v[112:115], v3, s[12:15], s41 offen offset:0 sc1
    buffer_store_dwordx4 v[116:119], v3, s[12:15], s41 offen offset:1024 sc1
    buffer_store_dwordx4 v[120:123], v3, s[12:15], s41 offen offset:2048 sc1
    buffer_store_dwordx4 v[124:127], v3, s[12:15], s41 offen offset:3072 sc1
    s_waitcnt vmcnt(0)
    buffer_store_dword v0, off, s[12:15], s56 offset:24 sc1
    s_branch L_ro_back
L_ml_retry:
    s_mov_b32 s30, 400000
L_ml_spin:
    s_sleep 1
    buffer_load_dwordx2 v[12:13], v9, s[12:15], s42 offen offset:0 sc1
    buffer_load_dwordx2 v[14:15], v9, s[12:15], s42 offen offset:512 sc1
    s_waitcnt vmcnt(0)
    v_and_b32 v8, v13, v15
    v_cmp_gt_i32 vcc, 0, v8
    s_nop 1
    s_cmp_eq_u64 vcc, -1
    s_cbranch_scc1 L_ml_ok
    s_sub_u32 s30, s30, 1
    s_cbranch_scc0 L_ml_spin
    s_branch L_ml_ok
L_o_retry:
    s_mov_b32 s30, 400000
L_o_spin:
    s_sleep 1
    buffer_load_dword v11, off, s[12:15], s57 offset:24 sc1
    s_waitcnt vmcnt(0)
    v_readfirstlane_b32 s26, v11
    s_cmp_eq_u32 s26, 1
    s_cbranch_scc1 L_o_ok
    s_sub_u32 s30, s30, 1
    s_cbranch_scc0 L_o_spin
    s_branch L_o_ok
L_ry_far:
    buffer_store_dwordx4 v[64:67], v3, s[12:15], s54 offen offset:0 sc1
    buffer_store_dwordx4 v[68:71], v3, s[12:15], s54 offen offset:1024 sc1
    buffer_store_dwordx4 v[72:75], v3, s[12:15], s54 offen offset:2048 sc1
    buffer_store_dwordx4 v[76:79], v3, s[12:15], s54 offen offset:3072 sc1
    buffer_store_dwordx4 v[80:83], v3, s[12:15], s55 offen offset:0 sc1
    buffer_store_dwordx4 v[84:87], v3, s[12:15], s55 offen offset:1024 sc1
    buffer_store_dwordx4 v[88:91], v3, s[12:15], s55 offen offset:2048 sc1
    buffer_store_dwordx4 v[92:95], v3, s[12:15], s55 offen offset:3072 sc1
    s_waitcnt vmcnt(0)
    buffer_store_dword v12, off, s[12:15], s56 sc1
    s_branch L_ry_back
L_y_retry:
    s_mov_b32 s30, 400000
L_y_spin:
    s_sleep 1
    buffer_load_dword v14, off, s[12:15], s57 sc1
    s_waitcnt vmcnt(0)
    v_readfirstlane_b32 s26, v14
    s_cmp_eq_u32 s26, 1
    s_cbranch_scc1 L_y_ok
    s_sub_u32 s30, s30, 1
    s_cbranch_scc0 L_y_spin
    s_branch L_y_ok
L_aux:
    s_add_u32 m0, s19, 96256
    s_nop 0
    buffer_load_dwordx4 v3, s[40:43], s17 offen offset:0 lds
    s_add_u32 m0, s19, 96288
    s_nop 0
    buffer_load_dwordx4 v3, s[40:43], s17 offen offset:1024 lds
    s_add_u32 m0, s19, 96320
    s_nop 0
    buffer_load_dwordx4 v3, s[40:43], s17 offen offset:2048 lds
    s_add_u32 m0, s19, 96352
    s_nop 0
    buffer_load_dwordx4 v3, s[40:43], s17 offen offset:3072 lds
    s_add_u32 m0, s19, 113152
    s_add_u32 s17, s17, 4096
    buffer_load_dwordx4 v3, s[40:43], s17 offen offset:0 lds
    s_add_u32 m0, s19, 113184
    s_nop 0
    buffer_load_dwordx4 v3, s[40:43], s17 offen offset:1024 lds
    s_add_u32 m0, s19, 113216
    s_nop 0
    buffer_load_dwordx4 v3, s[40:43], s17 offen offset:2048 lds
    s_add_u32 m0, s19, 113248
    s_nop 0
    buffer_load_dwordx4 v3, s[40:43], s17 offen offset:3072 lds
    s_add_u32 m0, s19, 130048
    s_nop 0
    buffer_load_dwordx4 v3, s[8:11], s18 offen offset:0 lds
    s_add_u32 m0, s19, 130080
    s_nop 0
    buffer_load_dwordx4 v3, s[8:11], s18 offen offset:1024 lds
    s_add_u32 m0, s19, 130112
    s_nop 0
    buffer_load_dwordx4 v3, s[8:11], s18 offen offset:2048 lds
    s_add_u32 m0, s19, 130144
    s_nop 0
    buffer_load_dwordx4 v3, s[8:11], s18 offen offset:3072 lds
    s_add_u32 m0, s19, 146944
    s_add_u32 s18, s18, 4096
    buffer_load_dwordx4 v3, s[8:11], s18 offen offset:0 lds
    s_add_u32 m0, s19, 146976
    s_nop 0
    buffer_load_dwordx4 v3, s[8:11], s18 offen offset:1024 lds
    s_add_u32 m0, s19, 147008
    s_nop 0
    buffer_load_dwordx4 v3, s[8:11], s18 offen offset:2048 lds
    s_add_u32 m0, s19, 147040
    s_nop 0
    buffer_load_dwordx4 v3, s[8:11], s18 offen offset:3072 lds
    buffer_load_dword v0, v7, s[44:47], 0 offen
    v_and_b32 v4, 15, v2
    v_lshrrev_b32 v5, 4, v2
    v_mul_u32_u24 v6, 1056, v4
    v_lshl_add_u32 v6, v5, 4, v6
    v_add_u32 v6, 96256, v6
    s_and_b32 s26, s16, 1
    s_lshr_b32 s28, s16, 1
    s_mul_i32 s29, s26, 16896
    v_add_u32 v7, s29, v6
    s_mul_i32 s29, s28, 16896
    v_add_u32 v6, s29, v6
    s_bfe_u32 s29, s100, 0x30001
    s_lshl_b32 s29, s29, 16
    s_lshr_b32 s30, s100, 4
    s_lshl_b32 s30, s30, 12
    s_add_u32 s29, s29, s30
    s_and_b32 s30, s100, 1
    s_lshl_b32 s30, s30, 1
    s_add_u32 s30, s30, s28
    s_lshl_b32 s30, s30, 10
    s_add_u32 s29, s29, s30
    s_lshl_b32 s30, s26, 9
    s_add_u32 s29, s29, s30
    s_add_u32 s30, s29, 59768832
    s_lshl_b32 s29, s28, 10
    s_lshl_b32 s26, s26, 3
    s_add_u32 s29, s29, s26
    s_add_u32 s29, s29, 86528
    v_add_u32 v112, s29, v3
    s_lshl_b32 s29, s16, 9
    s_add_u32 s29, s29, 86528
    v_and_b32 v114, 0x1ff, v3
    v_add_u32 v113, s29, v114
    s_waitcnt vmcnt(1)
    s_barrier
    ds_read_b128 a[0:3], v7 offset:0
    ds_read_b128 a[4:7], v6 offset:33792
    ds_read_b128 a[8:11], v7 offset:64
    ds_read_b128 a[12:15], v6 offset:33856
    ds_read_b128 a[16:19], v7 offset:128
    ds_read_b128 a[20:23], v6 offset:33920
    ds_read_b128 a[24:27], v7 offset:192
    ds_read_b128 a[28:31], v6 offset:33984
    ds_read_b128 a[32:35], v7 offset:256
    ds_read_b128 a[36:39], v6 offset:34048
    ds_read_b128 a[40:43], v7 offset:320
    ds_read_b128 a[44:47], v6 offset:34112
    ds_read_b128 a[48:51], v7 offset:384
    ds_read_b128 a[52:55], v6 offset:34176
    s_waitcnt lgkmcnt(12)
    v_mfma_f32_16x16x32_bf16 v[8:11], a[0:3], a[4:7], 0
    ds_read_b128 a[56:59], v7 offset:448
    ds_read_b128 a[60:63], v6 offset:34240
    s_waitcnt lgkmcnt(12)
    v_mfma_f32_16x16x32_bf16 v[8:11], a[8:11], a[12:15], v[8:11]
    ds_read_b128 a[64:67], v7 offset:512
    ds_read_b128 a[68:71], v6 offset:34304
    s_waitcnt lgkmcnt(12)
    v_mfma_f32_16x16x32_bf16 v[8:11], a[16:19], a[20:23], v[8:11]
    ds_read_b128 a[72:75], v7 offset:576
    ds_read_b128 a[76:79], v6 offset:34368
    s_waitcnt lgkmcnt(12)
    v_mfma_f32_16x16x32_bf16 v[8:11], a[24:27], a[28:31], v[8:11]
    ds_read_b128 a[80:83], v7 offset:640
    ds_read_b128 a[84:87], v6 offset:34432
    s_waitcnt lgkmcnt(12)
    v_mfma_f32_16x16x32_bf16 v[8:11], a[32:35], a[36:39], v[8:11]
    ds_read_b128 a[88:91], v7 offset:704
    ds_read_b128 a[92:95], v6 offset:34496
    s_waitcnt lgkmcnt(12)
    v_mfma_f32_16x16x32_bf16 v[8:11], a[40:43], a[44:47], v[8:11]
    ds_read_b128 a[96:99], v7 offset:768
    ds_read_b128 a[100:103], v6 offset:34560
    s_waitcnt lgkmcnt(12)
    v_mfma_f32_16x16x32_bf16 v[8:11], a[48:51], a[52:55], v[8:11]
    ds_read_b128 a[104:107], v7 offset:832
    ds_read_b128 a[108:111], v6 offset:34624
    s_waitcnt lgkmcnt(12)
    v_mfma_f32_16x16x32_bf16 v[8:11], a[56:59], a[60:63], v[8:11]
    ds_read_b128 a[112:115], v7 offset:896
    ds_read_b128 a[116:119], v6 offset:34688
    s_waitcnt lgkmcnt(12)
    v_mfma_f32_16x16x32_bf16 v[8:11], a[64:67], a[68:71], v[8:11]
    ds_read_b128 a[120:123], v7 offset:960
    ds_read_b128 a[124:127], v6 offset:34752
    s_waitcnt lgkmcnt(12)
    v_mfma_f32_16x16x32_bf16 v[8:11], a[72:75], a[76:79], v[8:11]
    s_waitcnt lgkmcnt(10)
    v_mfma_f32_16x16x32_bf16 v[8:11], a[80:83], a[84:87], v[8:11]
    s_waitcnt lgkmcnt(8)
    v_mfma_f32_16x16x32_bf16 v[8:11], a[88:91], a[92:95], v[8:11]
    s_waitcnt lgkmcnt(6)
    v_mfma_f32_16x16x32_bf16 v[8:11], a[96:99], a[100:103], v[8:11]
    s_waitcnt lgkmcnt(4)
    v_mfma_f32_16x16x32_bf16 v[8:11], a[104:107], a[108:111], v[8:11]
    s_waitcnt lgkmcnt(2)
    v_mfma_f32_16x16x32_bf16 v[8:11], a[112:115], a[116:119], v[8:11]
    s_waitcnt lgkmcnt(0)
    v_mfma_f32_16x16x32_bf16 v[8:11], a[120:123], a[124:127], v[8:11]
    s_nop 7
    v_mul_f32 v8, 0x3e949ec1, v8
    v_mul_f32 v9, 0x3e949ec1, v9
    v_mul_f32 v10, 0x3e949ec1, v10
    v_mul_f32 v11, 0x3e949ec1, v11
    v_cvt_pk_bf16_f32 v8, v8, v9
    v_cvt_pk_bf16_f32 v9, v10, v11
    ds_write_b64 v112, v[8:9]
    s_waitcnt lgkmcnt(0)
    s_barrier
    ds_read_b128 v[8:11], v113
    s_waitcnt lgkmcnt(0)
    buffer_store_dwordx4 v[8:11], v114, s[12:15], s30 offen sc1
    s_waitcnt vmcnt(0) lgkmcnt(0)
    s_barrier
    s_cmp_lg_u32 s16, 0
    s_cbranch_scc1 L_sig1a
    v_mov_b32 v14, 1
    s_and_b32 s26, s2, 3
    s_lshl_b32 s26, s26, 6
    s_mov_b64 exec, 1
    buffer_atomic_add v14, off, s[92:95], s26 offset:0
    s_mov_b64 exec, -1
L_sig1a:
    s_cmp_lg_u32 s16, 1
    s_cbranch_scc1 L_sig2a
    v_mov_b32 v14, 1
    s_and_b32 s26, s2, 3
    s_lshl_b32 s26, s26, 6
    s_mov_b64 exec, 1
    buffer_atomic_add v14, off, s[92:95], s26 offset:8
    s_mov_b64 exec, -1
L_sig2a:
    s_cmp_lg_u32 s16, 2
    s_cbranch_scc1 L_sig3a
    v_mov_b32 v14, 1
    s_and_b32 s26, s2, 3
    s_lshl_b32 s26, s26, 6
    s_mov_b64 exec, 1
    buffer_atomic_add v14, off, s[92:95], s26 offset:4
    s_mov_b64 exec, -1
L_sig3a:
    s_lshl_b32 s20, s21, 1
    s_add_u32 s20, s20, s22
    s_load_dwordx4 s[24:27], s[0:1], 24
    s_load_dwordx4 s[28:31], s[0:1], 56
    s_waitcnt lgkmcnt(0)
    s_mov_b32 s8, s30
    s_and_b32 s9, s31, 0xffff
    s_mov_b32 s10, 1048576
    s_mov_b32 s11, 0x00020000
    s_and_b32 s25, s25, 0xffff
    s_and_b32 s27, s27, 0xffff
    s_and_b32 s29, s29, 0xffff
    s_lshl_b32 s17, s20, 2
    s_add_u32 s17, s17, s16
    s_lshl_b32 s40, s17, 6
    s_lshl_b32 s47, s16, 15
    v_lshrrev_b32 v4, 2, v2
    v_and_b32 v5, 3, v2
    v_lshlrev_b32 v6, 10, v4
    v_lshl_add_u32 v6, v5, 4, v6
    v_lshrrev_b32 v7, 4, v2
    v_and_b32 v8, 3, v4
    v_lshl_add_u32 v7, v7, 3, v8
    v_lshlrev_b32 v7, 6, v7
    v_lshl_add_u32 v7, v5, 4, v7
    v_add_u32 v7, s47, v7
    s_add_u32 m0, s47, 0
    s_add_u32 s41, s40, 0
    buffer_load_dwordx4 v6, s[8:11], s41 offen lds
    s_add_u32 m0, s47, 1024
    s_add_u32 s41, s40, 16384
    buffer_load_dwordx4 v6, s[8:11], s41 offen lds
    s_add_u32 m0, s47, 2048
    s_add_u32 s41, s40, 32768
    buffer_load_dwordx4 v6, s[8:11], s41 offen lds
    s_add_u32 m0, s47, 3072
    s_add_u32 s41, s40, 49152
    buffer_load_dwordx4 v6, s[8:11], s41 offen lds
    s_add_u32 m0, s47, 4096
    s_add_u32 s41, s40, 65536
    buffer_load_dwordx4 v6, s[8:11], s41 offen lds
    s_add_u32 m0, s47, 5120
    s_add_u32 s41, s40, 81920
    buffer_load_dwordx4 v6, s[8:11], s41 offen lds
    s_add_u32 m0, s47, 6144
    s_add_u32 s41, s40, 98304
    buffer_load_dwordx4 v6, s[8:11], s41 offen lds
    s_add_u32 m0, s47, 7168
    s_add_u32 s41, s40, 114688
    buffer_load_dwordx4 v6, s[8:11], s41 offen lds
    s_add_u32 m0, s47, 8192
    s_add_u32 s41, s40, 131072
    buffer_load_dwordx4 v6, s[8:11], s41 offen lds
    s_add_u32 m0, s47, 9216
    s_add_u32 s41, s40, 147456
    buffer_load_dwordx4 v6, s[8:11], s41 offen lds
    s_add_u32 m0, s47, 10240
    s_add_u32 s41, s40, 163840
    buffer_load_dwordx4 v6, s[8:11], s41 offen lds
    s_add_u32 m0, s47, 11264
    s_add_u32 s41, s40, 180224
    buffer_load_dwordx4 v6, s[8:11], s41 offen lds
    s_add_u32 m0, s47, 12288
    s_add_u32 s41, s40, 196608
    buffer_load_dwordx4 v6, s[8:11], s41 offen lds
    s_add_u32 m0, s47, 13312
    s_add_u32 s41, s40, 212992
    buffer_load_dwordx4 v6, s[8:11], s41 offen lds
    s_add_u32 m0, s47, 14336
    s_add_u32 s41, s40, 229376
    buffer_load_dwordx4 v6, s[8:11], s41 offen lds
    s_add_u32 m0, s47, 15360
    s_add_u32 s41, s40, 245760
    buffer_load_dwordx4 v6, s[8:11], s41 offen lds
    s_add_u32 m0, s47, 16384
    s_add_u32 s41, s40, 262144
    buffer_load_dwordx4 v6, s[8:11], s41 offen lds
    s_add_u32 m0, s47, 17408
    s_add_u32 s41, s40, 278528
    buffer_load_dwordx4 v6, s[8:11], s41 offen lds
    s_add_u32 m0, s47, 18432
    s_add_u32 s41, s40, 294912
    buffer_load_dwordx4 v6, s[8:11], s41 offen lds
    s_add_u32 m0, s47, 19456
    s_add_u32 s41, s40, 311296
    buffer_load_dwordx4 v6, s[8:11], s41 offen lds
    s_add_u32 m0, s47, 20480
    s_add_u32 s41, s40, 327680
    buffer_load_dwordx4 v6, s[8:11], s41 offen lds
    s_add_u32 m0, s47, 21504
    s_add_u32 s41, s40, 344064
    buffer_load_dwordx4 v6, s[8:11], s41 offen lds
    s_add_u32 m0, s47, 22528
    s_add_u32 s41, s40, 360448
    buffer_load_dwordx4 v6, s[8:11], s41 offen lds
    s_add_u32 m0, s47, 23552
    s_add_u32 s41, s40, 376832
    buffer_load_dwordx4 v6, s[8:11], s41 offen lds
    s_add_u32 m0, s47, 24576
    s_add_u32 s41, s40, 393216
    buffer_load_dwordx4 v6, s[8:11], s41 offen lds
    s_add_u32 m0, s47, 25600
    s_add_u32 s41, s40, 409600
    buffer_load_dwordx4 v6, s[8:11], s41 offen lds
    s_add_u32 m0, s47, 26624
    s_add_u32 s41, s40, 425984
    buffer_load_dwordx4 v6, s[8:11], s41 offen lds
    s_add_u32 m0, s47, 27648
    s_add_u32 s41, s40, 442368
    buffer_load_dwordx4 v6, s[8:11], s41 offen lds
    s_add_u32 m0, s47, 28672
    s_add_u32 s41, s40, 458752
    buffer_load_dwordx4 v6, s[8:11], s41 offen lds
    s_add_u32 m0, s47, 29696
    s_add_u32 s41, s40, 475136
    buffer_load_dwordx4 v6, s[8:11], s41 offen lds
    s_add_u32 m0, s47, 30720
    s_add_u32 s41, s40, 491520
    buffer_load_dwordx4 v6, s[8:11], s41 offen lds
    s_add_u32 m0, s47, 31744
    s_add_u32 s41, s40, 507904
    buffer_load_dwordx4 v6, s[8:11], s41 offen lds
    s_waitcnt vmcnt(30)
    ds_read_b64_tr_b16 v[128:129], v7 offset:0
    ds_read_b64_tr_b16 v[130:131], v7 offset:256
    ds_read_b64_tr_b16 v[192:193], v7 offset:8
    ds_read_b64_tr_b16 v[194:195], v7 offset:264
    s_waitcnt vmcnt(28)
    ds_read_b64_tr_b16 v[132:133], v7 offset:2048
    ds_read_b64_tr_b16 v[134:135], v7 offset:2304
    ds_read_b64_tr_b16 v[196:197], v7 offset:2056
    ds_read_b64_tr_b16 v[198:199], v7 offset:2312
    s_waitcnt lgkmcnt(4)
    s_add_u32 m0, s47, 0
    s_add_u32 s41, s40, 524288
    buffer_load_dwordx4 v6, s[8:11], s41 offen lds
    s_add_u32 m0, s47, 1024
    s_add_u32 s41, s40, 540672
    buffer_load_dwordx4 v6, s[8:11], s41 offen lds
    s_waitcnt vmcnt(28)
    ds_read_b64_tr_b16 v[136:137], v7 offset:4096
    ds_read_b64_tr_b16 v[138:139], v7 offset:4352
    ds_read_b64_tr_b16 v[200:201], v7 offset:4104
    ds_read_b64_tr_b16 v[202:203], v7 offset:4360
    s_waitcnt lgkmcnt(4)
    s_add_u32 m0, s47, 2048
    s_add_u32 s41, s40, 557056
    buffer_load_dwordx4 v6, s[8:11], s41 offen lds
    s_add_u32 m0, s47, 3072
    s_add_u32 s41, s40, 573440
    buffer_load_dwordx4 v6, s[8:11], s41 offen lds
    s_waitcnt vmcnt(28)
    ds_read_b64_tr_b16 v[140:141], v7 offset:6144
    ds_read_b64_tr_b16 v[142:143], v7 offset:6400
    ds_read_b64_tr_b16 v[204:205], v7 offset:6152
    ds_read_b64_tr_b16 v[206:207], v7 offset:6408
    s_waitcnt lgkmcnt(4)
    s_add_u32 m0, s47, 4096
    s_add_u32 s41, s40, 589824
    buffer_load_dwordx4 v6, s[8:11], s41 offen lds
    s_add_u32 m0, s47, 5120
    s_add_u32 s41, s40, 606208
    buffer_load_dwordx4 v6, s[8:11], s41 offen lds
    s_waitcnt vmcnt(28)
    ds_read_b64_tr_b16 v[144:145], v7 offset:8192
    ds_read_b64_tr_b16 v[146:147], v7 offset:8448
    ds_read_b64_tr_b16 v[208:209], v7 offset:8200
    ds_read_b64_tr_b16 v[210:211], v7 offset:8456
    s_waitcnt lgkmcnt(4)
    s_add_u32 m0, s47, 6144
    s_add_u32 s41, s40, 622592
    buffer_load_dwordx4 v6, s[8:11], s41 offen lds
    s_add_u32 m0, s47, 7168
    s_add_u32 s41, s40, 638976
    buffer_load_dwordx4 v6, s[8:11], s41 offen lds
    s_waitcnt vmcnt(28)
    ds_read_b64_tr_b16 v[148:149], v7 offset:10240
    ds_read_b64_tr_b16 v[150:151], v7 offset:10496
    ds_read_b64_tr_b16 v[212:213], v7 offset:10248
    ds_read_b64_tr_b16 v[214:215], v7 offset:10504
    s_waitcnt lgkmcnt(4)
    s_add_u32 m0, s47, 8192
    s_add_u32 s41, s40, 655360
    buffer_load_dwordx4 v6, s[8:11], s41 offen lds
    s_add_u32 m0, s47, 9216
    s_add_u32 s41, s40, 671744
    buffer_load_dwordx4 v6, s[8:11], s41 offen lds
    s_waitcnt vmcnt(28)
    ds_read_b64_tr_b16 v[152:153], v7 offset:12288
    ds_read_b64_tr_b16 v[154:155], v7 offset:12544
    ds_read_b64_tr_b16 v[216:217], v7 offset:12296
    ds_read_b64_tr_b16 v[218:219], v7 offset:12552
    s_waitcnt lgkmcnt(4)
    s_add_u32 m0, s47, 10240
    s_add_u32 s41, s40, 688128
    buffer_load_dwordx4 v6, s[8:11], s41 offen lds
    s_add_u32 m0, s47, 11264
    s_add_u32 s41, s40, 704512
    buffer_load_dwordx4 v6, s[8:11], s41 offen lds
    s_waitcnt vmcnt(28)
    ds_read_b64_tr_b16 v[156:157], v7 offset:14336
    ds_read_b64_tr_b16 v[158:159], v7 offset:14592
    ds_read_b64_tr_b16 v[220:221], v7 offset:14344
    ds_read_b64_tr_b16 v[222:223], v7 offset:14600
    s_waitcnt lgkmcnt(4)
    s_add_u32 m0, s47, 12288
    s_add_u32 s41, s40, 720896
    buffer_load_dwordx4 v6, s[8:11], s41 offen lds
    s_add_u32 m0, s47, 13312
    s_add_u32 s41, s40, 737280
    buffer_load_dwordx4 v6, s[8:11], s41 offen lds
    s_waitcnt vmcnt(28)
    ds_read_b64_tr_b16 v[160:161], v7 offset:16384
    ds_read_b64_tr_b16 v[162:163], v7 offset:16640
    ds_read_b64_tr_b16 v[224:225], v7 offset:16392
    ds_read_b64_tr_b16 v[226:227], v7 offset:16648
    s_waitcnt lgkmcnt(4)
    s_add_u32 m0, s47, 14336
    s_add_u32 s41, s40, 753664
    buffer_load_dwordx4 v6, s[8:11], s41 offen lds
    s_add_u32 m0, s47, 15360
    s_add_u32 s41, s40, 770048
    buffer_load_dwordx4 v6, s[8:11], s41 offen lds
    s_waitcnt vmcnt(28)
    ds_read_b64_tr_b16 v[164:165], v7 offset:18432
    ds_read_b64_tr_b16 v[166:167], v7 offset:18688
    ds_read_b64_tr_b16 v[228:229], v7 offset:18440
    ds_read_b64_tr_b16 v[230:231], v7 offset:18696
    s_waitcnt lgkmcnt(4)
    s_add_u32 m0, s47, 16384
    s_add_u32 s41, s40, 786432
    buffer_load_dwordx4 v6, s[8:11], s41 offen lds
    s_add_u32 m0, s47, 17408
    s_add_u32 s41, s40, 802816
    buffer_load_dwordx4 v6, s[8:11], s41 offen lds
    s_waitcnt vmcnt(28)
    ds_read_b64_tr_b16 v[168:169], v7 offset:20480
    ds_read_b64_tr_b16 v[170:171], v7 offset:20736
    ds_read_b64_tr_b16 v[232:233], v7 offset:20488
    ds_read_b64_tr_b16 v[234:235], v7 offset:20744
    s_waitcnt lgkmcnt(4)
    s_add_u32 m0, s47, 18432
    s_add_u32 s41, s40, 819200
    buffer_load_dwordx4 v6, s[8:11], s41 offen lds
    s_add_u32 m0, s47, 19456
    s_add_u32 s41, s40, 835584
    buffer_load_dwordx4 v6, s[8:11], s41 offen lds
    s_waitcnt vmcnt(28)
    ds_read_b64_tr_b16 v[172:173], v7 offset:22528
    ds_read_b64_tr_b16 v[174:175], v7 offset:22784
    ds_read_b64_tr_b16 v[236:237], v7 offset:22536
    ds_read_b64_tr_b16 v[238:239], v7 offset:22792
    s_waitcnt lgkmcnt(4)
    s_add_u32 m0, s47, 20480
    s_add_u32 s41, s40, 851968
    buffer_load_dwordx4 v6, s[8:11], s41 offen lds
    s_add_u32 m0, s47, 21504
    s_add_u32 s41, s40, 868352
    buffer_load_dwordx4 v6, s[8:11], s41 offen lds
    s_waitcnt vmcnt(28)
    ds_read_b64_tr_b16 v[176:177], v7 offset:24576
    ds_read_b64_tr_b16 v[178:179], v7 offset:24832
    ds_read_b64_tr_b16 v[240:241], v7 offset:24584
    ds_read_b64_tr_b16 v[242:243], v7 offset:24840
    s_waitcnt lgkmcnt(4)
    s_add_u32 m0, s47, 22528
    s_add_u32 s41, s40, 884736
    buffer_load_dwordx4 v6, s[8:11], s41 offen lds
    s_add_u32 m0, s47, 23552
    s_add_u32 s41, s40, 901120
    buffer_load_dwordx4 v6, s[8:11], s41 offen lds
    s_waitcnt vmcnt(28)
    ds_read_b64_tr_b16 v[180:181], v7 offset:26624
    ds_read_b64_tr_b16 v[182:183], v7 offset:26880
    ds_read_b64_tr_b16 v[244:245], v7 offset:26632
    ds_read_b64_tr_b16 v[246:247], v7 offset:26888
    s_waitcnt lgkmcnt(4)
    s_add_u32 m0, s47, 24576
    s_add_u32 s41, s40, 917504
    buffer_load_dwordx4 v6, s[8:11], s41 offen lds
    s_add_u32 m0, s47, 25600
    s_add_u32 s41, s40, 933888
    buffer_load_dwordx4 v6, s[8:11], s41 offen lds
    s_waitcnt vmcnt(28)
    ds_read_b64_tr_b16 v[184:185], v7 offset:28672
    ds_read_b64_tr_b16 v[186:187], v7 offset:28928
    ds_read_b64_tr_b16 v[248:249], v7 offset:28680
    ds_read_b64_tr_b16 v[250:251], v7 offset:28936
    s_waitcnt lgkmcnt(4)
    s_add_u32 m0, s47, 26624
    s_add_u32 s41, s40, 950272
    buffer_load_dwordx4 v6, s[8:11], s41 offen lds
    s_add_u32 m0, s47, 27648
    s_add_u32 s41, s40, 966656
    buffer_load_dwordx4 v6, s[8:11], s41 offen lds
    s_waitcnt vmcnt(28)
    ds_read_b64_tr_b16 v[188:189], v7 offset:30720
    ds_read_b64_tr_b16 v[190:191], v7 offset:30976
    ds_read_b64_tr_b16 v[252:253], v7 offset:30728
    ds_read_b64_tr_b16 v[254:255], v7 offset:30984
    s_waitcnt lgkmcnt(4)
    s_add_u32 m0, s47, 28672
    s_add_u32 s41, s40, 983040
    buffer_load_dwordx4 v6, s[8:11], s41 offen lds
    s_add_u32 m0, s47, 29696
    s_add_u32 s41, s40, 999424
    buffer_load_dwordx4 v6, s[8:11], s41 offen lds
    s_waitcnt vmcnt(28)
    ds_read_b64_tr_b16 a[0:1], v7 offset:0
    ds_read_b64_tr_b16 a[2:3], v7 offset:256
    ds_read_b64_tr_b16 a[64:65], v7 offset:8
    ds_read_b64_tr_b16 a[66:67], v7 offset:264
    s_waitcnt lgkmcnt(4)
    s_add_u32 m0, s47, 30720
    s_add_u32 s41, s40, 1015808
    buffer_load_dwordx4 v6, s[8:11], s41 offen lds
    s_add_u32 m0, s47, 31744
    s_add_u32 s41, s40, 1032192
    buffer_load_dwordx4 v6, s[8:11], s41 offen lds
    s_waitcnt vmcnt(28)
    ds_read_b64_tr_b16 a[4:5], v7 offset:2048
    ds_read_b64_tr_b16 a[6:7], v7 offset:2304
    ds_read_b64_tr_b16 a[68:69], v7 offset:2056
    ds_read_b64_tr_b16 a[70:71], v7 offset:2312
    s_waitcnt vmcnt(26)
    ds_read_b64_tr_b16 a[8:9], v7 offset:4096
    ds_read_b64_tr_b16 a[10:11], v7 offset:4352
    ds_read_b64_tr_b16 a[72:73], v7 offset:4104
    ds_read_b64_tr_b16 a[74:75], v7 offset:4360
    s_waitcnt vmcnt(24)
    ds_read_b64_tr_b16 a[12:13], v7 offset:6144
    ds_read_b64_tr_b16 a[14:15], v7 offset:6400
    ds_read_b64_tr_b16 a[76:77], v7 offset:6152
    s_waitcnt lgkmcnt(14)
    ds_read_b64_tr_b16 a[78:79], v7 offset:6408
    s_waitcnt vmcnt(22)
    s_waitcnt lgkmcnt(14)
    ds_read_b64_tr_b16 a[16:17], v7 offset:8192
    s_waitcnt lgkmcnt(14)
    ds_read_b64_tr_b16 a[18:19], v7 offset:8448
    s_waitcnt lgkmcnt(14)
    ds_read_b64_tr_b16 a[80:81], v7 offset:8200
    s_waitcnt lgkmcnt(14)
    ds_read_b64_tr_b16 a[82:83], v7 offset:8456
    s_waitcnt vmcnt(20)
    s_waitcnt lgkmcnt(14)
    ds_read_b64_tr_b16 a[20:21], v7 offset:10240
    s_waitcnt lgkmcnt(14)
    ds_read_b64_tr_b16 a[22:23], v7 offset:10496
    s_waitcnt lgkmcnt(14)
    ds_read_b64_tr_b16 a[84:85], v7 offset:10248
    s_waitcnt lgkmcnt(14)
    ds_read_b64_tr_b16 a[86:87], v7 offset:10504
    s_waitcnt vmcnt(18)
    s_waitcnt lgkmcnt(14)
    ds_read_b64_tr_b16 a[24:25], v7 offset:12288
    s_waitcnt lgkmcnt(14)
    ds_read_b64_tr_b16 a[26:27], v7 offset:12544
    s_waitcnt lgkmcnt(14)
    ds_read_b64_tr_b16 a[88:89], v7 offset:12296
    s_waitcnt lgkmcnt(14)
    ds_read_b64_tr_b16 a[90:91], v7 offset:12552
    s_waitcnt vmcnt(16)
    s_waitcnt lgkmcnt(14)
    ds_read_b64_tr_b16 a[28:29], v7 offset:14336
    s_waitcnt lgkmcnt(14)
    ds_read_b64_tr_b16 a[30:31], v7 offset:14592
    s_waitcnt lgkmcnt(14)
    ds_read_b64_tr_b16 a[92:93], v7 offset:14344
    s_waitcnt lgkmcnt(14)
    ds_read_b64_tr_b16 a[94:95], v7 offset:14600
    s_waitcnt vmcnt(14)
    s_waitcnt lgkmcnt(14)
    ds_read_b64_tr_b16 a[32:33], v7 offset:16384
    s_waitcnt lgkmcnt(14)
    ds_read_b64_tr_b16 a[34:35], v7 offset:16640
    s_waitcnt lgkmcnt(14)
    ds_read_b64_tr_b16 a[96:97], v7 offset:16392
    s_waitcnt lgkmcnt(14)
    ds_read_b64_tr_b16 a[98:99], v7 offset:16648
    s_waitcnt vmcnt(12)
    s_waitcnt lgkmcnt(14)
    ds_read_b64_tr_b16 a[36:37], v7 offset:18432
    s_waitcnt lgkmcnt(14)
    ds_read_b64_tr_b16 a[38:39], v7 offset:18688
    s_waitcnt lgkmcnt(14)
    ds_read_b64_tr_b16 a[100:101], v7 offset:18440
    s_waitcnt lgkmcnt(14)
    ds_read_b64_tr_b16 a[102:103], v7 offset:18696
    s_waitcnt vmcnt(10)
    s_waitcnt lgkmcnt(14)
    ds_read_b64_tr_b16 a[40:41], v7 offset:20480
    s_waitcnt lgkmcnt(14)
    ds_read_b64_tr_b16 a[42:43], v7 offset:20736
    s_waitcnt lgkmcnt(14)
    ds_read_b64_tr_b16 a[104:105], v7 offset:20488
    s_waitcnt lgkmcnt(14)
    ds_read_b64_tr_b16 a[106:107], v7 offset:20744
    s_waitcnt vmcnt(8)
    s_waitcnt lgkmcnt(14)
    ds_read_b64_tr_b16 a[44:45], v7 offset:22528
    s_waitcnt lgkmcnt(14)
    ds_read_b64_tr_b16 a[46:47], v7 offset:22784
    s_waitcnt lgkmcnt(14)
    ds_read_b64_tr_b16 a[108:109], v7 offset:22536
    s_waitcnt lgkmcnt(14)
    ds_read_b64_tr_b16 a[110:111], v7 offset:22792
    s_waitcnt vmcnt(6)
    s_waitcnt lgkmcnt(14)
    ds_read_b64_tr_b16 a[48:49], v7 offset:24576
    s_waitcnt lgkmcnt(14)
    ds_read_b64_tr_b16 a[50:51], v7 offset:24832
    s_waitcnt lgkmcnt(14)
    ds_read_b64_tr_b16 a[112:113], v7 offset:24584
    s_waitcnt lgkmcnt(14)
    ds_read_b64_tr_b16 a[114:115], v7 offset:24840
    s_waitcnt vmcnt(4)
    s_waitcnt lgkmcnt(14)
    ds_read_b64_tr_b16 a[52:53], v7 offset:26624
    s_waitcnt lgkmcnt(14)
    ds_read_b64_tr_b16 a[54:55], v7 offset:26880
    s_waitcnt lgkmcnt(14)
    ds_read_b64_tr_b16 a[116:117], v7 offset:26632
    s_waitcnt lgkmcnt(14)
    ds_read_b64_tr_b16 a[118:119], v7 offset:26888
    s_waitcnt vmcnt(2)
    s_waitcnt lgkmcnt(14)
    ds_read_b64_tr_b16 a[56:57], v7 offset:28672
    s_waitcnt lgkmcnt(14)
    ds_read_b64_tr_b16 a[58:59], v7 offset:28928
    s_waitcnt lgkmcnt(14)
    ds_read_b64_tr_b16 a[120:121], v7 offset:28680
    s_waitcnt lgkmcnt(14)
    ds_read_b64_tr_b16 a[122:123], v7 offset:28936
    s_waitcnt vmcnt(0)
    s_waitcnt lgkmcnt(14)
    ds_read_b64_tr_b16 a[60:61], v7 offset:30720
    s_waitcnt lgkmcnt(14)
    ds_read_b64_tr_b16 a[62:63], v7 offset:30976
    s_waitcnt lgkmcnt(14)
    ds_read_b64_tr_b16 a[124:125], v7 offset:30728
    s_waitcnt lgkmcnt(14)
    ds_read_b64_tr_b16 a[126:127], v7 offset:30984
    s_waitcnt vmcnt(0) lgkmcnt(0)
    s_barrier
    s_mov_b32 s36, s26
    s_mov_b32 s37, s27
    s_mov_b32 s38, 524288
    s_mov_b32 s39, 0x00020000
    s_lshl_b32 s45, s16, 13
    s_lshl_b32 s41, s20, 17
    s_add_u32 s45, s45, s41
    s_mov_b32 s41, s45
    s_mov_b32 s42, 0
    s_mul_i32 s43, s16, 4224
    s_mov_b32 s44, 16896
    s_mul_i32 s52, s16, 8448
    s_add_u32 s46, s42, s43
    s_add_u32 m0, s46, 0
    s_nop 0
    buffer_load_dwordx4 v3, s[36:39], s41 offen offset:0  lds
    s_add_u32 m0, s46, 32
    s_nop 0
    buffer_load_dwordx4 v3, s[36:39], s41 offen offset:1024  lds
    s_add_u32 m0, s46, 64
    s_nop 0
    buffer_load_dwordx4 v3, s[36:39], s41 offen offset:2048  lds
    s_add_u32 m0, s46, 96
    s_nop 0
    buffer_load_dwordx4 v3, s[36:39], s41 offen offset:3072  lds
    s_add_u32 s41, s41, 4096
    s_add_u32 s46, s46, s44
    s_add_u32 m0, s46, 0
    s_nop 0
    buffer_load_dwordx4 v3, s[36:39], s41 offen offset:0  lds
    s_add_u32 m0, s46, 32
    s_nop 0
    buffer_load_dwordx4 v3, s[36:39], s41 offen offset:1024  lds
    s_add_u32 m0, s46, 64
    s_nop 0
    buffer_load_dwordx4 v3, s[36:39], s41 offen offset:2048  lds
    s_add_u32 m0, s46, 96
    s_nop 0
    buffer_load_dwordx4 v3, s[36:39], s41 offen offset:3072  lds
    s_add_u32 s41, s41, 28672
    s_and_b32 s41, s41, 0x7ffff
    s_add_u32 s42, s42, 33792
    s_cmp_eq_u32 s42, 135168
    s_cselect_b32 s42, 0, s42
    s_add_u32 s46, s42, s43
    s_add_u32 m0, s46, 0
    s_nop 0
    buffer_load_dwordx4 v3, s[36:39], s41 offen offset:0  lds
    s_add_u32 m0, s46, 32
    s_nop 0
    buffer_load_dwordx4 v3, s[36:39], s41 offen offset:1024  lds
    s_add_u32 m0, s46, 64
    s_nop 0
    buffer_load_dwordx4 v3, s[36:39], s41 offen offset:2048  lds
    s_add_u32 m0, s46, 96
    s_nop 0
    buffer_load_dwordx4 v3, s[36:39], s41 offen offset:3072  lds
    s_add_u32 s41, s41, 4096
    s_add_u32 s46, s46, s44
    s_add_u32 m0, s46, 0
    s_nop 0
    buffer_load_dwordx4 v3, s[36:39], s41 offen offset:0  lds
    s_add_u32 m0, s46, 32
    s_nop 0
    buffer_load_dwordx4 v3, s[36:39], s41 offen offset:1024  lds
    s_add_u32 m0, s46, 64
    s_nop 0
    buffer_load_dwordx4 v3, s[36:39], s41 offen offset:2048  lds
    s_add_u32 m0, s46, 96
    s_nop 0
    buffer_load_dwordx4 v3, s[36:39], s41 offen offset:3072  lds
    s_add_u32 s41, s41, 28672
    s_and_b32 s41, s41, 0x7ffff
    s_add_u32 s42, s42, 33792
    s_cmp_eq_u32 s42, 135168
    s_cselect_b32 s42, 0, s42
    s_add_u32 s46, s42, s43
    s_add_u32 m0, s46, 0
    s_nop 0
    buffer_load_dwordx4 v3, s[36:39], s41 offen offset:0  lds
    s_add_u32 m0, s46, 32
    s_nop 0
    buffer_load_dwordx4 v3, s[36:39], s41 offen offset:1024  lds
    s_add_u32 m0, s46, 64
    s_nop 0
    buffer_load_dwordx4 v3, s[36:39], s41 offen offset:2048  lds
    s_add_u32 m0, s46, 96
    s_nop 0
    buffer_load_dwordx4 v3, s[36:39], s41 offen offset:3072  lds
    s_add_u32 s41, s41, 4096
    s_add_u32 s46, s46, s44
    s_add_u32 m0, s46, 0
    s_nop 0
    buffer_load_dwordx4 v3, s[36:39], s41 offen offset:0  lds
    s_add_u32 m0, s46, 32
    s_nop 0
    buffer_load_dwordx4 v3, s[36:39], s41 offen offset:1024  lds
    s_add_u32 m0, s46, 64
    s_nop 0
    buffer_load_dwordx4 v3, s[36:39], s41 offen offset:2048  lds
    s_add_u32 m0, s46, 96
    s_nop 0
    buffer_load_dwordx4 v3, s[36:39], s41 offen offset:3072  lds
    s_add_u32 s41, s41, 28672
    s_and_b32 s41, s41, 0x7ffff
    s_add_u32 s42, s42, 33792
    s_cmp_eq_u32 s42, 135168
    s_cselect_b32 s42, 0, s42
    v_and_b32 v4, 15, v2
    v_lshrrev_b32 v5, 4, v2
    v_mul_u32_u24 v4, 1056, v4
    v_lshl_add_u32 v4, v5, 4, v4
    v_mov_b32 v9, v4
    s_mov_b32 s48, 0
    s_lshr_b32 s49, s17, 1
    s_lshl_b32 s49, s49, 16
    s_and_b32 s50, s17, 1
    s_lshl_b32 s50, s50, 11
    s_add_u32 s49, s49, s50
    v_mov_b32 v104, 0
    v_mov_b32 v105, 0
    v_mov_b32 v106, 0
    v_mov_b32 v107, 0
    v_mov_b32 v108, 0
    v_mov_b32 v109, 0
    v_mov_b32 v110, 0
    v_mov_b32 v111, 0
    v_mov_b32 v112, 0
    v_mov_b32 v113, 0
    v_mov_b32 v114, 0
    v_mov_b32 v115, 0
    v_mov_b32 v116, 0
    v_mov_b32 v117, 0
    v_mov_b32 v118, 0
    v_mov_b32 v119, 0
    s_waitcnt vmcnt(8)
    s_barrier
    ds_read_b128 v[32:35], v9 offset:0
    ds_read_b128 v[36:39], v9 offset:16896
    ds_read_b128 v[40:43], v9 offset:64
    ds_read_b128 v[44:47], v9 offset:16960
    ds_read_b128 v[48:51], v9 offset:128
    ds_read_b128 v[52:55], v9 offset:17024
    ds_read_b128 v[56:59], v9 offset:192
    ds_read_b128 v[60:63], v9 offset:17088
    ds_read_b128 v[64:67], v9 offset:256
    ds_read_b128 v[68:71], v9 offset:17152
    ds_read_b128 v[72:75], v9 offset:320
    ds_read_b128 v[76:79], v9 offset:17216
    s_add_u32 s55, s49, 62914560
    s_lshl_b32 s51, s20, 14
    s_add_u32 s54, s49, 63438848
    s_mov_b32 s53, 0
L_auxl0:
    s_waitcnt vmcnt(10)
    s_barrier
    s_waitcnt lgkmcnt(8)
    v_mfma_f32_16x16x32_bf16 v[16:19], v[32:35], v[128:131], 0
    ds_read_b128 v[80:83], v9 offset:384
    v_mfma_f32_16x16x32_bf16 v[24:27], v[32:35], v[192:195], 0
    ds_read_b128 v[84:87], v9 offset:17280
    v_mfma_f32_16x16x32_bf16 v[20:23], v[36:39], v[128:131], 0
    s_add_u32 s46, s42, s43
    v_mfma_f32_16x16x32_bf16 v[28:31], v[36:39], v[192:195], 0
    s_add_u32 m0, s46, 0
    v_mfma_f32_16x16x32_bf16 v[16:19], v[40:43], v[132:135], v[16:19]
    ds_read_b128 v[88:91], v9 offset:448
    v_mfma_f32_16x16x32_bf16 v[24:27], v[40:43], v[196:199], v[24:27]
    ds_read_b128 v[92:95], v9 offset:17344
    v_mfma_f32_16x16x32_bf16 v[20:23], v[44:47], v[132:135], v[20:23]
    buffer_load_dwordx4 v3, s[36:39], s41 offen offset:0  lds
    v_mfma_f32_16x16x32_bf16 v[28:31], v[44:47], v[196:199], v[28:31]
    s_add_u32 m0, s46, 32
    s_waitcnt lgkmcnt(8)
    v_mfma_f32_16x16x32_bf16 v[16:19], v[48:51], v[136:139], v[16:19]
    ds_read_b128 v[32:35], v9 offset:512
    v_cvt_pk_bf16_f32 v96, v104, v105
    v_mfma_f32_16x16x32_bf16 v[24:27], v[48:51], v[200:203], v[24:27]
    ds_read_b128 v[36:39], v9 offset:17408
    v_cvt_pk_bf16_f32 v97, v106, v107
    v_mfma_f32_16x16x32_bf16 v[20:23], v[52:55], v[136:139], v[20:23]
    buffer_load_dwordx4 v3, s[36:39], s41 offen offset:1024  lds
    v_mfma_f32_16x16x32_bf16 v[28:31], v[52:55], v[200:203], v[28:31]
    s_add_u32 m0, s46, 64
    v_mfma_f32_16x16x32_bf16 v[16:19], v[56:59], v[140:143], v[16:19]
    ds_read_b128 v[40:43], v9 offset:576
    v_cvt_pk_bf16_f32 v98, v108, v109
    v_mfma_f32_16x16x32_bf16 v[24:27], v[56:59], v[204:207], v[24:27]
    ds_read_b128 v[44:47], v9 offset:17472
    v_cvt_pk_bf16_f32 v99, v110, v111
    v_mfma_f32_16x16x32_bf16 v[20:23], v[60:63], v[140:143], v[20:23]
    buffer_load_dwordx4 v3, s[36:39], s41 offen offset:2048  lds
    v_mfma_f32_16x16x32_bf16 v[28:31], v[60:63], v[204:207], v[28:31]
    s_add_u32 m0, s46, 96
    s_waitcnt lgkmcnt(8)
    v_mfma_f32_16x16x32_bf16 v[16:19], v[64:67], v[144:147], v[16:19]
    ds_read_b128 v[48:51], v9 offset:640
    buffer_store_dwordx4 v[96:99], v3, s[12:15], s54 offen offset:0 sc1
    v_mfma_f32_16x16x32_bf16 v[24:27], v[64:67], v[208:211], v[24:27]
    ds_read_b128 v[52:55], v9 offset:17536
    v_cvt_pk_bf16_f32 v100, v112, v113
    v_mfma_f32_16x16x32_bf16 v[20:23], v[68:71], v[144:147], v[20:23]
    buffer_load_dwordx4 v3, s[36:39], s41 offen offset:3072  lds
    v_mfma_f32_16x16x32_bf16 v[28:31], v[68:71], v[208:211], v[28:31]
    s_add_u32 s41, s41, 4096
    v_mfma_f32_16x16x32_bf16 v[16:19], v[72:75], v[148:151], v[16:19]
    ds_read_b128 v[56:59], v9 offset:704
    v_cvt_pk_bf16_f32 v101, v114, v115
    v_mfma_f32_16x16x32_bf16 v[24:27], v[72:75], v[212:215], v[24:27]
    ds_read_b128 v[60:63], v9 offset:17600
    v_cvt_pk_bf16_f32 v102, v116, v117
    v_mfma_f32_16x16x32_bf16 v[20:23], v[76:79], v[148:151], v[20:23]
    s_add_u32 s46, s46, s44
    v_mfma_f32_16x16x32_bf16 v[28:31], v[76:79], v[212:215], v[28:31]
    s_add_u32 m0, s46, 0
    s_waitcnt lgkmcnt(8)
    v_mfma_f32_16x16x32_bf16 v[16:19], v[80:83], v[152:155], v[16:19]
    ds_read_b128 v[64:67], v9 offset:768
    v_cvt_pk_bf16_f32 v103, v118, v119
    v_mfma_f32_16x16x32_bf16 v[24:27], v[80:83], v[216:219], v[24:27]
    ds_read_b128 v[68:71], v9 offset:17664
    buffer_store_dwordx4 v[100:103], v3, s[12:15], s54 offen offset:1024 sc1
    v_mfma_f32_16x16x32_bf16 v[20:23], v[84:87], v[152:155], v[20:23]
    buffer_load_dwordx4 v3, s[36:39], s41 offen offset:0  lds
    v_mfma_f32_16x16x32_bf16 v[28:31], v[84:87], v[216:219], v[28:31]
    s_add_u32 m0, s46, 32
    v_mfma_f32_16x16x32_bf16 v[16:19], v[88:91], v[156:159], v[16:19]
    ds_read_b128 v[72:75], v9 offset:832
    s_add_u32 s54, s55, s51
    v_mfma_f32_16x16x32_bf16 v[24:27], v[88:91], v[220:223], v[24:27]
    ds_read_b128 v[76:79], v9 offset:17728
    s_add_u32 s51, s51, 4096
    v_mfma_f32_16x16x32_bf16 v[20:23], v[92:95], v[156:159], v[20:23]
    buffer_load_dwordx4 v3, s[36:39], s41 offen offset:1024  lds
    v_mfma_f32_16x16x32_bf16 v[28:31], v[92:95], v[220:223], v[28:31]
    s_add_u32 m0, s46, 64
    s_waitcnt lgkmcnt(8)
    v_mfma_f32_16x16x32_bf16 v[16:19], v[32:35], v[160:163], v[16:19]
    ds_read_b128 v[80:83], v9 offset:896
    s_and_b32 s51, s51, 0xffff
    v_mfma_f32_16x16x32_bf16 v[24:27], v[32:35], v[224:227], v[24:27]
    ds_read_b128 v[84:87], v9 offset:17792
    v_mfma_f32_16x16x32_bf16 v[20:23], v[36:39], v[160:163], v[20:23]
    buffer_load_dwordx4 v3, s[36:39], s41 offen offset:2048  lds
    v_mfma_f32_16x16x32_bf16 v[28:31], v[36:39], v[224:227], v[28:31]
    s_add_u32 m0, s46, 96
    v_mfma_f32_16x16x32_bf16 v[16:19], v[40:43], v[164:167], v[16:19]
    ds_read_b128 v[88:91], v9 offset:960
    v_mfma_f32_16x16x32_bf16 v[24:27], v[40:43], v[228:231], v[24:27]
    ds_read_b128 v[92:95], v9 offset:17856
    v_mfma_f32_16x16x32_bf16 v[20:23], v[44:47], v[164:167], v[20:23]
    buffer_load_dwordx4 v3, s[36:39], s41 offen offset:3072  lds
    v_mfma_f32_16x16x32_bf16 v[28:31], v[44:47], v[228:231], v[28:31]
    s_add_u32 s41, s41, 28672
    s_waitcnt lgkmcnt(8)
    s_add_u32 s48, s48, 33792
    s_cmp_eq_u32 s48, 135168
    s_cselect_b32 s48, 0, s48
    v_add_u32 v9, s48, v4
    v_mfma_f32_16x16x32_bf16 v[16:19], v[48:51], v[168:171], v[16:19]
    ds_read_b128 v[32:35], v9 offset:0
    v_mfma_f32_16x16x32_bf16 v[24:27], v[48:51], v[232:235], v[24:27]
    ds_read_b128 v[36:39], v9 offset:16896
    v_mfma_f32_16x16x32_bf16 v[20:23], v[52:55], v[168:171], v[20:23]
    s_and_b32 s41, s41, 0x7ffff
    v_mfma_f32_16x16x32_bf16 v[28:31], v[52:55], v[232:235], v[28:31]
    s_add_u32 s42, s42, 33792
    v_mfma_f32_16x16x32_bf16 v[16:19], v[56:59], v[172:175], v[16:19]
    ds_read_b128 v[40:43], v9 offset:64
    v_mfma_f32_16x16x32_bf16 v[24:27], v[56:59], v[236:239], v[24:27]
    ds_read_b128 v[44:47], v9 offset:16960
    v_mfma_f32_16x16x32_bf16 v[20:23], v[60:63], v[172:175], v[20:23]
    s_cmp_eq_u32 s42, 135168
    v_mfma_f32_16x16x32_bf16 v[28:31], v[60:63], v[236:239], v[28:31]
    s_cselect_b32 s42, 0, s42
    s_waitcnt lgkmcnt(8)
    v_mfma_f32_16x16x32_bf16 v[16:19], v[64:67], v[176:179], v[16:19]
    ds_read_b128 v[48:51], v9 offset:128
    v_mfma_f32_16x16x32_bf16 v[24:27], v[64:67], v[240:243], v[24:27]
    ds_read_b128 v[52:55], v9 offset:17024
    v_mfma_f32_16x16x32_bf16 v[20:23], v[68:71], v[176:179], v[20:23]
    v_mfma_f32_16x16x32_bf16 v[28:31], v[68:71], v[240:243], v[28:31]
    v_mfma_f32_16x16x32_bf16 v[16:19], v[72:75], v[180:183], v[16:19]
    ds_read_b128 v[56:59], v9 offset:192
    v_mfma_f32_16x16x32_bf16 v[24:27], v[72:75], v[244:247], v[24:27]
    ds_read_b128 v[60:63], v9 offset:17088
    v_mfma_f32_16x16x32_bf16 v[20:23], v[76:79], v[180:183], v[20:23]
    v_mfma_f32_16x16x32_bf16 v[28:31], v[76:79], v[244:247], v[28:31]
    s_waitcnt lgkmcnt(8)
    v_mfma_f32_16x16x32_bf16 v[16:19], v[80:83], v[184:187], v[16:19]
    ds_read_b128 v[64:67], v9 offset:256
    v_mfma_f32_16x16x32_bf16 v[24:27], v[80:83], v[248:251], v[24:27]
    ds_read_b128 v[68:71], v9 offset:17152
    v_mfma_f32_16x16x32_bf16 v[20:23], v[84:87], v[184:187], v[20:23]
    v_mfma_f32_16x16x32_bf16 v[28:31], v[84:87], v[248:251], v[28:31]
    v_mfma_f32_16x16x32_bf16 v[16:19], v[88:91], v[188:191], v[16:19]
    ds_read_b128 v[72:75], v9 offset:320
    v_mfma_f32_16x16x32_bf16 v[24:27], v[88:91], v[252:255], v[24:27]
    ds_read_b128 v[76:79], v9 offset:17216
    v_mfma_f32_16x16x32_bf16 v[20:23], v[92:95], v[188:191], v[20:23]
    v_mfma_f32_16x16x32_bf16 v[28:31], v[92:95], v[252:255], v[28:31]
    s_waitcnt vmcnt(10)
    s_barrier
    s_cmp_eq_u32 s53, 6
    s_cselect_b32 s36, s28, s36
    s_cselect_b32 s37, s29, s37
    s_cselect_b32 s41, s45, s41
    s_waitcnt lgkmcnt(8)
    v_mfma_f32_16x16x32_bf16 v[104:107], v[32:35], v[128:131], 0
    ds_read_b128 v[80:83], v9 offset:384
    v_mfma_f32_16x16x32_bf16 v[112:115], v[32:35], v[192:195], 0
    ds_read_b128 v[84:87], v9 offset:17280
    v_mfma_f32_16x16x32_bf16 v[108:111], v[36:39], v[128:131], 0
    s_add_u32 s46, s42, s43
    v_mfma_f32_16x16x32_bf16 v[116:119], v[36:39], v[192:195], 0
    s_add_u32 m0, s46, 0
    v_mfma_f32_16x16x32_bf16 v[104:107], v[40:43], v[132:135], v[104:107]
    ds_read_b128 v[88:91], v9 offset:448
    v_mfma_f32_16x16x32_bf16 v[112:115], v[40:43], v[196:199], v[112:115]
    ds_read_b128 v[92:95], v9 offset:17344
    v_mfma_f32_16x16x32_bf16 v[108:111], v[44:47], v[132:135], v[108:111]
    buffer_load_dwordx4 v3, s[36:39], s41 offen offset:0  lds
    v_mfma_f32_16x16x32_bf16 v[116:119], v[44:47], v[196:199], v[116:119]
    s_add_u32 m0, s46, 32
    s_waitcnt lgkmcnt(8)
    v_mfma_f32_16x16x32_bf16 v[104:107], v[48:51], v[136:139], v[104:107]
    ds_read_b128 v[32:35], v9 offset:512
    v_cvt_pk_bf16_f32 v96, v16, v17
    v_mfma_f32_16x16x32_bf16 v[112:115], v[48:51], v[200:203], v[112:115]
    ds_read_b128 v[36:39], v9 offset:17408
    v_cvt_pk_bf16_f32 v97, v18, v19
    v_mfma_f32_16x16x32_bf16 v[108:111], v[52:55], v[136:139], v[108:111]
    buffer_load_dwordx4 v3, s[36:39], s41 offen offset:1024  lds
    v_mfma_f32_16x16x32_bf16 v[116:119], v[52:55], v[200:203], v[116:119]
    s_add_u32 m0, s46, 64
    v_mfma_f32_16x16x32_bf16 v[104:107], v[56:59], v[140:143], v[104:107]
    ds_read_b128 v[40:43], v9 offset:576
    v_cvt_pk_bf16_f32 v98, v20, v21
    v_mfma_f32_16x16x32_bf16 v[112:115], v[56:59], v[204:207], v[112:115]
    ds_read_b128 v[44:47], v9 offset:17472
    v_cvt_pk_bf16_f32 v99, v22, v23
    v_mfma_f32_16x16x32_bf16 v[108:111], v[60:63], v[140:143], v[108:111]
    buffer_load_dwordx4 v3, s[36:39], s41 offen offset:2048  lds
    v_mfma_f32_16x16x32_bf16 v[116:119], v[60:63], v[204:207], v[116:119]
    s_add_u32 m0, s46, 96
    s_waitcnt lgkmcnt(8)
    v_mfma_f32_16x16x32_bf16 v[104:107], v[64:67], v[144:147], v[104:107]
    ds_read_b128 v[48:51], v9 offset:640
    buffer_store_dwordx4 v[96:99], v3, s[12:15], s54 offen offset:0 sc1
    v_mfma_f32_16x16x32_bf16 v[112:115], v[64:67], v[208:211], v[112:115]
    ds_read_b128 v[52:55], v9 offset:17536
    v_cvt_pk_bf16_f32 v100, v24, v25
    v_mfma_f32_16x16x32_bf16 v[108:111], v[68:71], v[144:147], v[108:111]
    buffer_load_dwordx4 v3, s[36:39], s41 offen offset:3072  lds
    v_mfma_f32_16x16x32_bf16 v[116:119], v[68:71], v[208:211], v[116:119]
    s_add_u32 s41, s41, 4096
    v_mfma_f32_16x16x32_bf16 v[104:107], v[72:75], v[148:151], v[104:107]
    ds_read_b128 v[56:59], v9 offset:704
    v_cvt_pk_bf16_f32 v101, v26, v27
    v_mfma_f32_16x16x32_bf16 v[112:115], v[72:75], v[212:215], v[112:115]
    ds_read_b128 v[60:63], v9 offset:17600
    v_cvt_pk_bf16_f32 v102, v28, v29
    v_mfma_f32_16x16x32_bf16 v[108:111], v[76:79], v[148:151], v[108:111]
    s_add_u32 s46, s46, s44
    v_mfma_f32_16x16x32_bf16 v[116:119], v[76:79], v[212:215], v[116:119]
    s_add_u32 m0, s46, 0
    s_waitcnt lgkmcnt(8)
    v_mfma_f32_16x16x32_bf16 v[104:107], v[80:83], v[152:155], v[104:107]
    ds_read_b128 v[64:67], v9 offset:768
    v_cvt_pk_bf16_f32 v103, v30, v31
    v_mfma_f32_16x16x32_bf16 v[112:115], v[80:83], v[216:219], v[112:115]
    ds_read_b128 v[68:71], v9 offset:17664
    buffer_store_dwordx4 v[100:103], v3, s[12:15], s54 offen offset:1024 sc1
    v_mfma_f32_16x16x32_bf16 v[108:111], v[84:87], v[152:155], v[108:111]
    buffer_load_dwordx4 v3, s[36:39], s41 offen offset:0  lds
    v_mfma_f32_16x16x32_bf16 v[116:119], v[84:87], v[216:219], v[116:119]
    s_add_u32 m0, s46, 32
    v_mfma_f32_16x16x32_bf16 v[104:107], v[88:91], v[156:159], v[104:107]
    ds_read_b128 v[72:75], v9 offset:832
    s_add_u32 s54, s55, s51
    v_mfma_f32_16x16x32_bf16 v[112:115], v[88:91], v[220:223], v[112:115]
    ds_read_b128 v[76:79], v9 offset:17728
    s_add_u32 s51, s51, 4096
    v_mfma_f32_16x16x32_bf16 v[108:111], v[92:95], v[156:159], v[108:111]
    buffer_load_dwordx4 v3, s[36:39], s41 offen offset:1024  lds
    v_mfma_f32_16x16x32_bf16 v[116:119], v[92:95], v[220:223], v[116:119]
    s_add_u32 m0, s46, 64
    s_waitcnt lgkmcnt(8)
    v_mfma_f32_16x16x32_bf16 v[104:107], v[32:35], v[160:163], v[104:107]
    ds_read_b128 v[80:83], v9 offset:896
    s_and_b32 s51, s51, 0xffff
    v_mfma_f32_16x16x32_bf16 v[112:115], v[32:35], v[224:227], v[112:115]
    ds_read_b128 v[84:87], v9 offset:17792
    v_mfma_f32_16x16x32_bf16 v[108:111], v[36:39], v[160:163], v[108:111]
    buffer_load_dwordx4 v3, s[36:39], s41 offen offset:2048  lds
    v_mfma_f32_16x16x32_bf16 v[116:119], v[36:39], v[224:227], v[116:119]
    s_add_u32 m0, s46, 96
    v_mfma_f32_16x16x32_bf16 v[104:107], v[40:43], v[164:167], v[104:107]
    ds_read_b128 v[88:91], v9 offset:960
    v_mfma_f32_16x16x32_bf16 v[112:115], v[40:43], v[228:231], v[112:115]
    ds_read_b128 v[92:95], v9 offset:17856
    v_mfma_f32_16x16x32_bf16 v[108:111], v[44:47], v[164:167], v[108:111]
    buffer_load_dwordx4 v3, s[36:39], s41 offen offset:3072  lds
    v_mfma_f32_16x16x32_bf16 v[116:119], v[44:47], v[228:231], v[116:119]
    s_add_u32 s41, s41, 28672
    s_waitcnt lgkmcnt(8)
    s_add_u32 s48, s48, 33792
    s_cmp_eq_u32 s48, 135168
    s_cselect_b32 s48, 0, s48
    v_add_u32 v9, s48, v4
    v_mfma_f32_16x16x32_bf16 v[104:107], v[48:51], v[168:171], v[104:107]
    ds_read_b128 v[32:35], v9 offset:0
    v_mfma_f32_16x16x32_bf16 v[112:115], v[48:51], v[232:235], v[112:115]
    ds_read_b128 v[36:39], v9 offset:16896
    v_mfma_f32_16x16x32_bf16 v[108:111], v[52:55], v[168:171], v[108:111]
    s_and_b32 s41, s41, 0x7ffff
    v_mfma_f32_16x16x32_bf16 v[116:119], v[52:55], v[232:235], v[116:119]
    s_add_u32 s42, s42, 33792
    v_mfma_f32_16x16x32_bf16 v[104:107], v[56:59], v[172:175], v[104:107]
    ds_read_b128 v[40:43], v9 offset:64
    v_mfma_f32_16x16x32_bf16 v[112:115], v[56:59], v[236:239], v[112:115]
    ds_read_b128 v[44:47], v9 offset:16960
    v_mfma_f32_16x16x32_bf16 v[108:111], v[60:63], v[172:175], v[108:111]
    s_cmp_eq_u32 s42, 135168
    v_mfma_f32_16x16x32_bf16 v[116:119], v[60:63], v[236:239], v[116:119]
    s_cselect_b32 s42, 0, s42
    s_waitcnt lgkmcnt(8)
    v_mfma_f32_16x16x32_bf16 v[104:107], v[64:67], v[176:179], v[104:107]
    ds_read_b128 v[48:51], v9 offset:128
    v_mfma_f32_16x16x32_bf16 v[112:115], v[64:67], v[240:243], v[112:115]
    ds_read_b128 v[52:55], v9 offset:17024
    v_mfma_f32_16x16x32_bf16 v[108:111], v[68:71], v[176:179], v[108:111]
    v_mfma_f32_16x16x32_bf16 v[116:119], v[68:71], v[240:243], v[116:119]
    v_mfma_f32_16x16x32_bf16 v[104:107], v[72:75], v[180:183], v[104:107]
    ds_read_b128 v[56:59], v9 offset:192
    v_mfma_f32_16x16x32_bf16 v[112:115], v[72:75], v[244:247], v[112:115]
    ds_read_b128 v[60:63], v9 offset:17088
    v_mfma_f32_16x16x32_bf16 v[108:111], v[76:79], v[180:183], v[108:111]
    v_mfma_f32_16x16x32_bf16 v[116:119], v[76:79], v[244:247], v[116:119]
    s_waitcnt lgkmcnt(8)
    v_mfma_f32_16x16x32_bf16 v[104:107], v[80:83], v[184:187], v[104:107]
    ds_read_b128 v[64:67], v9 offset:256
    v_mfma_f32_16x16x32_bf16 v[112:115], v[80:83], v[248:251], v[112:115]
    ds_read_b128 v[68:71], v9 offset:17152
    v_mfma_f32_16x16x32_bf16 v[108:111], v[84:87], v[184:187], v[108:111]
    v_mfma_f32_16x16x32_bf16 v[116:119], v[84:87], v[248:251], v[116:119]
    v_mfma_f32_16x16x32_bf16 v[104:107], v[88:91], v[188:191], v[104:107]
    ds_read_b128 v[72:75], v9 offset:320
    v_mfma_f32_16x16x32_bf16 v[112:115], v[88:91], v[252:255], v[112:115]
    ds_read_b128 v[76:79], v9 offset:17216
    v_mfma_f32_16x16x32_bf16 v[108:111], v[92:95], v[188:191], v[108:111]
    v_mfma_f32_16x16x32_bf16 v[116:119], v[92:95], v[252:255], v[116:119]
    s_add_u32 s53, s53, 1
    s_cmp_lt_u32 s53, 8
    s_cbranch_scc1 L_auxl0
    s_nop 7
    v_cvt_pk_bf16_f32 v96, v104, v105
    v_cvt_pk_bf16_f32 v97, v106, v107
    v_cvt_pk_bf16_f32 v98, v108, v109
    v_cvt_pk_bf16_f32 v99, v110, v111
    buffer_store_dwordx4 v[96:99], v3, s[12:15], s54 offen offset:0 sc1
    v_cvt_pk_bf16_f32 v100, v112, v113
    v_cvt_pk_bf16_f32 v101, v114, v115
    v_cvt_pk_bf16_f32 v102, v116, v117
    v_cvt_pk_bf16_f32 v103, v118, v119
    buffer_store_dwordx4 v[100:103], v3, s[12:15], s54 offen offset:1024 sc1
    s_add_u32 s54, s55, s51
    s_add_u32 s51, s51, 4096
    s_and_b32 s51, s51, 0xffff
    s_add_u32 s55, s49, 63963136
    s_lshl_b32 s51, s20, 14
    s_add_u32 s54, s49, 63438848
    s_waitcnt vmcnt(0)
    s_add_u32 s50, s49, 62914560
    buffer_load_dwordx4 v[128:131], v3, s[12:15], s50 offen offset:0 sc1
    buffer_load_dwordx4 v[192:195], v3, s[12:15], s50 offen offset:1024 sc1
    s_add_u32 s50, s49, 62918656
    buffer_load_dwordx4 v[132:135], v3, s[12:15], s50 offen offset:0 sc1
    buffer_load_dwordx4 v[196:199], v3, s[12:15], s50 offen offset:1024 sc1
    s_add_u32 s50, s49, 62922752
    buffer_load_dwordx4 v[136:139], v3, s[12:15], s50 offen offset:0 sc1
    buffer_load_dwordx4 v[200:203], v3, s[12:15], s50 offen offset:1024 sc1
    s_add_u32 s50, s49, 62926848
    buffer_load_dwordx4 v[140:143], v3, s[12:15], s50 offen offset:0 sc1
    buffer_load_dwordx4 v[204:207], v3, s[12:15], s50 offen offset:1024 sc1
    s_add_u32 s50, s49, 62930944
    buffer_load_dwordx4 v[144:147], v3, s[12:15], s50 offen offset:0 sc1
    buffer_load_dwordx4 v[208:211], v3, s[12:15], s50 offen offset:1024 sc1
    s_add_u32 s50, s49, 62935040
    buffer_load_dwordx4 v[148:151], v3, s[12:15], s50 offen offset:0 sc1
    buffer_load_dwordx4 v[212:215], v3, s[12:15], s50 offen offset:1024 sc1
    s_add_u32 s50, s49, 62939136
    buffer_load_dwordx4 v[152:155], v3, s[12:15], s50 offen offset:0 sc1
    buffer_load_dwordx4 v[216:219], v3, s[12:15], s50 offen offset:1024 sc1
    s_add_u32 s50, s49, 62943232
    buffer_load_dwordx4 v[156:159], v3, s[12:15], s50 offen offset:0 sc1
    buffer_load_dwordx4 v[220:223], v3, s[12:15], s50 offen offset:1024 sc1
    s_add_u32 s50, s49, 62947328
    buffer_load_dwordx4 v[160:163], v3, s[12:15], s50 offen offset:0 sc1
    buffer_load_dwordx4 v[224:227], v3, s[12:15], s50 offen offset:1024 sc1
    s_add_u32 s50, s49, 62951424
    buffer_load_dwordx4 v[164:167], v3, s[12:15], s50 offen offset:0 sc1
    buffer_load_dwordx4 v[228:231], v3, s[12:15], s50 offen offset:1024 sc1
    s_add_u32 s50, s49, 62955520
    buffer_load_dwordx4 v[168:171], v3, s[12:15], s50 offen offset:0 sc1
    buffer_load_dwordx4 v[232:235], v3, s[12:15], s50 offen offset:1024 sc1
    s_add_u32 s50, s49, 62959616
    buffer_load_dwordx4 v[172:175], v3, s[12:15], s50 offen offset:0 sc1
    buffer_load_dwordx4 v[236:239], v3, s[12:15], s50 offen offset:1024 sc1
    s_add_u32 s50, s49, 62963712
    buffer_load_dwordx4 v[176:179], v3, s[12:15], s50 offen offset:0 sc1
    buffer_load_dwordx4 v[240:243], v3, s[12:15], s50 offen offset:1024 sc1
    s_add_u32 s50, s49, 62967808
    buffer_load_dwordx4 v[180:183], v3, s[12:15], s50 offen offset:0 sc1
    buffer_load_dwordx4 v[244:247], v3, s[12:15], s50 offen offset:1024 sc1
    s_add_u32 s50, s49, 62971904
    buffer_load_dwordx4 v[184:187], v3, s[12:15], s50 offen offset:0 sc1
    buffer_load_dwordx4 v[248:251], v3, s[12:15], s50 offen offset:1024 sc1
    s_add_u32 s50, s49, 62976000
    buffer_load_dwordx4 v[188:191], v3, s[12:15], s50 offen offset:0 sc1
    buffer_load_dwordx4 v[252:255], v3, s[12:15], s50 offen offset:1024 sc1
    s_mov_b32 s53, 0
L_auxl1:
    s_waitcnt vmcnt(10)
    s_barrier
    s_waitcnt lgkmcnt(8)
    v_mfma_f32_16x16x32_bf16 v[16:19], v[32:35], a[0:3], 0
    ds_read_b128 v[80:83], v9 offset:384
    v_mfma_f32_16x16x32_bf16 v[24:27], v[32:35], a[64:67], 0
    ds_read_b128 v[84:87], v9 offset:17280
    v_mfma_f32_16x16x32_bf16 v[20:23], v[36:39], a[0:3], 0
    s_add_u32 s46, s42, s43
    v_mfma_f32_16x16x32_bf16 v[28:31], v[36:39], a[64:67], 0
    s_add_u32 m0, s46, 0
    v_mfma_f32_16x16x32_bf16 v[16:19], v[40:43], a[4:7], v[16:19]
    ds_read_b128 v[88:91], v9 offset:448
    v_mfma_f32_16x16x32_bf16 v[24:27], v[40:43], a[68:71], v[24:27]
    ds_read_b128 v[92:95], v9 offset:17344
    v_mfma_f32_16x16x32_bf16 v[20:23], v[44:47], a[4:7], v[20:23]
    buffer_load_dwordx4 v3, s[36:39], s41 offen offset:0  lds
    v_mfma_f32_16x16x32_bf16 v[28:31], v[44:47], a[68:71], v[28:31]
    s_add_u32 m0, s46, 32
    s_waitcnt lgkmcnt(8)
    v_mfma_f32_16x16x32_bf16 v[16:19], v[48:51], a[8:11], v[16:19]
    ds_read_b128 v[32:35], v9 offset:512
    v_cvt_pk_bf16_f32 v96, v104, v105
    v_mfma_f32_16x16x32_bf16 v[24:27], v[48:51], a[72:75], v[24:27]
    ds_read_b128 v[36:39], v9 offset:17408
    v_cvt_pk_bf16_f32 v97, v106, v107
    v_mfma_f32_16x16x32_bf16 v[20:23], v[52:55], a[8:11], v[20:23]
    buffer_load_dwordx4 v3, s[36:39], s41 offen offset:1024  lds
    v_mfma_f32_16x16x32_bf16 v[28:31], v[52:55], a[72:75], v[28:31]
    s_add_u32 m0, s46, 64
    v_mfma_f32_16x16x32_bf16 v[16:19], v[56:59], a[12:15], v[16:19]
    ds_read_b128 v[40:43], v9 offset:576
    v_cvt_pk_bf16_f32 v98, v108, v109
    v_mfma_f32_16x16x32_bf16 v[24:27], v[56:59], a[76:79], v[24:27]
    ds_read_b128 v[44:47], v9 offset:17472
    v_cvt_pk_bf16_f32 v99, v110, v111
    v_mfma_f32_16x16x32_bf16 v[20:23], v[60:63], a[12:15], v[20:23]
    buffer_load_dwordx4 v3, s[36:39], s41 offen offset:2048  lds
    v_mfma_f32_16x16x32_bf16 v[28:31], v[60:63], a[76:79], v[28:31]
    s_add_u32 m0, s46, 96
    s_waitcnt lgkmcnt(8)
    v_mfma_f32_16x16x32_bf16 v[16:19], v[64:67], a[16:19], v[16:19]
    ds_read_b128 v[48:51], v9 offset:640
    buffer_store_dwordx4 v[96:99], v3, s[12:15], s54 offen offset:0 sc1
    v_mfma_f32_16x16x32_bf16 v[24:27], v[64:67], a[80:83], v[24:27]
    ds_read_b128 v[52:55], v9 offset:17536
    v_cvt_pk_bf16_f32 v100, v112, v113
    v_mfma_f32_16x16x32_bf16 v[20:23], v[68:71], a[16:19], v[20:23]
    buffer_load_dwordx4 v3, s[36:39], s41 offen offset:3072  lds
    v_mfma_f32_16x16x32_bf16 v[28:31], v[68:71], a[80:83], v[28:31]
    s_add_u32 s41, s41, 4096
    v_mfma_f32_16x16x32_bf16 v[16:19], v[72:75], a[20:23], v[16:19]
    ds_read_b128 v[56:59], v9 offset:704
    v_cvt_pk_bf16_f32 v101, v114, v115
    v_mfma_f32_16x16x32_bf16 v[24:27], v[72:75], a[84:87], v[24:27]
    ds_read_b128 v[60:63], v9 offset:17600
    v_cvt_pk_bf16_f32 v102, v116, v117
    v_mfma_f32_16x16x32_bf16 v[20:23], v[76:79], a[20:23], v[20:23]
    s_add_u32 s46, s46, s44
    v_mfma_f32_16x16x32_bf16 v[28:31], v[76:79], a[84:87], v[28:31]
    s_add_u32 m0, s46, 0
    s_waitcnt lgkmcnt(8)
    v_mfma_f32_16x16x32_bf16 v[16:19], v[80:83], a[24:27], v[16:19]
    ds_read_b128 v[64:67], v9 offset:768
    v_cvt_pk_bf16_f32 v103, v118, v119
    v_mfma_f32_16x16x32_bf16 v[24:27], v[80:83], a[88:91], v[24:27]
    ds_read_b128 v[68:71], v9 offset:17664
    buffer_store_dwordx4 v[100:103], v3, s[12:15], s54 offen offset:1024 sc1
    v_mfma_f32_16x16x32_bf16 v[20:23], v[84:87], a[24:27], v[20:23]
    buffer_load_dwordx4 v3, s[36:39], s41 offen offset:0  lds
    v_mfma_f32_16x16x32_bf16 v[28:31], v[84:87], a[88:91], v[28:31]
    s_add_u32 m0, s46, 32
    v_mfma_f32_16x16x32_bf16 v[16:19], v[88:91], a[28:31], v[16:19]
    ds_read_b128 v[72:75], v9 offset:832
    s_add_u32 s54, s55, s51
    v_mfma_f32_16x16x32_bf16 v[24:27], v[88:91], a[92:95], v[24:27]
    ds_read_b128 v[76:79], v9 offset:17728
    s_add_u32 s51, s51, 4096
    v_mfma_f32_16x16x32_bf16 v[20:23], v[92:95], a[28:31], v[20:23]
    buffer_load_dwordx4 v3, s[36:39], s41 offen offset:1024  lds
    v_mfma_f32_16x16x32_bf16 v[28:31], v[92:95], a[92:95], v[28:31]
    s_add_u32 m0, s46, 64
    s_waitcnt lgkmcnt(8)
    v_mfma_f32_16x16x32_bf16 v[16:19], v[32:35], a[32:35], v[16:19]
    ds_read_b128 v[80:83], v9 offset:896
    s_and_b32 s51, s51, 0xffff
    v_mfma_f32_16x16x32_bf16 v[24:27], v[32:35], a[96:99], v[24:27]
    ds_read_b128 v[84:87], v9 offset:17792
    v_mfma_f32_16x16x32_bf16 v[20:23], v[36:39], a[32:35], v[20:23]
    buffer_load_dwordx4 v3, s[36:39], s41 offen offset:2048  lds
    v_mfma_f32_16x16x32_bf16 v[28:31], v[36:39], a[96:99], v[28:31]
    s_add_u32 m0, s46, 96
    v_mfma_f32_16x16x32_bf16 v[16:19], v[40:43], a[36:39], v[16:19]
    ds_read_b128 v[88:91], v9 offset:960
    v_mfma_f32_16x16x32_bf16 v[24:27], v[40:43], a[100:103], v[24:27]
    ds_read_b128 v[92:95], v9 offset:17856
    v_mfma_f32_16x16x32_bf16 v[20:23], v[44:47], a[36:39], v[20:23]
    buffer_load_dwordx4 v3, s[36:39], s41 offen offset:3072  lds
    v_mfma_f32_16x16x32_bf16 v[28:31], v[44:47], a[100:103], v[28:31]
    s_add_u32 s41, s41, 28672
    s_waitcnt lgkmcnt(8)
    s_add_u32 s48, s48, 33792
    s_cmp_eq_u32 s48, 135168
    s_cselect_b32 s48, 0, s48
    v_add_u32 v9, s48, v4
    v_mfma_f32_16x16x32_bf16 v[16:19], v[48:51], a[40:43], v[16:19]
    ds_read_b128 v[32:35], v9 offset:0
    v_mfma_f32_16x16x32_bf16 v[24:27], v[48:51], a[104:107], v[24:27]
    ds_read_b128 v[36:39], v9 offset:16896
    v_mfma_f32_16x16x32_bf16 v[20:23], v[52:55], a[40:43], v[20:23]
    s_and_b32 s41, s41, 0x7ffff
    v_mfma_f32_16x16x32_bf16 v[28:31], v[52:55], a[104:107], v[28:31]
    s_add_u32 s42, s42, 33792
    v_mfma_f32_16x16x32_bf16 v[16:19], v[56:59], a[44:47], v[16:19]
    ds_read_b128 v[40:43], v9 offset:64
    v_mfma_f32_16x16x32_bf16 v[24:27], v[56:59], a[108:111], v[24:27]
    ds_read_b128 v[44:47], v9 offset:16960
    v_mfma_f32_16x16x32_bf16 v[20:23], v[60:63], a[44:47], v[20:23]
    s_cmp_eq_u32 s42, 135168
    v_mfma_f32_16x16x32_bf16 v[28:31], v[60:63], a[108:111], v[28:31]
    s_cselect_b32 s42, 0, s42
    s_waitcnt lgkmcnt(8)
    v_mfma_f32_16x16x32_bf16 v[16:19], v[64:67], a[48:51], v[16:19]
    ds_read_b128 v[48:51], v9 offset:128
    v_mfma_f32_16x16x32_bf16 v[24:27], v[64:67], a[112:115], v[24:27]
    ds_read_b128 v[52:55], v9 offset:17024
    v_mfma_f32_16x16x32_bf16 v[20:23], v[68:71], a[48:51], v[20:23]
    v_mfma_f32_16x16x32_bf16 v[28:31], v[68:71], a[112:115], v[28:31]
    v_mfma_f32_16x16x32_bf16 v[16:19], v[72:75], a[52:55], v[16:19]
    ds_read_b128 v[56:59], v9 offset:192
    v_mfma_f32_16x16x32_bf16 v[24:27], v[72:75], a[116:119], v[24:27]
    ds_read_b128 v[60:63], v9 offset:17088
    v_mfma_f32_16x16x32_bf16 v[20:23], v[76:79], a[52:55], v[20:23]
    v_mfma_f32_16x16x32_bf16 v[28:31], v[76:79], a[116:119], v[28:31]
    s_waitcnt lgkmcnt(8)
    v_mfma_f32_16x16x32_bf16 v[16:19], v[80:83], a[56:59], v[16:19]
    ds_read_b128 v[64:67], v9 offset:256
    v_mfma_f32_16x16x32_bf16 v[24:27], v[80:83], a[120:123], v[24:27]
    ds_read_b128 v[68:71], v9 offset:17152
    v_mfma_f32_16x16x32_bf16 v[20:23], v[84:87], a[56:59], v[20:23]
    v_mfma_f32_16x16x32_bf16 v[28:31], v[84:87], a[120:123], v[28:31]
    v_mfma_f32_16x16x32_bf16 v[16:19], v[88:91], a[60:63], v[16:19]
    ds_read_b128 v[72:75], v9 offset:320
    v_mfma_f32_16x16x32_bf16 v[24:27], v[88:91], a[124:127], v[24:27]
    ds_read_b128 v[76:79], v9 offset:17216
    v_mfma_f32_16x16x32_bf16 v[20:23], v[92:95], a[60:63], v[20:23]
    v_mfma_f32_16x16x32_bf16 v[28:31], v[92:95], a[124:127], v[28:31]
    s_waitcnt vmcnt(10)
    s_barrier
    s_cmp_eq_u32 s53, 6
    s_cselect_b32 s36, s24, s36
    s_cselect_b32 s37, s25, s37
    s_cselect_b32 s41, s45, s41
    s_cselect_b32 s43, s52, s43
    s_cselect_b32 s44, 4224, s44
    s_waitcnt lgkmcnt(8)
    v_mfma_f32_16x16x32_bf16 v[104:107], v[32:35], a[0:3], 0
    ds_read_b128 v[80:83], v9 offset:384
    v_mfma_f32_16x16x32_bf16 v[112:115], v[32:35], a[64:67], 0
    ds_read_b128 v[84:87], v9 offset:17280
    v_mfma_f32_16x16x32_bf16 v[108:111], v[36:39], a[0:3], 0
    s_add_u32 s46, s42, s43
    v_mfma_f32_16x16x32_bf16 v[116:119], v[36:39], a[64:67], 0
    s_add_u32 m0, s46, 0
    v_mfma_f32_16x16x32_bf16 v[104:107], v[40:43], a[4:7], v[104:107]
    ds_read_b128 v[88:91], v9 offset:448
    v_mfma_f32_16x16x32_bf16 v[112:115], v[40:43], a[68:71], v[112:115]
    ds_read_b128 v[92:95], v9 offset:17344
    v_mfma_f32_16x16x32_bf16 v[108:111], v[44:47], a[4:7], v[108:111]
    buffer_load_dwordx4 v3, s[36:39], s41 offen offset:0  lds
    v_mfma_f32_16x16x32_bf16 v[116:119], v[44:47], a[68:71], v[116:119]
    s_add_u32 m0, s46, 32
    s_waitcnt lgkmcnt(8)
    v_mfma_f32_16x16x32_bf16 v[104:107], v[48:51], a[8:11], v[104:107]
    ds_read_b128 v[32:35], v9 offset:512
    v_cvt_pk_bf16_f32 v96, v16, v17
    v_mfma_f32_16x16x32_bf16 v[112:115], v[48:51], a[72:75], v[112:115]
    ds_read_b128 v[36:39], v9 offset:17408
    v_cvt_pk_bf16_f32 v97, v18, v19
    v_mfma_f32_16x16x32_bf16 v[108:111], v[52:55], a[8:11], v[108:111]
    buffer_load_dwordx4 v3, s[36:39], s41 offen offset:1024  lds
    v_mfma_f32_16x16x32_bf16 v[116:119], v[52:55], a[72:75], v[116:119]
    s_add_u32 m0, s46, 64
    v_mfma_f32_16x16x32_bf16 v[104:107], v[56:59], a[12:15], v[104:107]
    ds_read_b128 v[40:43], v9 offset:576
    v_cvt_pk_bf16_f32 v98, v20, v21
    v_mfma_f32_16x16x32_bf16 v[112:115], v[56:59], a[76:79], v[112:115]
    ds_read_b128 v[44:47], v9 offset:17472
    v_cvt_pk_bf16_f32 v99, v22, v23
    v_mfma_f32_16x16x32_bf16 v[108:111], v[60:63], a[12:15], v[108:111]
    buffer_load_dwordx4 v3, s[36:39], s41 offen offset:2048  lds
    v_mfma_f32_16x16x32_bf16 v[116:119], v[60:63], a[76:79], v[116:119]
    s_add_u32 m0, s46, 96
    s_waitcnt lgkmcnt(8)
    v_mfma_f32_16x16x32_bf16 v[104:107], v[64:67], a[16:19], v[104:107]
    ds_read_b128 v[48:51], v9 offset:640
    buffer_store_dwordx4 v[96:99], v3, s[12:15], s54 offen offset:0 sc1
    v_mfma_f32_16x16x32_bf16 v[112:115], v[64:67], a[80:83], v[112:115]
    ds_read_b128 v[52:55], v9 offset:17536
    v_cvt_pk_bf16_f32 v100, v24, v25
    v_mfma_f32_16x16x32_bf16 v[108:111], v[68:71], a[16:19], v[108:111]
    buffer_load_dwordx4 v3, s[36:39], s41 offen offset:3072  lds
    v_mfma_f32_16x16x32_bf16 v[116:119], v[68:71], a[80:83], v[116:119]
    s_add_u32 s41, s41, 4096
    v_mfma_f32_16x16x32_bf16 v[104:107], v[72:75], a[20:23], v[104:107]
    ds_read_b128 v[56:59], v9 offset:704
    v_cvt_pk_bf16_f32 v101, v26, v27
    v_mfma_f32_16x16x32_bf16 v[112:115], v[72:75], a[84:87], v[112:115]
    ds_read_b128 v[60:63], v9 offset:17600
    v_cvt_pk_bf16_f32 v102, v28, v29
    v_mfma_f32_16x16x32_bf16 v[108:111], v[76:79], a[20:23], v[108:111]
    s_add_u32 s46, s46, s44
    v_mfma_f32_16x16x32_bf16 v[116:119], v[76:79], a[84:87], v[116:119]
    s_add_u32 m0, s46, 0
    s_waitcnt lgkmcnt(8)
    v_mfma_f32_16x16x32_bf16 v[104:107], v[80:83], a[24:27], v[104:107]
    ds_read_b128 v[64:67], v9 offset:768
    v_cvt_pk_bf16_f32 v103, v30, v31
    v_mfma_f32_16x16x32_bf16 v[112:115], v[80:83], a[88:91], v[112:115]
    ds_read_b128 v[68:71], v9 offset:17664
    buffer_store_dwordx4 v[100:103], v3, s[12:15], s54 offen offset:1024 sc1
    v_mfma_f32_16x16x32_bf16 v[108:111], v[84:87], a[24:27], v[108:111]
    buffer_load_dwordx4 v3, s[36:39], s41 offen offset:0  lds
    v_mfma_f32_16x16x32_bf16 v[116:119], v[84:87], a[88:91], v[116:119]
    s_add_u32 m0, s46, 32
    v_mfma_f32_16x16x32_bf16 v[104:107], v[88:91], a[28:31], v[104:107]
    ds_read_b128 v[72:75], v9 offset:832
    s_add_u32 s54, s55, s51
    v_mfma_f32_16x16x32_bf16 v[112:115], v[88:91], a[92:95], v[112:115]
    ds_read_b128 v[76:79], v9 offset:17728
    s_add_u32 s51, s51, 4096
    v_mfma_f32_16x16x32_bf16 v[108:111], v[92:95], a[28:31], v[108:111]
    buffer_load_dwordx4 v3, s[36:39], s41 offen offset:1024  lds
    v_mfma_f32_16x16x32_bf16 v[116:119], v[92:95], a[92:95], v[116:119]
    s_add_u32 m0, s46, 64
    s_waitcnt lgkmcnt(8)
    v_mfma_f32_16x16x32_bf16 v[104:107], v[32:35], a[32:35], v[104:107]
    ds_read_b128 v[80:83], v9 offset:896
    s_and_b32 s51, s51, 0xffff
    v_mfma_f32_16x16x32_bf16 v[112:115], v[32:35], a[96:99], v[112:115]
    ds_read_b128 v[84:87], v9 offset:17792
    v_mfma_f32_16x16x32_bf16 v[108:111], v[36:39], a[32:35], v[108:111]
    buffer_load_dwordx4 v3, s[36:39], s41 offen offset:2048  lds
    v_mfma_f32_16x16x32_bf16 v[116:119], v[36:39], a[96:99], v[116:119]
    s_add_u32 m0, s46, 96
    v_mfma_f32_16x16x32_bf16 v[104:107], v[40:43], a[36:39], v[104:107]
    ds_read_b128 v[88:91], v9 offset:960
    v_mfma_f32_16x16x32_bf16 v[112:115], v[40:43], a[100:103], v[112:115]
    ds_read_b128 v[92:95], v9 offset:17856
    v_mfma_f32_16x16x32_bf16 v[108:111], v[44:47], a[36:39], v[108:111]
    buffer_load_dwordx4 v3, s[36:39], s41 offen offset:3072  lds
    v_mfma_f32_16x16x32_bf16 v[116:119], v[44:47], a[100:103], v[116:119]
    s_add_u32 s41, s41, 28672
    s_waitcnt lgkmcnt(8)
    s_add_u32 s48, s48, 33792
    s_cmp_eq_u32 s48, 135168
    s_cselect_b32 s48, 0, s48
    v_add_u32 v9, s48, v4
    v_mfma_f32_16x16x32_bf16 v[104:107], v[48:51], a[40:43], v[104:107]
    ds_read_b128 v[32:35], v9 offset:0
    v_mfma_f32_16x16x32_bf16 v[112:115], v[48:51], a[104:107], v[112:115]
    ds_read_b128 v[36:39], v9 offset:16896
    v_mfma_f32_16x16x32_bf16 v[108:111], v[52:55], a[40:43], v[108:111]
    s_and_b32 s41, s41, 0x7ffff
    v_mfma_f32_16x16x32_bf16 v[116:119], v[52:55], a[104:107], v[116:119]
    s_add_u32 s42, s42, 33792
    v_mfma_f32_16x16x32_bf16 v[104:107], v[56:59], a[44:47], v[104:107]
    ds_read_b128 v[40:43], v9 offset:64
    v_mfma_f32_16x16x32_bf16 v[112:115], v[56:59], a[108:111], v[112:115]
    ds_read_b128 v[44:47], v9 offset:16960
    v_mfma_f32_16x16x32_bf16 v[108:111], v[60:63], a[44:47], v[108:111]
    s_cmp_eq_u32 s42, 135168
    v_mfma_f32_16x16x32_bf16 v[116:119], v[60:63], a[108:111], v[116:119]
    s_cselect_b32 s42, 0, s42
    s_waitcnt lgkmcnt(8)
    v_mfma_f32_16x16x32_bf16 v[104:107], v[64:67], a[48:51], v[104:107]
    ds_read_b128 v[48:51], v9 offset:128
    v_mfma_f32_16x16x32_bf16 v[112:115], v[64:67], a[112:115], v[112:115]
    ds_read_b128 v[52:55], v9 offset:17024
    v_mfma_f32_16x16x32_bf16 v[108:111], v[68:71], a[48:51], v[108:111]
    v_mfma_f32_16x16x32_bf16 v[116:119], v[68:71], a[112:115], v[116:119]
    v_mfma_f32_16x16x32_bf16 v[104:107], v[72:75], a[52:55], v[104:107]
    ds_read_b128 v[56:59], v9 offset:192
    v_mfma_f32_16x16x32_bf16 v[112:115], v[72:75], a[116:119], v[112:115]
    ds_read_b128 v[60:63], v9 offset:17088
    v_mfma_f32_16x16x32_bf16 v[108:111], v[76:79], a[52:55], v[108:111]
    v_mfma_f32_16x16x32_bf16 v[116:119], v[76:79], a[116:119], v[116:119]
    s_waitcnt lgkmcnt(8)
    v_mfma_f32_16x16x32_bf16 v[104:107], v[80:83], a[56:59], v[104:107]
    ds_read_b128 v[64:67], v9 offset:256
    v_mfma_f32_16x16x32_bf16 v[112:115], v[80:83], a[120:123], v[112:115]
    ds_read_b128 v[68:71], v9 offset:17152
    v_mfma_f32_16x16x32_bf16 v[108:111], v[84:87], a[56:59], v[108:111]
    v_mfma_f32_16x16x32_bf16 v[116:119], v[84:87], a[120:123], v[116:119]
    v_mfma_f32_16x16x32_bf16 v[104:107], v[88:91], a[60:63], v[104:107]
    ds_read_b128 v[72:75], v9 offset:320
    v_mfma_f32_16x16x32_bf16 v[112:115], v[88:91], a[124:127], v[112:115]
    ds_read_b128 v[76:79], v9 offset:17216
    v_mfma_f32_16x16x32_bf16 v[108:111], v[92:95], a[60:63], v[108:111]
    v_mfma_f32_16x16x32_bf16 v[116:119], v[92:95], a[124:127], v[116:119]
    s_add_u32 s53, s53, 1
    s_cmp_lt_u32 s53, 8
    s_cbranch_scc1 L_auxl1
    s_nop 7
    v_cvt_pk_bf16_f32 v96, v104, v105
    v_cvt_pk_bf16_f32 v97, v106, v107
    v_cvt_pk_bf16_f32 v98, v108, v109
    v_cvt_pk_bf16_f32 v99, v110, v111
    buffer_store_dwordx4 v[96:99], v3, s[12:15], s54 offen offset:0 sc1
    v_cvt_pk_bf16_f32 v100, v112, v113
    v_cvt_pk_bf16_f32 v101, v114, v115
    v_cvt_pk_bf16_f32 v102, v116, v117
    v_cvt_pk_bf16_f32 v103, v118, v119
    buffer_store_dwordx4 v[100:103], v3, s[12:15], s54 offen offset:1024 sc1
    s_add_u32 s54, s55, s51
    s_add_u32 s51, s51, 4096
    s_and_b32 s51, s51, 0xffff
    s_add_u32 s55, s49, 64487424
    s_lshl_b32 s51, s20, 14
    s_add_u32 s54, s49, 63438848
    s_mov_b32 s53, 0
L_auxl2:
    s_waitcnt vmcnt(10)
    s_barrier
    s_waitcnt lgkmcnt(8)
    v_mfma_f32_16x16x32_bf16 v[16:19], v[32:35], v[128:131], 0
    ds_read_b128 v[80:83], v9 offset:384
    v_mfma_f32_16x16x32_bf16 v[24:27], v[32:35], v[192:195], 0
    ds_read_b128 v[84:87], v9 offset:17280
    v_mfma_f32_16x16x32_bf16 v[20:23], v[36:39], v[128:131], 0
    s_add_u32 s46, s42, s43
    v_mfma_f32_16x16x32_bf16 v[28:31], v[36:39], v[192:195], 0
    s_add_u32 m0, s46, 0
    v_mfma_f32_16x16x32_bf16 v[16:19], v[40:43], v[132:135], v[16:19]
    ds_read_b128 v[88:91], v9 offset:448
    v_mfma_f32_16x16x32_bf16 v[24:27], v[40:43], v[196:199], v[24:27]
    ds_read_b128 v[92:95], v9 offset:17344
    v_mfma_f32_16x16x32_bf16 v[20:23], v[44:47], v[132:135], v[20:23]
    buffer_load_dwordx4 v3, s[36:39], s41 offen offset:0  lds
    v_mfma_f32_16x16x32_bf16 v[28:31], v[44:47], v[196:199], v[28:31]
    s_add_u32 m0, s46, 32
    s_waitcnt lgkmcnt(8)
    v_mfma_f32_16x16x32_bf16 v[16:19], v[48:51], v[136:139], v[16:19]
    ds_read_b128 v[32:35], v9 offset:512
    v_cvt_pk_bf16_f32 v96, v104, v105
    v_mfma_f32_16x16x32_bf16 v[24:27], v[48:51], v[200:203], v[24:27]
    ds_read_b128 v[36:39], v9 offset:17408
    v_cvt_pk_bf16_f32 v97, v106, v107
    v_mfma_f32_16x16x32_bf16 v[20:23], v[52:55], v[136:139], v[20:23]
    buffer_load_dwordx4 v3, s[36:39], s41 offen offset:1024  lds
    v_mfma_f32_16x16x32_bf16 v[28:31], v[52:55], v[200:203], v[28:31]
    s_add_u32 m0, s46, 64
    v_mfma_f32_16x16x32_bf16 v[16:19], v[56:59], v[140:143], v[16:19]
    ds_read_b128 v[40:43], v9 offset:576
    v_cvt_pk_bf16_f32 v98, v108, v109
    v_mfma_f32_16x16x32_bf16 v[24:27], v[56:59], v[204:207], v[24:27]
    ds_read_b128 v[44:47], v9 offset:17472
    v_cvt_pk_bf16_f32 v99, v110, v111
    v_mfma_f32_16x16x32_bf16 v[20:23], v[60:63], v[140:143], v[20:23]
    buffer_load_dwordx4 v3, s[36:39], s41 offen offset:2048  lds
    v_mfma_f32_16x16x32_bf16 v[28:31], v[60:63], v[204:207], v[28:31]
    s_add_u32 m0, s46, 96
    s_waitcnt lgkmcnt(8)
    v_mfma_f32_16x16x32_bf16 v[16:19], v[64:67], v[144:147], v[16:19]
    ds_read_b128 v[48:51], v9 offset:640
    buffer_store_dwordx4 v[96:99], v3, s[12:15], s54 offen offset:0 sc1
    v_mfma_f32_16x16x32_bf16 v[24:27], v[64:67], v[208:211], v[24:27]
    ds_read_b128 v[52:55], v9 offset:17536
    v_cvt_pk_bf16_f32 v100, v112, v113
    v_mfma_f32_16x16x32_bf16 v[20:23], v[68:71], v[144:147], v[20:23]
    buffer_load_dwordx4 v3, s[36:39], s41 offen offset:3072  lds
    v_mfma_f32_16x16x32_bf16 v[28:31], v[68:71], v[208:211], v[28:31]
    s_add_u32 s41, s41, 4096
    v_mfma_f32_16x16x32_bf16 v[16:19], v[72:75], v[148:151], v[16:19]
    ds_read_b128 v[56:59], v9 offset:704
    v_cvt_pk_bf16_f32 v101, v114, v115
    v_mfma_f32_16x16x32_bf16 v[24:27], v[72:75], v[212:215], v[24:27]
    ds_read_b128 v[60:63], v9 offset:17600
    v_cvt_pk_bf16_f32 v102, v116, v117
    v_mfma_f32_16x16x32_bf16 v[20:23], v[76:79], v[148:151], v[20:23]
    s_add_u32 s46, s46, s44
    v_mfma_f32_16x16x32_bf16 v[28:31], v[76:79], v[212:215], v[28:31]
    s_add_u32 m0, s46, 0
    s_waitcnt lgkmcnt(8)
    v_mfma_f32_16x16x32_bf16 v[16:19], v[80:83], v[152:155], v[16:19]
    ds_read_b128 v[64:67], v9 offset:768
    v_cvt_pk_bf16_f32 v103, v118, v119
    v_mfma_f32_16x16x32_bf16 v[24:27], v[80:83], v[216:219], v[24:27]
    ds_read_b128 v[68:71], v9 offset:17664
    buffer_store_dwordx4 v[100:103], v3, s[12:15], s54 offen offset:1024 sc1
    v_mfma_f32_16x16x32_bf16 v[20:23], v[84:87], v[152:155], v[20:23]
    buffer_load_dwordx4 v3, s[36:39], s41 offen offset:0  lds
    v_mfma_f32_16x16x32_bf16 v[28:31], v[84:87], v[216:219], v[28:31]
    s_add_u32 m0, s46, 32
    v_mfma_f32_16x16x32_bf16 v[16:19], v[88:91], v[156:159], v[16:19]
    ds_read_b128 v[72:75], v9 offset:832
    s_add_u32 s54, s55, s51
    v_mfma_f32_16x16x32_bf16 v[24:27], v[88:91], v[220:223], v[24:27]
    ds_read_b128 v[76:79], v9 offset:17728
    s_add_u32 s51, s51, 4096
    v_mfma_f32_16x16x32_bf16 v[20:23], v[92:95], v[156:159], v[20:23]
    buffer_load_dwordx4 v3, s[36:39], s41 offen offset:1024  lds
    v_mfma_f32_16x16x32_bf16 v[28:31], v[92:95], v[220:223], v[28:31]
    s_add_u32 m0, s46, 64
    s_waitcnt lgkmcnt(8)
    v_mfma_f32_16x16x32_bf16 v[16:19], v[32:35], v[160:163], v[16:19]
    ds_read_b128 v[80:83], v9 offset:896
    s_and_b32 s51, s51, 0xffff
    v_mfma_f32_16x16x32_bf16 v[24:27], v[32:35], v[224:227], v[24:27]
    ds_read_b128 v[84:87], v9 offset:17792
    v_mfma_f32_16x16x32_bf16 v[20:23], v[36:39], v[160:163], v[20:23]
    buffer_load_dwordx4 v3, s[36:39], s41 offen offset:2048  lds
    v_mfma_f32_16x16x32_bf16 v[28:31], v[36:39], v[224:227], v[28:31]
    s_add_u32 m0, s46, 96
    v_mfma_f32_16x16x32_bf16 v[16:19], v[40:43], v[164:167], v[16:19]
    ds_read_b128 v[88:91], v9 offset:960
    v_mfma_f32_16x16x32_bf16 v[24:27], v[40:43], v[228:231], v[24:27]
    ds_read_b128 v[92:95], v9 offset:17856
    v_mfma_f32_16x16x32_bf16 v[20:23], v[44:47], v[164:167], v[20:23]
    buffer_load_dwordx4 v3, s[36:39], s41 offen offset:3072  lds
    v_mfma_f32_16x16x32_bf16 v[28:31], v[44:47], v[228:231], v[28:31]
    s_add_u32 s41, s41, 28672
    s_waitcnt lgkmcnt(8)
    s_add_u32 s48, s48, 33792
    s_cmp_eq_u32 s48, 135168
    s_cselect_b32 s48, 0, s48
    v_add_u32 v9, s48, v4
    v_mfma_f32_16x16x32_bf16 v[16:19], v[48:51], v[168:171], v[16:19]
    ds_read_b128 v[32:35], v9 offset:0
    v_mfma_f32_16x16x32_bf16 v[24:27], v[48:51], v[232:235], v[24:27]
    ds_read_b128 v[36:39], v9 offset:16896
    v_mfma_f32_16x16x32_bf16 v[20:23], v[52:55], v[168:171], v[20:23]
    s_and_b32 s41, s41, 0x7ffff
    v_mfma_f32_16x16x32_bf16 v[28:31], v[52:55], v[232:235], v[28:31]
    s_add_u32 s42, s42, 33792
    v_mfma_f32_16x16x32_bf16 v[16:19], v[56:59], v[172:175], v[16:19]
    ds_read_b128 v[40:43], v9 offset:64
    v_mfma_f32_16x16x32_bf16 v[24:27], v[56:59], v[236:239], v[24:27]
    ds_read_b128 v[44:47], v9 offset:16960
    v_mfma_f32_16x16x32_bf16 v[20:23], v[60:63], v[172:175], v[20:23]
    s_cmp_eq_u32 s42, 135168
    v_mfma_f32_16x16x32_bf16 v[28:31], v[60:63], v[236:239], v[28:31]
    s_cselect_b32 s42, 0, s42
    s_waitcnt lgkmcnt(8)
    v_mfma_f32_16x16x32_bf16 v[16:19], v[64:67], v[176:179], v[16:19]
    ds_read_b128 v[48:51], v9 offset:128
    v_mfma_f32_16x16x32_bf16 v[24:27], v[64:67], v[240:243], v[24:27]
    ds_read_b128 v[52:55], v9 offset:17024
    v_mfma_f32_16x16x32_bf16 v[20:23], v[68:71], v[176:179], v[20:23]
    v_mfma_f32_16x16x32_bf16 v[28:31], v[68:71], v[240:243], v[28:31]
    v_mfma_f32_16x16x32_bf16 v[16:19], v[72:75], v[180:183], v[16:19]
    ds_read_b128 v[56:59], v9 offset:192
    v_mfma_f32_16x16x32_bf16 v[24:27], v[72:75], v[244:247], v[24:27]
    ds_read_b128 v[60:63], v9 offset:17088
    v_mfma_f32_16x16x32_bf16 v[20:23], v[76:79], v[180:183], v[20:23]
    v_mfma_f32_16x16x32_bf16 v[28:31], v[76:79], v[244:247], v[28:31]
    s_waitcnt lgkmcnt(8)
    v_mfma_f32_16x16x32_bf16 v[16:19], v[80:83], v[184:187], v[16:19]
    ds_read_b128 v[64:67], v9 offset:256
    v_mfma_f32_16x16x32_bf16 v[24:27], v[80:83], v[248:251], v[24:27]
    ds_read_b128 v[68:71], v9 offset:17152
    v_mfma_f32_16x16x32_bf16 v[20:23], v[84:87], v[184:187], v[20:23]
    v_mfma_f32_16x16x32_bf16 v[28:31], v[84:87], v[248:251], v[28:31]
    v_mfma_f32_16x16x32_bf16 v[16:19], v[88:91], v[188:191], v[16:19]
    ds_read_b128 v[72:75], v9 offset:320
    v_mfma_f32_16x16x32_bf16 v[24:27], v[88:91], v[252:255], v[24:27]
    ds_read_b128 v[76:79], v9 offset:17216
    v_mfma_f32_16x16x32_bf16 v[20:23], v[92:95], v[188:191], v[20:23]
    v_mfma_f32_16x16x32_bf16 v[28:31], v[92:95], v[252:255], v[28:31]
    s_waitcnt vmcnt(10)
    s_barrier
    s_waitcnt lgkmcnt(8)
    v_mfma_f32_16x16x32_bf16 v[104:107], v[32:35], v[128:131], 0
    ds_read_b128 v[80:83], v9 offset:384
    v_mfma_f32_16x16x32_bf16 v[112:115], v[32:35], v[192:195], 0
    ds_read_b128 v[84:87], v9 offset:17280
    v_mfma_f32_16x16x32_bf16 v[108:111], v[36:39], v[128:131], 0
    s_add_u32 s46, s42, s43
    v_mfma_f32_16x16x32_bf16 v[116:119], v[36:39], v[192:195], 0
    s_add_u32 m0, s46, 0
    v_mfma_f32_16x16x32_bf16 v[104:107], v[40:43], v[132:135], v[104:107]
    ds_read_b128 v[88:91], v9 offset:448
    v_mfma_f32_16x16x32_bf16 v[112:115], v[40:43], v[196:199], v[112:115]
    ds_read_b128 v[92:95], v9 offset:17344
    v_mfma_f32_16x16x32_bf16 v[108:111], v[44:47], v[132:135], v[108:111]
    buffer_load_dwordx4 v3, s[36:39], s41 offen offset:0  lds
    v_mfma_f32_16x16x32_bf16 v[116:119], v[44:47], v[196:199], v[116:119]
    s_add_u32 m0, s46, 32
    s_waitcnt lgkmcnt(8)
    v_mfma_f32_16x16x32_bf16 v[104:107], v[48:51], v[136:139], v[104:107]
    ds_read_b128 v[32:35], v9 offset:512
    v_cvt_pk_bf16_f32 v96, v16, v17
    v_mfma_f32_16x16x32_bf16 v[112:115], v[48:51], v[200:203], v[112:115]
    ds_read_b128 v[36:39], v9 offset:17408
    v_cvt_pk_bf16_f32 v97, v18, v19
    v_mfma_f32_16x16x32_bf16 v[108:111], v[52:55], v[136:139], v[108:111]
    buffer_load_dwordx4 v3, s[36:39], s41 offen offset:1024  lds
    v_mfma_f32_16x16x32_bf16 v[116:119], v[52:55], v[200:203], v[116:119]
    s_add_u32 m0, s46, 64
    v_mfma_f32_16x16x32_bf16 v[104:107], v[56:59], v[140:143], v[104:107]
    ds_read_b128 v[40:43], v9 offset:576
    v_cvt_pk_bf16_f32 v98, v20, v21
    v_mfma_f32_16x16x32_bf16 v[112:115], v[56:59], v[204:207], v[112:115]
    ds_read_b128 v[44:47], v9 offset:17472
    v_cvt_pk_bf16_f32 v99, v22, v23
    v_mfma_f32_16x16x32_bf16 v[108:111], v[60:63], v[140:143], v[108:111]
    buffer_load_dwordx4 v3, s[36:39], s41 offen offset:2048  lds
    v_mfma_f32_16x16x32_bf16 v[116:119], v[60:63], v[204:207], v[116:119]
    s_add_u32 m0, s46, 96
    s_waitcnt lgkmcnt(8)
    v_mfma_f32_16x16x32_bf16 v[104:107], v[64:67], v[144:147], v[104:107]
    ds_read_b128 v[48:51], v9 offset:640
    buffer_store_dwordx4 v[96:99], v3, s[12:15], s54 offen offset:0 sc1
    v_mfma_f32_16x16x32_bf16 v[112:115], v[64:67], v[208:211], v[112:115]
    ds_read_b128 v[52:55], v9 offset:17536
    v_cvt_pk_bf16_f32 v100, v24, v25
    v_mfma_f32_16x16x32_bf16 v[108:111], v[68:71], v[144:147], v[108:111]
    buffer_load_dwordx4 v3, s[36:39], s41 offen offset:3072  lds
    v_mfma_f32_16x16x32_bf16 v[116:119], v[68:71], v[208:211], v[116:119]
    s_add_u32 s41, s41, 4096
    v_mfma_f32_16x16x32_bf16 v[104:107], v[72:75], v[148:151], v[104:107]
    ds_read_b128 v[56:59], v9 offset:704
    v_cvt_pk_bf16_f32 v101, v26, v27
    v_mfma_f32_16x16x32_bf16 v[112:115], v[72:75], v[212:215], v[112:115]
    ds_read_b128 v[60:63], v9 offset:17600
    v_cvt_pk_bf16_f32 v102, v28, v29
    v_mfma_f32_16x16x32_bf16 v[108:111], v[76:79], v[148:151], v[108:111]
    s_add_u32 s46, s46, s44
    v_mfma_f32_16x16x32_bf16 v[116:119], v[76:79], v[212:215], v[116:119]
    s_add_u32 m0, s46, 0
    s_waitcnt lgkmcnt(8)
    v_mfma_f32_16x16x32_bf16 v[104:107], v[80:83], v[152:155], v[104:107]
    ds_read_b128 v[64:67], v9 offset:768
    v_cvt_pk_bf16_f32 v103, v30, v31
    v_mfma_f32_16x16x32_bf16 v[112:115], v[80:83], v[216:219], v[112:115]
    ds_read_b128 v[68:71], v9 offset:17664
    buffer_store_dwordx4 v[100:103], v3, s[12:15], s54 offen offset:1024 sc1
    v_mfma_f32_16x16x32_bf16 v[108:111], v[84:87], v[152:155], v[108:111]
    buffer_load_dwordx4 v3, s[36:39], s41 offen offset:0  lds
    v_mfma_f32_16x16x32_bf16 v[116:119], v[84:87], v[216:219], v[116:119]
    s_add_u32 m0, s46, 32
    v_mfma_f32_16x16x32_bf16 v[104:107], v[88:91], v[156:159], v[104:107]
    ds_read_b128 v[72:75], v9 offset:832
    s_add_u32 s54, s55, s51
    v_mfma_f32_16x16x32_bf16 v[112:115], v[88:91], v[220:223], v[112:115]
    ds_read_b128 v[76:79], v9 offset:17728
    s_add_u32 s51, s51, 4096
    v_mfma_f32_16x16x32_bf16 v[108:111], v[92:95], v[156:159], v[108:111]
    buffer_load_dwordx4 v3, s[36:39], s41 offen offset:1024  lds
    v_mfma_f32_16x16x32_bf16 v[116:119], v[92:95], v[220:223], v[116:119]
    s_add_u32 m0, s46, 64
    s_waitcnt lgkmcnt(8)
    v_mfma_f32_16x16x32_bf16 v[104:107], v[32:35], v[160:163], v[104:107]
    ds_read_b128 v[80:83], v9 offset:896
    s_and_b32 s51, s51, 0xffff
    v_mfma_f32_16x16x32_bf16 v[112:115], v[32:35], v[224:227], v[112:115]
    ds_read_b128 v[84:87], v9 offset:17792
    v_mfma_f32_16x16x32_bf16 v[108:111], v[36:39], v[160:163], v[108:111]
    buffer_load_dwordx4 v3, s[36:39], s41 offen offset:2048  lds
    v_mfma_f32_16x16x32_bf16 v[116:119], v[36:39], v[224:227], v[116:119]
    s_add_u32 m0, s46, 96
    v_mfma_f32_16x16x32_bf16 v[104:107], v[40:43], v[164:167], v[104:107]
    ds_read_b128 v[88:91], v9 offset:960
    v_mfma_f32_16x16x32_bf16 v[112:115], v[40:43], v[228:231], v[112:115]
    ds_read_b128 v[92:95], v9 offset:17856
    v_mfma_f32_16x16x32_bf16 v[108:111], v[44:47], v[164:167], v[108:111]
    buffer_load_dwordx4 v3, s[36:39], s41 offen offset:3072  lds
    v_mfma_f32_16x16x32_bf16 v[116:119], v[44:47], v[228:231], v[116:119]
    s_add_u32 s41, s41, 28672
    s_waitcnt lgkmcnt(8)
    s_add_u32 s48, s48, 33792
    s_cmp_eq_u32 s48, 135168
    s_cselect_b32 s48, 0, s48
    v_add_u32 v9, s48, v4
    v_mfma_f32_16x16x32_bf16 v[104:107], v[48:51], v[168:171], v[104:107]
    ds_read_b128 v[32:35], v9 offset:0
    v_mfma_f32_16x16x32_bf16 v[112:115], v[48:51], v[232:235], v[112:115]
    ds_read_b128 v[36:39], v9 offset:16896
    v_mfma_f32_16x16x32_bf16 v[108:111], v[52:55], v[168:171], v[108:111]
    s_and_b32 s41, s41, 0x7ffff
    v_mfma_f32_16x16x32_bf16 v[116:119], v[52:55], v[232:235], v[116:119]
    s_add_u32 s42, s42, 33792
    v_mfma_f32_16x16x32_bf16 v[104:107], v[56:59], v[172:175], v[104:107]
    ds_read_b128 v[40:43], v9 offset:64
    v_mfma_f32_16x16x32_bf16 v[112:115], v[56:59], v[236:239], v[112:115]
    ds_read_b128 v[44:47], v9 offset:16960
    v_mfma_f32_16x16x32_bf16 v[108:111], v[60:63], v[172:175], v[108:111]
    s_cmp_eq_u32 s42, 135168
    v_mfma_f32_16x16x32_bf16 v[116:119], v[60:63], v[236:239], v[116:119]
    s_cselect_b32 s42, 0, s42
    s_waitcnt lgkmcnt(8)
    v_mfma_f32_16x16x32_bf16 v[104:107], v[64:67], v[176:179], v[104:107]
    ds_read_b128 v[48:51], v9 offset:128
    v_mfma_f32_16x16x32_bf16 v[112:115], v[64:67], v[240:243], v[112:115]
    ds_read_b128 v[52:55], v9 offset:17024
    v_mfma_f32_16x16x32_bf16 v[108:111], v[68:71], v[176:179], v[108:111]
    v_mfma_f32_16x16x32_bf16 v[116:119], v[68:71], v[240:243], v[116:119]
    v_mfma_f32_16x16x32_bf16 v[104:107], v[72:75], v[180:183], v[104:107]
    ds_read_b128 v[56:59], v9 offset:192
    v_mfma_f32_16x16x32_bf16 v[112:115], v[72:75], v[244:247], v[112:115]
    ds_read_b128 v[60:63], v9 offset:17088
    v_mfma_f32_16x16x32_bf16 v[108:111], v[76:79], v[180:183], v[108:111]
    v_mfma_f32_16x16x32_bf16 v[116:119], v[76:79], v[244:247], v[116:119]
    s_waitcnt lgkmcnt(8)
    v_mfma_f32_16x16x32_bf16 v[104:107], v[80:83], v[184:187], v[104:107]
    ds_read_b128 v[64:67], v9 offset:256
    v_mfma_f32_16x16x32_bf16 v[112:115], v[80:83], v[248:251], v[112:115]
    ds_read_b128 v[68:71], v9 offset:17152
    v_mfma_f32_16x16x32_bf16 v[108:111], v[84:87], v[184:187], v[108:111]
    v_mfma_f32_16x16x32_bf16 v[116:119], v[84:87], v[248:251], v[116:119]
    v_mfma_f32_16x16x32_bf16 v[104:107], v[88:91], v[188:191], v[104:107]
    ds_read_b128 v[72:75], v9 offset:320
    v_mfma_f32_16x16x32_bf16 v[112:115], v[88:91], v[252:255], v[112:115]
    ds_read_b128 v[76:79], v9 offset:17216
    v_mfma_f32_16x16x32_bf16 v[108:111], v[92:95], v[188:191], v[108:111]
    v_mfma_f32_16x16x32_bf16 v[116:119], v[92:95], v[252:255], v[116:119]
    s_add_u32 s53, s53, 1
    s_cmp_lt_u32 s53, 8
    s_cbranch_scc1 L_auxl2
    s_nop 7
    v_cvt_pk_bf16_f32 v96, v104, v105
    v_cvt_pk_bf16_f32 v97, v106, v107
    v_cvt_pk_bf16_f32 v98, v108, v109
    v_cvt_pk_bf16_f32 v99, v110, v111
    buffer_store_dwordx4 v[96:99], v3, s[12:15], s54 offen offset:0 sc1
    v_cvt_pk_bf16_f32 v100, v112, v113
    v_cvt_pk_bf16_f32 v101, v114, v115
    v_cvt_pk_bf16_f32 v102, v116, v117
    v_cvt_pk_bf16_f32 v103, v118, v119
    buffer_store_dwordx4 v[100:103], v3, s[12:15], s54 offen offset:1024 sc1
    s_add_u32 s54, s55, s51
    s_add_u32 s51, s51, 4096
    s_and_b32 s51, s51, 0xffff
    s_waitcnt vmcnt(0)
    s_barrier
    s_cmp_lg_u32 s16, 0
    s_cbranch_scc1 L_sig4a
    v_mov_b32 v14, 1
    s_and_b32 s26, s2, 0
    s_lshl_b32 s26, s26, 6
    s_mov_b64 exec, 1
    buffer_atomic_add v14, off, s[92:95], s26 offset:12
    s_mov_b64 exec, -1
L_sig4a:
    s_branch L_fin
.section .rodata,"a"
.p2align 6
.amdhsa_kernel standalone__conformer_family_branchformer__speech_kernel
  .amdhsa_next_free_vgpr 512
  .amdhsa_next_free_sgpr 102
  .amdhsa_accum_offset 256
  .amdhsa_group_segment_fixed_size 0
  .amdhsa_kernarg_size 96
  .amdhsa_user_sgpr_count 2
  .amdhsa_user_sgpr_kernarg_segment_ptr 1
  .amdhsa_system_sgpr_workgroup_id_x 1
  .amdhsa_float_denorm_mode_32 3
.end_amdhsa_kernel
```
